```python
import torch

def _softmax(x, axis=-1):
    return torch.softmax(x, dim=axis)

def _gelu(x):
    return torch.nn.functional.gelu(x, approximate='tanh')

def _silu(x):
    return torch.nn.functional.silu(x)

def _sigmoid(x):
    return torch.sigmoid(x)

def _layernorm(x, axis=-1, eps=1e-05):
    m = x.mean(dim=axis, keepdim=True)
    v = x.var(dim=axis, keepdim=True, unbiased=False)
    return (x - m) / torch.sqrt(v + eps)

def _scatter_add(tgt, idx, src, axis=0):
    return tgt.clone().index_add_(axis, idx, src)

def _segment_sum(src, seg, n):
    out = torch.zeros((n,) + src.shape[1:], dtype=src.dtype)
    return out.index_add_(0, seg, src)

def _pad(x, pw):
    flat = tuple((v for pair in reversed(pw) for v in pair))
    return torch.nn.functional.pad(x, flat)
kernel_name = 'interleave_layers__memory_aug_recurrent_mem_tr__softmax_full_mha__prompt'

def setup_inputs():

    _w = lambda a: (lambda t: t.to(torch.bfloat16) if t.is_floating_point() else t)(torch.as_tensor(a))

    def _A_setup():
        B, S, Dm = (1, 2048, 512)
        H, Dh = (32, 128)
        M, seg = (8, 32)
        seg = min(seg, S)
        S = S // seg * seg
        return {'x': _w((lambda *s: torch.randn(*s, dtype=torch.bfloat16) * 0.05)(B, S, Dm)), 'mem0': _w((lambda *s: torch.randn(*s, dtype=torch.bfloat16) * 0.2)(B, M, Dm)), 'Wq': _w((lambda *s: torch.randn(*s, dtype=torch.bfloat16) * 1.6)(Dm, H, Dh) * Dm ** (-0.5)), 'Wk': _w((lambda *s: torch.randn(*s, dtype=torch.bfloat16) * 1.6)(Dm, H, Dh) * Dm ** (-0.5)), 'Wv': _w((lambda *s: torch.randn(*s, dtype=torch.bfloat16) * 0.2)(Dm, H, Dh) * Dm ** (-0.5)), 'Wo': _w((lambda *s: torch.randn(*s, dtype=torch.bfloat16) * 0.2)(H, Dh, Dm) * (H * Dh) ** (-0.5)), 'seg_len': seg}
    _A_in = _A_setup()

    def _B_setup():
        B, S, D = (1, 2048, 512)
        return {'x': _w((lambda *s: torch.randn(*s, dtype=torch.bfloat16) * 0.05)(B, S, D)), 'wqkv': _w((lambda *s: torch.randn(*s, dtype=torch.bfloat16) * 0.05)(D, 3 * D)), 'wo': _w((lambda *s: torch.randn(*s, dtype=torch.bfloat16) * 0.05)(D, D))}
    _B_in = _B_setup()
    return {'A_x': _A_in['x'], 'A_mem0': _A_in['mem0'], 'A_Wq': _A_in['Wq'], 'A_Wk': _A_in['Wk'], 'A_Wv': _A_in['Wv'], 'A_Wo': _A_in['Wo'], 'A_seg_len': _A_in['seg_len'], 'B_x': _B_in['x'], 'B_wqkv': _B_in['wqkv'], 'B_wo': _B_in['wo']}

def reference(A_x, A_mem0, A_Wq, A_Wk, A_Wv, A_Wo, A_seg_len, B_x, B_wqkv, B_wo):

    def _A_ref(x, mem0, Wq, Wk, Wv, Wo, seg_len):
        B, S, Dm = x.shape
        H, Dh = (Wq.shape[1], Wq.shape[2])
        M = mem0.shape[1]
        scale = Dh ** (-0.5)
        n_seg = S // seg_len
        L = M + seg_len
        idx = torch.arange(L)
        mask = (idx[:, None] < M) | (idx[:, None] >= idx[None, :])
        mem = mem0
        outs = []
        for s in range(n_seg):
            xs = x[:, s * seg_len:(s + 1) * seg_len, :].clone()
            h = torch.concatenate([mem, xs], axis=1)
            q = torch.einsum('btd,dhe->bhte', h, Wq)
            k = torch.einsum('btd,dhe->bhte', h, Wk)
            v = torch.einsum('btd,dhe->bhte', h, Wv)
            scores = torch.einsum('bhqe,bhke->bhqk', q, k) * scale
            scores = torch.where(mask[None, None], scores, -1000000000.0)
            p = _softmax(scores, axis=-1)
            o = torch.einsum('bhqk,bhke->bhqe', p, v)
            o = torch.einsum('bhte,hed->btd', o, Wo)
            mem = o[:, :M, :].clone()
            outs.append(o[:, M:, :])
        return torch.concatenate(outs, axis=1)

    def _B_ref(x, wqkv, wo):
        B, S, D = x.shape
        H = 32
        Dh = D // H
        qkv = (lambda x, *d: x.permute(*d))((x @ wqkv).reshape(B, S, 3, H, Dh), 2, 0, 3, 1, 4)
        q, k, v = (qkv[0], qkv[1], qkv[2])
        scale = Dh ** (-0.5)
        scores = torch.einsum('bhqd,bhkd->bhqk', q, k) * scale
        p = _softmax(scores, axis=-1)
        o = torch.einsum('bhqk,bhkd->bhqd', p, v)
        return (lambda x, *d: x.permute(*d))(o, 0, 2, 1, 3).reshape(B, S, D) @ wo
    x = A_x
    x = x + _A_ref(_layernorm(x, axis=-1), A_mem0, A_Wq, A_Wk, A_Wv, A_Wo, A_seg_len)
    x = x + _B_ref(_layernorm(x, axis=-1), B_wqkv, B_wo)
    x = x + _A_ref(_layernorm(x, axis=-1), A_mem0, A_Wq, A_Wk, A_Wv, A_Wo, A_seg_len)
    x = x + _B_ref(_layernorm(x, axis=-1), B_wqkv, B_wo)
    return x
```

```asm
; @launch grid=(256,1,1) block=(256,1,1) lds=163840
.amdgcn_target "amdgcn-amd-amdhsa--gfx950"
.text
.globl interleave_layers__memory_aug_recurrent_mem_tr__softmax_full_mha__prompt_kernel
.p2align 8
.type interleave_layers__memory_aug_recurrent_mem_tr__softmax_full_mha__prompt_kernel,@function
interleave_layers__memory_aug_recurrent_mem_tr__softmax_full_mha__prompt_kernel:
    s_cmp_ge_u32 s2, 256
    s_cbranch_scc1 L_end
    s_load_dwordx2 s[8:9], s[0:1], 32
    s_getpc_b64 s[16:17]
L_pc:
    s_lshr_b32 s18, s2, 3
    v_lshrrev_b32 v125, 3, v0
    v_lshl_add_u32 v125, s18, 5, v125
    v_lshlrev_b32 v125, 7, v125
    v_min_u32 v125, L_last-L_pc-4, v125
    global_load_dword v125, v125, s[16:17]
    s_load_dwordx2 s[4:5], s[0:1], 96
    s_load_dwordx2 s[56:57], s[0:1], 88
    s_mov_b32 s6, 268435456
    s_mov_b32 s7, 0x20000
    s_getreg_b32 s61, hwreg(HW_REG_XCC_ID)
    s_and_b32 s61, s61, 15
    s_cmp_eq_u32 s61, 1
    s_cbranch_scc0 L_nopre
    s_mov_b32 s10, 4194304
    s_mov_b32 s11, 0x20000
    s_lshl_b32 s18, s18, 8
    v_lshrrev_b32 v1, 1, v0
    v_and_b32 v2, 1, v0
    v_lshlrev_b32 v2, 7, v2
    v_lshl_add_u32 v1, v1, 13, v2
    s_waitcnt lgkmcnt(0)
L_nopre:
    v_lshrrev_b32 v1, 6, v0
    v_and_b32 v0, 63, v0
    v_readfirstlane_b32 s13, v1
    v_lshlrev_b32 v0, 4, v0
    s_mov_b32 s40, 0
    s_mov_b32 s59, 0
    s_mov_b32 s60, 0
    s_lshr_b32 s16, s2, 3
    s_and_b32 s58, s61, 7
    s_lshl_b32 s58, s58, 2
    s_lshr_b32 s58, 0x73425106, s58
    s_and_b32 s58, s58, 7
    s_lshl_b32 s58, s58, 5
    s_add_u32 s58, s58, s16
    v_mov_b32 v126, 0
    v_mov_b32 v127, 0
    s_waitcnt lgkmcnt(0)
    s_cmp_eq_u32 s13, 3
    s_cbranch_scc0 L_dispatch
    v_mov_b64 v[4:5], 0
    v_mov_b64 v[6:7], 0
    s_mul_i32 s17, s2, 640
    s_mov_b32 exec_hi, 0xff
    buffer_store_dwordx4 v[4:7], v0, s[4:7], s17 offen sc1
    s_mov_b64 exec, -1
    v_mov_b64 v[8:9], -1
    v_mov_b64 v[10:11], -1
    s_lshl_b32 s17, s2, 12
    s_add_u32 s17, s17, 174063616
    buffer_store_dwordx4 v[8:11], v0, s[4:7], s17 offen offset:0 sc1
    buffer_store_dwordx4 v[8:11], v0, s[4:7], s17 offen offset:1024 sc1
    buffer_store_dwordx4 v[8:11], v0, s[4:7], s17 offen offset:2048 sc1
    buffer_store_dwordx4 v[8:11], v0, s[4:7], s17 offen offset:3072 sc1
    s_mov_b64 exec, -1
    s_branch L_dispatch
L_redo:
    v_mov_b32 v1, 0
    s_waitcnt vmcnt(0) lgkmcnt(0)
    s_barrier
    s_cmp_eq_u32 s13, 3
    s_cbranch_scc0 L_redo2
    s_mov_b64 exec, 1
    ds_write_b32 v1, v127
    s_mov_b64 exec, -1
    s_waitcnt lgkmcnt(0)
L_redo2:
    s_barrier
    ds_read_b32 v2, v1
    s_waitcnt lgkmcnt(0)
    v_readfirstlane_b32 s16, v2
    s_barrier
    s_lshr_b32 s16, s16, 8
    s_and_b32 s16, s16, 31
    s_and_b32 s58, s61, 7
    s_lshl_b32 s58, s58, 2
    s_lshr_b32 s58, 0x73425106, s58
    s_and_b32 s58, s58, 7
    s_lshl_b32 s58, s58, 5
    s_add_u32 s58, s58, s16
    s_cmp_lg_u32 s60, 0
    s_cselect_b32 s58, s2, s58
L_dispatch:
    s_cmp_lt_u32 s58, 32
    s_cbranch_scc1 L_team
    s_cmp_lt_u32 s58, 128
    s_cbranch_scc1 L_r1
    s_cmp_ge_u32 s58, 192
    s_cbranch_scc1 L_r4
    s_and_b32 s16, s58, 16
    s_cbranch_scc1 L_rg
L_g1c:
    s_cmp_eq_u32 s13, 3
    s_cbranch_scc0 L_ar_1
    s_cmp_lg_u32 s59, 0
    s_cbranch_scc1 L_ar_1
    s_lshr_b32 s16, s2, 3
    s_lshl_b32 s16, 1, s16
    v_mov_b32 v100, s16
    s_and_b32 s16, s61, 7
    s_lshl_b32 s16, s16, 5
    s_and_b32 s17, s61, 8
    s_lshl_b32 s17, s17, 1
    s_or_b32 s16, s16, s17
    v_mov_b32 v101, 0x100
    v_mov_b32 v102, s16
    s_mov_b64 exec, 1
    s_waitcnt vmcnt(0)
    global_atomic_add_x2 v[126:127], v102, v[100:101], s[56:57] sc0 sc1
    s_mov_b64 exec, -1
L_ar_1:
    s_bfe_u32 s12, s58, 0x10005
    s_and_b32 s14, s58, 15
    s_lshr_b32 s26, s14, 2
    s_and_b32 s27, s14, 3
    s_lshl_b32 s29, s12, 4
    s_add_u32 s29, s29, s14
    s_lshl_b32 s29, s29, 7
    s_lshl_b32 s20, s13, 13
    s_mul_i32 s31, s13, 8320
    s_lshl_b32 s44, s27, 8
    s_lshl_b32 s16, s13, 6
    s_add_u32 s25, s44, s16
    v_bfe_u32 v3, v0, 4, 5
    v_lshlrev_b32 v5, 10, v3
    v_lshlrev_b32 v4, 2, v3
    v_lshlrev_b32 v3, 7, v3
    v_bfe_u32 v1, v0, 9, 1
    v_lshl_add_u32 v4, v1, 15, v4
    v_lshl_add_u32 v5, v1, 5, v5
    v_bfe_u32 v2, v0, 4, 3
    v_mul_u32_u24 v2, 384, v2
    s_mov_b32 s15, 0
    s_load_dwordx2 s[36:37], s[0:1], 80
    s_mov_b32 s38, 2097152
    s_mov_b32 s39, 0x20000
    s_waitcnt lgkmcnt(0)
    s_lshl_b32 s24, s26, 20
    s_add_u32 s24, s24, s44
    s_cmp_lg_u32 s59, 0
    s_cbranch_scc1 L_vok_3
L_vp_2:
    v_and_b32 v102, 0xf0, v0
    global_load_dwordx2 v[100:101], v102, s[56:57] sc1
    s_waitcnt vmcnt(0)
L_vc_5:
    v_lshrrev_b32 v103, 8, v101
    s_nop 1
    v_add_u32_dpp v103, v103, v103 quad_perm:[1,0,3,2] row_mask:0xf bank_mask:0xf
    s_nop 1
    v_add_u32_dpp v103, v103, v103 quad_perm:[2,3,0,1] row_mask:0xf bank_mask:0xf
    s_nop 1
    v_add_u32_dpp v103, v103, v103 row_half_mirror row_mask:0xf bank_mask:0xf
    s_nop 1
    v_add_u32_dpp v103, v103, v103 row_mirror row_mask:0xf bank_mask:0xf
    v_cmp_ne_u32 vcc, 0x100, v103
    s_cbranch_vccz L_vgo_4
    s_add_u32 s40, s40, 1
    s_cmp_gt_u32 s40, 262144
    s_cbranch_scc1 L_abort
    s_sleep 2
    s_branch L_vp_2
L_vgo_4:
    s_mov_b32 s59, 1
    v_cmp_ne_u32 vcc, -1, v100
    s_and_b32 s16, vcc_lo, 0x5555
    v_cmp_ne_u32 vcc, 0x2000, v101
    s_and_b32 s17, vcc_lo, 0x5555
    s_or_b32 s16, s16, s17
    s_cbranch_scc0 L_vok_3
    v_lshrrev_b32 v103, 8, v101
    v_cmp_ne_u32 vcc, 32, v103
    s_and_b32 s60, vcc_lo, 0x5555
    s_branch L_redo
L_vok_3:
    v_lshlrev_b32 v124, 16, v0
    s_lshl_b32 s16, s13, 26
    s_add_u32 s16, s16, 1048448
    buffer_load_dword v124, v124, s[4:7], s16 offen sc1
    s_load_dwordx2 s[8:9], s[0:1], 40
    s_mov_b32 s10, 4194304
    s_mov_b32 s11, 0x20000
    s_waitcnt lgkmcnt(0)
    v_lshrrev_b32 v11, 8, v0
    v_lshl_add_u32 v11, s13, 4, v11
    v_mul_u32_u24 v11, 1024, v11
    v_and_b32 v8, 0xf0, v0
    v_add_u32 v8, v11, v8
    s_mul_i32 s19, s13, 4160
    s_add_u32 m0, s19, 0
    s_add_u32 s16, s24, 0
    buffer_load_dwordx4 v8, s[8:11], s16 offen lds
    s_add_u32 m0, s19, 1040
    s_add_u32 s16, s24, 4096
    buffer_load_dwordx4 v8, s[8:11], s16 offen lds
    s_add_u32 m0, s19, 2080
    s_add_u32 s16, s24, 8192
    buffer_load_dwordx4 v8, s[8:11], s16 offen lds
    s_add_u32 m0, s19, 3120
    s_add_u32 s16, s24, 12288
    buffer_load_dwordx4 v8, s[8:11], s16 offen lds
    s_mul_i32 s19, s13, 4160
    s_add_u32 m0, s19, 16640
    s_add_u32 s16, s24, 65536
    buffer_load_dwordx4 v8, s[8:11], s16 offen lds
    s_add_u32 m0, s19, 17680
    s_add_u32 s16, s24, 69632
    buffer_load_dwordx4 v8, s[8:11], s16 offen lds
    s_add_u32 m0, s19, 18720
    s_add_u32 s16, s24, 73728
    buffer_load_dwordx4 v8, s[8:11], s16 offen lds
    s_add_u32 m0, s19, 19760
    s_add_u32 s16, s24, 77824
    buffer_load_dwordx4 v8, s[8:11], s16 offen lds
    s_mul_i32 s19, s13, 4160
    s_add_u32 m0, s19, 33280
    s_add_u32 s16, s24, 131072
    buffer_load_dwordx4 v8, s[8:11], s16 offen lds
    s_add_u32 m0, s19, 34320
    s_add_u32 s16, s24, 135168
    buffer_load_dwordx4 v8, s[8:11], s16 offen lds
    s_add_u32 m0, s19, 35360
    s_add_u32 s16, s24, 139264
    buffer_load_dwordx4 v8, s[8:11], s16 offen lds
    s_add_u32 m0, s19, 36400
    s_add_u32 s16, s24, 143360
    buffer_load_dwordx4 v8, s[8:11], s16 offen lds
    s_mul_i32 s19, s13, 4160
    s_add_u32 m0, s19, 49920
    s_add_u32 s16, s24, 196608
    buffer_load_dwordx4 v8, s[8:11], s16 offen lds
    s_add_u32 m0, s19, 50960
    s_add_u32 s16, s24, 200704
    buffer_load_dwordx4 v8, s[8:11], s16 offen lds
    s_add_u32 m0, s19, 52000
    s_add_u32 s16, s24, 204800
    buffer_load_dwordx4 v8, s[8:11], s16 offen lds
    s_add_u32 m0, s19, 53040
    s_add_u32 s16, s24, 208896
    buffer_load_dwordx4 v8, s[8:11], s16 offen lds
    s_mul_i32 s19, s13, 4160
    s_add_u32 m0, s19, 66560
    s_add_u32 s16, s24, 262144
    buffer_load_dwordx4 v8, s[8:11], s16 offen lds
    s_add_u32 m0, s19, 67600
    s_add_u32 s16, s24, 266240
    buffer_load_dwordx4 v8, s[8:11], s16 offen lds
    s_add_u32 m0, s19, 68640
    s_add_u32 s16, s24, 270336
    buffer_load_dwordx4 v8, s[8:11], s16 offen lds
    s_add_u32 m0, s19, 69680
    s_add_u32 s16, s24, 274432
    buffer_load_dwordx4 v8, s[8:11], s16 offen lds
    s_mul_i32 s19, s13, 4160
    s_add_u32 m0, s19, 83200
    s_add_u32 s16, s24, 327680
    buffer_load_dwordx4 v8, s[8:11], s16 offen lds
    s_add_u32 m0, s19, 84240
    s_add_u32 s16, s24, 331776
    buffer_load_dwordx4 v8, s[8:11], s16 offen lds
    s_add_u32 m0, s19, 85280
    s_add_u32 s16, s24, 335872
    buffer_load_dwordx4 v8, s[8:11], s16 offen lds
    s_add_u32 m0, s19, 86320
    s_add_u32 s16, s24, 339968
    buffer_load_dwordx4 v8, s[8:11], s16 offen lds
    s_waitcnt vmcnt(20)
    s_waitcnt lgkmcnt(0)
    s_barrier
    s_mul_i32 s19, s13, 4160
    s_add_u32 m0, s19, 99840
    s_add_u32 s16, s24, 393216
    buffer_load_dwordx4 v8, s[8:11], s16 offen lds
    s_add_u32 m0, s19, 100880
    s_add_u32 s16, s24, 397312
    buffer_load_dwordx4 v8, s[8:11], s16 offen lds
    s_add_u32 m0, s19, 101920
    s_add_u32 s16, s24, 401408
    buffer_load_dwordx4 v8, s[8:11], s16 offen lds
    s_add_u32 m0, s19, 102960
    s_add_u32 s16, s24, 405504
    buffer_load_dwordx4 v8, s[8:11], s16 offen lds
    v_bfe_u32 v11, v0, 9, 1
    v_mul_u32_u24 v11, 1040, v11
    v_bfe_u32 v12, v0, 6, 2
    v_lshl_add_u32 v11, v12, 8, v11
    v_lshl_add_u32 v11, s13, 6, v11
    v_bfe_u32 v12, v0, 8, 1
    v_lshl_add_u32 v11, v12, 5, v11
    v_bfe_u32 v12, v0, 4, 2
    v_lshl_add_u32 v9, v12, 3, v11
    v_add_u32 v10, 0x10000, v9
    ds_read_b64_tr_b16 a[0:1], v9 offset:0
    ds_read_b64_tr_b16 a[2:3], v9 offset:2080
    ds_read_b64_tr_b16 a[4:5], v9 offset:4160
    ds_read_b64_tr_b16 a[6:7], v9 offset:6240
    ds_read_b64_tr_b16 a[8:9], v9 offset:8320
    ds_read_b64_tr_b16 a[10:11], v9 offset:10400
    ds_read_b64_tr_b16 a[12:13], v9 offset:12480
    ds_read_b64_tr_b16 a[14:15], v9 offset:14560
    s_waitcnt vmcnt(20)
    s_waitcnt lgkmcnt(0)
    s_barrier
    s_mul_i32 s19, s13, 4160
    s_add_u32 m0, s19, 0
    s_add_u32 s16, s24, 458752
    buffer_load_dwordx4 v8, s[8:11], s16 offen lds
    s_add_u32 m0, s19, 1040
    s_add_u32 s16, s24, 462848
    buffer_load_dwordx4 v8, s[8:11], s16 offen lds
    s_add_u32 m0, s19, 2080
    s_add_u32 s16, s24, 466944
    buffer_load_dwordx4 v8, s[8:11], s16 offen lds
    s_add_u32 m0, s19, 3120
    s_add_u32 s16, s24, 471040
    buffer_load_dwordx4 v8, s[8:11], s16 offen lds
    ds_read_b64_tr_b16 a[16:17], v9 offset:16640
    ds_read_b64_tr_b16 a[18:19], v9 offset:18720
    ds_read_b64_tr_b16 a[20:21], v9 offset:20800
    ds_read_b64_tr_b16 a[22:23], v9 offset:22880
    ds_read_b64_tr_b16 a[24:25], v9 offset:24960
    ds_read_b64_tr_b16 a[26:27], v9 offset:27040
    ds_read_b64_tr_b16 a[28:29], v9 offset:29120
    ds_read_b64_tr_b16 a[30:31], v9 offset:31200
    s_waitcnt vmcnt(20)
    s_waitcnt lgkmcnt(0)
    s_barrier
    s_mul_i32 s19, s13, 4160
    s_add_u32 m0, s19, 16640
    s_add_u32 s16, s24, 524288
    buffer_load_dwordx4 v8, s[8:11], s16 offen lds
    s_add_u32 m0, s19, 17680
    s_add_u32 s16, s24, 528384
    buffer_load_dwordx4 v8, s[8:11], s16 offen lds
    s_add_u32 m0, s19, 18720
    s_add_u32 s16, s24, 532480
    buffer_load_dwordx4 v8, s[8:11], s16 offen lds
    s_add_u32 m0, s19, 19760
    s_add_u32 s16, s24, 536576
    buffer_load_dwordx4 v8, s[8:11], s16 offen lds
    ds_read_b64_tr_b16 a[32:33], v9 offset:33280
    ds_read_b64_tr_b16 a[34:35], v9 offset:35360
    ds_read_b64_tr_b16 a[36:37], v9 offset:37440
    ds_read_b64_tr_b16 a[38:39], v9 offset:39520
    ds_read_b64_tr_b16 a[40:41], v9 offset:41600
    ds_read_b64_tr_b16 a[42:43], v9 offset:43680
    ds_read_b64_tr_b16 a[44:45], v9 offset:45760
    ds_read_b64_tr_b16 a[46:47], v9 offset:47840
    s_waitcnt vmcnt(20)
    s_waitcnt lgkmcnt(0)
    s_barrier
    s_mul_i32 s19, s13, 4160
    s_add_u32 m0, s19, 33280
    s_add_u32 s16, s24, 589824
    buffer_load_dwordx4 v8, s[8:11], s16 offen lds
    s_add_u32 m0, s19, 34320
    s_add_u32 s16, s24, 593920
    buffer_load_dwordx4 v8, s[8:11], s16 offen lds
    s_add_u32 m0, s19, 35360
    s_add_u32 s16, s24, 598016
    buffer_load_dwordx4 v8, s[8:11], s16 offen lds
    s_add_u32 m0, s19, 36400
    s_add_u32 s16, s24, 602112
    buffer_load_dwordx4 v8, s[8:11], s16 offen lds
    ds_read_b64_tr_b16 a[48:49], v9 offset:49920
    ds_read_b64_tr_b16 a[50:51], v9 offset:52000
    ds_read_b64_tr_b16 a[52:53], v9 offset:54080
    ds_read_b64_tr_b16 a[54:55], v9 offset:56160
    ds_read_b64_tr_b16 a[56:57], v9 offset:58240
    ds_read_b64_tr_b16 a[58:59], v9 offset:60320
    ds_read_b64_tr_b16 a[60:61], v9 offset:62400
    ds_read_b64_tr_b16 a[62:63], v9 offset:64480
    s_waitcnt vmcnt(20)
    s_waitcnt lgkmcnt(0)
    s_barrier
    s_mul_i32 s19, s13, 4160
    s_add_u32 m0, s19, 49920
    s_add_u32 s16, s24, 655360
    buffer_load_dwordx4 v8, s[8:11], s16 offen lds
    s_add_u32 m0, s19, 50960
    s_add_u32 s16, s24, 659456
    buffer_load_dwordx4 v8, s[8:11], s16 offen lds
    s_add_u32 m0, s19, 52000
    s_add_u32 s16, s24, 663552
    buffer_load_dwordx4 v8, s[8:11], s16 offen lds
    s_add_u32 m0, s19, 53040
    s_add_u32 s16, s24, 667648
    buffer_load_dwordx4 v8, s[8:11], s16 offen lds
    ds_read_b64_tr_b16 a[64:65], v10 offset:1024
    ds_read_b64_tr_b16 a[66:67], v10 offset:3104
    ds_read_b64_tr_b16 a[68:69], v10 offset:5184
    ds_read_b64_tr_b16 a[70:71], v10 offset:7264
    ds_read_b64_tr_b16 a[72:73], v10 offset:9344
    ds_read_b64_tr_b16 a[74:75], v10 offset:11424
    ds_read_b64_tr_b16 a[76:77], v10 offset:13504
    ds_read_b64_tr_b16 a[78:79], v10 offset:15584
    s_waitcnt vmcnt(20)
    s_waitcnt lgkmcnt(0)
    s_barrier
    s_mul_i32 s19, s13, 4160
    s_add_u32 m0, s19, 66560
    s_add_u32 s16, s24, 720896
    buffer_load_dwordx4 v8, s[8:11], s16 offen lds
    s_add_u32 m0, s19, 67600
    s_add_u32 s16, s24, 724992
    buffer_load_dwordx4 v8, s[8:11], s16 offen lds
    s_add_u32 m0, s19, 68640
    s_add_u32 s16, s24, 729088
    buffer_load_dwordx4 v8, s[8:11], s16 offen lds
    s_add_u32 m0, s19, 69680
    s_add_u32 s16, s24, 733184
    buffer_load_dwordx4 v8, s[8:11], s16 offen lds
    ds_read_b64_tr_b16 a[80:81], v10 offset:17664
    ds_read_b64_tr_b16 a[82:83], v10 offset:19744
    ds_read_b64_tr_b16 a[84:85], v10 offset:21824
    ds_read_b64_tr_b16 a[86:87], v10 offset:23904
    ds_read_b64_tr_b16 a[88:89], v10 offset:25984
    ds_read_b64_tr_b16 a[90:91], v10 offset:28064
    ds_read_b64_tr_b16 a[92:93], v10 offset:30144
    ds_read_b64_tr_b16 a[94:95], v10 offset:32224
    s_waitcnt vmcnt(20)
    s_waitcnt lgkmcnt(0)
    s_barrier
    s_mul_i32 s19, s13, 4160
    s_add_u32 m0, s19, 83200
    s_add_u32 s16, s24, 786432
    buffer_load_dwordx4 v8, s[8:11], s16 offen lds
    s_add_u32 m0, s19, 84240
    s_add_u32 s16, s24, 790528
    buffer_load_dwordx4 v8, s[8:11], s16 offen lds
    s_add_u32 m0, s19, 85280
    s_add_u32 s16, s24, 794624
    buffer_load_dwordx4 v8, s[8:11], s16 offen lds
    s_add_u32 m0, s19, 86320
    s_add_u32 s16, s24, 798720
    buffer_load_dwordx4 v8, s[8:11], s16 offen lds
    ds_read_b64_tr_b16 a[96:97], v10 offset:34304
    ds_read_b64_tr_b16 a[98:99], v10 offset:36384
    ds_read_b64_tr_b16 a[100:101], v10 offset:38464
    ds_read_b64_tr_b16 a[102:103], v10 offset:40544
    ds_read_b64_tr_b16 a[104:105], v10 offset:42624
    ds_read_b64_tr_b16 a[106:107], v10 offset:44704
    ds_read_b64_tr_b16 a[108:109], v10 offset:46784
    ds_read_b64_tr_b16 a[110:111], v10 offset:48864
    s_waitcnt vmcnt(20)
    s_waitcnt lgkmcnt(0)
    s_barrier
    s_mul_i32 s19, s13, 4160
    s_add_u32 m0, s19, 99840
    s_add_u32 s16, s24, 851968
    buffer_load_dwordx4 v8, s[8:11], s16 offen lds
    s_add_u32 m0, s19, 100880
    s_add_u32 s16, s24, 856064
    buffer_load_dwordx4 v8, s[8:11], s16 offen lds
    s_add_u32 m0, s19, 101920
    s_add_u32 s16, s24, 860160
    buffer_load_dwordx4 v8, s[8:11], s16 offen lds
    s_add_u32 m0, s19, 102960
    s_add_u32 s16, s24, 864256
    buffer_load_dwordx4 v8, s[8:11], s16 offen lds
    ds_read_b64_tr_b16 a[112:113], v9 offset:0
    ds_read_b64_tr_b16 a[114:115], v9 offset:2080
    ds_read_b64_tr_b16 a[116:117], v9 offset:4160
    ds_read_b64_tr_b16 a[118:119], v9 offset:6240
    ds_read_b64_tr_b16 a[120:121], v9 offset:8320
    ds_read_b64_tr_b16 a[122:123], v9 offset:10400
    ds_read_b64_tr_b16 a[124:125], v9 offset:12480
    ds_read_b64_tr_b16 a[126:127], v9 offset:14560
    s_waitcnt vmcnt(20)
    s_waitcnt lgkmcnt(0)
    s_barrier
    s_mul_i32 s19, s13, 4160
    s_add_u32 m0, s19, 0
    s_add_u32 s16, s24, 917504
    buffer_load_dwordx4 v8, s[8:11], s16 offen lds
    s_add_u32 m0, s19, 1040
    s_add_u32 s16, s24, 921600
    buffer_load_dwordx4 v8, s[8:11], s16 offen lds
    s_add_u32 m0, s19, 2080
    s_add_u32 s16, s24, 925696
    buffer_load_dwordx4 v8, s[8:11], s16 offen lds
    s_add_u32 m0, s19, 3120
    s_add_u32 s16, s24, 929792
    buffer_load_dwordx4 v8, s[8:11], s16 offen lds
    ds_read_b64_tr_b16 a[128:129], v9 offset:16640
    ds_read_b64_tr_b16 a[130:131], v9 offset:18720
    ds_read_b64_tr_b16 a[132:133], v9 offset:20800
    ds_read_b64_tr_b16 a[134:135], v9 offset:22880
    ds_read_b64_tr_b16 a[136:137], v9 offset:24960
    ds_read_b64_tr_b16 a[138:139], v9 offset:27040
    ds_read_b64_tr_b16 a[140:141], v9 offset:29120
    ds_read_b64_tr_b16 a[142:143], v9 offset:31200
    s_waitcnt vmcnt(20)
    s_waitcnt lgkmcnt(0)
    s_barrier
    s_mul_i32 s19, s13, 4160
    s_add_u32 m0, s19, 16640
    s_add_u32 s16, s24, 983040
    buffer_load_dwordx4 v8, s[8:11], s16 offen lds
    s_add_u32 m0, s19, 17680
    s_add_u32 s16, s24, 987136
    buffer_load_dwordx4 v8, s[8:11], s16 offen lds
    s_add_u32 m0, s19, 18720
    s_add_u32 s16, s24, 991232
    buffer_load_dwordx4 v8, s[8:11], s16 offen lds
    s_add_u32 m0, s19, 19760
    s_add_u32 s16, s24, 995328
    buffer_load_dwordx4 v8, s[8:11], s16 offen lds
    ds_read_b64_tr_b16 a[144:145], v9 offset:33280
    ds_read_b64_tr_b16 a[146:147], v9 offset:35360
    ds_read_b64_tr_b16 a[148:149], v9 offset:37440
    ds_read_b64_tr_b16 a[150:151], v9 offset:39520
    ds_read_b64_tr_b16 a[152:153], v9 offset:41600
    ds_read_b64_tr_b16 a[154:155], v9 offset:43680
    ds_read_b64_tr_b16 a[156:157], v9 offset:45760
    ds_read_b64_tr_b16 a[158:159], v9 offset:47840
    s_waitcnt vmcnt(20)
    s_waitcnt lgkmcnt(0)
    s_barrier
    s_load_dwordx2 s[8:9], s[0:1], 72
    s_mov_b32 s10, 524288
    s_mov_b32 s11, 0x20000
    s_waitcnt lgkmcnt(0)
    v_lshrrev_b32 v11, 8, v0
    v_lshl_add_u32 v11, s13, 4, v11
    v_mul_u32_u24 v11, 1024, v11
    v_and_b32 v8, 0xf0, v0
    v_add_u32 v8, v11, v8
    s_mul_i32 s19, s13, 4160
    s_add_u32 m0, s19, 33280
    s_add_u32 s16, s44, 0
    buffer_load_dwordx4 v8, s[8:11], s16 offen lds
    s_add_u32 m0, s19, 34320
    s_add_u32 s16, s44, 4096
    buffer_load_dwordx4 v8, s[8:11], s16 offen lds
    s_add_u32 m0, s19, 35360
    s_add_u32 s16, s44, 8192
    buffer_load_dwordx4 v8, s[8:11], s16 offen lds
    s_add_u32 m0, s19, 36400
    s_add_u32 s16, s44, 12288
    buffer_load_dwordx4 v8, s[8:11], s16 offen lds
    ds_read_b64_tr_b16 a[160:161], v9 offset:49920
    ds_read_b64_tr_b16 a[162:163], v9 offset:52000
    ds_read_b64_tr_b16 a[164:165], v9 offset:54080
    ds_read_b64_tr_b16 a[166:167], v9 offset:56160
    ds_read_b64_tr_b16 a[168:169], v9 offset:58240
    ds_read_b64_tr_b16 a[170:171], v9 offset:60320
    ds_read_b64_tr_b16 a[172:173], v9 offset:62400
    ds_read_b64_tr_b16 a[174:175], v9 offset:64480
    s_waitcnt vmcnt(20)
    s_waitcnt lgkmcnt(0)
    s_barrier
    s_mul_i32 s19, s13, 4160
    s_add_u32 m0, s19, 49920
    s_add_u32 s16, s44, 65536
    buffer_load_dwordx4 v8, s[8:11], s16 offen lds
    s_add_u32 m0, s19, 50960
    s_add_u32 s16, s44, 69632
    buffer_load_dwordx4 v8, s[8:11], s16 offen lds
    s_add_u32 m0, s19, 52000
    s_add_u32 s16, s44, 73728
    buffer_load_dwordx4 v8, s[8:11], s16 offen lds
    s_add_u32 m0, s19, 53040
    s_add_u32 s16, s44, 77824
    buffer_load_dwordx4 v8, s[8:11], s16 offen lds
    ds_read_b64_tr_b16 a[176:177], v10 offset:1024
    ds_read_b64_tr_b16 a[178:179], v10 offset:3104
    ds_read_b64_tr_b16 a[180:181], v10 offset:5184
    ds_read_b64_tr_b16 a[182:183], v10 offset:7264
    ds_read_b64_tr_b16 a[184:185], v10 offset:9344
    ds_read_b64_tr_b16 a[186:187], v10 offset:11424
    ds_read_b64_tr_b16 a[188:189], v10 offset:13504
    ds_read_b64_tr_b16 a[190:191], v10 offset:15584
    s_waitcnt vmcnt(20)
    s_waitcnt lgkmcnt(0)
    s_barrier
    s_mul_i32 s19, s13, 4160
    s_add_u32 m0, s19, 66560
    s_add_u32 s16, s44, 131072
    buffer_load_dwordx4 v8, s[8:11], s16 offen lds
    s_add_u32 m0, s19, 67600
    s_add_u32 s16, s44, 135168
    buffer_load_dwordx4 v8, s[8:11], s16 offen lds
    s_add_u32 m0, s19, 68640
    s_add_u32 s16, s44, 139264
    buffer_load_dwordx4 v8, s[8:11], s16 offen lds
    s_add_u32 m0, s19, 69680
    s_add_u32 s16, s44, 143360
    buffer_load_dwordx4 v8, s[8:11], s16 offen lds
    ds_read_b64_tr_b16 a[192:193], v10 offset:17664
    ds_read_b64_tr_b16 a[194:195], v10 offset:19744
    ds_read_b64_tr_b16 a[196:197], v10 offset:21824
    ds_read_b64_tr_b16 a[198:199], v10 offset:23904
    ds_read_b64_tr_b16 a[200:201], v10 offset:25984
    ds_read_b64_tr_b16 a[202:203], v10 offset:28064
    ds_read_b64_tr_b16 a[204:205], v10 offset:30144
    ds_read_b64_tr_b16 a[206:207], v10 offset:32224
    s_waitcnt vmcnt(20)
    s_waitcnt lgkmcnt(0)
    s_barrier
    s_mul_i32 s19, s13, 4160
    s_add_u32 m0, s19, 83200
    s_add_u32 s16, s44, 196608
    buffer_load_dwordx4 v8, s[8:11], s16 offen lds
    s_add_u32 m0, s19, 84240
    s_add_u32 s16, s44, 200704
    buffer_load_dwordx4 v8, s[8:11], s16 offen lds
    s_add_u32 m0, s19, 85280
    s_add_u32 s16, s44, 204800
    buffer_load_dwordx4 v8, s[8:11], s16 offen lds
    s_add_u32 m0, s19, 86320
    s_add_u32 s16, s44, 208896
    buffer_load_dwordx4 v8, s[8:11], s16 offen lds
    ds_read_b64_tr_b16 a[208:209], v10 offset:34304
    ds_read_b64_tr_b16 a[210:211], v10 offset:36384
    ds_read_b64_tr_b16 a[212:213], v10 offset:38464
    ds_read_b64_tr_b16 a[214:215], v10 offset:40544
    ds_read_b64_tr_b16 a[216:217], v10 offset:42624
    ds_read_b64_tr_b16 a[218:219], v10 offset:44704
    ds_read_b64_tr_b16 a[220:221], v10 offset:46784
    ds_read_b64_tr_b16 a[222:223], v10 offset:48864
    s_waitcnt vmcnt(20)
    s_waitcnt lgkmcnt(0)
    s_barrier
    s_mul_i32 s19, s13, 4160
    s_add_u32 m0, s19, 99840
    s_add_u32 s16, s44, 262144
    buffer_load_dwordx4 v8, s[8:11], s16 offen lds
    s_add_u32 m0, s19, 100880
    s_add_u32 s16, s44, 266240
    buffer_load_dwordx4 v8, s[8:11], s16 offen lds
    s_add_u32 m0, s19, 101920
    s_add_u32 s16, s44, 270336
    buffer_load_dwordx4 v8, s[8:11], s16 offen lds
    s_add_u32 m0, s19, 102960
    s_add_u32 s16, s44, 274432
    buffer_load_dwordx4 v8, s[8:11], s16 offen lds
    ds_read_b64_tr_b16 a[224:225], v9 offset:0
    ds_read_b64_tr_b16 a[226:227], v9 offset:2080
    ds_read_b64_tr_b16 a[228:229], v9 offset:4160
    ds_read_b64_tr_b16 a[230:231], v9 offset:6240
    ds_read_b64_tr_b16 a[232:233], v9 offset:8320
    ds_read_b64_tr_b16 a[234:235], v9 offset:10400
    ds_read_b64_tr_b16 a[236:237], v9 offset:12480
    ds_read_b64_tr_b16 a[238:239], v9 offset:14560
    s_waitcnt vmcnt(20)
    s_waitcnt lgkmcnt(0)
    s_barrier
    s_mul_i32 s19, s13, 4160
    s_add_u32 m0, s19, 0
    s_add_u32 s16, s44, 327680
    buffer_load_dwordx4 v8, s[8:11], s16 offen lds
    s_add_u32 m0, s19, 1040
    s_add_u32 s16, s44, 331776
    buffer_load_dwordx4 v8, s[8:11], s16 offen lds
    s_add_u32 m0, s19, 2080
    s_add_u32 s16, s44, 335872
    buffer_load_dwordx4 v8, s[8:11], s16 offen lds
    s_add_u32 m0, s19, 3120
    s_add_u32 s16, s44, 339968
    buffer_load_dwordx4 v8, s[8:11], s16 offen lds
    ds_read_b64_tr_b16 a[240:241], v9 offset:16640
    ds_read_b64_tr_b16 a[242:243], v9 offset:18720
    ds_read_b64_tr_b16 a[244:245], v9 offset:20800
    ds_read_b64_tr_b16 a[246:247], v9 offset:22880
    ds_read_b64_tr_b16 a[248:249], v9 offset:24960
    ds_read_b64_tr_b16 a[250:251], v9 offset:27040
    ds_read_b64_tr_b16 a[252:253], v9 offset:29120
    ds_read_b64_tr_b16 a[254:255], v9 offset:31200
    s_waitcnt vmcnt(20)
    s_waitcnt lgkmcnt(0)
    s_barrier
    s_mul_i32 s19, s13, 4160
    s_add_u32 m0, s19, 16640
    s_add_u32 s16, s44, 393216
    buffer_load_dwordx4 v8, s[8:11], s16 offen lds
    s_add_u32 m0, s19, 17680
    s_add_u32 s16, s44, 397312
    buffer_load_dwordx4 v8, s[8:11], s16 offen lds
    s_add_u32 m0, s19, 18720
    s_add_u32 s16, s44, 401408
    buffer_load_dwordx4 v8, s[8:11], s16 offen lds
    s_add_u32 m0, s19, 19760
    s_add_u32 s16, s44, 405504
    buffer_load_dwordx4 v8, s[8:11], s16 offen lds
    v_bfe_u32 v11, v0, 9, 1
    v_mul_u32_u24 v11, 1040, v11
    v_bfe_u32 v12, v0, 6, 2
    v_lshl_add_u32 v11, v12, 8, v11
    v_lshl_add_u32 v11, s13, 6, v11
    v_bfe_u32 v12, v0, 8, 1
    v_lshl_add_u32 v11, v12, 4, v11
    v_bfe_u32 v12, v0, 4, 1
    v_lshl_add_u32 v11, v12, 5, v11
    v_bfe_u32 v12, v0, 5, 1
    v_lshl_add_u32 v9, v12, 3, v11
    v_add_u32 v10, 0x10000, v9
    ds_read_b64_tr_b16 v[128:129], v9 offset:33280
    ds_read_b64_tr_b16 v[130:131], v9 offset:35360
    ds_read_b64_tr_b16 v[132:133], v9 offset:37440
    ds_read_b64_tr_b16 v[134:135], v9 offset:39520
    ds_read_b64_tr_b16 v[136:137], v9 offset:41600
    ds_read_b64_tr_b16 v[138:139], v9 offset:43680
    ds_read_b64_tr_b16 v[140:141], v9 offset:45760
    ds_read_b64_tr_b16 v[142:143], v9 offset:47840
    s_waitcnt vmcnt(20)
    s_waitcnt lgkmcnt(0)
    s_barrier
    s_mul_i32 s19, s13, 4160
    s_add_u32 m0, s19, 33280
    s_add_u32 s16, s44, 458752
    buffer_load_dwordx4 v8, s[8:11], s16 offen lds
    s_add_u32 m0, s19, 34320
    s_add_u32 s16, s44, 462848
    buffer_load_dwordx4 v8, s[8:11], s16 offen lds
    s_add_u32 m0, s19, 35360
    s_add_u32 s16, s44, 466944
    buffer_load_dwordx4 v8, s[8:11], s16 offen lds
    s_add_u32 m0, s19, 36400
    s_add_u32 s16, s44, 471040
    buffer_load_dwordx4 v8, s[8:11], s16 offen lds
    ds_read_b64_tr_b16 v[144:145], v9 offset:49920
    ds_read_b64_tr_b16 v[146:147], v9 offset:52000
    ds_read_b64_tr_b16 v[148:149], v9 offset:54080
    ds_read_b64_tr_b16 v[150:151], v9 offset:56160
    ds_read_b64_tr_b16 v[152:153], v9 offset:58240
    ds_read_b64_tr_b16 v[154:155], v9 offset:60320
    ds_read_b64_tr_b16 v[156:157], v9 offset:62400
    ds_read_b64_tr_b16 v[158:159], v9 offset:64480
    s_waitcnt vmcnt(20)
    s_waitcnt lgkmcnt(0)
    s_barrier
    ds_read_b64_tr_b16 v[160:161], v10 offset:1024
    ds_read_b64_tr_b16 v[162:163], v10 offset:3104
    ds_read_b64_tr_b16 v[164:165], v10 offset:5184
    ds_read_b64_tr_b16 v[166:167], v10 offset:7264
    ds_read_b64_tr_b16 v[168:169], v10 offset:9344
    ds_read_b64_tr_b16 v[170:171], v10 offset:11424
    ds_read_b64_tr_b16 v[172:173], v10 offset:13504
    ds_read_b64_tr_b16 v[174:175], v10 offset:15584
    s_waitcnt vmcnt(16)
    s_waitcnt lgkmcnt(0)
    s_barrier
    ds_read_b64_tr_b16 v[176:177], v10 offset:17664
    ds_read_b64_tr_b16 v[178:179], v10 offset:19744
    ds_read_b64_tr_b16 v[180:181], v10 offset:21824
    ds_read_b64_tr_b16 v[182:183], v10 offset:23904
    ds_read_b64_tr_b16 v[184:185], v10 offset:25984
    ds_read_b64_tr_b16 v[186:187], v10 offset:28064
    ds_read_b64_tr_b16 v[188:189], v10 offset:30144
    ds_read_b64_tr_b16 v[190:191], v10 offset:32224
    s_waitcnt vmcnt(12)
    s_waitcnt lgkmcnt(0)
    s_barrier
    ds_read_b64_tr_b16 v[192:193], v10 offset:34304
    ds_read_b64_tr_b16 v[194:195], v10 offset:36384
    ds_read_b64_tr_b16 v[196:197], v10 offset:38464
    ds_read_b64_tr_b16 v[198:199], v10 offset:40544
    ds_read_b64_tr_b16 v[200:201], v10 offset:42624
    ds_read_b64_tr_b16 v[202:203], v10 offset:44704
    ds_read_b64_tr_b16 v[204:205], v10 offset:46784
    ds_read_b64_tr_b16 v[206:207], v10 offset:48864
    s_waitcnt vmcnt(8)
    s_waitcnt lgkmcnt(0)
    s_barrier
    ds_read_b64_tr_b16 v[208:209], v9 offset:0
    ds_read_b64_tr_b16 v[210:211], v9 offset:2080
    ds_read_b64_tr_b16 v[212:213], v9 offset:4160
    ds_read_b64_tr_b16 v[214:215], v9 offset:6240
    ds_read_b64_tr_b16 v[216:217], v9 offset:8320
    ds_read_b64_tr_b16 v[218:219], v9 offset:10400
    ds_read_b64_tr_b16 v[220:221], v9 offset:12480
    ds_read_b64_tr_b16 v[222:223], v9 offset:14560
    s_waitcnt vmcnt(4)
    s_waitcnt lgkmcnt(0)
    s_barrier
    ds_read_b64_tr_b16 v[224:225], v9 offset:16640
    ds_read_b64_tr_b16 v[226:227], v9 offset:18720
    ds_read_b64_tr_b16 v[228:229], v9 offset:20800
    ds_read_b64_tr_b16 v[230:231], v9 offset:22880
    ds_read_b64_tr_b16 v[232:233], v9 offset:24960
    ds_read_b64_tr_b16 v[234:235], v9 offset:27040
    ds_read_b64_tr_b16 v[236:237], v9 offset:29120
    ds_read_b64_tr_b16 v[238:239], v9 offset:31200
    s_waitcnt vmcnt(0)
    s_waitcnt lgkmcnt(0)
    s_barrier
    ds_read_b64_tr_b16 v[240:241], v9 offset:33280
    ds_read_b64_tr_b16 v[242:243], v9 offset:35360
    ds_read_b64_tr_b16 v[244:245], v9 offset:37440
    ds_read_b64_tr_b16 v[246:247], v9 offset:39520
    ds_read_b64_tr_b16 v[248:249], v9 offset:41600
    ds_read_b64_tr_b16 v[250:251], v9 offset:43680
    ds_read_b64_tr_b16 v[252:253], v9 offset:45760
    ds_read_b64_tr_b16 v[254:255], v9 offset:47840
    s_waitcnt lgkmcnt(0)
    s_barrier
    s_lshl_b32 s23, s13, 12
L_g1l_6:
    s_mov_b32 s21, s12
    s_mov_b32 s46, 0
    s_mov_b32 s42, s23
    v_mov_b32 v6, v0
    s_barrier
L_g1a_7:
    s_lshl_b32 s22, s15, 6
    s_add_u32 s22, s22, s21
    s_lshr_b32 s30, s22, 1
    s_add_u32 s30, s30, 1
    s_mov_b32 s45, 0
    s_cmp_lg_u32 s46, 0
    s_cbranch_scc1 L_g1w_11
    s_add_u32 s17, s21, 0
    s_mul_i32 s48, s17, 21846
    s_lshr_b32 s48, s48, 16
    s_mul_i32 s47, s48, 3
    s_sub_u32 s47, s17, s47
    s_mul_i32 s16, s26, 24
    s_add_u32 s47, s47, s16
    s_lshl_b32 s47, s47, 7
    s_add_u32 s47, s47, 32768
    s_lshl_b32 s16, s15, 5
    s_add_u32 s48, s48, s16
    s_add_u32 s48, s48, 1
    s_add_u32 s43, s22, 0
    s_lshl_b32 s43, s43, 2
    s_add_u32 s43, s43, s26
    s_lshl_b32 s43, s43, 16
    s_add_u32 s43, s43, s23
    s_add_u32 s43, s43, 117440512
    s_cmp_eq_u32 s21, 63
    s_cbranch_scc1 L_g1x_8
    s_mov_b64 exec, 0xff
L_wf_14:
    buffer_load_dword v1, v2, s[4:7], s47 offen offset:0 sc1
    s_add_u32 s40, s40, 1
    s_cmp_gt_u32 s40, 262144
    s_cbranch_scc1 L_abort
    s_waitcnt vmcnt(0)
    v_cmp_gt_u32 vcc, s48, v1
    s_cbranch_vccnz L_wf_14
L_wfo_15:
    s_mov_b64 exec, -1
    s_branch L_g1y_9
L_g1x_8:
    s_mov_b32 s45, 1
    v_and_b32 v64, 0x30, v0
    v_lshlrev_b32 v64, 6, v64
    v_bfe_u32 v65, v0, 6, 2
    v_lshl_add_u32 v64, v65, 14, v64
    s_mov_b64 exec, 0xffff
L_pr_17:
    buffer_load_dword v1, v64, s[4:7], s43 offen offset:1020 sc1
    s_add_u32 s40, s40, 1
    s_cmp_gt_u32 s40, 262144
    s_cbranch_scc1 L_abort
    s_waitcnt vmcnt(0)
    v_cmp_eq_u32 vcc, -1, v1
    s_cbranch_vccnz L_pr_17
    s_mov_b64 exec, -1
L_g1y_9:
    s_xor_b32 s42, s42, 0x10000
    s_add_u32 m0, s42, 0
    s_mov_b32 s16, s43
    buffer_load_dwordx4 v0, s[4:7], s16 offen offset:0 sc1 lds
    buffer_load_dwordx4 v0, s[4:7], s16 offen offset:1024 sc1 lds
    buffer_load_dwordx4 v0, s[4:7], s16 offen offset:2048 sc1 lds
    buffer_load_dwordx4 v0, s[4:7], s16 offen offset:3072 sc1 lds
    s_add_u32 s43, s43, 16384
    s_add_u32 m0, s42, 16384
    s_mov_b32 s16, s43
    buffer_load_dwordx4 v0, s[4:7], s16 offen offset:0 sc1 lds
    buffer_load_dwordx4 v0, s[4:7], s16 offen offset:1024 sc1 lds
    buffer_load_dwordx4 v0, s[4:7], s16 offen offset:2048 sc1 lds
    buffer_load_dwordx4 v0, s[4:7], s16 offen offset:3072 sc1 lds
    s_add_u32 s43, s43, 16384
    s_add_u32 m0, s42, 32768
    s_mov_b32 s16, s43
    buffer_load_dwordx4 v0, s[4:7], s16 offen offset:0 sc1 lds
    buffer_load_dwordx4 v0, s[4:7], s16 offen offset:1024 sc1 lds
    buffer_load_dwordx4 v0, s[4:7], s16 offen offset:2048 sc1 lds
    buffer_load_dwordx4 v0, s[4:7], s16 offen offset:3072 sc1 lds
    s_add_u32 s43, s43, 16384
    s_add_u32 m0, s42, 49152
    s_mov_b32 s16, s43
    buffer_load_dwordx4 v0, s[4:7], s16 offen offset:0 sc1 lds
    buffer_load_dwordx4 v0, s[4:7], s16 offen offset:1024 sc1 lds
    buffer_load_dwordx4 v0, s[4:7], s16 offen offset:2048 sc1 lds
    buffer_load_dwordx4 v0, s[4:7], s16 offen offset:3072 sc1 lds
L_g1w_11:
    s_mov_b32 s46, 0
    v_xor_b32 v6, 0x10000, v6
    s_waitcnt vmcnt(12)
    s_barrier
    ds_read_b128 v[8:11], v6 offset:0
    ds_read_b128 v[12:15], v6 offset:1024
    s_waitcnt lgkmcnt(1)
    v_mfma_f32_32x32x16_bf16 v[32:47], v[8:11], a[0:3], 0
    s_nop 0
    ds_read_b128 v[16:19], v6 offset:2048
    s_waitcnt lgkmcnt(1)
    v_mfma_f32_32x32x16_bf16 v[32:47], v[12:15], a[4:7], v[32:47]
    s_nop 0
    ds_read_b128 v[8:11], v6 offset:3072
    s_waitcnt lgkmcnt(1)
    v_mfma_f32_32x32x16_bf16 v[32:47], v[16:19], a[8:11], v[32:47]
    s_nop 0
    ds_read_b128 v[12:15], v6 offset:4096
    s_waitcnt lgkmcnt(1)
    v_mfma_f32_32x32x16_bf16 v[32:47], v[8:11], a[12:15], v[32:47]
    s_nop 0
    ds_read_b128 v[16:19], v6 offset:5120
    s_waitcnt lgkmcnt(1)
    v_mfma_f32_32x32x16_bf16 v[32:47], v[12:15], a[16:19], v[32:47]
    s_nop 0
    ds_read_b128 v[8:11], v6 offset:6144
    s_waitcnt lgkmcnt(1)
    v_mfma_f32_32x32x16_bf16 v[32:47], v[16:19], a[20:23], v[32:47]
    s_nop 0
    ds_read_b128 v[12:15], v6 offset:7168
    s_waitcnt lgkmcnt(1)
    v_mfma_f32_32x32x16_bf16 v[32:47], v[8:11], a[24:27], v[32:47]
    s_nop 0
    ds_read_b128 v[16:19], v6 offset:8192
    s_waitcnt lgkmcnt(1)
    v_mfma_f32_32x32x16_bf16 v[32:47], v[12:15], a[28:31], v[32:47]
    s_nop 0
    ds_read_b128 v[8:11], v6 offset:9216
    s_waitcnt lgkmcnt(1)
    v_mfma_f32_32x32x16_bf16 v[32:47], v[16:19], a[32:35], v[32:47]
    s_nop 0
    ds_read_b128 v[12:15], v6 offset:10240
    s_waitcnt lgkmcnt(1)
    v_mfma_f32_32x32x16_bf16 v[32:47], v[8:11], a[36:39], v[32:47]
    s_nop 0
    ds_read_b128 v[16:19], v6 offset:11264
    s_waitcnt lgkmcnt(1)
    v_mfma_f32_32x32x16_bf16 v[32:47], v[12:15], a[40:43], v[32:47]
    s_nop 0
    ds_read_b128 v[8:11], v6 offset:12288
    s_waitcnt lgkmcnt(1)
    v_mfma_f32_32x32x16_bf16 v[32:47], v[16:19], a[44:47], v[32:47]
    s_nop 0
    ds_read_b128 v[12:15], v6 offset:13312
    s_waitcnt lgkmcnt(1)
    v_mfma_f32_32x32x16_bf16 v[32:47], v[8:11], a[48:51], v[32:47]
    s_nop 0
    ds_read_b128 v[16:19], v6 offset:14336
    s_waitcnt vmcnt(8)
    s_barrier
    s_waitcnt lgkmcnt(1)
    v_mfma_f32_32x32x16_bf16 v[32:47], v[12:15], a[52:55], v[32:47]
    s_nop 0
    ds_read_b128 v[8:11], v6 offset:15360
    s_waitcnt lgkmcnt(1)
    v_mfma_f32_32x32x16_bf16 v[32:47], v[16:19], a[56:59], v[32:47]
    s_nop 0
    ds_read_b128 v[12:15], v6 offset:16384
    s_add_u32 s17, s21, 2
    s_mul_i32 s48, s17, 21846
    s_lshr_b32 s48, s48, 16
    s_mul_i32 s47, s48, 3
    s_sub_u32 s47, s17, s47
    s_mul_i32 s16, s26, 24
    s_add_u32 s47, s47, s16
    s_lshl_b32 s47, s47, 7
    s_add_u32 s47, s47, 32768
    s_lshl_b32 s16, s15, 5
    s_add_u32 s48, s48, s16
    s_add_u32 s48, s48, 1
    s_add_u32 s43, s22, 2
    s_lshl_b32 s43, s43, 2
    s_add_u32 s43, s43, s26
    s_lshl_b32 s43, s43, 16
    s_add_u32 s43, s43, s23
    s_add_u32 s43, s43, 117440512
    s_lshl_b32 s18, s12, 11
    s_add_u32 s18, s18, 49152
    s_mov_b64 exec, 0xffff
    buffer_load_dword v27, v3, s[4:7], s18 offen sc1
    buffer_load_dword v26, v2, s[4:7], s47 offen sc1
    s_mov_b64 exec, -1
    s_waitcnt lgkmcnt(1)
    v_mfma_f32_32x32x16_bf16 v[32:47], v[8:11], a[60:63], v[32:47]
    s_nop 0
    ds_read_b128 v[16:19], v6 offset:17408
    s_waitcnt lgkmcnt(1)
    v_mfma_f32_32x32x16_bf16 v[32:47], v[12:15], a[64:67], v[32:47]
    s_nop 0
    ds_read_b128 v[8:11], v6 offset:18432
    s_waitcnt lgkmcnt(1)
    v_mfma_f32_32x32x16_bf16 v[32:47], v[16:19], a[68:71], v[32:47]
    s_nop 0
    ds_read_b128 v[12:15], v6 offset:19456
    s_waitcnt lgkmcnt(1)
    v_mfma_f32_32x32x16_bf16 v[32:47], v[8:11], a[72:75], v[32:47]
    s_nop 0
    ds_read_b128 v[16:19], v6 offset:20480
    s_waitcnt lgkmcnt(1)
    v_mfma_f32_32x32x16_bf16 v[32:47], v[12:15], a[76:79], v[32:47]
    s_nop 0
    ds_read_b128 v[8:11], v6 offset:21504
    s_waitcnt lgkmcnt(1)
    v_mfma_f32_32x32x16_bf16 v[32:47], v[16:19], a[80:83], v[32:47]
    s_nop 0
    ds_read_b128 v[12:15], v6 offset:22528
    s_waitcnt lgkmcnt(1)
    v_mfma_f32_32x32x16_bf16 v[32:47], v[8:11], a[84:87], v[32:47]
    s_nop 0
    ds_read_b128 v[16:19], v6 offset:23552
    s_waitcnt lgkmcnt(1)
    v_mfma_f32_32x32x16_bf16 v[32:47], v[12:15], a[88:91], v[32:47]
    s_nop 0
    ds_read_b128 v[8:11], v6 offset:24576
    s_waitcnt lgkmcnt(1)
    v_mfma_f32_32x32x16_bf16 v[32:47], v[16:19], a[92:95], v[32:47]
    s_nop 0
    ds_read_b128 v[12:15], v6 offset:25600
    s_waitcnt lgkmcnt(1)
    v_mfma_f32_32x32x16_bf16 v[32:47], v[8:11], a[96:99], v[32:47]
    s_nop 0
    ds_read_b128 v[16:19], v6 offset:26624
    s_waitcnt lgkmcnt(1)
    v_mfma_f32_32x32x16_bf16 v[32:47], v[12:15], a[100:103], v[32:47]
    s_nop 0
    ds_read_b128 v[8:11], v6 offset:27648
    s_waitcnt lgkmcnt(1)
    v_mfma_f32_32x32x16_bf16 v[32:47], v[16:19], a[104:107], v[32:47]
    s_nop 0
    ds_read_b128 v[12:15], v6 offset:28672
    s_waitcnt lgkmcnt(1)
    v_mfma_f32_32x32x16_bf16 v[32:47], v[8:11], a[108:111], v[32:47]
    s_nop 0
    ds_read_b128 v[16:19], v6 offset:29696
    s_waitcnt lgkmcnt(1)
    v_mfma_f32_32x32x16_bf16 v[32:47], v[12:15], a[112:115], v[32:47]
    s_nop 0
    ds_read_b128 v[8:11], v6 offset:30720
    s_waitcnt vmcnt(6)
    s_barrier
    s_waitcnt lgkmcnt(1)
    v_mfma_f32_32x32x16_bf16 v[32:47], v[16:19], a[116:119], v[32:47]
    s_nop 0
    ds_read_b128 v[12:15], v6 offset:31744
    s_waitcnt lgkmcnt(1)
    v_mfma_f32_32x32x16_bf16 v[32:47], v[8:11], a[120:123], v[32:47]
    s_nop 0
    ds_read_b128 v[16:19], v6 offset:32768
    s_waitcnt lgkmcnt(1)
    v_mfma_f32_32x32x16_bf16 v[32:47], v[12:15], a[124:127], v[32:47]
    s_nop 0
    ds_read_b128 v[8:11], v6 offset:33792
    s_waitcnt lgkmcnt(1)
    v_mfma_f32_32x32x16_bf16 v[32:47], v[16:19], a[128:131], v[32:47]
    s_nop 0
    ds_read_b128 v[12:15], v6 offset:34816
    s_waitcnt lgkmcnt(1)
    v_mfma_f32_32x32x16_bf16 v[32:47], v[8:11], a[132:135], v[32:47]
    s_nop 0
    ds_read_b128 v[16:19], v6 offset:35840
    s_waitcnt lgkmcnt(1)
    v_mfma_f32_32x32x16_bf16 v[32:47], v[12:15], a[136:139], v[32:47]
    s_nop 0
    ds_read_b128 v[8:11], v6 offset:36864
    s_waitcnt lgkmcnt(1)
    v_mfma_f32_32x32x16_bf16 v[32:47], v[16:19], a[140:143], v[32:47]
    s_nop 0
    ds_read_b128 v[12:15], v6 offset:37888
    s_waitcnt lgkmcnt(1)
    v_mfma_f32_32x32x16_bf16 v[32:47], v[8:11], a[144:147], v[32:47]
    s_nop 0
    ds_read_b128 v[16:19], v6 offset:38912
    s_waitcnt lgkmcnt(1)
    v_mfma_f32_32x32x16_bf16 v[32:47], v[12:15], a[148:151], v[32:47]
    s_nop 0
    ds_read_b128 v[8:11], v6 offset:39936
    s_waitcnt lgkmcnt(1)
    v_mfma_f32_32x32x16_bf16 v[32:47], v[16:19], a[152:155], v[32:47]
    s_nop 0
    ds_read_b128 v[12:15], v6 offset:40960
    s_waitcnt lgkmcnt(1)
    v_mfma_f32_32x32x16_bf16 v[32:47], v[8:11], a[156:159], v[32:47]
    s_nop 0
    ds_read_b128 v[16:19], v6 offset:41984
    s_waitcnt lgkmcnt(1)
    v_mfma_f32_32x32x16_bf16 v[32:47], v[12:15], a[160:163], v[32:47]
    s_nop 0
    ds_read_b128 v[8:11], v6 offset:43008
    s_waitcnt lgkmcnt(1)
    v_mfma_f32_32x32x16_bf16 v[32:47], v[16:19], a[164:167], v[32:47]
    s_nop 0
    ds_read_b128 v[12:15], v6 offset:44032
    s_waitcnt lgkmcnt(1)
    v_mfma_f32_32x32x16_bf16 v[32:47], v[8:11], a[168:171], v[32:47]
    s_nop 0
    ds_read_b128 v[16:19], v6 offset:45056
    s_waitcnt lgkmcnt(1)
    v_mfma_f32_32x32x16_bf16 v[32:47], v[12:15], a[172:175], v[32:47]
    s_nop 0
    ds_read_b128 v[8:11], v6 offset:46080
    s_waitcnt lgkmcnt(1)
    v_mfma_f32_32x32x16_bf16 v[32:47], v[16:19], a[176:179], v[32:47]
    s_nop 0
    ds_read_b128 v[12:15], v6 offset:47104
    s_waitcnt vmcnt(0)
    s_barrier
    s_waitcnt lgkmcnt(1)
    v_mfma_f32_32x32x16_bf16 v[32:47], v[8:11], a[180:183], v[32:47]
    s_nop 0
    ds_read_b128 v[16:19], v6 offset:48128
    v_cmp_gt_u32 vcc, s48, v26
    s_cmp_lt_u32 s21, 62
    s_cbranch_scc0 L_g1n_12
    s_and_b32 s16, vcc_lo, 0xff
    s_cbranch_scc1 L_g1n_12
    s_mov_b32 s46, 1
    s_xor_b32 s42, s42, 0x10000
    s_add_u32 m0, s42, 0
    s_mov_b32 s16, s43
    buffer_load_dwordx4 v0, s[4:7], s16 offen offset:0 sc1 lds
    buffer_load_dwordx4 v0, s[4:7], s16 offen offset:1024 sc1 lds
    buffer_load_dwordx4 v0, s[4:7], s16 offen offset:2048 sc1 lds
    buffer_load_dwordx4 v0, s[4:7], s16 offen offset:3072 sc1 lds
    s_add_u32 s43, s43, 16384
    s_add_u32 m0, s42, 16384
    s_mov_b32 s16, s43
    buffer_load_dwordx4 v0, s[4:7], s16 offen offset:0 sc1 lds
    buffer_load_dwordx4 v0, s[4:7], s16 offen offset:1024 sc1 lds
    buffer_load_dwordx4 v0, s[4:7], s16 offen offset:2048 sc1 lds
    buffer_load_dwordx4 v0, s[4:7], s16 offen offset:3072 sc1 lds
    s_add_u32 s43, s43, 16384
    s_add_u32 m0, s42, 32768
    s_mov_b32 s16, s43
    buffer_load_dwordx4 v0, s[4:7], s16 offen offset:0 sc1 lds
    buffer_load_dwordx4 v0, s[4:7], s16 offen offset:1024 sc1 lds
    buffer_load_dwordx4 v0, s[4:7], s16 offen offset:2048 sc1 lds
    buffer_load_dwordx4 v0, s[4:7], s16 offen offset:3072 sc1 lds
    s_add_u32 s43, s43, 16384
    s_add_u32 m0, s42, 49152
    s_mov_b32 s16, s43
    buffer_load_dwordx4 v0, s[4:7], s16 offen offset:0 sc1 lds
    buffer_load_dwordx4 v0, s[4:7], s16 offen offset:1024 sc1 lds
    buffer_load_dwordx4 v0, s[4:7], s16 offen offset:2048 sc1 lds
    buffer_load_dwordx4 v0, s[4:7], s16 offen offset:3072 sc1 lds
L_g1n_12:
    s_waitcnt lgkmcnt(1)
    v_mfma_f32_32x32x16_bf16 v[32:47], v[12:15], a[184:187], v[32:47]
    s_nop 0
    ds_read_b128 v[8:11], v6 offset:49152
    s_waitcnt lgkmcnt(1)
    v_mfma_f32_32x32x16_bf16 v[32:47], v[16:19], a[188:191], v[32:47]
    s_nop 0
    ds_read_b128 v[12:15], v6 offset:50176
    s_waitcnt lgkmcnt(1)
    v_mfma_f32_32x32x16_bf16 v[32:47], v[8:11], a[192:195], v[32:47]
    s_nop 0
    ds_read_b128 v[16:19], v6 offset:51200
    s_waitcnt lgkmcnt(1)
    v_mfma_f32_32x32x16_bf16 v[32:47], v[12:15], a[196:199], v[32:47]
    s_nop 0
    ds_read_b128 v[8:11], v6 offset:52224
    s_waitcnt lgkmcnt(1)
    v_mfma_f32_32x32x16_bf16 v[32:47], v[16:19], a[200:203], v[32:47]
    s_nop 0
    ds_read_b128 v[12:15], v6 offset:53248
    s_waitcnt lgkmcnt(1)
    v_mfma_f32_32x32x16_bf16 v[32:47], v[8:11], a[204:207], v[32:47]
    s_nop 0
    ds_read_b128 v[16:19], v6 offset:54272
    s_waitcnt lgkmcnt(1)
    v_mfma_f32_32x32x16_bf16 v[32:47], v[12:15], a[208:211], v[32:47]
    s_nop 0
    ds_read_b128 v[8:11], v6 offset:55296
    s_waitcnt lgkmcnt(1)
    v_mfma_f32_32x32x16_bf16 v[32:47], v[16:19], a[212:215], v[32:47]
    s_nop 0
    ds_read_b128 v[12:15], v6 offset:56320
    s_waitcnt lgkmcnt(1)
    v_mfma_f32_32x32x16_bf16 v[32:47], v[8:11], a[216:219], v[32:47]
    s_nop 0
    ds_read_b128 v[16:19], v6 offset:57344
    s_waitcnt lgkmcnt(1)
    v_mfma_f32_32x32x16_bf16 v[32:47], v[12:15], a[220:223], v[32:47]
    s_nop 0
    ds_read_b128 v[8:11], v6 offset:58368
    s_waitcnt lgkmcnt(1)
    v_mfma_f32_32x32x16_bf16 v[32:47], v[16:19], a[224:227], v[32:47]
    s_nop 0
    ds_read_b128 v[12:15], v6 offset:59392
    s_bfe_u32 s17, s21, 0x10001
    s_lshl_b32 s16, s12, 1
    s_add_u32 s17, s17, s16
    s_lshl_b32 s17, s17, 18
    s_waitcnt lgkmcnt(1)
    v_mfma_f32_32x32x16_bf16 v[32:47], v[8:11], a[228:231], v[32:47]
    s_nop 0
    ds_read_b128 v[16:19], v6 offset:60416
    s_lshl_b32 s16, s26, 11
    s_add_u32 s17, s17, s16
    s_lshl_b32 s16, s25, 1
    s_add_u32 s17, s17, s16
    s_waitcnt lgkmcnt(1)
    v_mfma_f32_32x32x16_bf16 v[32:47], v[12:15], a[232:235], v[32:47]
    s_nop 0
    ds_read_b128 v[8:11], v6 offset:61440
    s_add_u32 s24, s17, 1048576
    s_sub_u32 s19, s30, 2
    s_max_i32 s19, s19, 0
    v_cmp_gt_u32 vcc, s19, v27
    s_waitcnt lgkmcnt(1)
    v_mfma_f32_32x32x16_bf16 v[32:47], v[16:19], a[236:239], v[32:47]
    s_nop 0
    ds_read_b128 v[12:15], v6 offset:62464
    s_waitcnt lgkmcnt(1)
    v_mfma_f32_32x32x16_bf16 v[32:47], v[8:11], a[240:243], v[32:47]
    s_nop 0
    ds_read_b128 v[16:19], v6 offset:63488
    s_waitcnt lgkmcnt(1)
    v_mfma_f32_32x32x16_bf16 v[32:47], v[12:15], a[244:247], v[32:47]
    s_nop 0
    ds_read_b128 v[8:11], v6 offset:64512
    s_waitcnt lgkmcnt(1)
    v_mfma_f32_32x32x16_bf16 v[32:47], v[16:19], a[248:251], v[32:47]
    s_waitcnt lgkmcnt(0)
    v_mfma_f32_32x32x16_bf16 v[32:47], v[8:11], a[252:255], v[32:47]
    s_and_b32 s16, vcc_lo, 0xffff
    s_cbranch_scc0 L_g1h_13
    s_mov_b64 exec, 0xffff
    s_branch L_wg_20
L_wf_18:
    s_sleep 2
L_wg_20:
    buffer_load_dword v1, v3, s[4:7], s18 offen offset:0 sc1
    s_add_u32 s40, s40, 1
    s_cmp_gt_u32 s40, 262144
    s_cbranch_scc1 L_abort
    s_waitcnt vmcnt(0)
    v_cmp_gt_u32 vcc, s19, v1
    s_cbranch_vccnz L_wf_18
L_wfo_19:
    s_mov_b64 exec, -1
L_g1h_13:
    s_add_u32 s18, s29, 45056
    s_nop 4
    s_cmp_eq_u32 s21, 63
    s_cbranch_scc0 L_g1z_10
    s_nop 1
    v_pk_add_f32 v[64:65], v[32:33], v[40:41]
    v_pk_add_f32 v[66:67], v[34:35], v[42:43]
    v_pk_add_f32 v[68:69], v[36:37], v[44:45]
    v_pk_add_f32 v[70:71], v[38:39], v[46:47]
    v_pk_add_f32 v[64:65], v[64:65], v[68:69]
    v_pk_add_f32 v[66:67], v[66:67], v[70:71]
    v_pk_add_f32 v[64:65], v[64:65], v[66:67]
    v_cmp_u_f32 vcc, v64, v65
    s_cbranch_vccz L_g1z_10
    s_add_u32 s17, s21, 0
    s_mul_i32 s48, s17, 21846
    s_lshr_b32 s48, s48, 16
    s_mul_i32 s47, s48, 3
    s_sub_u32 s47, s17, s47
    s_mul_i32 s16, s26, 24
    s_add_u32 s47, s47, s16
    s_lshl_b32 s47, s47, 7
    s_add_u32 s47, s47, 32768
    s_lshl_b32 s16, s15, 5
    s_add_u32 s48, s48, s16
    s_add_u32 s48, s48, 1
    s_add_u32 s43, s22, 0
    s_lshl_b32 s43, s43, 2
    s_add_u32 s43, s43, s26
    s_lshl_b32 s43, s43, 16
    s_add_u32 s43, s43, s23
    s_add_u32 s43, s43, 117440512
    s_mov_b64 exec, 0xff
    s_branch L_wg_23
L_wf_21:
    s_sleep 1
L_wg_23:
    buffer_load_dword v1, v2, s[4:7], s47 offen offset:0 sc1
    s_add_u32 s40, s40, 1
    s_cmp_gt_u32 s40, 262144
    s_cbranch_scc1 L_abort
    s_waitcnt vmcnt(0)
    v_cmp_gt_u32 vcc, s48, v1
    s_cbranch_vccnz L_wf_21
L_wfo_22:
    s_mov_b64 exec, -1
    s_sub_u32 s43, s43, s23
    s_and_b32 s17, s42, 0x10000
    s_mov_b32 m0, s17
    s_mov_b32 s16, 64
L_da_24:
    buffer_load_dwordx4 v0, s[4:7], s43 offen sc1 lds
    s_add_u32 s43, s43, 1024
    s_add_u32 m0, m0, 1024
    s_waitcnt vmcnt(16)
    s_sub_u32 s16, s16, 1
    s_cmp_lg_u32 s16, 0
    s_cbranch_scc1 L_da_24
    s_waitcnt vmcnt(0)
    ds_read_b128 v[8:11], v6 offset:0
    ds_read_b128 v[12:15], v6 offset:1024
    s_waitcnt lgkmcnt(1)
    v_mfma_f32_32x32x16_bf16 v[32:47], v[8:11], a[0:3], 0
    s_nop 0
    ds_read_b128 v[16:19], v6 offset:2048
    s_waitcnt lgkmcnt(1)
    v_mfma_f32_32x32x16_bf16 v[32:47], v[12:15], a[4:7], v[32:47]
    s_nop 0
    ds_read_b128 v[8:11], v6 offset:3072
    s_waitcnt lgkmcnt(1)
    v_mfma_f32_32x32x16_bf16 v[32:47], v[16:19], a[8:11], v[32:47]
    s_nop 0
    ds_read_b128 v[12:15], v6 offset:4096
    s_waitcnt lgkmcnt(1)
    v_mfma_f32_32x32x16_bf16 v[32:47], v[8:11], a[12:15], v[32:47]
    s_nop 0
    ds_read_b128 v[16:19], v6 offset:5120
    s_waitcnt lgkmcnt(1)
    v_mfma_f32_32x32x16_bf16 v[32:47], v[12:15], a[16:19], v[32:47]
    s_nop 0
    ds_read_b128 v[8:11], v6 offset:6144
    s_waitcnt lgkmcnt(1)
    v_mfma_f32_32x32x16_bf16 v[32:47], v[16:19], a[20:23], v[32:47]
    s_nop 0
    ds_read_b128 v[12:15], v6 offset:7168
    s_waitcnt lgkmcnt(1)
    v_mfma_f32_32x32x16_bf16 v[32:47], v[8:11], a[24:27], v[32:47]
    s_nop 0
    ds_read_b128 v[16:19], v6 offset:8192
    s_waitcnt lgkmcnt(1)
    v_mfma_f32_32x32x16_bf16 v[32:47], v[12:15], a[28:31], v[32:47]
    s_nop 0
    ds_read_b128 v[8:11], v6 offset:9216
    s_waitcnt lgkmcnt(1)
    v_mfma_f32_32x32x16_bf16 v[32:47], v[16:19], a[32:35], v[32:47]
    s_nop 0
    ds_read_b128 v[12:15], v6 offset:10240
    s_waitcnt lgkmcnt(1)
    v_mfma_f32_32x32x16_bf16 v[32:47], v[8:11], a[36:39], v[32:47]
    s_nop 0
    ds_read_b128 v[16:19], v6 offset:11264
    s_waitcnt lgkmcnt(1)
    v_mfma_f32_32x32x16_bf16 v[32:47], v[12:15], a[40:43], v[32:47]
    s_nop 0
    ds_read_b128 v[8:11], v6 offset:12288
    s_waitcnt lgkmcnt(1)
    v_mfma_f32_32x32x16_bf16 v[32:47], v[16:19], a[44:47], v[32:47]
    s_nop 0
    ds_read_b128 v[12:15], v6 offset:13312
    s_waitcnt lgkmcnt(1)
    v_mfma_f32_32x32x16_bf16 v[32:47], v[8:11], a[48:51], v[32:47]
    s_nop 0
    ds_read_b128 v[16:19], v6 offset:14336
    s_waitcnt lgkmcnt(1)
    v_mfma_f32_32x32x16_bf16 v[32:47], v[12:15], a[52:55], v[32:47]
    s_nop 0
    ds_read_b128 v[8:11], v6 offset:15360
    s_waitcnt lgkmcnt(1)
    v_mfma_f32_32x32x16_bf16 v[32:47], v[16:19], a[56:59], v[32:47]
    s_nop 0
    ds_read_b128 v[12:15], v6 offset:16384
    s_waitcnt lgkmcnt(1)
    v_mfma_f32_32x32x16_bf16 v[32:47], v[8:11], a[60:63], v[32:47]
    s_nop 0
    ds_read_b128 v[16:19], v6 offset:17408
    s_waitcnt lgkmcnt(1)
    v_mfma_f32_32x32x16_bf16 v[32:47], v[12:15], a[64:67], v[32:47]
    s_nop 0
    ds_read_b128 v[8:11], v6 offset:18432
    s_waitcnt lgkmcnt(1)
    v_mfma_f32_32x32x16_bf16 v[32:47], v[16:19], a[68:71], v[32:47]
    s_nop 0
    ds_read_b128 v[12:15], v6 offset:19456
    s_waitcnt lgkmcnt(1)
    v_mfma_f32_32x32x16_bf16 v[32:47], v[8:11], a[72:75], v[32:47]
    s_nop 0
    ds_read_b128 v[16:19], v6 offset:20480
    s_waitcnt lgkmcnt(1)
    v_mfma_f32_32x32x16_bf16 v[32:47], v[12:15], a[76:79], v[32:47]
    s_nop 0
    ds_read_b128 v[8:11], v6 offset:21504
    s_waitcnt lgkmcnt(1)
    v_mfma_f32_32x32x16_bf16 v[32:47], v[16:19], a[80:83], v[32:47]
    s_nop 0
    ds_read_b128 v[12:15], v6 offset:22528
    s_waitcnt lgkmcnt(1)
    v_mfma_f32_32x32x16_bf16 v[32:47], v[8:11], a[84:87], v[32:47]
    s_nop 0
    ds_read_b128 v[16:19], v6 offset:23552
    s_waitcnt lgkmcnt(1)
    v_mfma_f32_32x32x16_bf16 v[32:47], v[12:15], a[88:91], v[32:47]
    s_nop 0
    ds_read_b128 v[8:11], v6 offset:24576
    s_waitcnt lgkmcnt(1)
    v_mfma_f32_32x32x16_bf16 v[32:47], v[16:19], a[92:95], v[32:47]
    s_nop 0
    ds_read_b128 v[12:15], v6 offset:25600
    s_waitcnt lgkmcnt(1)
    v_mfma_f32_32x32x16_bf16 v[32:47], v[8:11], a[96:99], v[32:47]
    s_nop 0
    ds_read_b128 v[16:19], v6 offset:26624
    s_waitcnt lgkmcnt(1)
    v_mfma_f32_32x32x16_bf16 v[32:47], v[12:15], a[100:103], v[32:47]
    s_nop 0
    ds_read_b128 v[8:11], v6 offset:27648
    s_waitcnt lgkmcnt(1)
    v_mfma_f32_32x32x16_bf16 v[32:47], v[16:19], a[104:107], v[32:47]
    s_nop 0
    ds_read_b128 v[12:15], v6 offset:28672
    s_waitcnt lgkmcnt(1)
    v_mfma_f32_32x32x16_bf16 v[32:47], v[8:11], a[108:111], v[32:47]
    s_nop 0
    ds_read_b128 v[16:19], v6 offset:29696
    s_waitcnt lgkmcnt(1)
    v_mfma_f32_32x32x16_bf16 v[32:47], v[12:15], a[112:115], v[32:47]
    s_nop 0
    ds_read_b128 v[8:11], v6 offset:30720
    s_waitcnt lgkmcnt(1)
    v_mfma_f32_32x32x16_bf16 v[32:47], v[16:19], a[116:119], v[32:47]
    s_nop 0
    ds_read_b128 v[12:15], v6 offset:31744
    s_waitcnt lgkmcnt(1)
    v_mfma_f32_32x32x16_bf16 v[32:47], v[8:11], a[120:123], v[32:47]
    s_nop 0
    ds_read_b128 v[16:19], v6 offset:32768
    s_waitcnt lgkmcnt(1)
    v_mfma_f32_32x32x16_bf16 v[32:47], v[12:15], a[124:127], v[32:47]
    s_nop 0
    ds_read_b128 v[8:11], v6 offset:33792
    s_waitcnt lgkmcnt(1)
    v_mfma_f32_32x32x16_bf16 v[32:47], v[16:19], a[128:131], v[32:47]
    s_nop 0
    ds_read_b128 v[12:15], v6 offset:34816
    s_waitcnt lgkmcnt(1)
    v_mfma_f32_32x32x16_bf16 v[32:47], v[8:11], a[132:135], v[32:47]
    s_nop 0
    ds_read_b128 v[16:19], v6 offset:35840
    s_waitcnt lgkmcnt(1)
    v_mfma_f32_32x32x16_bf16 v[32:47], v[12:15], a[136:139], v[32:47]
    s_nop 0
    ds_read_b128 v[8:11], v6 offset:36864
    s_waitcnt lgkmcnt(1)
    v_mfma_f32_32x32x16_bf16 v[32:47], v[16:19], a[140:143], v[32:47]
    s_nop 0
    ds_read_b128 v[12:15], v6 offset:37888
    s_waitcnt lgkmcnt(1)
    v_mfma_f32_32x32x16_bf16 v[32:47], v[8:11], a[144:147], v[32:47]
    s_nop 0
    ds_read_b128 v[16:19], v6 offset:38912
    s_waitcnt lgkmcnt(1)
    v_mfma_f32_32x32x16_bf16 v[32:47], v[12:15], a[148:151], v[32:47]
    s_nop 0
    ds_read_b128 v[8:11], v6 offset:39936
    s_waitcnt lgkmcnt(1)
    v_mfma_f32_32x32x16_bf16 v[32:47], v[16:19], a[152:155], v[32:47]
    s_nop 0
    ds_read_b128 v[12:15], v6 offset:40960
    s_waitcnt lgkmcnt(1)
    v_mfma_f32_32x32x16_bf16 v[32:47], v[8:11], a[156:159], v[32:47]
    s_nop 0
    ds_read_b128 v[16:19], v6 offset:41984
    s_waitcnt lgkmcnt(1)
    v_mfma_f32_32x32x16_bf16 v[32:47], v[12:15], a[160:163], v[32:47]
    s_nop 0
    ds_read_b128 v[8:11], v6 offset:43008
    s_waitcnt lgkmcnt(1)
    v_mfma_f32_32x32x16_bf16 v[32:47], v[16:19], a[164:167], v[32:47]
    s_nop 0
    ds_read_b128 v[12:15], v6 offset:44032
    s_waitcnt lgkmcnt(1)
    v_mfma_f32_32x32x16_bf16 v[32:47], v[8:11], a[168:171], v[32:47]
    s_nop 0
    ds_read_b128 v[16:19], v6 offset:45056
    s_waitcnt lgkmcnt(1)
    v_mfma_f32_32x32x16_bf16 v[32:47], v[12:15], a[172:175], v[32:47]
    s_nop 0
    ds_read_b128 v[8:11], v6 offset:46080
    s_waitcnt lgkmcnt(1)
    v_mfma_f32_32x32x16_bf16 v[32:47], v[16:19], a[176:179], v[32:47]
    s_nop 0
    ds_read_b128 v[12:15], v6 offset:47104
    s_waitcnt lgkmcnt(1)
    v_mfma_f32_32x32x16_bf16 v[32:47], v[8:11], a[180:183], v[32:47]
    s_nop 0
    ds_read_b128 v[16:19], v6 offset:48128
    s_waitcnt lgkmcnt(1)
    v_mfma_f32_32x32x16_bf16 v[32:47], v[12:15], a[184:187], v[32:47]
    s_nop 0
    ds_read_b128 v[8:11], v6 offset:49152
    s_waitcnt lgkmcnt(1)
    v_mfma_f32_32x32x16_bf16 v[32:47], v[16:19], a[188:191], v[32:47]
    s_nop 0
    ds_read_b128 v[12:15], v6 offset:50176
    s_waitcnt lgkmcnt(1)
    v_mfma_f32_32x32x16_bf16 v[32:47], v[8:11], a[192:195], v[32:47]
    s_nop 0
    ds_read_b128 v[16:19], v6 offset:51200
    s_waitcnt lgkmcnt(1)
    v_mfma_f32_32x32x16_bf16 v[32:47], v[12:15], a[196:199], v[32:47]
    s_nop 0
    ds_read_b128 v[8:11], v6 offset:52224
    s_waitcnt lgkmcnt(1)
    v_mfma_f32_32x32x16_bf16 v[32:47], v[16:19], a[200:203], v[32:47]
    s_nop 0
    ds_read_b128 v[12:15], v6 offset:53248
    s_waitcnt lgkmcnt(1)
    v_mfma_f32_32x32x16_bf16 v[32:47], v[8:11], a[204:207], v[32:47]
    s_nop 0
    ds_read_b128 v[16:19], v6 offset:54272
    s_waitcnt lgkmcnt(1)
    v_mfma_f32_32x32x16_bf16 v[32:47], v[12:15], a[208:211], v[32:47]
    s_nop 0
    ds_read_b128 v[8:11], v6 offset:55296
    s_waitcnt lgkmcnt(1)
    v_mfma_f32_32x32x16_bf16 v[32:47], v[16:19], a[212:215], v[32:47]
    s_nop 0
    ds_read_b128 v[12:15], v6 offset:56320
    s_waitcnt lgkmcnt(1)
    v_mfma_f32_32x32x16_bf16 v[32:47], v[8:11], a[216:219], v[32:47]
    s_nop 0
    ds_read_b128 v[16:19], v6 offset:57344
    s_waitcnt lgkmcnt(1)
    v_mfma_f32_32x32x16_bf16 v[32:47], v[12:15], a[220:223], v[32:47]
    s_nop 0
    ds_read_b128 v[8:11], v6 offset:58368
    s_waitcnt lgkmcnt(1)
    v_mfma_f32_32x32x16_bf16 v[32:47], v[16:19], a[224:227], v[32:47]
    s_nop 0
    ds_read_b128 v[12:15], v6 offset:59392
    s_waitcnt lgkmcnt(1)
    v_mfma_f32_32x32x16_bf16 v[32:47], v[8:11], a[228:231], v[32:47]
    s_nop 0
    ds_read_b128 v[16:19], v6 offset:60416
    s_waitcnt lgkmcnt(1)
    v_mfma_f32_32x32x16_bf16 v[32:47], v[12:15], a[232:235], v[32:47]
    s_nop 0
    ds_read_b128 v[8:11], v6 offset:61440
    s_waitcnt lgkmcnt(1)
    v_mfma_f32_32x32x16_bf16 v[32:47], v[16:19], a[236:239], v[32:47]
    s_nop 0
    ds_read_b128 v[12:15], v6 offset:62464
    s_waitcnt lgkmcnt(1)
    v_mfma_f32_32x32x16_bf16 v[32:47], v[8:11], a[240:243], v[32:47]
    s_nop 0
    ds_read_b128 v[16:19], v6 offset:63488
    s_waitcnt lgkmcnt(1)
    v_mfma_f32_32x32x16_bf16 v[32:47], v[12:15], a[244:247], v[32:47]
    s_nop 0
    ds_read_b128 v[8:11], v6 offset:64512
    s_waitcnt lgkmcnt(1)
    v_mfma_f32_32x32x16_bf16 v[32:47], v[16:19], a[248:251], v[32:47]
    s_waitcnt lgkmcnt(0)
    v_mfma_f32_32x32x16_bf16 v[32:47], v[8:11], a[252:255], v[32:47]
    s_nop 9
L_g1z_10:
    s_cmp_lg_u32 s60, 0
    s_cbranch_scc1 L_du_25
    s_add_u32 s16, s24, 0
    buffer_store_dword v32, v4, s[4:7], s16 offen
    s_add_u32 s16, s24, 8192
    buffer_store_dword v33, v4, s[4:7], s16 offen
    s_add_u32 s16, s24, 16384
    buffer_store_dword v34, v4, s[4:7], s16 offen
    s_add_u32 s16, s24, 24576
    buffer_store_dword v35, v4, s[4:7], s16 offen
    s_add_u32 s16, s24, 65536
    buffer_store_dword v36, v4, s[4:7], s16 offen
    s_add_u32 s16, s24, 73728
    buffer_store_dword v37, v4, s[4:7], s16 offen
    s_add_u32 s16, s24, 81920
    buffer_store_dword v38, v4, s[4:7], s16 offen
    s_add_u32 s16, s24, 90112
    buffer_store_dword v39, v4, s[4:7], s16 offen
    s_add_u32 s16, s24, 131072
    buffer_store_dword v40, v4, s[4:7], s16 offen
    s_add_u32 s16, s24, 139264
    buffer_store_dword v41, v4, s[4:7], s16 offen
    s_add_u32 s16, s24, 147456
    buffer_store_dword v42, v4, s[4:7], s16 offen
    s_add_u32 s16, s24, 155648
    buffer_store_dword v43, v4, s[4:7], s16 offen
    s_add_u32 s16, s24, 196608
    buffer_store_dword v44, v4, s[4:7], s16 offen
    s_add_u32 s16, s24, 204800
    buffer_store_dword v45, v4, s[4:7], s16 offen
    s_add_u32 s16, s24, 212992
    buffer_store_dword v46, v4, s[4:7], s16 offen
    s_add_u32 s16, s24, 221184
    buffer_store_dword v47, v4, s[4:7], s16 offen
    s_branch L_dv_26
L_du_25:
    s_add_u32 s16, s24, 0
    buffer_store_dword v32, v4, s[4:7], s16 offen sc1
    s_add_u32 s16, s24, 8192
    buffer_store_dword v33, v4, s[4:7], s16 offen sc1
    s_add_u32 s16, s24, 16384
    buffer_store_dword v34, v4, s[4:7], s16 offen sc1
    s_add_u32 s16, s24, 24576
    buffer_store_dword v35, v4, s[4:7], s16 offen sc1
    s_add_u32 s16, s24, 65536
    buffer_store_dword v36, v4, s[4:7], s16 offen sc1
    s_add_u32 s16, s24, 73728
    buffer_store_dword v37, v4, s[4:7], s16 offen sc1
    s_add_u32 s16, s24, 81920
    buffer_store_dword v38, v4, s[4:7], s16 offen sc1
    s_add_u32 s16, s24, 90112
    buffer_store_dword v39, v4, s[4:7], s16 offen sc1
    s_add_u32 s16, s24, 131072
    buffer_store_dword v40, v4, s[4:7], s16 offen sc1
    s_add_u32 s16, s24, 139264
    buffer_store_dword v41, v4, s[4:7], s16 offen sc1
    s_add_u32 s16, s24, 147456
    buffer_store_dword v42, v4, s[4:7], s16 offen sc1
    s_add_u32 s16, s24, 155648
    buffer_store_dword v43, v4, s[4:7], s16 offen sc1
    s_add_u32 s16, s24, 196608
    buffer_store_dword v44, v4, s[4:7], s16 offen sc1
    s_add_u32 s16, s24, 204800
    buffer_store_dword v45, v4, s[4:7], s16 offen sc1
    s_add_u32 s16, s24, 212992
    buffer_store_dword v46, v4, s[4:7], s16 offen sc1
    s_add_u32 s16, s24, 221184
    buffer_store_dword v47, v4, s[4:7], s16 offen sc1
L_dv_26:
    s_waitcnt vmcnt(0)
    s_barrier
    s_cmp_eq_u32 s13, 3
    s_cbranch_scc0 L_pub_27
    v_mov_b32 v1, s30
    s_mov_b64 exec, 1
    s_cmp_lg_u32 s60, 0
    s_cbranch_scc1 L_du_28
    buffer_store_dword v1, off, s[4:7], s18
    s_branch L_dv_29
L_du_28:
    buffer_store_dword v1, off, s[4:7], s18 sc1
L_dv_29:
    s_mov_b64 exec, -1
L_pub_27:
    s_add_u32 s21, s21, 2
    s_cmp_lt_u32 s21, 64
    s_cbranch_scc1 L_g1a_7
    s_lshl_b32 s21, s26, 1
    s_add_u32 s21, s21, s12
    s_lshl_b32 s41, 8, s15
    s_cmp_eq_u32 s15, 0
    s_cselect_b32 s49, 64, 48
    s_cbranch_scc0 L_g3
    s_lshl_b32 s17, s21, 15
    s_add_u32 s17, s17, s25
    s_add_u32 s17, s17, 171966464
    s_mov_b32 exec_hi, 0
    buffer_load_dword v80, v5, s[4:7], s17 offen sc1
    s_add_u32 s17, s17, 262144
    buffer_load_dword v80, v5, s[4:7], s17 offen sc1
    s_add_u32 s17, s17, 262144
    buffer_load_dword v80, v5, s[4:7], s17 offen sc1
    s_add_u32 s17, s17, 262144
    buffer_load_dword v80, v5, s[4:7], s17 offen sc1
    s_add_u32 s17, s17, 262144
    buffer_load_dword v80, v5, s[4:7], s17 offen sc1
    s_add_u32 s17, s17, 262144
    buffer_load_dword v80, v5, s[4:7], s17 offen sc1
    s_add_u32 s17, s17, 262144
    buffer_load_dword v80, v5, s[4:7], s17 offen sc1
    s_add_u32 s17, s17, 262144
    buffer_load_dword v80, v5, s[4:7], s17 offen sc1
    s_add_u32 s17, s17, 262144
    s_mov_b32 exec_hi, -1
L_g3:
    s_lshl_b32 s42, s13, 11
    v_mov_b32 v6, v0
    s_mov_b32 s46, 0
    s_mov_b32 s45, 1
    s_lshl_b32 s47, s12, 2
    s_add_u32 s47, s47, s26
    s_lshl_b32 s47, s47, 12
    s_add_u32 s47, s47, 65536
    s_cmp_eq_u32 s13, 0
    s_cbranch_scc0 L_wfo_39
    s_mov_b32 exec_hi, 0
    s_branch L_wg_40
L_wf_38:
    s_sleep 1
L_wg_40:
    buffer_load_dword v1, v3, s[4:7], s47 offen offset:0 sc1
    s_add_u32 s40, s40, 1
    s_cmp_gt_u32 s40, 262144
    s_cbranch_scc1 L_abort
    s_waitcnt vmcnt(0)
    v_cmp_eq_u32 vcc, 0, v1
    s_cbranch_vccnz L_wf_38
L_wfo_39:
    s_mov_b64 exec, -1
    s_barrier
L_g3b_30:
    s_cmp_lg_u32 s46, 0
    s_cbranch_scc1 L_g3e_33
    s_lshl_b32 s18, s15, 6
    s_add_u32 s18, s18, s21
    s_lshl_b32 s18, s18, 15
    s_lshl_b32 s17, s13, 11
    s_add_u32 s24, s18, s17
    s_add_u32 s24, s24, 167772160
    s_add_u32 s28, s18, s25
    s_add_u32 s28, s28, 8388608
    s_cmp_lg_u32 s45, 0
    s_cbranch_scc1 L_g3c_31
    s_lshl_b32 s47, s12, 2
    s_add_u32 s47, s47, s26
    s_lshl_b32 s47, s47, 12
    s_add_u32 s47, s47, 65536
    s_lshr_b32 s48, s21, 3
    s_min_u32 s48, s48, 2
    s_lshl_b32 s16, s15, 2
    s_add_u32 s16, s16, s21
    s_cmp_ge_u32 s16, 56
    s_addc_u32 s48, s48, 2
    s_lshl_b32 s16, s15, 3
    s_add_u32 s48, s48, s16
    s_lshl_b32 s16, s21, 12
    s_add_u32 s16, s16, 4294852608
    s_cmp_eq_u32 s48, 13
    s_cselect_b32 s47, s16, s47
    s_mov_b32 exec_hi, 0
L_wf_41:
    buffer_load_dword v26, v3, s[4:7], s47 offen offset:0 sc1
    s_add_u32 s40, s40, 1
    s_cmp_gt_u32 s40, 262144
    s_cbranch_scc1 L_abort
    s_waitcnt vmcnt(0)
    v_cmp_gt_u32 vcc, s48, v26
    s_cbranch_vccnz L_wf_41
L_wfo_42:
    s_mov_b64 exec, -1
    s_branch L_g3d_32
L_g3c_31:
    v_and_b32 v26, 16, v0
    v_lshlrev_b32 v26, 6, v26
    v_bfe_u32 v1, v0, 5, 2
    v_lshl_add_u32 v26, v1, 13, v26
    s_mov_b64 exec, 0xff
L_pr_44:
    buffer_load_dword v1, v26, s[4:7], s24 offen offset:1020 sc1
    s_add_u32 s40, s40, 1
    s_cmp_gt_u32 s40, 262144
    s_cbranch_scc1 L_abort
    s_waitcnt vmcnt(0)
    v_cmp_eq_u32 vcc, -1, v1
    s_cbranch_vccnz L_pr_44
    s_mov_b64 exec, -1
    v_mov_b32 v26, 0
L_g3d_32:
    s_xor_b32 s42, s42, 0x8000
    s_add_u32 m0, s42, 0
    s_mov_b32 s16, s24
    buffer_load_dwordx4 v0, s[4:7], s16 offen offset:0 sc1 lds
    buffer_load_dwordx4 v0, s[4:7], s16 offen offset:1024 sc1 lds
    s_add_u32 s24, s24, 8192
    s_add_u32 m0, s42, 8192
    s_mov_b32 s16, s24
    buffer_load_dwordx4 v0, s[4:7], s16 offen offset:0 sc1 lds
    buffer_load_dwordx4 v0, s[4:7], s16 offen offset:1024 sc1 lds
    s_add_u32 s24, s24, 8192
    s_add_u32 m0, s42, 16384
    s_mov_b32 s16, s24
    buffer_load_dwordx4 v0, s[4:7], s16 offen offset:0 sc1 lds
    buffer_load_dwordx4 v0, s[4:7], s16 offen offset:1024 sc1 lds
    s_add_u32 s24, s24, 8192
    s_add_u32 m0, s42, 24576
    s_mov_b32 s16, s24
    buffer_load_dwordx4 v0, s[4:7], s16 offen offset:0 sc1 lds
    buffer_load_dwordx4 v0, s[4:7], s16 offen offset:1024 sc1 lds
    s_add_u32 s24, s24, 8192
    buffer_load_dwordx4 v[56:59], v5, s[4:7], s28 offen offset:0 sc1
    buffer_load_dwordx4 v[60:63], v5, s[4:7], s28 offen offset:16 sc1
L_g3e_33:
    s_lshl_b32 s22, s15, 6
    s_add_u32 s22, s22, s21
    s_lshr_b32 s30, s22, 3
    s_add_u32 s30, s30, 1
    v_xor_b32 v6, 0x8000, v6
    s_add_u32 s43, s21, s41
    s_mov_b32 s46, 0
    s_lshl_b32 s47, s12, 2
    s_add_u32 s47, s47, s26
    s_lshl_b32 s47, s47, 12
    s_add_u32 s47, s47, 65536
    s_lshr_b32 s48, s43, 3
    s_min_u32 s48, s48, 2
    s_lshl_b32 s16, s15, 2
    s_add_u32 s16, s16, s43
    s_cmp_ge_u32 s16, 56
    s_addc_u32 s48, s48, 2
    s_lshl_b32 s16, s15, 3
    s_add_u32 s48, s48, s16
    s_lshl_b32 s16, s43, 12
    s_add_u32 s16, s16, 4294852608
    s_cmp_eq_u32 s48, 13
    s_cselect_b32 s47, s16, s47
    s_waitcnt vmcnt(8)
    s_barrier
    ds_read_b128 v[8:11], v6 offset:0
    ds_read_b128 v[12:15], v6 offset:1024
    s_waitcnt lgkmcnt(1)
    v_mfma_f32_32x32x16_bf16 v[32:47], v[128:131], v[8:11], 0
    s_nop 0
    ds_read_b128 v[16:19], v6 offset:2048
    s_waitcnt lgkmcnt(1)
    v_mfma_f32_32x32x16_bf16 v[32:47], v[132:135], v[12:15], v[32:47]
    s_nop 0
    ds_read_b128 v[8:11], v6 offset:3072
    s_waitcnt lgkmcnt(1)
    v_mfma_f32_32x32x16_bf16 v[32:47], v[136:139], v[16:19], v[32:47]
    s_nop 0
    ds_read_b128 v[12:15], v6 offset:4096
    s_waitcnt lgkmcnt(1)
    v_mfma_f32_32x32x16_bf16 v[32:47], v[140:143], v[8:11], v[32:47]
    s_nop 0
    ds_read_b128 v[16:19], v6 offset:5120
    s_waitcnt lgkmcnt(1)
    v_mfma_f32_32x32x16_bf16 v[32:47], v[144:147], v[12:15], v[32:47]
    s_nop 0
    ds_read_b128 v[8:11], v6 offset:6144
    s_waitcnt lgkmcnt(1)
    v_mfma_f32_32x32x16_bf16 v[32:47], v[148:151], v[16:19], v[32:47]
    s_nop 0
    ds_read_b128 v[12:15], v6 offset:7168
    s_waitcnt vmcnt(6)
    s_barrier
    s_waitcnt lgkmcnt(1)
    v_mfma_f32_32x32x16_bf16 v[32:47], v[152:155], v[8:11], v[32:47]
    s_nop 0
    ds_read_b128 v[16:19], v6 offset:8192
    v_cmp_gt_u32 vcc, s48, v26
    s_cmp_lt_u32 s43, s49
    s_cbranch_scc0 L_g3r_46
    s_lshl_b32 s18, s15, 6
    s_add_u32 s18, s18, s43
    s_lshl_b32 s18, s18, 15
    s_lshl_b32 s17, s13, 11
    s_add_u32 s24, s18, s17
    s_add_u32 s24, s24, 167772160
    s_add_u32 s28, s18, s25
    s_add_u32 s28, s28, 8388608
    s_cmp_eq_u32 vcc_lo, 0
    s_cbranch_scc0 L_g3q_45
    s_mov_b32 s46, 1
    s_waitcnt vmcnt(0)
    s_xor_b32 s42, s42, 0x8000
    s_add_u32 m0, s42, 0
    s_mov_b32 s16, s24
    buffer_load_dwordx4 v0, s[4:7], s16 offen offset:0 sc1 lds
    buffer_load_dwordx4 v0, s[4:7], s16 offen offset:1024 sc1 lds
    s_add_u32 s24, s24, 8192
    s_add_u32 m0, s42, 8192
    s_mov_b32 s16, s24
    buffer_load_dwordx4 v0, s[4:7], s16 offen offset:0 sc1 lds
    buffer_load_dwordx4 v0, s[4:7], s16 offen offset:1024 sc1 lds
    s_add_u32 s24, s24, 8192
    s_add_u32 m0, s42, 16384
    s_mov_b32 s16, s24
    buffer_load_dwordx4 v0, s[4:7], s16 offen offset:0 sc1 lds
    buffer_load_dwordx4 v0, s[4:7], s16 offen offset:1024 sc1 lds
    s_add_u32 s24, s24, 8192
    s_add_u32 m0, s42, 24576
    s_mov_b32 s16, s24
    buffer_load_dwordx4 v0, s[4:7], s16 offen offset:0 sc1 lds
    buffer_load_dwordx4 v0, s[4:7], s16 offen offset:1024 sc1 lds
    s_add_u32 s24, s24, 8192
    s_branch L_g3r_46
L_g3q_45:
    s_mov_b32 exec_hi, 0
    buffer_load_dword v26, v3, s[4:7], s47 offen sc1
    s_mov_b32 exec_hi, -1
L_g3r_46:
    s_waitcnt lgkmcnt(1)
    v_mfma_f32_32x32x16_bf16 v[32:47], v[156:159], v[12:15], v[32:47]
    s_nop 0
    ds_read_b128 v[8:11], v6 offset:9216
    s_waitcnt lgkmcnt(1)
    v_mfma_f32_32x32x16_bf16 v[32:47], v[160:163], v[16:19], v[32:47]
    s_nop 0
    ds_read_b128 v[12:15], v6 offset:10240
    s_waitcnt lgkmcnt(1)
    v_mfma_f32_32x32x16_bf16 v[32:47], v[164:167], v[8:11], v[32:47]
    s_nop 0
    ds_read_b128 v[16:19], v6 offset:11264
    s_waitcnt lgkmcnt(1)
    v_mfma_f32_32x32x16_bf16 v[32:47], v[168:171], v[12:15], v[32:47]
    s_nop 0
    ds_read_b128 v[8:11], v6 offset:12288
    s_waitcnt lgkmcnt(1)
    v_mfma_f32_32x32x16_bf16 v[32:47], v[172:175], v[16:19], v[32:47]
    s_nop 0
    ds_read_b128 v[12:15], v6 offset:13312
    s_waitcnt lgkmcnt(1)
    v_mfma_f32_32x32x16_bf16 v[32:47], v[176:179], v[8:11], v[32:47]
    s_nop 0
    ds_read_b128 v[16:19], v6 offset:14336
    s_waitcnt lgkmcnt(1)
    v_mfma_f32_32x32x16_bf16 v[32:47], v[180:183], v[12:15], v[32:47]
    s_nop 0
    ds_read_b128 v[8:11], v6 offset:15360
    s_cmp_lg_u32 s46, 0
    s_cbranch_scc1 L_g3w_48
    s_waitcnt vmcnt(4)
L_g3w_48:
    s_barrier
    s_waitcnt lgkmcnt(1)
    v_mfma_f32_32x32x16_bf16 v[32:47], v[184:187], v[16:19], v[32:47]
    s_nop 0
    ds_read_b128 v[12:15], v6 offset:16384
    s_waitcnt lgkmcnt(1)
    v_mfma_f32_32x32x16_bf16 v[32:47], v[188:191], v[8:11], v[32:47]
    s_nop 0
    ds_read_b128 v[16:19], v6 offset:17408
    s_waitcnt lgkmcnt(1)
    v_mfma_f32_32x32x16_bf16 v[32:47], v[192:195], v[12:15], v[32:47]
    s_nop 0
    ds_read_b128 v[8:11], v6 offset:18432
    s_waitcnt lgkmcnt(1)
    v_mfma_f32_32x32x16_bf16 v[32:47], v[196:199], v[16:19], v[32:47]
    s_nop 0
    ds_read_b128 v[12:15], v6 offset:19456
    s_waitcnt lgkmcnt(1)
    v_mfma_f32_32x32x16_bf16 v[32:47], v[200:203], v[8:11], v[32:47]
    s_nop 0
    ds_read_b128 v[16:19], v6 offset:20480
    s_waitcnt lgkmcnt(1)
    v_mfma_f32_32x32x16_bf16 v[32:47], v[204:207], v[12:15], v[32:47]
    s_nop 0
    ds_read_b128 v[8:11], v6 offset:21504
    s_waitcnt lgkmcnt(1)
    v_mfma_f32_32x32x16_bf16 v[32:47], v[208:211], v[16:19], v[32:47]
    s_nop 0
    ds_read_b128 v[12:15], v6 offset:22528
    s_waitcnt lgkmcnt(1)
    v_mfma_f32_32x32x16_bf16 v[32:47], v[212:215], v[8:11], v[32:47]
    s_nop 0
    ds_read_b128 v[16:19], v6 offset:23552
    s_cmp_lg_u32 s46, 0
    s_cbranch_scc1 L_g3w_49
    s_waitcnt vmcnt(2)
L_g3w_49:
    s_barrier
    s_waitcnt lgkmcnt(1)
    v_mfma_f32_32x32x16_bf16 v[32:47], v[216:219], v[12:15], v[32:47]
    s_nop 0
    ds_read_b128 v[8:11], v6 offset:24576
    s_cmp_lg_u32 s46, 0
    s_cbranch_scc1 L_g3w_50
    s_waitcnt vmcnt(0)
L_g3w_50:
    v_lshlrev_b32 v64, 16, v56
    v_and_b32 v65, 0xffff0000, v56
    v_lshlrev_b32 v66, 16, v57
    v_and_b32 v67, 0xffff0000, v57
    v_lshlrev_b32 v68, 16, v58
    v_and_b32 v69, 0xffff0000, v58
    v_lshlrev_b32 v70, 16, v59
    v_and_b32 v71, 0xffff0000, v59
    s_waitcnt lgkmcnt(1)
    v_mfma_f32_32x32x16_bf16 v[32:47], v[220:223], v[16:19], v[32:47]
    s_nop 0
    ds_read_b128 v[12:15], v6 offset:25600
    s_waitcnt lgkmcnt(1)
    v_mfma_f32_32x32x16_bf16 v[32:47], v[224:227], v[8:11], v[32:47]
    s_nop 0
    ds_read_b128 v[16:19], v6 offset:26624
    v_lshlrev_b32 v72, 16, v60
    v_and_b32 v73, 0xffff0000, v60
    v_lshlrev_b32 v74, 16, v61
    v_and_b32 v75, 0xffff0000, v61
    v_lshlrev_b32 v76, 16, v62
    v_and_b32 v77, 0xffff0000, v62
    v_lshlrev_b32 v78, 16, v63
    v_and_b32 v79, 0xffff0000, v63
    s_waitcnt lgkmcnt(1)
    v_mfma_f32_32x32x16_bf16 v[32:47], v[228:231], v[12:15], v[32:47]
    s_nop 0
    ds_read_b128 v[8:11], v6 offset:27648
    s_waitcnt lgkmcnt(1)
    v_mfma_f32_32x32x16_bf16 v[32:47], v[232:235], v[16:19], v[32:47]
    s_nop 0
    ds_read_b128 v[12:15], v6 offset:28672
    s_cmp_lg_u32 s46, 0
    s_cbranch_scc1 L_g3s_47
    s_cmp_lt_u32 s43, s49
    s_cbranch_scc0 L_g3np_34
    s_cmp_lt_u32 s22, 8
    s_cbranch_scc1 L_g3np_34
    s_waitcnt vmcnt(0)
    v_cmp_gt_u32 vcc, s48, v26
    s_cmp_eq_u32 vcc_lo, 0
    s_cbranch_scc0 L_g3np_34
    s_mov_b32 s46, 1
    s_xor_b32 s42, s42, 0x8000
    s_add_u32 m0, s42, 0
    s_mov_b32 s16, s24
    buffer_load_dwordx4 v0, s[4:7], s16 offen offset:0 sc1 lds
    buffer_load_dwordx4 v0, s[4:7], s16 offen offset:1024 sc1 lds
    s_add_u32 s24, s24, 8192
    s_add_u32 m0, s42, 8192
    s_mov_b32 s16, s24
    buffer_load_dwordx4 v0, s[4:7], s16 offen offset:0 sc1 lds
    buffer_load_dwordx4 v0, s[4:7], s16 offen offset:1024 sc1 lds
    s_add_u32 s24, s24, 8192
    s_add_u32 m0, s42, 16384
    s_mov_b32 s16, s24
    buffer_load_dwordx4 v0, s[4:7], s16 offen offset:0 sc1 lds
    buffer_load_dwordx4 v0, s[4:7], s16 offen offset:1024 sc1 lds
    s_add_u32 s24, s24, 8192
    s_add_u32 m0, s42, 24576
    s_mov_b32 s16, s24
    buffer_load_dwordx4 v0, s[4:7], s16 offen offset:0 sc1 lds
    buffer_load_dwordx4 v0, s[4:7], s16 offen offset:1024 sc1 lds
    s_add_u32 s24, s24, 8192
L_g3s_47:
    buffer_load_dwordx4 v[56:59], v5, s[4:7], s28 offen offset:0 sc1
    buffer_load_dwordx4 v[60:63], v5, s[4:7], s28 offen offset:16 sc1
L_g3np_34:
    s_waitcnt lgkmcnt(1)
    v_mfma_f32_32x32x16_bf16 v[32:47], v[236:239], v[8:11], v[32:47]
    s_nop 0
    ds_read_b128 v[16:19], v6 offset:29696
    s_waitcnt lgkmcnt(1)
    v_mfma_f32_32x32x16_bf16 v[32:47], v[240:243], v[12:15], v[32:47]
    s_nop 0
    ds_read_b128 v[8:11], v6 offset:30720
    s_waitcnt lgkmcnt(1)
    v_mfma_f32_32x32x16_bf16 v[32:47], v[244:247], v[16:19], v[32:47]
    s_nop 0
    ds_read_b128 v[12:15], v6 offset:31744
    s_waitcnt lgkmcnt(1)
    v_mfma_f32_32x32x16_bf16 v[32:47], v[248:251], v[8:11], v[32:47]
    s_waitcnt lgkmcnt(0)
    v_mfma_f32_32x32x16_bf16 v[32:47], v[252:255], v[12:15], v[32:47]
    s_cmp_lg_u32 s45, 0
    s_cbranch_scc0 L_g3v_37
    s_mov_b32 s45, 0
    s_nop 8
    v_cmp_u_f32 vcc, v32, v32
    s_cbranch_vccz L_g3v_37
    s_lshl_b32 s47, s12, 2
    s_add_u32 s47, s47, s26
    s_lshl_b32 s47, s47, 12
    s_add_u32 s47, s47, 65536
    s_lshr_b32 s48, s21, 3
    s_min_u32 s48, s48, 2
    s_lshl_b32 s16, s15, 2
    s_add_u32 s16, s16, s21
    s_cmp_ge_u32 s16, 56
    s_addc_u32 s48, s48, 2
    s_lshl_b32 s16, s15, 3
    s_add_u32 s48, s48, s16
    s_lshl_b32 s16, s21, 12
    s_add_u32 s16, s16, 4294852608
    s_cmp_eq_u32 s48, 13
    s_cselect_b32 s47, s16, s47
    s_mov_b32 exec_hi, 0
    s_branch L_wg_53
L_wf_51:
    s_sleep 1
L_wg_53:
    buffer_load_dword v1, v3, s[4:7], s47 offen offset:0 sc1
    s_add_u32 s40, s40, 1
    s_cmp_gt_u32 s40, 262144
    s_cbranch_scc1 L_abort
    s_waitcnt vmcnt(0)
    v_cmp_gt_u32 vcc, s48, v1
    s_cbranch_vccnz L_wf_51
L_wfo_52:
    s_mov_b64 exec, -1
    s_lshl_b32 s17, s22, 15
    s_add_u32 s17, s17, 167772160
    s_mov_b32 m0, 32768
    s_mov_b32 s16, 32
L_da_54:
    buffer_load_dwordx4 v0, s[4:7], s17 offen sc1 lds
    s_add_u32 s17, s17, 1024
    s_add_u32 m0, m0, 1024
    s_waitcnt vmcnt(16)
    s_sub_u32 s16, s16, 1
    s_cmp_lg_u32 s16, 0
    s_cbranch_scc1 L_da_54
    s_waitcnt vmcnt(0)
    ds_read_b128 v[8:11], v6 offset:0
    ds_read_b128 v[12:15], v6 offset:1024
    s_waitcnt lgkmcnt(1)
    v_mfma_f32_32x32x16_bf16 v[32:47], v[128:131], v[8:11], 0
    s_nop 0
    ds_read_b128 v[16:19], v6 offset:2048
    s_waitcnt lgkmcnt(1)
    v_mfma_f32_32x32x16_bf16 v[32:47], v[132:135], v[12:15], v[32:47]
    s_nop 0
    ds_read_b128 v[8:11], v6 offset:3072
    s_waitcnt lgkmcnt(1)
    v_mfma_f32_32x32x16_bf16 v[32:47], v[136:139], v[16:19], v[32:47]
    s_nop 0
    ds_read_b128 v[12:15], v6 offset:4096
    s_waitcnt lgkmcnt(1)
    v_mfma_f32_32x32x16_bf16 v[32:47], v[140:143], v[8:11], v[32:47]
    s_nop 0
    ds_read_b128 v[16:19], v6 offset:5120
    s_waitcnt lgkmcnt(1)
    v_mfma_f32_32x32x16_bf16 v[32:47], v[144:147], v[12:15], v[32:47]
    s_nop 0
    ds_read_b128 v[8:11], v6 offset:6144
    s_waitcnt lgkmcnt(1)
    v_mfma_f32_32x32x16_bf16 v[32:47], v[148:151], v[16:19], v[32:47]
    s_nop 0
    ds_read_b128 v[12:15], v6 offset:7168
    s_waitcnt lgkmcnt(1)
    v_mfma_f32_32x32x16_bf16 v[32:47], v[152:155], v[8:11], v[32:47]
    s_nop 0
    ds_read_b128 v[16:19], v6 offset:8192
    s_waitcnt lgkmcnt(1)
    v_mfma_f32_32x32x16_bf16 v[32:47], v[156:159], v[12:15], v[32:47]
    s_nop 0
    ds_read_b128 v[8:11], v6 offset:9216
    s_waitcnt lgkmcnt(1)
    v_mfma_f32_32x32x16_bf16 v[32:47], v[160:163], v[16:19], v[32:47]
    s_nop 0
    ds_read_b128 v[12:15], v6 offset:10240
    s_waitcnt lgkmcnt(1)
    v_mfma_f32_32x32x16_bf16 v[32:47], v[164:167], v[8:11], v[32:47]
    s_nop 0
    ds_read_b128 v[16:19], v6 offset:11264
    s_waitcnt lgkmcnt(1)
    v_mfma_f32_32x32x16_bf16 v[32:47], v[168:171], v[12:15], v[32:47]
    s_nop 0
    ds_read_b128 v[8:11], v6 offset:12288
    s_waitcnt lgkmcnt(1)
    v_mfma_f32_32x32x16_bf16 v[32:47], v[172:175], v[16:19], v[32:47]
    s_nop 0
    ds_read_b128 v[12:15], v6 offset:13312
    s_waitcnt lgkmcnt(1)
    v_mfma_f32_32x32x16_bf16 v[32:47], v[176:179], v[8:11], v[32:47]
    s_nop 0
    ds_read_b128 v[16:19], v6 offset:14336
    s_waitcnt lgkmcnt(1)
    v_mfma_f32_32x32x16_bf16 v[32:47], v[180:183], v[12:15], v[32:47]
    s_nop 0
    ds_read_b128 v[8:11], v6 offset:15360
    s_waitcnt lgkmcnt(1)
    v_mfma_f32_32x32x16_bf16 v[32:47], v[184:187], v[16:19], v[32:47]
    s_nop 0
    ds_read_b128 v[12:15], v6 offset:16384
    s_waitcnt lgkmcnt(1)
    v_mfma_f32_32x32x16_bf16 v[32:47], v[188:191], v[8:11], v[32:47]
    s_nop 0
    ds_read_b128 v[16:19], v6 offset:17408
    s_waitcnt lgkmcnt(1)
    v_mfma_f32_32x32x16_bf16 v[32:47], v[192:195], v[12:15], v[32:47]
    s_nop 0
    ds_read_b128 v[8:11], v6 offset:18432
    s_waitcnt lgkmcnt(1)
    v_mfma_f32_32x32x16_bf16 v[32:47], v[196:199], v[16:19], v[32:47]
    s_nop 0
    ds_read_b128 v[12:15], v6 offset:19456
    s_waitcnt lgkmcnt(1)
    v_mfma_f32_32x32x16_bf16 v[32:47], v[200:203], v[8:11], v[32:47]
    s_nop 0
    ds_read_b128 v[16:19], v6 offset:20480
    s_waitcnt lgkmcnt(1)
    v_mfma_f32_32x32x16_bf16 v[32:47], v[204:207], v[12:15], v[32:47]
    s_nop 0
    ds_read_b128 v[8:11], v6 offset:21504
    s_waitcnt lgkmcnt(1)
    v_mfma_f32_32x32x16_bf16 v[32:47], v[208:211], v[16:19], v[32:47]
    s_nop 0
    ds_read_b128 v[12:15], v6 offset:22528
    s_waitcnt lgkmcnt(1)
    v_mfma_f32_32x32x16_bf16 v[32:47], v[212:215], v[8:11], v[32:47]
    s_nop 0
    ds_read_b128 v[16:19], v6 offset:23552
    s_waitcnt lgkmcnt(1)
    v_mfma_f32_32x32x16_bf16 v[32:47], v[216:219], v[12:15], v[32:47]
    s_nop 0
    ds_read_b128 v[8:11], v6 offset:24576
    s_waitcnt lgkmcnt(1)
    v_mfma_f32_32x32x16_bf16 v[32:47], v[220:223], v[16:19], v[32:47]
    s_nop 0
    ds_read_b128 v[12:15], v6 offset:25600
    s_waitcnt lgkmcnt(1)
    v_mfma_f32_32x32x16_bf16 v[32:47], v[224:227], v[8:11], v[32:47]
    s_nop 0
    ds_read_b128 v[16:19], v6 offset:26624
    s_waitcnt lgkmcnt(1)
    v_mfma_f32_32x32x16_bf16 v[32:47], v[228:231], v[12:15], v[32:47]
    s_nop 0
    ds_read_b128 v[8:11], v6 offset:27648
    s_waitcnt lgkmcnt(1)
    v_mfma_f32_32x32x16_bf16 v[32:47], v[232:235], v[16:19], v[32:47]
    s_nop 0
    ds_read_b128 v[12:15], v6 offset:28672
    s_waitcnt lgkmcnt(1)
    v_mfma_f32_32x32x16_bf16 v[32:47], v[236:239], v[8:11], v[32:47]
    s_nop 0
    ds_read_b128 v[16:19], v6 offset:29696
    s_waitcnt lgkmcnt(1)
    v_mfma_f32_32x32x16_bf16 v[32:47], v[240:243], v[12:15], v[32:47]
    s_nop 0
    ds_read_b128 v[8:11], v6 offset:30720
    s_waitcnt lgkmcnt(1)
    v_mfma_f32_32x32x16_bf16 v[32:47], v[244:247], v[16:19], v[32:47]
    s_nop 0
    ds_read_b128 v[12:15], v6 offset:31744
    s_waitcnt lgkmcnt(1)
    v_mfma_f32_32x32x16_bf16 v[32:47], v[248:251], v[8:11], v[32:47]
    s_waitcnt lgkmcnt(0)
    v_mfma_f32_32x32x16_bf16 v[32:47], v[252:255], v[12:15], v[32:47]
L_g3v_37:
    s_lshl_b32 s17, s21, 15
    s_add_u32 s17, s17, s25
    s_nop 9
    v_cvt_pk_bf16_f32 v48, v32, v33
    v_cvt_pk_bf16_f32 v49, v34, v35
    v_cvt_pk_bf16_f32 v50, v36, v37
    v_cvt_pk_bf16_f32 v51, v38, v39
    v_cvt_pk_bf16_f32 v52, v40, v41
    v_cvt_pk_bf16_f32 v53, v42, v43
    v_cvt_pk_bf16_f32 v54, v44, v45
    v_cvt_pk_bf16_f32 v55, v46, v47
    v_lshlrev_b32 v80, 16, v48
    v_and_b32 v81, 0xffff0000, v48
    v_lshlrev_b32 v82, 16, v49
    v_and_b32 v83, 0xffff0000, v49
    v_lshlrev_b32 v84, 16, v50
    v_and_b32 v85, 0xffff0000, v50
    v_lshlrev_b32 v86, 16, v51
    v_and_b32 v87, 0xffff0000, v51
    v_lshlrev_b32 v88, 16, v52
    v_and_b32 v89, 0xffff0000, v52
    v_lshlrev_b32 v90, 16, v53
    v_and_b32 v91, 0xffff0000, v53
    v_lshlrev_b32 v92, 16, v54
    v_and_b32 v93, 0xffff0000, v54
    v_lshlrev_b32 v94, 16, v55
    v_and_b32 v95, 0xffff0000, v55
    v_pk_add_f32 v[64:65], v[64:65], v[80:81]
    v_pk_add_f32 v[66:67], v[66:67], v[82:83]
    v_pk_add_f32 v[68:69], v[68:69], v[84:85]
    v_pk_add_f32 v[70:71], v[70:71], v[86:87]
    v_pk_add_f32 v[72:73], v[72:73], v[88:89]
    v_pk_add_f32 v[74:75], v[74:75], v[90:91]
    v_pk_add_f32 v[76:77], v[76:77], v[92:93]
    v_pk_add_f32 v[78:79], v[78:79], v[94:95]
    v_cvt_pk_bf16_f32 v48, v64, v65
    v_cvt_pk_bf16_f32 v49, v66, v67
    v_cvt_pk_bf16_f32 v50, v68, v69
    v_cvt_pk_bf16_f32 v51, v70, v71
    v_cvt_pk_bf16_f32 v52, v72, v73
    v_cvt_pk_bf16_f32 v53, v74, v75
    v_cvt_pk_bf16_f32 v54, v76, v77
    v_cvt_pk_bf16_f32 v55, v78, v79
    s_cmp_eq_u32 s15, 0
    s_cbranch_scc0 L_g3o_35
    s_add_u32 s17, s17, 171966464
    s_cmp_lg_u32 s60, 0
    s_cbranch_scc1 L_du_55
    buffer_store_dwordx4 v[48:51], v5, s[4:7], s17 offen offset:0
    buffer_store_dwordx4 v[52:55], v5, s[4:7], s17 offen offset:16
    s_branch L_dv_56
L_du_55:
    buffer_store_dwordx4 v[48:51], v5, s[4:7], s17 offen offset:0 sc1
    buffer_store_dwordx4 v[52:55], v5, s[4:7], s17 offen offset:16 sc1
L_dv_56:
    s_add_u32 s18, s29, 61440
    s_waitcnt vmcnt(0)
    s_barrier
    s_cmp_eq_u32 s13, 3
    s_cbranch_scc0 L_pub_57
    v_mov_b32 v1, s30
    s_mov_b64 exec, 1
    s_cmp_lg_u32 s60, 0
    s_cbranch_scc1 L_du_58
    buffer_store_dword v1, off, s[4:7], s18
    s_branch L_dv_59
L_du_58:
    buffer_store_dword v1, off, s[4:7], s18 sc1
L_dv_59:
    s_mov_b64 exec, -1
L_pub_57:
    s_branch L_g3p_36
L_g3o_35:
    buffer_store_dwordx4 v[48:51], v5, s[36:39], s17 offen offset:0
    buffer_store_dwordx4 v[52:55], v5, s[36:39], s17 offen offset:16
    s_waitcnt vmcnt(2)
L_g3p_36:
    s_mov_b32 s21, s43
    s_cmp_lt_u32 s21, s49
    s_cbranch_scc1 L_g3b_30
    s_add_u32 s15, s15, 1
    s_cmp_lt_u32 s15, 2
    s_cbranch_scc1 L_g1l_6
    s_branch L_fin
L_rg:
L_rgc:
    s_cmp_eq_u32 s13, 3
    s_cbranch_scc0 L_ar_60
    s_cmp_lg_u32 s59, 0
    s_cbranch_scc1 L_ar_60
    s_lshr_b32 s16, s2, 3
    s_lshl_b32 s16, 1, s16
    v_mov_b32 v100, s16
    s_and_b32 s16, s61, 7
    s_lshl_b32 s16, s16, 5
    s_and_b32 s17, s61, 8
    s_lshl_b32 s17, s17, 1
    s_or_b32 s16, s16, s17
    v_mov_b32 v101, 0x100
    v_mov_b32 v102, s16
    s_mov_b64 exec, 1
    s_waitcnt vmcnt(0)
    global_atomic_add_x2 v[126:127], v102, v[100:101], s[56:57] sc0 sc1
    s_mov_b64 exec, -1
L_ar_60:
    s_bfe_u32 s12, s58, 0x10005
    s_and_b32 s14, s58, 15
    s_lshr_b32 s26, s14, 2
    s_and_b32 s27, s14, 3
    s_lshl_b32 s29, s12, 4
    s_add_u32 s29, s29, s14
    s_lshl_b32 s29, s29, 7
    s_lshl_b32 s20, s13, 13
    s_mul_i32 s31, s13, 8320
    s_lshl_b32 s44, s27, 8
    s_lshl_b32 s16, s13, 6
    s_add_u32 s25, s44, s16
    v_bfe_u32 v3, v0, 4, 5
    v_lshlrev_b32 v5, 10, v3
    v_lshlrev_b32 v4, 2, v3
    v_lshlrev_b32 v3, 7, v3
    v_bfe_u32 v1, v0, 9, 1
    v_lshl_add_u32 v4, v1, 15, v4
    v_lshl_add_u32 v5, v1, 5, v5
    v_bfe_u32 v2, v0, 4, 3
    v_mul_u32_u24 v2, 384, v2
    s_mov_b32 s15, 0
    s_load_dwordx2 s[36:37], s[0:1], 80
    s_mov_b32 s38, 2097152
    s_mov_b32 s39, 0x20000
    s_waitcnt lgkmcnt(0)
    s_cmp_lg_u32 s59, 0
    s_cbranch_scc1 L_vok_62
L_vp_61:
    v_and_b32 v102, 0xf0, v0
    global_load_dwordx2 v[100:101], v102, s[56:57] sc1
    s_waitcnt vmcnt(0)
L_vc_64:
    v_lshrrev_b32 v103, 8, v101
    s_nop 1
    v_add_u32_dpp v103, v103, v103 quad_perm:[1,0,3,2] row_mask:0xf bank_mask:0xf
    s_nop 1
    v_add_u32_dpp v103, v103, v103 quad_perm:[2,3,0,1] row_mask:0xf bank_mask:0xf
    s_nop 1
    v_add_u32_dpp v103, v103, v103 row_half_mirror row_mask:0xf bank_mask:0xf
    s_nop 1
    v_add_u32_dpp v103, v103, v103 row_mirror row_mask:0xf bank_mask:0xf
    v_cmp_ne_u32 vcc, 0x100, v103
    s_cbranch_vccz L_vgo_63
    s_add_u32 s40, s40, 1
    s_cmp_gt_u32 s40, 262144
    s_cbranch_scc1 L_abort
    s_sleep 2
    s_branch L_vp_61
L_vgo_63:
    s_mov_b32 s59, 1
    v_cmp_ne_u32 vcc, -1, v100
    s_and_b32 s16, vcc_lo, 0x5555
    v_cmp_ne_u32 vcc, 0x2000, v101
    s_and_b32 s17, vcc_lo, 0x5555
    s_or_b32 s16, s16, s17
    s_cbranch_scc0 L_vok_62
    v_lshrrev_b32 v103, 8, v101
    v_cmp_ne_u32 vcc, 32, v103
    s_and_b32 s60, vcc_lo, 0x5555
    s_branch L_redo
L_vok_62:
    s_load_dwordx2 s[32:33], s[0:1], 0
    s_mov_b32 s34, 2097152
    s_mov_b32 s35, 0x20000
    s_waitcnt lgkmcnt(0)
    v_bfe_u32 v64, v0, 4, 5
    v_mul_u32_u24 v20, 1040, v64
    v_bfe_u32 v64, v0, 9, 1
    v_lshl_add_u32 v20, v64, 4, v20
    v_lshrrev_b32 v7, 1, v0
    v_bfe_u32 v21, v0, 4, 4
    v_lshlrev_b32 v22, 4, v21
    v_bfe_u32 v1, v0, 9, 1
    v_lshl_add_u32 v22, v1, 8, v22
    v_bfe_u32 v1, v0, 8, 1
    v_mul_u32_u24 v1, 3072, v1
    v_add_u32 v22, v1, v22
    v_and_b32 v23, 0x330, v0
    v_bfe_u32 v1, v0, 6, 1
    v_lshl_add_u32 v23, v1, 7, v23
    v_bfe_u32 v1, v0, 7, 1
    v_lshl_add_u32 v23, v1, 6, v23
    s_cmp_eq_u32 s13, 0
    s_cselect_b32 s28, 0x3eb8aa3b, 1.0
    s_cselect_b64 vcc, -1, 0
    v_cndmask_b32 v23, v23, v0, vcc
    v_bfe_u32 v1, v0, 4, 2
    v_min_u32 v1, 2, v1
    v_lshlrev_b32 v24, 2, v1
    v_add_u32 v24, 140000, v24
    v_lshrrev_b32 v25, 6, v0
    v_lshl_add_u32 v25, v25, 2, v1
    v_lshlrev_b32 v25, 7, v25
    s_lshl_b32 s17, s26, 1
    s_add_u32 s17, s17, s12
    s_lshl_b32 s17, s17, 2
    s_add_u32 s17, s17, s27
    s_lshl_b32 s17, s17, 2
    s_add_u32 s17, s17, s13
    s_lshl_b32 s17, s17, 11
    s_add_u32 s17, s17, 6291456
    v_mov_b64 v[28:29], -1
    v_mov_b64 v[30:31], -1
    buffer_store_dwordx4 v[28:31], v0, s[4:7], s17 offen offset:0 sc1
    buffer_store_dwordx4 v[28:31], v0, s[4:7], s17 offen offset:1024 sc1
    s_cmp_eq_u32 s12, 1
    s_cbranch_scc0 L_rgq_78
    s_lshr_b32 s17, s13, 1
    s_mul_i32 s17, s17, 6291456
    s_lshl_b32 s16, s14, 1
    s_and_b32 s18, s13, 1
    s_add_u32 s16, s16, s18
    s_mul_i32 s16, s16, 3072
    s_add_u32 s17, s17, s16
    s_add_u32 s17, s17, 157188096
    v_mov_b64 v[28:29], -1
    v_mov_b64 v[30:31], -1
    buffer_store_dwordx4 v[28:31], v0, s[4:7], s17 offen offset:0 sc1
    buffer_store_dwordx4 v[28:31], v0, s[4:7], s17 offen offset:1024 sc1
    buffer_store_dwordx4 v[28:31], v0, s[4:7], s17 offen offset:2048 sc1
L_rgq_78:
L_rgl_65:
    s_lshl_b32 s21, s26, 1
    s_add_u32 s21, s21, s12
L_rga_66:
    s_lshl_b32 s22, s15, 6
    s_add_u32 s22, s22, s21
    s_lshl_b32 s17, s21, 2
    s_add_u32 s17, s17, s27
    s_lshl_b32 s17, s17, 2
    s_add_u32 s17, s17, s13
    s_lshl_b32 s17, s17, 11
    s_cmp_eq_u32 s15, 0
    s_cbranch_scc0 L_rga1_67
    buffer_load_dwordx4 v[64:67], v0, s[32:35], s17 offen offset:0
    buffer_load_dwordx4 v[68:71], v0, s[32:35], s17 offen offset:1024
    s_branch L_rga2_68
L_rga1_67:
    s_and_b32 s18, s29, 0xe00
    s_add_u32 s18, s18, 61440
    s_lshr_b32 s19, s21, 3
    s_add_u32 s19, s19, 1
    s_cmp_eq_u32 s13, 0
    s_cbranch_scc0 L_wfo_80
    s_mov_b64 exec, 0xf
L_wf_79:
    buffer_load_dword v1, v3, s[4:7], s18 offen offset:0 sc1
    s_add_u32 s40, s40, 1
    s_cmp_gt_u32 s40, 262144
    s_cbranch_scc1 L_abort
    s_waitcnt vmcnt(0)
    v_cmp_gt_u32 vcc, s19, v1
    s_cbranch_vccnz L_wf_79
L_wfo_80:
    s_mov_b64 exec, -1
    s_barrier
    s_add_u32 s18, s17, 171966464
    buffer_load_dwordx4 v[64:67], v0, s[4:7], s18 offen offset:0 sc1
    buffer_load_dwordx4 v[68:71], v0, s[4:7], s18 offen offset:1024 sc1
L_rga2_68:
    s_lshl_b32 s16, s15, 21
    s_add_u32 s17, s17, s16
    s_add_u32 s17, s17, 4194304
    s_add_u32 s18, s29, 28672
    s_lshr_b32 s30, s22, 3
    s_add_u32 s30, s30, 1
    s_waitcnt vmcnt(0)
    v_lshlrev_b32 v96, 16, v64
    v_and_b32 v97, 0xffff0000, v64
    v_lshlrev_b32 v98, 16, v65
    v_and_b32 v99, 0xffff0000, v65
    v_lshlrev_b32 v100, 16, v66
    v_and_b32 v101, 0xffff0000, v66
    v_lshlrev_b32 v102, 16, v67
    v_and_b32 v103, 0xffff0000, v67
    v_lshlrev_b32 v104, 16, v68
    v_and_b32 v105, 0xffff0000, v68
    v_lshlrev_b32 v106, 16, v69
    v_and_b32 v107, 0xffff0000, v69
    v_lshlrev_b32 v108, 16, v70
    v_and_b32 v109, 0xffff0000, v70
    v_lshlrev_b32 v110, 16, v71
    v_and_b32 v111, 0xffff0000, v71
    v_pk_add_f32 v[112:113], v[96:97], v[98:99]
    v_pk_add_f32 v[114:115], v[100:101], v[102:103]
    v_pk_add_f32 v[120:121], v[104:105], v[106:107]
    v_pk_add_f32 v[122:123], v[108:109], v[110:111]
    v_pk_add_f32 v[112:113], v[112:113], v[114:115]
    v_pk_add_f32 v[120:121], v[120:121], v[122:123]
    v_add_f32 v32, v112, v113
    v_add_f32 v34, v120, v121
    s_nop 0
    v_add_f32_dpp v32, v32, v32 quad_perm:[1,0,3,2] row_mask:0xf bank_mask:0xf
    v_add_f32_dpp v34, v34, v34 quad_perm:[1,0,3,2] row_mask:0xf bank_mask:0xf
    s_nop 0
    v_add_f32_dpp v32, v32, v32 quad_perm:[2,3,0,1] row_mask:0xf bank_mask:0xf
    v_add_f32_dpp v34, v34, v34 quad_perm:[2,3,0,1] row_mask:0xf bank_mask:0xf
    s_nop 0
    v_add_f32_dpp v32, v32, v32 row_half_mirror row_mask:0xf bank_mask:0xf
    v_add_f32_dpp v34, v34, v34 row_half_mirror row_mask:0xf bank_mask:0xf
    s_nop 0
    v_add_f32_dpp v32, v32, v32 row_mirror row_mask:0xf bank_mask:0xf
    v_add_f32_dpp v34, v34, v34 row_mirror row_mask:0xf bank_mask:0xf
    v_mov_b32 v40, v32
    v_mov_b32 v41, v34
    s_nop 0
    v_permlane16_swap_b32 v32, v40
    v_permlane16_swap_b32 v34, v41
    v_add_f32 v32, v32, v40
    v_add_f32 v34, v34, v41
    v_mov_b32 v40, v32
    v_mov_b32 v41, v34
    s_nop 0
    v_permlane32_swap_b32 v32, v40
    v_permlane32_swap_b32 v34, v41
    v_add_f32 v32, v32, v40
    v_add_f32 v34, v34, v41
    v_mul_f32 v32, 0xbb000000, v32
    v_mul_f32 v34, 0xbb000000, v34
    v_pk_add_f32 v[112:113], v[96:97], v[32:33] op_sel_hi:[1,0]
    v_pk_add_f32 v[114:115], v[98:99], v[32:33] op_sel_hi:[1,0]
    v_pk_add_f32 v[116:117], v[100:101], v[32:33] op_sel_hi:[1,0]
    v_pk_add_f32 v[118:119], v[102:103], v[32:33] op_sel_hi:[1,0]
    v_pk_add_f32 v[120:121], v[104:105], v[34:35] op_sel_hi:[1,0]
    v_pk_add_f32 v[122:123], v[106:107], v[34:35] op_sel_hi:[1,0]
    v_pk_add_f32 v[124:125], v[108:109], v[34:35] op_sel_hi:[1,0]
    v_pk_add_f32 v[126:127], v[110:111], v[34:35] op_sel_hi:[1,0]
    v_pk_mul_f32 v[36:37], v[112:113], v[112:113]
    v_pk_fma_f32 v[36:37], v[114:115], v[114:115], v[36:37]
    v_pk_fma_f32 v[36:37], v[116:117], v[116:117], v[36:37]
    v_pk_fma_f32 v[36:37], v[118:119], v[118:119], v[36:37]
    v_pk_mul_f32 v[38:39], v[120:121], v[120:121]
    v_pk_fma_f32 v[38:39], v[122:123], v[122:123], v[38:39]
    v_pk_fma_f32 v[38:39], v[124:125], v[124:125], v[38:39]
    v_pk_fma_f32 v[38:39], v[126:127], v[126:127], v[38:39]
    v_add_f32 v36, v36, v37
    v_add_f32 v38, v38, v39
    s_nop 0
    v_add_f32_dpp v36, v36, v36 quad_perm:[1,0,3,2] row_mask:0xf bank_mask:0xf
    v_add_f32_dpp v38, v38, v38 quad_perm:[1,0,3,2] row_mask:0xf bank_mask:0xf
    s_nop 0
    v_add_f32_dpp v36, v36, v36 quad_perm:[2,3,0,1] row_mask:0xf bank_mask:0xf
    v_add_f32_dpp v38, v38, v38 quad_perm:[2,3,0,1] row_mask:0xf bank_mask:0xf
    s_nop 0
    v_add_f32_dpp v36, v36, v36 row_half_mirror row_mask:0xf bank_mask:0xf
    v_add_f32_dpp v38, v38, v38 row_half_mirror row_mask:0xf bank_mask:0xf
    s_nop 0
    v_add_f32_dpp v36, v36, v36 row_mirror row_mask:0xf bank_mask:0xf
    v_add_f32_dpp v38, v38, v38 row_mirror row_mask:0xf bank_mask:0xf
    v_mov_b32 v40, v36
    v_mov_b32 v41, v38
    s_nop 0
    v_permlane16_swap_b32 v36, v40
    v_permlane16_swap_b32 v38, v41
    v_add_f32 v36, v36, v40
    v_add_f32 v38, v38, v41
    v_mov_b32 v40, v36
    v_mov_b32 v41, v38
    s_nop 0
    v_permlane32_swap_b32 v36, v40
    v_permlane32_swap_b32 v38, v41
    v_add_f32 v36, v36, v40
    v_add_f32 v38, v38, v41
    v_cvt_pk_bf16_f32 v32, v32, v32
    v_lshlrev_b32 v32, 16, v32
    v_mul_f32 v36, 0x3b000000, v36
    v_cvt_pk_bf16_f32 v36, v36, v36
    v_lshlrev_b32 v36, 16, v36
    v_add_f32 v36, 0x3727c5ac, v36
    v_cvt_pk_bf16_f32 v36, v36, v36
    v_lshlrev_b32 v36, 16, v36
    v_sqrt_f32 v36, v36
    v_pk_add_f32 v[112:113], v[96:97], v[32:33] op_sel_hi:[1,0]
    v_pk_add_f32 v[114:115], v[98:99], v[32:33] op_sel_hi:[1,0]
    v_pk_add_f32 v[116:117], v[100:101], v[32:33] op_sel_hi:[1,0]
    v_pk_add_f32 v[118:119], v[102:103], v[32:33] op_sel_hi:[1,0]
    v_cvt_pk_bf16_f32 v36, v36, v36
    v_lshlrev_b32 v36, 16, v36
    v_rcp_f32 v36, v36
    v_cvt_pk_bf16_f32 v48, v112, v113
    v_cvt_pk_bf16_f32 v49, v114, v115
    v_cvt_pk_bf16_f32 v50, v116, v117
    v_cvt_pk_bf16_f32 v51, v118, v119
    v_lshlrev_b32 v112, 16, v48
    v_and_b32 v113, 0xffff0000, v48
    v_lshlrev_b32 v114, 16, v49
    v_and_b32 v115, 0xffff0000, v49
    v_lshlrev_b32 v116, 16, v50
    v_and_b32 v117, 0xffff0000, v50
    v_lshlrev_b32 v118, 16, v51
    v_and_b32 v119, 0xffff0000, v51
    v_pk_mul_f32 v[112:113], v[112:113], v[36:37] op_sel_hi:[1,0]
    v_pk_mul_f32 v[114:115], v[114:115], v[36:37] op_sel_hi:[1,0]
    v_pk_mul_f32 v[116:117], v[116:117], v[36:37] op_sel_hi:[1,0]
    v_pk_mul_f32 v[118:119], v[118:119], v[36:37] op_sel_hi:[1,0]
    v_cvt_pk_bf16_f32 v48, v112, v113
    v_cvt_pk_bf16_f32 v49, v114, v115
    v_cvt_pk_bf16_f32 v50, v116, v117
    v_cvt_pk_bf16_f32 v51, v118, v119
    v_cvt_pk_bf16_f32 v34, v34, v34
    v_lshlrev_b32 v34, 16, v34
    v_mul_f32 v38, 0x3b000000, v38
    v_cvt_pk_bf16_f32 v38, v38, v38
    v_lshlrev_b32 v38, 16, v38
    v_add_f32 v38, 0x3727c5ac, v38
    v_cvt_pk_bf16_f32 v38, v38, v38
    v_lshlrev_b32 v38, 16, v38
    v_sqrt_f32 v38, v38
    v_pk_add_f32 v[120:121], v[104:105], v[34:35] op_sel_hi:[1,0]
    v_pk_add_f32 v[122:123], v[106:107], v[34:35] op_sel_hi:[1,0]
    v_pk_add_f32 v[124:125], v[108:109], v[34:35] op_sel_hi:[1,0]
    v_pk_add_f32 v[126:127], v[110:111], v[34:35] op_sel_hi:[1,0]
    v_cvt_pk_bf16_f32 v38, v38, v38
    v_lshlrev_b32 v38, 16, v38
    v_rcp_f32 v38, v38
    v_cvt_pk_bf16_f32 v52, v120, v121
    v_cvt_pk_bf16_f32 v53, v122, v123
    v_cvt_pk_bf16_f32 v54, v124, v125
    v_cvt_pk_bf16_f32 v55, v126, v127
    v_lshlrev_b32 v120, 16, v52
    v_and_b32 v121, 0xffff0000, v52
    v_lshlrev_b32 v122, 16, v53
    v_and_b32 v123, 0xffff0000, v53
    v_lshlrev_b32 v124, 16, v54
    v_and_b32 v125, 0xffff0000, v54
    v_lshlrev_b32 v126, 16, v55
    v_and_b32 v127, 0xffff0000, v55
    v_pk_mul_f32 v[120:121], v[120:121], v[38:39] op_sel_hi:[1,0]
    v_pk_mul_f32 v[122:123], v[122:123], v[38:39] op_sel_hi:[1,0]
    v_pk_mul_f32 v[124:125], v[124:125], v[38:39] op_sel_hi:[1,0]
    v_pk_mul_f32 v[126:127], v[126:127], v[38:39] op_sel_hi:[1,0]
    v_cvt_pk_bf16_f32 v52, v120, v121
    v_cvt_pk_bf16_f32 v53, v122, v123
    v_cvt_pk_bf16_f32 v54, v124, v125
    v_cvt_pk_bf16_f32 v55, v126, v127
    buffer_store_dwordx4 v[48:51], v0, s[4:7], s17 offen offset:0 sc1
    buffer_store_dwordx4 v[52:55], v0, s[4:7], s17 offen offset:1024 sc1
    s_waitcnt vmcnt(0)
    s_barrier
    s_cmp_eq_u32 s13, 3
    s_cbranch_scc0 L_pub_82
    v_mov_b32 v1, s30
    s_mov_b64 exec, 1
    buffer_store_dword v1, off, s[4:7], s18 sc1
    s_mov_b64 exec, -1
L_pub_82:
    s_add_u32 s21, s21, 8
    s_cmp_lt_u32 s21, 64
    s_cbranch_scc1 L_rga_66
    s_cmp_eq_u32 s15, 0
    s_cbranch_scc0 L_rgnw_69
    s_lshl_b32 s24, s14, 6
    s_waitcnt vmcnt(0)
    v_lshlrev_b32 v31, 16, v0
    s_lshl_b32 s16, s13, 26
    s_add_u32 s16, s16, 1048448
    buffer_load_dword v31, v31, s[4:7], s16 offen sc1
    s_load_dwordx2 s[8:9], s[0:1], 64
    s_mov_b32 s10, 1572864
    s_mov_b32 s11, 0x20000
    s_waitcnt lgkmcnt(0)
    v_lshrrev_b32 v64, 8, v0
    v_lshl_add_u32 v64, s13, 4, v64
    v_mul_u32_u24 v64, 3072, v64
    v_bfe_u32 v65, v0, 6, 2
    v_min_u32 v65, 2, v65
    v_lshl_add_u32 v64, v65, 10, v64
    v_and_b32 v8, 0x30, v0
    v_add_u32 v8, v64, v8
    s_mul_i32 s19, s13, 4160
    s_add_u32 m0, s19, 0
    s_add_u32 s16, s24, 0
    buffer_load_dwordx4 v8, s[8:11], s16 offen lds
    s_add_u32 m0, s19, 1040
    s_add_u32 s16, s24, 12288
    buffer_load_dwordx4 v8, s[8:11], s16 offen lds
    s_add_u32 m0, s19, 2080
    s_add_u32 s16, s24, 24576
    buffer_load_dwordx4 v8, s[8:11], s16 offen lds
    s_add_u32 m0, s19, 3120
    s_add_u32 s16, s24, 36864
    buffer_load_dwordx4 v8, s[8:11], s16 offen lds
    s_mul_i32 s19, s13, 4160
    s_add_u32 m0, s19, 16640
    s_add_u32 s16, s24, 196608
    buffer_load_dwordx4 v8, s[8:11], s16 offen lds
    s_add_u32 m0, s19, 17680
    s_add_u32 s16, s24, 208896
    buffer_load_dwordx4 v8, s[8:11], s16 offen lds
    s_add_u32 m0, s19, 18720
    s_add_u32 s16, s24, 221184
    buffer_load_dwordx4 v8, s[8:11], s16 offen lds
    s_add_u32 m0, s19, 19760
    s_add_u32 s16, s24, 233472
    buffer_load_dwordx4 v8, s[8:11], s16 offen lds
    s_mul_i32 s19, s13, 4160
    s_add_u32 m0, s19, 33280
    s_add_u32 s16, s24, 393216
    buffer_load_dwordx4 v8, s[8:11], s16 offen lds
    s_add_u32 m0, s19, 34320
    s_add_u32 s16, s24, 405504
    buffer_load_dwordx4 v8, s[8:11], s16 offen lds
    s_add_u32 m0, s19, 35360
    s_add_u32 s16, s24, 417792
    buffer_load_dwordx4 v8, s[8:11], s16 offen lds
    s_add_u32 m0, s19, 36400
    s_add_u32 s16, s24, 430080
    buffer_load_dwordx4 v8, s[8:11], s16 offen lds
    s_mul_i32 s19, s13, 4160
    s_add_u32 m0, s19, 49920
    s_add_u32 s16, s24, 589824
    buffer_load_dwordx4 v8, s[8:11], s16 offen lds
    s_add_u32 m0, s19, 50960
    s_add_u32 s16, s24, 602112
    buffer_load_dwordx4 v8, s[8:11], s16 offen lds
    s_add_u32 m0, s19, 52000
    s_add_u32 s16, s24, 614400
    buffer_load_dwordx4 v8, s[8:11], s16 offen lds
    s_add_u32 m0, s19, 53040
    s_add_u32 s16, s24, 626688
    buffer_load_dwordx4 v8, s[8:11], s16 offen lds
    s_mul_i32 s19, s13, 4160
    s_add_u32 m0, s19, 66560
    s_add_u32 s16, s24, 786432
    buffer_load_dwordx4 v8, s[8:11], s16 offen lds
    s_add_u32 m0, s19, 67600
    s_add_u32 s16, s24, 798720
    buffer_load_dwordx4 v8, s[8:11], s16 offen lds
    s_add_u32 m0, s19, 68640
    s_add_u32 s16, s24, 811008
    buffer_load_dwordx4 v8, s[8:11], s16 offen lds
    s_add_u32 m0, s19, 69680
    s_add_u32 s16, s24, 823296
    buffer_load_dwordx4 v8, s[8:11], s16 offen lds
    s_mul_i32 s19, s13, 4160
    s_add_u32 m0, s19, 83200
    s_add_u32 s16, s24, 983040
    buffer_load_dwordx4 v8, s[8:11], s16 offen lds
    s_add_u32 m0, s19, 84240
    s_add_u32 s16, s24, 995328
    buffer_load_dwordx4 v8, s[8:11], s16 offen lds
    s_add_u32 m0, s19, 85280
    s_add_u32 s16, s24, 1007616
    buffer_load_dwordx4 v8, s[8:11], s16 offen lds
    s_add_u32 m0, s19, 86320
    s_add_u32 s16, s24, 1019904
    buffer_load_dwordx4 v8, s[8:11], s16 offen lds
    s_waitcnt vmcnt(20)
    s_waitcnt lgkmcnt(0)
    s_barrier
    s_mul_i32 s19, s13, 4160
    s_add_u32 m0, s19, 99840
    s_add_u32 s16, s24, 1179648
    buffer_load_dwordx4 v8, s[8:11], s16 offen lds
    s_add_u32 m0, s19, 100880
    s_add_u32 s16, s24, 1191936
    buffer_load_dwordx4 v8, s[8:11], s16 offen lds
    s_add_u32 m0, s19, 101920
    s_add_u32 s16, s24, 1204224
    buffer_load_dwordx4 v8, s[8:11], s16 offen lds
    s_add_u32 m0, s19, 102960
    s_add_u32 s16, s24, 1216512
    buffer_load_dwordx4 v8, s[8:11], s16 offen lds
    v_bfe_u32 v11, v0, 9, 1
    v_mul_u32_u24 v11, 2080, v11
    v_bfe_u32 v12, v0, 6, 2
    v_lshl_add_u32 v11, v12, 8, v11
    v_lshl_add_u32 v11, s13, 6, v11
    v_bfe_u32 v12, v0, 8, 1
    v_lshl_add_u32 v11, v12, 5, v11
    v_bfe_u32 v12, v0, 4, 2
    v_lshl_add_u32 v9, v12, 3, v11
    v_add_u32 v10, 0x10000, v9
    ds_read_b64_tr_b16 a[0:1], v9 offset:0
    ds_read_b64_tr_b16 a[2:3], v9 offset:1040
    ds_read_b64_tr_b16 a[4:5], v9 offset:4160
    ds_read_b64_tr_b16 a[6:7], v9 offset:5200
    ds_read_b64_tr_b16 a[8:9], v9 offset:8320
    ds_read_b64_tr_b16 a[10:11], v9 offset:9360
    ds_read_b64_tr_b16 a[12:13], v9 offset:12480
    ds_read_b64_tr_b16 a[14:15], v9 offset:13520
    s_waitcnt vmcnt(20)
    s_waitcnt lgkmcnt(0)
    s_barrier
    s_mul_i32 s19, s13, 4160
    s_add_u32 m0, s19, 0
    s_add_u32 s16, s24, 1376256
    buffer_load_dwordx4 v8, s[8:11], s16 offen lds
    s_add_u32 m0, s19, 1040
    s_add_u32 s16, s24, 1388544
    buffer_load_dwordx4 v8, s[8:11], s16 offen lds
    s_add_u32 m0, s19, 2080
    s_add_u32 s16, s24, 1400832
    buffer_load_dwordx4 v8, s[8:11], s16 offen lds
    s_add_u32 m0, s19, 3120
    s_add_u32 s16, s24, 1413120
    buffer_load_dwordx4 v8, s[8:11], s16 offen lds
    ds_read_b64_tr_b16 a[16:17], v9 offset:16640
    ds_read_b64_tr_b16 a[18:19], v9 offset:17680
    ds_read_b64_tr_b16 a[20:21], v9 offset:20800
    ds_read_b64_tr_b16 a[22:23], v9 offset:21840
    ds_read_b64_tr_b16 a[24:25], v9 offset:24960
    ds_read_b64_tr_b16 a[26:27], v9 offset:26000
    ds_read_b64_tr_b16 a[28:29], v9 offset:29120
    ds_read_b64_tr_b16 a[30:31], v9 offset:30160
    s_waitcnt vmcnt(20)
    s_waitcnt lgkmcnt(0)
    s_barrier
    s_load_dwordx2 s[8:9], s[0:1], 72
    s_mov_b32 s10, 524288
    s_mov_b32 s11, 0x20000
    s_waitcnt lgkmcnt(0)
    v_lshrrev_b32 v11, 8, v0
    v_lshl_add_u32 v11, s13, 4, v11
    v_mul_u32_u24 v11, 1024, v11
    v_and_b32 v8, 0xf0, v0
    v_add_u32 v8, v11, v8
    s_mul_i32 s19, s13, 4160
    s_add_u32 m0, s19, 16640
    s_add_u32 s16, s44, 0
    buffer_load_dwordx4 v8, s[8:11], s16 offen lds
    s_add_u32 m0, s19, 17680
    s_add_u32 s16, s44, 4096
    buffer_load_dwordx4 v8, s[8:11], s16 offen lds
    s_add_u32 m0, s19, 18720
    s_add_u32 s16, s44, 8192
    buffer_load_dwordx4 v8, s[8:11], s16 offen lds
    s_add_u32 m0, s19, 19760
    s_add_u32 s16, s44, 12288
    buffer_load_dwordx4 v8, s[8:11], s16 offen lds
    ds_read_b64_tr_b16 a[32:33], v9 offset:33280
    ds_read_b64_tr_b16 a[34:35], v9 offset:34320
    ds_read_b64_tr_b16 a[36:37], v9 offset:37440
    ds_read_b64_tr_b16 a[38:39], v9 offset:38480
    ds_read_b64_tr_b16 a[40:41], v9 offset:41600
    ds_read_b64_tr_b16 a[42:43], v9 offset:42640
    ds_read_b64_tr_b16 a[44:45], v9 offset:45760
    ds_read_b64_tr_b16 a[46:47], v9 offset:46800
    s_waitcnt vmcnt(20)
    s_waitcnt lgkmcnt(0)
    s_barrier
    s_mul_i32 s19, s13, 4160
    s_add_u32 m0, s19, 33280
    s_add_u32 s16, s44, 65536
    buffer_load_dwordx4 v8, s[8:11], s16 offen lds
    s_add_u32 m0, s19, 34320
    s_add_u32 s16, s44, 69632
    buffer_load_dwordx4 v8, s[8:11], s16 offen lds
    s_add_u32 m0, s19, 35360
    s_add_u32 s16, s44, 73728
    buffer_load_dwordx4 v8, s[8:11], s16 offen lds
    s_add_u32 m0, s19, 36400
    s_add_u32 s16, s44, 77824
    buffer_load_dwordx4 v8, s[8:11], s16 offen lds
    ds_read_b64_tr_b16 a[48:49], v9 offset:49920
    ds_read_b64_tr_b16 a[50:51], v9 offset:50960
    ds_read_b64_tr_b16 a[52:53], v9 offset:54080
    ds_read_b64_tr_b16 a[54:55], v9 offset:55120
    ds_read_b64_tr_b16 a[56:57], v9 offset:58240
    ds_read_b64_tr_b16 a[58:59], v9 offset:59280
    ds_read_b64_tr_b16 a[60:61], v9 offset:62400
    ds_read_b64_tr_b16 a[62:63], v9 offset:63440
    s_waitcnt vmcnt(20)
    s_waitcnt lgkmcnt(0)
    s_barrier
    s_mul_i32 s19, s13, 4160
    s_add_u32 m0, s19, 49920
    s_add_u32 s16, s44, 131072
    buffer_load_dwordx4 v8, s[8:11], s16 offen lds
    s_add_u32 m0, s19, 50960
    s_add_u32 s16, s44, 135168
    buffer_load_dwordx4 v8, s[8:11], s16 offen lds
    s_add_u32 m0, s19, 52000
    s_add_u32 s16, s44, 139264
    buffer_load_dwordx4 v8, s[8:11], s16 offen lds
    s_add_u32 m0, s19, 53040
    s_add_u32 s16, s44, 143360
    buffer_load_dwordx4 v8, s[8:11], s16 offen lds
    ds_read_b64_tr_b16 a[64:65], v10 offset:1024
    ds_read_b64_tr_b16 a[66:67], v10 offset:2064
    ds_read_b64_tr_b16 a[68:69], v10 offset:5184
    ds_read_b64_tr_b16 a[70:71], v10 offset:6224
    ds_read_b64_tr_b16 a[72:73], v10 offset:9344
    ds_read_b64_tr_b16 a[74:75], v10 offset:10384
    ds_read_b64_tr_b16 a[76:77], v10 offset:13504
    ds_read_b64_tr_b16 a[78:79], v10 offset:14544
    s_waitcnt vmcnt(20)
    s_waitcnt lgkmcnt(0)
    s_barrier
    s_mul_i32 s19, s13, 4160
    s_add_u32 m0, s19, 66560
    s_add_u32 s16, s44, 196608
    buffer_load_dwordx4 v8, s[8:11], s16 offen lds
    s_add_u32 m0, s19, 67600
    s_add_u32 s16, s44, 200704
    buffer_load_dwordx4 v8, s[8:11], s16 offen lds
    s_add_u32 m0, s19, 68640
    s_add_u32 s16, s44, 204800
    buffer_load_dwordx4 v8, s[8:11], s16 offen lds
    s_add_u32 m0, s19, 69680
    s_add_u32 s16, s44, 208896
    buffer_load_dwordx4 v8, s[8:11], s16 offen lds
    ds_read_b64_tr_b16 a[80:81], v10 offset:17664
    ds_read_b64_tr_b16 a[82:83], v10 offset:18704
    ds_read_b64_tr_b16 a[84:85], v10 offset:21824
    ds_read_b64_tr_b16 a[86:87], v10 offset:22864
    ds_read_b64_tr_b16 a[88:89], v10 offset:25984
    ds_read_b64_tr_b16 a[90:91], v10 offset:27024
    ds_read_b64_tr_b16 a[92:93], v10 offset:30144
    ds_read_b64_tr_b16 a[94:95], v10 offset:31184
    s_waitcnt vmcnt(20)
    s_waitcnt lgkmcnt(0)
    s_barrier
    s_mul_i32 s19, s13, 4160
    s_add_u32 m0, s19, 83200
    s_add_u32 s16, s44, 262144
    buffer_load_dwordx4 v8, s[8:11], s16 offen lds
    s_add_u32 m0, s19, 84240
    s_add_u32 s16, s44, 266240
    buffer_load_dwordx4 v8, s[8:11], s16 offen lds
    s_add_u32 m0, s19, 85280
    s_add_u32 s16, s44, 270336
    buffer_load_dwordx4 v8, s[8:11], s16 offen lds
    s_add_u32 m0, s19, 86320
    s_add_u32 s16, s44, 274432
    buffer_load_dwordx4 v8, s[8:11], s16 offen lds
    ds_read_b64_tr_b16 a[96:97], v10 offset:34304
    ds_read_b64_tr_b16 a[98:99], v10 offset:35344
    ds_read_b64_tr_b16 a[100:101], v10 offset:38464
    ds_read_b64_tr_b16 a[102:103], v10 offset:39504
    ds_read_b64_tr_b16 a[104:105], v10 offset:42624
    ds_read_b64_tr_b16 a[106:107], v10 offset:43664
    ds_read_b64_tr_b16 a[108:109], v10 offset:46784
    ds_read_b64_tr_b16 a[110:111], v10 offset:47824
    s_waitcnt vmcnt(20)
    s_waitcnt lgkmcnt(0)
    s_barrier
    s_mul_i32 s19, s13, 4160
    s_add_u32 m0, s19, 99840
    s_add_u32 s16, s44, 327680
    buffer_load_dwordx4 v8, s[8:11], s16 offen lds
    s_add_u32 m0, s19, 100880
    s_add_u32 s16, s44, 331776
    buffer_load_dwordx4 v8, s[8:11], s16 offen lds
    s_add_u32 m0, s19, 101920
    s_add_u32 s16, s44, 335872
    buffer_load_dwordx4 v8, s[8:11], s16 offen lds
    s_add_u32 m0, s19, 102960
    s_add_u32 s16, s44, 339968
    buffer_load_dwordx4 v8, s[8:11], s16 offen lds
    ds_read_b64_tr_b16 a[112:113], v9 offset:0
    ds_read_b64_tr_b16 a[114:115], v9 offset:1040
    ds_read_b64_tr_b16 a[116:117], v9 offset:4160
    ds_read_b64_tr_b16 a[118:119], v9 offset:5200
    ds_read_b64_tr_b16 a[120:121], v9 offset:8320
    ds_read_b64_tr_b16 a[122:123], v9 offset:9360
    ds_read_b64_tr_b16 a[124:125], v9 offset:12480
    ds_read_b64_tr_b16 a[126:127], v9 offset:13520
    s_waitcnt vmcnt(20)
    s_waitcnt lgkmcnt(0)
    s_barrier
    s_mul_i32 s19, s13, 4160
    s_add_u32 m0, s19, 0
    s_add_u32 s16, s44, 393216
    buffer_load_dwordx4 v8, s[8:11], s16 offen lds
    s_add_u32 m0, s19, 1040
    s_add_u32 s16, s44, 397312
    buffer_load_dwordx4 v8, s[8:11], s16 offen lds
    s_add_u32 m0, s19, 2080
    s_add_u32 s16, s44, 401408
    buffer_load_dwordx4 v8, s[8:11], s16 offen lds
    s_add_u32 m0, s19, 3120
    s_add_u32 s16, s44, 405504
    buffer_load_dwordx4 v8, s[8:11], s16 offen lds
    v_bfe_u32 v11, v0, 9, 1
    v_mul_u32_u24 v11, 1040, v11
    v_bfe_u32 v12, v0, 6, 2
    v_lshl_add_u32 v11, v12, 8, v11
    v_lshl_add_u32 v11, s13, 6, v11
    v_bfe_u32 v12, v0, 8, 1
    v_lshl_add_u32 v11, v12, 4, v11
    v_bfe_u32 v12, v0, 4, 1
    v_lshl_add_u32 v11, v12, 5, v11
    v_bfe_u32 v12, v0, 5, 1
    v_lshl_add_u32 v9, v12, 3, v11
    v_add_u32 v10, 0x10000, v9
    ds_read_b64_tr_b16 v[128:129], v9 offset:16640
    ds_read_b64_tr_b16 v[130:131], v9 offset:18720
    ds_read_b64_tr_b16 v[132:133], v9 offset:20800
    ds_read_b64_tr_b16 v[134:135], v9 offset:22880
    ds_read_b64_tr_b16 v[136:137], v9 offset:24960
    ds_read_b64_tr_b16 v[138:139], v9 offset:27040
    ds_read_b64_tr_b16 v[140:141], v9 offset:29120
    ds_read_b64_tr_b16 v[142:143], v9 offset:31200
    s_waitcnt vmcnt(20)
    s_waitcnt lgkmcnt(0)
    s_barrier
    s_mul_i32 s19, s13, 4160
    s_add_u32 m0, s19, 16640
    s_add_u32 s16, s44, 458752
    buffer_load_dwordx4 v8, s[8:11], s16 offen lds
    s_add_u32 m0, s19, 17680
    s_add_u32 s16, s44, 462848
    buffer_load_dwordx4 v8, s[8:11], s16 offen lds
    s_add_u32 m0, s19, 18720
    s_add_u32 s16, s44, 466944
    buffer_load_dwordx4 v8, s[8:11], s16 offen lds
    s_add_u32 m0, s19, 19760
    s_add_u32 s16, s44, 471040
    buffer_load_dwordx4 v8, s[8:11], s16 offen lds
    ds_read_b64_tr_b16 v[144:145], v9 offset:33280
    ds_read_b64_tr_b16 v[146:147], v9 offset:35360
    ds_read_b64_tr_b16 v[148:149], v9 offset:37440
    ds_read_b64_tr_b16 v[150:151], v9 offset:39520
    ds_read_b64_tr_b16 v[152:153], v9 offset:41600
    ds_read_b64_tr_b16 v[154:155], v9 offset:43680
    ds_read_b64_tr_b16 v[156:157], v9 offset:45760
    ds_read_b64_tr_b16 v[158:159], v9 offset:47840
    s_waitcnt vmcnt(20)
    s_waitcnt lgkmcnt(0)
    s_barrier
    ds_read_b64_tr_b16 v[160:161], v9 offset:49920
    ds_read_b64_tr_b16 v[162:163], v9 offset:52000
    ds_read_b64_tr_b16 v[164:165], v9 offset:54080
    ds_read_b64_tr_b16 v[166:167], v9 offset:56160
    ds_read_b64_tr_b16 v[168:169], v9 offset:58240
    ds_read_b64_tr_b16 v[170:171], v9 offset:60320
    ds_read_b64_tr_b16 v[172:173], v9 offset:62400
    ds_read_b64_tr_b16 v[174:175], v9 offset:64480
    s_waitcnt vmcnt(16)
    s_waitcnt lgkmcnt(0)
    s_barrier
    ds_read_b64_tr_b16 v[176:177], v10 offset:1024
    ds_read_b64_tr_b16 v[178:179], v10 offset:3104
    ds_read_b64_tr_b16 v[180:181], v10 offset:5184
    ds_read_b64_tr_b16 v[182:183], v10 offset:7264
    ds_read_b64_tr_b16 v[184:185], v10 offset:9344
    ds_read_b64_tr_b16 v[186:187], v10 offset:11424
    ds_read_b64_tr_b16 v[188:189], v10 offset:13504
    ds_read_b64_tr_b16 v[190:191], v10 offset:15584
    s_waitcnt vmcnt(12)
    s_waitcnt lgkmcnt(0)
    s_barrier
    ds_read_b64_tr_b16 v[192:193], v10 offset:17664
    ds_read_b64_tr_b16 v[194:195], v10 offset:19744
    ds_read_b64_tr_b16 v[196:197], v10 offset:21824
    ds_read_b64_tr_b16 v[198:199], v10 offset:23904
    ds_read_b64_tr_b16 v[200:201], v10 offset:25984
    ds_read_b64_tr_b16 v[202:203], v10 offset:28064
    ds_read_b64_tr_b16 v[204:205], v10 offset:30144
    ds_read_b64_tr_b16 v[206:207], v10 offset:32224
    s_waitcnt vmcnt(8)
    s_waitcnt lgkmcnt(0)
    s_barrier
    ds_read_b64_tr_b16 v[208:209], v10 offset:34304
    ds_read_b64_tr_b16 v[210:211], v10 offset:36384
    ds_read_b64_tr_b16 v[212:213], v10 offset:38464
    ds_read_b64_tr_b16 v[214:215], v10 offset:40544
    ds_read_b64_tr_b16 v[216:217], v10 offset:42624
    ds_read_b64_tr_b16 v[218:219], v10 offset:44704
    ds_read_b64_tr_b16 v[220:221], v10 offset:46784
    ds_read_b64_tr_b16 v[222:223], v10 offset:48864
    s_waitcnt vmcnt(4)
    s_waitcnt lgkmcnt(0)
    s_barrier
    ds_read_b64_tr_b16 v[224:225], v9 offset:0
    ds_read_b64_tr_b16 v[226:227], v9 offset:2080
    ds_read_b64_tr_b16 v[228:229], v9 offset:4160
    ds_read_b64_tr_b16 v[230:231], v9 offset:6240
    ds_read_b64_tr_b16 v[232:233], v9 offset:8320
    ds_read_b64_tr_b16 v[234:235], v9 offset:10400
    ds_read_b64_tr_b16 v[236:237], v9 offset:12480
    ds_read_b64_tr_b16 v[238:239], v9 offset:14560
    s_waitcnt vmcnt(0)
    s_waitcnt lgkmcnt(0)
    s_barrier
    ds_read_b64_tr_b16 v[240:241], v9 offset:16640
    ds_read_b64_tr_b16 v[242:243], v9 offset:18720
    ds_read_b64_tr_b16 v[244:245], v9 offset:20800
    ds_read_b64_tr_b16 v[246:247], v9 offset:22880
    ds_read_b64_tr_b16 v[248:249], v9 offset:24960
    ds_read_b64_tr_b16 v[250:251], v9 offset:27040
    ds_read_b64_tr_b16 v[252:253], v9 offset:29120
    ds_read_b64_tr_b16 v[254:255], v9 offset:31200
    s_waitcnt lgkmcnt(0)
    s_barrier
    v_mov_b32 v1, 0
    ds_write_b32 v24, v1
    s_lshl_b32 s17, s13, 1
    s_add_u32 s17, s17, s12
    s_lshl_b32 s17, s17, 15
    s_lshl_b32 s16, s14, 11
    s_add_u32 s17, s17, s16
    s_add_u32 s17, s17, 12582912
    buffer_load_dwordx4 v[64:67], v0, s[4:7], s17 offen offset:0 sc1
    buffer_load_dwordx4 v[64:67], v0, s[4:7], s17 offen offset:1024 sc1
    s_add_u32 s17, s17, 0x40000
    buffer_load_dwordx4 v[64:67], v0, s[4:7], s17 offen offset:0 sc1
    buffer_load_dwordx4 v[64:67], v0, s[4:7], s17 offen offset:1024 sc1
    s_lshl_b32 s17, s29, 8
    s_add_u32 s17, s17, s20
    s_add_u32 s17, s17, 1048576
    v_lshlrev_b32 v1, 3, v0
    buffer_load_dword v64, v1, s[4:7], s17 offen sc1
    s_waitcnt vmcnt(0) lgkmcnt(0)
    s_barrier
    s_branch L_rgnx_70
L_rgnw_69:
    s_lshl_b32 s18, s12, 11
    s_add_u32 s18, s18, 61440
    s_mov_b32 s19, 8
    s_cmp_eq_u32 s13, 0
    s_cbranch_scc0 L_wfo_84
    s_mov_b64 exec, 0xffff
    s_branch L_wg_85
L_wf_83:
    s_sleep 1
L_wg_85:
    buffer_load_dword v1, v3, s[4:7], s18 offen offset:0 sc1
    s_add_u32 s40, s40, 1
    s_cmp_gt_u32 s40, 262144
    s_cbranch_scc1 L_abort
    s_waitcnt vmcnt(0)
    v_cmp_gt_u32 vcc, s19, v1
    s_cbranch_vccnz L_wf_83
L_wfo_84:
    s_mov_b64 exec, -1
    s_barrier
L_rgnx_70:
    s_mov_b32 s21, s12
    s_cmp_eq_u32 s13, 3
    s_cbranch_scc0 L_rgnr_74
L_rgb_71:
    s_lshl_b32 s22, s15, 6
    s_add_u32 s22, s22, s21
    s_lshr_b32 s30, s22, 1
    s_add_u32 s30, s30, 1
    s_lshl_b32 s17, s21, 4
    s_add_u32 s17, s17, s14
    s_lshl_b32 s17, s17, 11
    s_cmp_eq_u32 s15, 0
    s_cbranch_scc0 L_rgb1_72
    buffer_load_dwordx2 v[8:9], v7, s[32:35], s17 offen offset:0
    buffer_load_dwordx2 v[10:11], v7, s[32:35], s17 offen offset:512
    buffer_load_dwordx2 v[12:13], v7, s[32:35], s17 offen offset:1024
    buffer_load_dwordx2 v[14:15], v7, s[32:35], s17 offen offset:1536
    s_branch L_rgb2_73
L_rgb1_72:
    s_add_u32 s18, s17, 171966464
    buffer_load_dwordx2 v[8:9], v7, s[4:7], s18 offen offset:0 sc1
    buffer_load_dwordx2 v[10:11], v7, s[4:7], s18 offen offset:512 sc1
    buffer_load_dwordx2 v[12:13], v7, s[4:7], s18 offen offset:1024 sc1
    buffer_load_dwordx2 v[14:15], v7, s[4:7], s18 offen offset:1536 sc1
L_rgb2_73:
    s_sub_u32 s19, s30, 4
    s_max_i32 s19, s19, 0
    s_lshl_b32 s18, s12, 13
    s_add_u32 s18, s18, 147456
    s_and_b32 s16, s30, 3
    s_cmp_eq_u32 s16, 1
    s_cbranch_scc0 L_rgb4_86
    s_branch L_wg_89
L_wf_87:
    s_sleep 2
L_wg_89:
    buffer_load_dword v1, v25, s[4:7], s18 offen offset:0 sc1
    s_add_u32 s40, s40, 1
    s_cmp_gt_u32 s40, 262144
    s_cbranch_scc1 L_abort
    s_waitcnt vmcnt(0)
    v_cmp_gt_u32 vcc, s19, v1
    s_cbranch_vccnz L_wf_87
L_wfo_88:
L_rgb4_86:
    s_cmp_ge_u32 s22, 112
    s_cselect_b32 s23, 1, s60
    s_waitcnt vmcnt(0)
    v_lshlrev_b32 v96, 16, v8
    v_and_b32 v97, 0xffff0000, v8
    v_lshlrev_b32 v98, 16, v9
    v_and_b32 v99, 0xffff0000, v9
    v_lshlrev_b32 v100, 16, v10
    v_and_b32 v101, 0xffff0000, v10
    v_lshlrev_b32 v102, 16, v11
    v_and_b32 v103, 0xffff0000, v11
    v_lshlrev_b32 v104, 16, v12
    v_and_b32 v105, 0xffff0000, v12
    v_lshlrev_b32 v106, 16, v13
    v_and_b32 v107, 0xffff0000, v13
    v_lshlrev_b32 v108, 16, v14
    v_and_b32 v109, 0xffff0000, v14
    v_lshlrev_b32 v110, 16, v15
    v_and_b32 v111, 0xffff0000, v15
    s_bfe_u32 s19, s21, 0x10001
    s_lshl_b32 s16, s12, 1
    s_add_u32 s19, s19, s16
    s_lshl_b32 s19, s19, 4
    s_add_u32 s19, s19, s14
    s_lshl_b32 s19, s19, 14
    s_add_u32 s19, s19, 1048576
    s_lshl_b32 s18, s12, 11
    s_add_u32 s18, s18, 45056
    s_mov_b64 exec, 0xffff
L_wf_90:
    buffer_load_dword v1, v3, s[4:7], s18 offen offset:0 sc1
    s_add_u32 s40, s40, 1
    s_cmp_gt_u32 s40, 262144
    s_cbranch_scc1 L_abort
    s_waitcnt vmcnt(0)
    v_cmp_gt_u32 vcc, s30, v1
    s_cbranch_vccnz L_wf_90
L_wfo_91:
    s_mov_b64 exec, -1
    buffer_load_dwordx4 v[32:35], v0, s[4:7], s19 offen offset:0 sc1
    buffer_load_dwordx4 v[36:39], v0, s[4:7], s19 offen offset:1024 sc1
    buffer_load_dwordx4 v[40:43], v0, s[4:7], s19 offen offset:2048 sc1
    buffer_load_dwordx4 v[44:47], v0, s[4:7], s19 offen offset:3072 sc1
    s_add_u32 s19, s19, 4096
    buffer_load_dwordx4 v[48:51], v0, s[4:7], s19 offen offset:0 sc1
    buffer_load_dwordx4 v[52:55], v0, s[4:7], s19 offen offset:1024 sc1
    buffer_load_dwordx4 v[56:59], v0, s[4:7], s19 offen offset:2048 sc1
    buffer_load_dwordx4 v[60:63], v0, s[4:7], s19 offen offset:3072 sc1
    s_add_u32 s19, s19, 4096
    buffer_load_dwordx4 v[64:67], v0, s[4:7], s19 offen offset:0 sc1
    buffer_load_dwordx4 v[68:71], v0, s[4:7], s19 offen offset:1024 sc1
    buffer_load_dwordx4 v[72:75], v0, s[4:7], s19 offen offset:2048 sc1
    buffer_load_dwordx4 v[76:79], v0, s[4:7], s19 offen offset:3072 sc1
    s_add_u32 s19, s19, 4096
    buffer_load_dwordx4 v[80:83], v0, s[4:7], s19 offen offset:0 sc1
    buffer_load_dwordx4 v[84:87], v0, s[4:7], s19 offen offset:1024 sc1
    buffer_load_dwordx4 v[88:91], v0, s[4:7], s19 offen offset:2048 sc1
    buffer_load_dwordx4 v[92:95], v0, s[4:7], s19 offen offset:3072 sc1
    s_lshl_b32 s16, s15, 21
    s_add_u32 s17, s17, s16
    s_add_u32 s19, s17, 8388608
    s_and_b32 s17, s17, 0x7ffff
    s_add_u32 s17, s17, 12582912
    s_add_u32 s18, s29, 49152
    s_waitcnt vmcnt(12)
    v_pk_add_f32 v[32:33], v[32:33], v[40:41]
    v_pk_add_f32 v[34:35], v[34:35], v[42:43]
    v_pk_add_f32 v[36:37], v[36:37], v[44:45]
    v_pk_add_f32 v[38:39], v[38:39], v[46:47]
    s_waitcnt vmcnt(8)
    v_pk_add_f32 v[48:49], v[48:49], v[56:57]
    v_pk_add_f32 v[50:51], v[50:51], v[58:59]
    v_pk_add_f32 v[52:53], v[52:53], v[60:61]
    v_pk_add_f32 v[54:55], v[54:55], v[62:63]
    v_pk_add_f32 v[32:33], v[32:33], v[48:49]
    v_pk_add_f32 v[34:35], v[34:35], v[50:51]
    v_pk_add_f32 v[36:37], v[36:37], v[52:53]
    v_pk_add_f32 v[38:39], v[38:39], v[54:55]
    v_cvt_pk_bf16_f32 v40, v32, v33
    v_cvt_pk_bf16_f32 v41, v34, v35
    v_cvt_pk_bf16_f32 v42, v36, v37
    v_cvt_pk_bf16_f32 v43, v38, v39
    v_lshlrev_b32 v32, 16, v40
    v_and_b32 v33, 0xffff0000, v40
    v_lshlrev_b32 v34, 16, v41
    v_and_b32 v35, 0xffff0000, v41
    v_lshlrev_b32 v36, 16, v42
    v_and_b32 v37, 0xffff0000, v42
    v_lshlrev_b32 v38, 16, v43
    v_and_b32 v39, 0xffff0000, v43
    v_pk_add_f32 v[96:97], v[96:97], v[32:33]
    v_pk_add_f32 v[98:99], v[98:99], v[34:35]
    v_pk_add_f32 v[100:101], v[100:101], v[36:37]
    v_pk_add_f32 v[102:103], v[102:103], v[38:39]
    v_cvt_pk_bf16_f32 v56, v96, v97
    v_cvt_pk_bf16_f32 v57, v98, v99
    v_cvt_pk_bf16_f32 v58, v100, v101
    v_cvt_pk_bf16_f32 v59, v102, v103
    s_cmp_lg_u32 s23, 0
    s_cbranch_scc1 L_du_93
    buffer_store_dwordx2 v[56:57], v7, s[4:7], s19 offen offset:0
    buffer_store_dwordx2 v[58:59], v7, s[4:7], s19 offen offset:512
    s_branch L_dv_94
L_du_93:
    buffer_store_dwordx2 v[56:57], v7, s[4:7], s19 offen offset:0 sc1
    buffer_store_dwordx2 v[58:59], v7, s[4:7], s19 offen offset:512 sc1
L_dv_94:
    v_lshlrev_b32 v96, 16, v56
    v_and_b32 v97, 0xffff0000, v56
    v_lshlrev_b32 v98, 16, v57
    v_and_b32 v99, 0xffff0000, v57
    v_lshlrev_b32 v100, 16, v58
    v_and_b32 v101, 0xffff0000, v58
    v_lshlrev_b32 v102, 16, v59
    v_and_b32 v103, 0xffff0000, v59
    s_waitcnt vmcnt(6)
    v_pk_add_f32 v[64:65], v[64:65], v[72:73]
    v_pk_add_f32 v[66:67], v[66:67], v[74:75]
    v_pk_add_f32 v[68:69], v[68:69], v[76:77]
    v_pk_add_f32 v[70:71], v[70:71], v[78:79]
    s_waitcnt vmcnt(2)
    v_pk_add_f32 v[80:81], v[80:81], v[88:89]
    v_pk_add_f32 v[82:83], v[82:83], v[90:91]
    v_pk_add_f32 v[84:85], v[84:85], v[92:93]
    v_pk_add_f32 v[86:87], v[86:87], v[94:95]
    v_pk_add_f32 v[64:65], v[64:65], v[80:81]
    v_pk_add_f32 v[66:67], v[66:67], v[82:83]
    v_pk_add_f32 v[68:69], v[68:69], v[84:85]
    v_pk_add_f32 v[70:71], v[70:71], v[86:87]
    v_cvt_pk_bf16_f32 v72, v64, v65
    v_cvt_pk_bf16_f32 v73, v66, v67
    v_cvt_pk_bf16_f32 v74, v68, v69
    v_cvt_pk_bf16_f32 v75, v70, v71
    v_lshlrev_b32 v64, 16, v72
    v_and_b32 v65, 0xffff0000, v72
    v_lshlrev_b32 v66, 16, v73
    v_and_b32 v67, 0xffff0000, v73
    v_lshlrev_b32 v68, 16, v74
    v_and_b32 v69, 0xffff0000, v74
    v_lshlrev_b32 v70, 16, v75
    v_and_b32 v71, 0xffff0000, v75
    v_pk_add_f32 v[104:105], v[104:105], v[64:65]
    v_pk_add_f32 v[106:107], v[106:107], v[66:67]
    v_pk_add_f32 v[108:109], v[108:109], v[68:69]
    v_pk_add_f32 v[110:111], v[110:111], v[70:71]
    v_cvt_pk_bf16_f32 v88, v104, v105
    v_cvt_pk_bf16_f32 v89, v106, v107
    v_cvt_pk_bf16_f32 v90, v108, v109
    v_cvt_pk_bf16_f32 v91, v110, v111
    s_cmp_lg_u32 s23, 0
    s_cbranch_scc1 L_du_95
    buffer_store_dwordx2 v[88:89], v7, s[4:7], s19 offen offset:1024
    buffer_store_dwordx2 v[90:91], v7, s[4:7], s19 offen offset:1536
    s_branch L_dv_96
L_du_95:
    buffer_store_dwordx2 v[88:89], v7, s[4:7], s19 offen offset:1024 sc1
    buffer_store_dwordx2 v[90:91], v7, s[4:7], s19 offen offset:1536 sc1
L_dv_96:
    v_lshlrev_b32 v104, 16, v88
    v_and_b32 v105, 0xffff0000, v88
    v_lshlrev_b32 v106, 16, v89
    v_and_b32 v107, 0xffff0000, v89
    v_lshlrev_b32 v108, 16, v90
    v_and_b32 v109, 0xffff0000, v90
    v_lshlrev_b32 v110, 16, v91
    v_and_b32 v111, 0xffff0000, v91
    v_pk_add_f32 v[112:113], v[96:97], v[98:99]
    v_pk_add_f32 v[114:115], v[100:101], v[102:103]
    v_pk_add_f32 v[120:121], v[104:105], v[106:107]
    v_pk_add_f32 v[122:123], v[108:109], v[110:111]
    v_pk_add_f32 v[112:113], v[112:113], v[114:115]
    v_pk_add_f32 v[120:121], v[120:121], v[122:123]
    v_add_f32 v32, v112, v113
    v_add_f32 v34, v120, v121
    s_nop 0
    v_add_f32_dpp v32, v32, v32 quad_perm:[1,0,3,2] row_mask:0xf bank_mask:0xf
    v_add_f32_dpp v34, v34, v34 quad_perm:[1,0,3,2] row_mask:0xf bank_mask:0xf
    s_nop 0
    v_add_f32_dpp v32, v32, v32 quad_perm:[2,3,0,1] row_mask:0xf bank_mask:0xf
    v_add_f32_dpp v34, v34, v34 quad_perm:[2,3,0,1] row_mask:0xf bank_mask:0xf
    s_nop 0
    v_add_f32_dpp v32, v32, v32 row_half_mirror row_mask:0xf bank_mask:0xf
    v_add_f32_dpp v34, v34, v34 row_half_mirror row_mask:0xf bank_mask:0xf
    s_nop 0
    v_add_f32_dpp v32, v32, v32 row_mirror row_mask:0xf bank_mask:0xf
    v_add_f32_dpp v34, v34, v34 row_mirror row_mask:0xf bank_mask:0xf
    v_mov_b32 v40, v32
    v_mov_b32 v41, v34
    s_nop 0
    v_permlane16_swap_b32 v32, v40
    v_permlane16_swap_b32 v34, v41
    v_add_f32 v32, v32, v40
    v_add_f32 v34, v34, v41
    v_mov_b32 v40, v32
    v_mov_b32 v41, v34
    s_nop 0
    v_permlane32_swap_b32 v32, v40
    v_permlane32_swap_b32 v34, v41
    v_add_f32 v32, v32, v40
    v_add_f32 v34, v34, v41
    v_mul_f32 v32, 0xbb000000, v32
    v_mul_f32 v34, 0xbb000000, v34
    v_pk_add_f32 v[112:113], v[96:97], v[32:33] op_sel_hi:[1,0]
    v_pk_add_f32 v[114:115], v[98:99], v[32:33] op_sel_hi:[1,0]
    v_pk_add_f32 v[116:117], v[100:101], v[32:33] op_sel_hi:[1,0]
    v_pk_add_f32 v[118:119], v[102:103], v[32:33] op_sel_hi:[1,0]
    v_pk_add_f32 v[120:121], v[104:105], v[34:35] op_sel_hi:[1,0]
    v_pk_add_f32 v[122:123], v[106:107], v[34:35] op_sel_hi:[1,0]
    v_pk_add_f32 v[124:125], v[108:109], v[34:35] op_sel_hi:[1,0]
    v_pk_add_f32 v[126:127], v[110:111], v[34:35] op_sel_hi:[1,0]
    v_pk_mul_f32 v[36:37], v[112:113], v[112:113]
    v_pk_fma_f32 v[36:37], v[114:115], v[114:115], v[36:37]
    v_pk_fma_f32 v[36:37], v[116:117], v[116:117], v[36:37]
    v_pk_fma_f32 v[36:37], v[118:119], v[118:119], v[36:37]
    v_pk_mul_f32 v[38:39], v[120:121], v[120:121]
    v_pk_fma_f32 v[38:39], v[122:123], v[122:123], v[38:39]
    v_pk_fma_f32 v[38:39], v[124:125], v[124:125], v[38:39]
    v_pk_fma_f32 v[38:39], v[126:127], v[126:127], v[38:39]
    v_add_f32 v36, v36, v37
    v_add_f32 v38, v38, v39
    s_nop 0
    v_add_f32_dpp v36, v36, v36 quad_perm:[1,0,3,2] row_mask:0xf bank_mask:0xf
    v_add_f32_dpp v38, v38, v38 quad_perm:[1,0,3,2] row_mask:0xf bank_mask:0xf
    s_nop 0
    v_add_f32_dpp v36, v36, v36 quad_perm:[2,3,0,1] row_mask:0xf bank_mask:0xf
    v_add_f32_dpp v38, v38, v38 quad_perm:[2,3,0,1] row_mask:0xf bank_mask:0xf
    s_nop 0
    v_add_f32_dpp v36, v36, v36 row_half_mirror row_mask:0xf bank_mask:0xf
    v_add_f32_dpp v38, v38, v38 row_half_mirror row_mask:0xf bank_mask:0xf
    s_nop 0
    v_add_f32_dpp v36, v36, v36 row_mirror row_mask:0xf bank_mask:0xf
    v_add_f32_dpp v38, v38, v38 row_mirror row_mask:0xf bank_mask:0xf
    v_mov_b32 v40, v36
    v_mov_b32 v41, v38
    s_nop 0
    v_permlane16_swap_b32 v36, v40
    v_permlane16_swap_b32 v38, v41
    v_add_f32 v36, v36, v40
    v_add_f32 v38, v38, v41
    v_mov_b32 v40, v36
    v_mov_b32 v41, v38
    s_nop 0
    v_permlane32_swap_b32 v36, v40
    v_permlane32_swap_b32 v38, v41
    v_add_f32 v36, v36, v40
    v_add_f32 v38, v38, v41
    v_cvt_pk_bf16_f32 v32, v32, v32
    v_lshlrev_b32 v32, 16, v32
    v_mul_f32 v36, 0x3b000000, v36
    v_cvt_pk_bf16_f32 v36, v36, v36
    v_lshlrev_b32 v36, 16, v36
    v_add_f32 v36, 0x3727c5ac, v36
    v_cvt_pk_bf16_f32 v36, v36, v36
    v_lshlrev_b32 v36, 16, v36
    v_sqrt_f32 v36, v36
    v_pk_add_f32 v[112:113], v[96:97], v[32:33] op_sel_hi:[1,0]
    v_pk_add_f32 v[114:115], v[98:99], v[32:33] op_sel_hi:[1,0]
    v_pk_add_f32 v[116:117], v[100:101], v[32:33] op_sel_hi:[1,0]
    v_pk_add_f32 v[118:119], v[102:103], v[32:33] op_sel_hi:[1,0]
    v_cvt_pk_bf16_f32 v36, v36, v36
    v_lshlrev_b32 v36, 16, v36
    v_rcp_f32 v36, v36
    v_cvt_pk_bf16_f32 v48, v112, v113
    v_cvt_pk_bf16_f32 v49, v114, v115
    v_cvt_pk_bf16_f32 v50, v116, v117
    v_cvt_pk_bf16_f32 v51, v118, v119
    v_lshlrev_b32 v112, 16, v48
    v_and_b32 v113, 0xffff0000, v48
    v_lshlrev_b32 v114, 16, v49
    v_and_b32 v115, 0xffff0000, v49
    v_lshlrev_b32 v116, 16, v50
    v_and_b32 v117, 0xffff0000, v50
    v_lshlrev_b32 v118, 16, v51
    v_and_b32 v119, 0xffff0000, v51
    v_pk_mul_f32 v[112:113], v[112:113], v[36:37] op_sel_hi:[1,0]
    v_pk_mul_f32 v[114:115], v[114:115], v[36:37] op_sel_hi:[1,0]
    v_pk_mul_f32 v[116:117], v[116:117], v[36:37] op_sel_hi:[1,0]
    v_pk_mul_f32 v[118:119], v[118:119], v[36:37] op_sel_hi:[1,0]
    v_cvt_pk_bf16_f32 v48, v112, v113
    v_cvt_pk_bf16_f32 v49, v114, v115
    v_cvt_pk_bf16_f32 v50, v116, v117
    v_cvt_pk_bf16_f32 v51, v118, v119
    v_cvt_pk_bf16_f32 v34, v34, v34
    v_lshlrev_b32 v34, 16, v34
    v_mul_f32 v38, 0x3b000000, v38
    v_cvt_pk_bf16_f32 v38, v38, v38
    v_lshlrev_b32 v38, 16, v38
    v_add_f32 v38, 0x3727c5ac, v38
    v_cvt_pk_bf16_f32 v38, v38, v38
    v_lshlrev_b32 v38, 16, v38
    v_sqrt_f32 v38, v38
    v_pk_add_f32 v[120:121], v[104:105], v[34:35] op_sel_hi:[1,0]
    v_pk_add_f32 v[122:123], v[106:107], v[34:35] op_sel_hi:[1,0]
    v_pk_add_f32 v[124:125], v[108:109], v[34:35] op_sel_hi:[1,0]
    v_pk_add_f32 v[126:127], v[110:111], v[34:35] op_sel_hi:[1,0]
    v_cvt_pk_bf16_f32 v38, v38, v38
    v_lshlrev_b32 v38, 16, v38
    v_rcp_f32 v38, v38
    v_cvt_pk_bf16_f32 v52, v120, v121
    v_cvt_pk_bf16_f32 v53, v122, v123
    v_cvt_pk_bf16_f32 v54, v124, v125
    v_cvt_pk_bf16_f32 v55, v126, v127
    v_lshlrev_b32 v120, 16, v52
    v_and_b32 v121, 0xffff0000, v52
    v_lshlrev_b32 v122, 16, v53
    v_and_b32 v123, 0xffff0000, v53
    v_lshlrev_b32 v124, 16, v54
    v_and_b32 v125, 0xffff0000, v54
    v_lshlrev_b32 v126, 16, v55
    v_and_b32 v127, 0xffff0000, v55
    v_pk_mul_f32 v[120:121], v[120:121], v[38:39] op_sel_hi:[1,0]
    v_pk_mul_f32 v[122:123], v[122:123], v[38:39] op_sel_hi:[1,0]
    v_pk_mul_f32 v[124:125], v[124:125], v[38:39] op_sel_hi:[1,0]
    v_pk_mul_f32 v[126:127], v[126:127], v[38:39] op_sel_hi:[1,0]
    v_cvt_pk_bf16_f32 v52, v120, v121
    v_cvt_pk_bf16_f32 v53, v122, v123
    v_cvt_pk_bf16_f32 v54, v124, v125
    v_cvt_pk_bf16_f32 v55, v126, v127
    s_cmp_lg_u32 s60, 0
    s_cbranch_scc1 L_du_97
    buffer_store_dwordx2 v[48:49], v7, s[4:7], s17 offen offset:0
    buffer_store_dwordx2 v[50:51], v7, s[4:7], s17 offen offset:512
    buffer_store_dwordx2 v[52:53], v7, s[4:7], s17 offen offset:1024
    buffer_store_dwordx2 v[54:55], v7, s[4:7], s17 offen offset:1536
    s_branch L_dv_98
L_du_97:
    buffer_store_dwordx2 v[48:49], v7, s[4:7], s17 offen offset:0 sc1
    buffer_store_dwordx2 v[50:51], v7, s[4:7], s17 offen offset:512 sc1
    buffer_store_dwordx2 v[52:53], v7, s[4:7], s17 offen offset:1024 sc1
    buffer_store_dwordx2 v[54:55], v7, s[4:7], s17 offen offset:1536 sc1
L_dv_98:
    s_waitcnt vmcnt(0)
    v_mov_b32 v1, s30
    s_mov_b64 exec, 1
    s_cmp_lg_u32 s60, 0
    s_cbranch_scc1 L_du_99
    buffer_store_dword v1, off, s[4:7], s18
    s_branch L_dv_100
L_du_99:
    buffer_store_dword v1, off, s[4:7], s18 sc1
L_dv_100:
    s_mov_b64 exec, -1
    s_add_u32 s21, s21, 2
    s_cmp_lt_u32 s21, 64
    s_cbranch_scc1 L_rgb_71
    s_branch L_rgng_75
L_rgnr_74:
    s_mul_i32 s23, s13, 10
    s_lshl_b32 s43, s23, 6
    s_lshl_b32 s16, s12, 11
    s_add_u32 s43, s43, s16
    s_add_u32 s43, s43, 49152
L_g2_101:
    s_lshl_b32 s22, s15, 6
    s_add_u32 s22, s22, s21
    s_lshr_b32 s30, s22, 1
    s_add_u32 s30, s30, 1
    s_and_b32 s16, s30, 1
    s_mul_i32 s42, s16, 33280
    v_add_u32 v6, s42, v20
    s_mul_i32 s16, s23, 1040
    s_add_u32 s42, s42, s16
    s_lshl_b32 s17, s22, 15
    s_and_b32 s17, s17, 0x7ffff
    s_lshl_b32 s16, s23, 10
    s_add_u32 s17, s17, s16
    s_add_u32 s17, s17, 12582912
    s_mov_b64 exec, 0x3f
L_wf_103:
    buffer_load_dword v1, v3, s[4:7], s43 offen offset:0 sc1
    s_add_u32 s40, s40, 1
    s_cmp_gt_u32 s40, 262144
    s_cbranch_scc1 L_abort
    s_waitcnt vmcnt(0)
    v_cmp_gt_u32 vcc, s30, v1
    s_cbranch_vccnz L_wf_103
L_wfo_104:
    s_mov_b64 exec, -1
    s_add_u32 m0, s42, 0
    s_add_u32 s16, s17, 0
    buffer_load_dwordx4 v0, s[4:7], s16 offen offset:0 sc1 lds
    s_add_u32 m0, s42, 16
    s_nop 0
    buffer_load_dwordx4 v0, s[4:7], s16 offen offset:1024 sc1 lds
    s_add_u32 m0, s42, 32
    s_nop 0
    buffer_load_dwordx4 v0, s[4:7], s16 offen offset:2048 sc1 lds
    s_add_u32 m0, s42, 48
    s_nop 0
    buffer_load_dwordx4 v0, s[4:7], s16 offen offset:3072 sc1 lds
    s_add_u32 m0, s42, 4160
    s_add_u32 s16, s17, 4096
    buffer_load_dwordx4 v0, s[4:7], s16 offen offset:0 sc1 lds
    s_add_u32 m0, s42, 4176
    s_nop 0
    buffer_load_dwordx4 v0, s[4:7], s16 offen offset:1024 sc1 lds
    s_add_u32 m0, s42, 4192
    s_nop 0
    buffer_load_dwordx4 v0, s[4:7], s16 offen offset:2048 sc1 lds
    s_add_u32 m0, s42, 4208
    s_nop 0
    buffer_load_dwordx4 v0, s[4:7], s16 offen offset:3072 sc1 lds
    s_add_u32 m0, s42, 8320
    s_add_u32 s16, s17, 8192
    buffer_load_dwordx4 v0, s[4:7], s16 offen offset:0 sc1 lds
    s_add_u32 m0, s42, 8336
    s_nop 0
    buffer_load_dwordx4 v0, s[4:7], s16 offen offset:1024 sc1 lds
    s_add_u32 m0, s42, 8352
    s_nop 0
    buffer_load_dwordx4 v0, s[4:7], s16 offen offset:2048 sc1 lds
    s_add_u32 m0, s42, 8368
    s_nop 0
    buffer_load_dwordx4 v0, s[4:7], s16 offen offset:3072 sc1 lds
    s_lshl_b32 s17, s22, 4
    s_add_u32 s17, s17, s14
    s_mul_i32 s17, s17, 6144
    s_lshl_b32 s16, s13, 10
    s_add_u32 s17, s17, s16
    s_add_u32 s17, s17, 150994944
    s_lshl_b32 s18, s29, 2
    s_lshl_b32 s16, s13, 7
    s_add_u32 s18, s18, s16
    s_add_u32 s18, s18, 147456
    s_lshl_b32 s16, 1, s13
    v_mov_b32 v1, s30
    s_mov_b32 exec_lo, s16
    s_mov_b32 exec_hi, 0
    s_waitcnt vmcnt(0)
    ds_write_b32 v24, v1
    s_mov_b64 exec, -1
L_g2s_102:
    ds_read_b32 v1, v24
    s_add_u32 s40, s40, 1
    s_cmp_gt_u32 s40, 262144
    s_cbranch_scc1 L_abort
    s_waitcnt lgkmcnt(0)
    v_cmp_gt_u32 vcc, s30, v1
    s_cbranch_vccnz L_g2s_102
    s_cmp_lt_u32 s13, 2
    s_cbranch_scc0 L_rgv_76
    ds_read_b128 v[8:11], v6 offset:0
    ds_read_b128 v[12:15], v6 offset:32
    s_waitcnt lgkmcnt(1)
    v_mfma_f32_32x32x16_bf16 v[32:47], a[0:3], v[8:11], 0
    s_nop 0
    ds_read_b128 v[16:19], v6 offset:64
    s_waitcnt lgkmcnt(1)
    v_mfma_f32_32x32x16_bf16 v[32:47], a[4:7], v[12:15], v[32:47]
    s_nop 0
    ds_read_b128 v[8:11], v6 offset:96
    s_waitcnt lgkmcnt(1)
    v_mfma_f32_32x32x16_bf16 v[32:47], a[8:11], v[16:19], v[32:47]
    s_nop 0
    ds_read_b128 v[12:15], v6 offset:128
    s_waitcnt lgkmcnt(1)
    v_mfma_f32_32x32x16_bf16 v[32:47], a[12:15], v[8:11], v[32:47]
    s_nop 0
    ds_read_b128 v[16:19], v6 offset:160
    s_waitcnt lgkmcnt(1)
    v_mfma_f32_32x32x16_bf16 v[32:47], a[16:19], v[12:15], v[32:47]
    s_nop 0
    ds_read_b128 v[8:11], v6 offset:192
    s_waitcnt lgkmcnt(1)
    v_mfma_f32_32x32x16_bf16 v[32:47], a[20:23], v[16:19], v[32:47]
    s_nop 0
    ds_read_b128 v[12:15], v6 offset:224
    s_waitcnt lgkmcnt(1)
    v_mfma_f32_32x32x16_bf16 v[32:47], a[24:27], v[8:11], v[32:47]
    s_nop 0
    ds_read_b128 v[16:19], v6 offset:256
    s_waitcnt lgkmcnt(1)
    v_mfma_f32_32x32x16_bf16 v[32:47], a[28:31], v[12:15], v[32:47]
    s_nop 0
    ds_read_b128 v[8:11], v6 offset:288
    s_waitcnt lgkmcnt(1)
    v_mfma_f32_32x32x16_bf16 v[32:47], a[32:35], v[16:19], v[32:47]
    s_nop 0
    ds_read_b128 v[12:15], v6 offset:320
    s_waitcnt lgkmcnt(1)
    v_mfma_f32_32x32x16_bf16 v[32:47], a[36:39], v[8:11], v[32:47]
    s_nop 0
    ds_read_b128 v[16:19], v6 offset:352
    s_waitcnt lgkmcnt(1)
    v_mfma_f32_32x32x16_bf16 v[32:47], a[40:43], v[12:15], v[32:47]
    s_nop 0
    ds_read_b128 v[8:11], v6 offset:384
    s_waitcnt lgkmcnt(1)
    v_mfma_f32_32x32x16_bf16 v[32:47], a[44:47], v[16:19], v[32:47]
    s_nop 0
    ds_read_b128 v[12:15], v6 offset:416
    s_waitcnt lgkmcnt(1)
    v_mfma_f32_32x32x16_bf16 v[32:47], a[48:51], v[8:11], v[32:47]
    s_nop 0
    ds_read_b128 v[16:19], v6 offset:448
    s_waitcnt lgkmcnt(1)
    v_mfma_f32_32x32x16_bf16 v[32:47], a[52:55], v[12:15], v[32:47]
    s_nop 0
    ds_read_b128 v[8:11], v6 offset:480
    s_waitcnt lgkmcnt(1)
    v_mfma_f32_32x32x16_bf16 v[32:47], a[56:59], v[16:19], v[32:47]
    s_nop 0
    ds_read_b128 v[12:15], v6 offset:512
    s_waitcnt lgkmcnt(1)
    v_mfma_f32_32x32x16_bf16 v[32:47], a[60:63], v[8:11], v[32:47]
    s_nop 0
    ds_read_b128 v[16:19], v6 offset:544
    s_waitcnt lgkmcnt(1)
    v_mfma_f32_32x32x16_bf16 v[32:47], a[64:67], v[12:15], v[32:47]
    s_nop 0
    ds_read_b128 v[8:11], v6 offset:576
    s_waitcnt lgkmcnt(1)
    v_mfma_f32_32x32x16_bf16 v[32:47], a[68:71], v[16:19], v[32:47]
    s_nop 0
    ds_read_b128 v[12:15], v6 offset:608
    s_waitcnt lgkmcnt(1)
    v_mfma_f32_32x32x16_bf16 v[32:47], a[72:75], v[8:11], v[32:47]
    s_nop 0
    ds_read_b128 v[16:19], v6 offset:640
    s_waitcnt lgkmcnt(1)
    v_mfma_f32_32x32x16_bf16 v[32:47], a[76:79], v[12:15], v[32:47]
    s_nop 0
    ds_read_b128 v[8:11], v6 offset:672
    s_waitcnt lgkmcnt(1)
    v_mfma_f32_32x32x16_bf16 v[32:47], a[80:83], v[16:19], v[32:47]
    s_nop 0
    ds_read_b128 v[12:15], v6 offset:704
    s_waitcnt lgkmcnt(1)
    v_mfma_f32_32x32x16_bf16 v[32:47], a[84:87], v[8:11], v[32:47]
    s_nop 0
    ds_read_b128 v[16:19], v6 offset:736
    s_waitcnt lgkmcnt(1)
    v_mfma_f32_32x32x16_bf16 v[32:47], a[88:91], v[12:15], v[32:47]
    s_nop 0
    ds_read_b128 v[8:11], v6 offset:768
    s_waitcnt lgkmcnt(1)
    v_mfma_f32_32x32x16_bf16 v[32:47], a[92:95], v[16:19], v[32:47]
    s_nop 0
    ds_read_b128 v[12:15], v6 offset:800
    s_waitcnt lgkmcnt(1)
    v_mfma_f32_32x32x16_bf16 v[32:47], a[96:99], v[8:11], v[32:47]
    s_nop 0
    ds_read_b128 v[16:19], v6 offset:832
    s_waitcnt lgkmcnt(1)
    v_mfma_f32_32x32x16_bf16 v[32:47], a[100:103], v[12:15], v[32:47]
    s_nop 0
    ds_read_b128 v[8:11], v6 offset:864
    s_waitcnt lgkmcnt(1)
    v_mfma_f32_32x32x16_bf16 v[32:47], a[104:107], v[16:19], v[32:47]
    s_nop 0
    ds_read_b128 v[12:15], v6 offset:896
    s_waitcnt lgkmcnt(1)
    v_mfma_f32_32x32x16_bf16 v[32:47], a[108:111], v[8:11], v[32:47]
    s_nop 0
    ds_read_b128 v[16:19], v6 offset:928
    s_waitcnt lgkmcnt(1)
    v_mfma_f32_32x32x16_bf16 v[32:47], a[112:115], v[12:15], v[32:47]
    s_nop 0
    ds_read_b128 v[8:11], v6 offset:960
    s_waitcnt lgkmcnt(1)
    v_mfma_f32_32x32x16_bf16 v[32:47], a[116:119], v[16:19], v[32:47]
    s_nop 0
    ds_read_b128 v[12:15], v6 offset:992
    s_waitcnt lgkmcnt(1)
    v_mfma_f32_32x32x16_bf16 v[32:47], a[120:123], v[8:11], v[32:47]
    s_waitcnt lgkmcnt(0)
    v_mfma_f32_32x32x16_bf16 v[32:47], a[124:127], v[12:15], v[32:47]
    v_mov_b32 v64, s28
    s_nop 10
    v_pk_mul_f32 v[32:33], v[32:33], v[64:65] op_sel_hi:[1,0]
    v_pk_mul_f32 v[34:35], v[34:35], v[64:65] op_sel_hi:[1,0]
    v_pk_mul_f32 v[36:37], v[36:37], v[64:65] op_sel_hi:[1,0]
    v_pk_mul_f32 v[38:39], v[38:39], v[64:65] op_sel_hi:[1,0]
    v_pk_mul_f32 v[40:41], v[40:41], v[64:65] op_sel_hi:[1,0]
    v_pk_mul_f32 v[42:43], v[42:43], v[64:65] op_sel_hi:[1,0]
    v_pk_mul_f32 v[44:45], v[44:45], v[64:65] op_sel_hi:[1,0]
    v_pk_mul_f32 v[46:47], v[46:47], v[64:65] op_sel_hi:[1,0]
    v_cvt_pk_bf16_f32 v48, v32, v33
    v_cvt_pk_bf16_f32 v49, v34, v35
    v_cvt_pk_bf16_f32 v50, v36, v37
    v_cvt_pk_bf16_f32 v51, v38, v39
    v_cvt_pk_bf16_f32 v52, v40, v41
    v_cvt_pk_bf16_f32 v53, v42, v43
    v_cvt_pk_bf16_f32 v54, v44, v45
    v_cvt_pk_bf16_f32 v55, v46, v47
    buffer_store_dwordx4 v[48:51], v23, s[4:7], s17 offen offset:0 sc1
    buffer_store_dwordx4 v[52:55], v23, s[4:7], s17 offen offset:3072 sc1
    s_branch L_rgv2_77
L_rgv_76:
    ds_read_b128 v[8:11], v6 offset:0
    ds_read_b128 v[12:15], v6 offset:32
    s_waitcnt lgkmcnt(1)
    v_mfma_f32_32x32x16_bf16 v[32:47], v[8:11], a[0:3], 0
    s_nop 0
    ds_read_b128 v[16:19], v6 offset:64
    s_waitcnt lgkmcnt(1)
    v_mfma_f32_32x32x16_bf16 v[32:47], v[12:15], a[4:7], v[32:47]
    s_nop 0
    ds_read_b128 v[8:11], v6 offset:96
    s_waitcnt lgkmcnt(1)
    v_mfma_f32_32x32x16_bf16 v[32:47], v[16:19], a[8:11], v[32:47]
    s_nop 0
    ds_read_b128 v[12:15], v6 offset:128
    s_waitcnt lgkmcnt(1)
    v_mfma_f32_32x32x16_bf16 v[32:47], v[8:11], a[12:15], v[32:47]
    s_nop 0
    ds_read_b128 v[16:19], v6 offset:160
    s_waitcnt lgkmcnt(1)
    v_mfma_f32_32x32x16_bf16 v[32:47], v[12:15], a[16:19], v[32:47]
    s_nop 0
    ds_read_b128 v[8:11], v6 offset:192
    s_waitcnt lgkmcnt(1)
    v_mfma_f32_32x32x16_bf16 v[32:47], v[16:19], a[20:23], v[32:47]
    s_nop 0
    ds_read_b128 v[12:15], v6 offset:224
    s_waitcnt lgkmcnt(1)
    v_mfma_f32_32x32x16_bf16 v[32:47], v[8:11], a[24:27], v[32:47]
    s_nop 0
    ds_read_b128 v[16:19], v6 offset:256
    s_waitcnt lgkmcnt(1)
    v_mfma_f32_32x32x16_bf16 v[32:47], v[12:15], a[28:31], v[32:47]
    s_nop 0
    ds_read_b128 v[8:11], v6 offset:288
    s_waitcnt lgkmcnt(1)
    v_mfma_f32_32x32x16_bf16 v[32:47], v[16:19], a[32:35], v[32:47]
    s_nop 0
    ds_read_b128 v[12:15], v6 offset:320
    s_waitcnt lgkmcnt(1)
    v_mfma_f32_32x32x16_bf16 v[32:47], v[8:11], a[36:39], v[32:47]
    s_nop 0
    ds_read_b128 v[16:19], v6 offset:352
    s_waitcnt lgkmcnt(1)
    v_mfma_f32_32x32x16_bf16 v[32:47], v[12:15], a[40:43], v[32:47]
    s_nop 0
    ds_read_b128 v[8:11], v6 offset:384
    s_waitcnt lgkmcnt(1)
    v_mfma_f32_32x32x16_bf16 v[32:47], v[16:19], a[44:47], v[32:47]
    s_nop 0
    ds_read_b128 v[12:15], v6 offset:416
    s_waitcnt lgkmcnt(1)
    v_mfma_f32_32x32x16_bf16 v[32:47], v[8:11], a[48:51], v[32:47]
    s_nop 0
    ds_read_b128 v[16:19], v6 offset:448
    s_waitcnt lgkmcnt(1)
    v_mfma_f32_32x32x16_bf16 v[32:47], v[12:15], a[52:55], v[32:47]
    s_nop 0
    ds_read_b128 v[8:11], v6 offset:480
    s_waitcnt lgkmcnt(1)
    v_mfma_f32_32x32x16_bf16 v[32:47], v[16:19], a[56:59], v[32:47]
    s_nop 0
    ds_read_b128 v[12:15], v6 offset:512
    s_waitcnt lgkmcnt(1)
    v_mfma_f32_32x32x16_bf16 v[32:47], v[8:11], a[60:63], v[32:47]
    s_nop 0
    ds_read_b128 v[16:19], v6 offset:544
    s_waitcnt lgkmcnt(1)
    v_mfma_f32_32x32x16_bf16 v[32:47], v[12:15], a[64:67], v[32:47]
    s_nop 0
    ds_read_b128 v[8:11], v6 offset:576
    s_waitcnt lgkmcnt(1)
    v_mfma_f32_32x32x16_bf16 v[32:47], v[16:19], a[68:71], v[32:47]
    s_nop 0
    ds_read_b128 v[12:15], v6 offset:608
    s_waitcnt lgkmcnt(1)
    v_mfma_f32_32x32x16_bf16 v[32:47], v[8:11], a[72:75], v[32:47]
    s_nop 0
    ds_read_b128 v[16:19], v6 offset:640
    s_waitcnt lgkmcnt(1)
    v_mfma_f32_32x32x16_bf16 v[32:47], v[12:15], a[76:79], v[32:47]
    s_nop 0
    ds_read_b128 v[8:11], v6 offset:672
    s_waitcnt lgkmcnt(1)
    v_mfma_f32_32x32x16_bf16 v[32:47], v[16:19], a[80:83], v[32:47]
    s_nop 0
    ds_read_b128 v[12:15], v6 offset:704
    s_waitcnt lgkmcnt(1)
    v_mfma_f32_32x32x16_bf16 v[32:47], v[8:11], a[84:87], v[32:47]
    s_nop 0
    ds_read_b128 v[16:19], v6 offset:736
    s_waitcnt lgkmcnt(1)
    v_mfma_f32_32x32x16_bf16 v[32:47], v[12:15], a[88:91], v[32:47]
    s_nop 0
    ds_read_b128 v[8:11], v6 offset:768
    s_waitcnt lgkmcnt(1)
    v_mfma_f32_32x32x16_bf16 v[32:47], v[16:19], a[92:95], v[32:47]
    s_nop 0
    ds_read_b128 v[12:15], v6 offset:800
    s_waitcnt lgkmcnt(1)
    v_mfma_f32_32x32x16_bf16 v[32:47], v[8:11], a[96:99], v[32:47]
    s_nop 0
    ds_read_b128 v[16:19], v6 offset:832
    s_waitcnt lgkmcnt(1)
    v_mfma_f32_32x32x16_bf16 v[32:47], v[12:15], a[100:103], v[32:47]
    s_nop 0
    ds_read_b128 v[8:11], v6 offset:864
    s_waitcnt lgkmcnt(1)
    v_mfma_f32_32x32x16_bf16 v[32:47], v[16:19], a[104:107], v[32:47]
    s_nop 0
    ds_read_b128 v[12:15], v6 offset:896
    s_waitcnt lgkmcnt(1)
    v_mfma_f32_32x32x16_bf16 v[32:47], v[8:11], a[108:111], v[32:47]
    s_nop 0
    ds_read_b128 v[16:19], v6 offset:928
    s_waitcnt lgkmcnt(1)
    v_mfma_f32_32x32x16_bf16 v[32:47], v[12:15], a[112:115], v[32:47]
    s_nop 0
    ds_read_b128 v[8:11], v6 offset:960
    s_waitcnt lgkmcnt(1)
    v_mfma_f32_32x32x16_bf16 v[32:47], v[16:19], a[116:119], v[32:47]
    s_nop 0
    ds_read_b128 v[12:15], v6 offset:992
    s_waitcnt lgkmcnt(1)
    v_mfma_f32_32x32x16_bf16 v[32:47], v[8:11], a[120:123], v[32:47]
    s_waitcnt lgkmcnt(0)
    v_mfma_f32_32x32x16_bf16 v[32:47], v[12:15], a[124:127], v[32:47]
    s_nop 11
    v_cvt_pk_bf16_f32 v48, v32, v33
    v_cvt_pk_bf16_f32 v49, v34, v35
    v_cvt_pk_bf16_f32 v50, v36, v37
    v_cvt_pk_bf16_f32 v51, v38, v39
    v_cvt_pk_bf16_f32 v52, v40, v41
    v_cvt_pk_bf16_f32 v53, v42, v43
    v_cvt_pk_bf16_f32 v54, v44, v45
    v_cvt_pk_bf16_f32 v55, v46, v47
    buffer_store_dwordx4 v[48:51], v22, s[4:7], s17 offen offset:0 sc1
    buffer_store_dwordx4 v[52:55], v22, s[4:7], s17 offen offset:512 sc1
L_rgv2_77:
    s_waitcnt vmcnt(0)
    v_mov_b32 v1, s30
    s_mov_b64 exec, 1
    buffer_store_dword v1, off, s[4:7], s18 sc1
    s_mov_b64 exec, -1
    s_add_u32 s21, s21, 2
    s_cmp_lt_u32 s21, 64
    s_cbranch_scc1 L_g2_101
L_rgng_75:
    s_add_u32 s15, s15, 1
    s_cmp_lt_u32 s15, 2
    s_cbranch_scc1 L_rgl_65
    s_mov_b32 s15, 1
    s_lshl_b32 s21, s26, 1
    s_add_u32 s21, s21, s12
    s_add_u32 s21, s21, 8
    s_mov_b32 s41, 16
    s_mov_b32 s49, 48
    s_branch L_g3
    s_branch L_fin
L_r4:
L_r4c:
    s_cmp_eq_u32 s13, 3
    s_cbranch_scc0 L_ar_106
    s_cmp_lg_u32 s59, 0
    s_cbranch_scc1 L_ar_106
    s_lshr_b32 s16, s2, 3
    s_lshl_b32 s16, 1, s16
    v_mov_b32 v100, s16
    s_and_b32 s16, s61, 7
    s_lshl_b32 s16, s16, 5
    s_and_b32 s17, s61, 8
    s_lshl_b32 s17, s17, 1
    s_or_b32 s16, s16, s17
    v_mov_b32 v101, 0x100
    v_mov_b32 v102, s16
    s_mov_b64 exec, 1
    s_waitcnt vmcnt(0)
    global_atomic_add_x2 v[126:127], v102, v[100:101], s[56:57] sc0 sc1
    s_mov_b64 exec, -1
L_ar_106:
    s_sub_u32 s17, s58, 192
    s_lshl_b32 s17, s17, 2
    s_add_u32 s17, s17, s13
    s_lshl_b32 s17, s17, 10
    s_load_dwordx2 s[8:9], s[0:1], 32
    s_mov_b32 s10, 4194304
    s_mov_b32 s11, 0x20000
    s_waitcnt lgkmcnt(0)
    s_mov_b32 s16, s17
L_wm_107:
    buffer_load_dwordx4 v[16:19], v0, s[8:11], s16 offen
    s_add_u32 s16, s16, 0x40000
    s_waitcnt vmcnt(24)
    s_cmp_lt_u32 s16, 4194304
    s_cbranch_scc1 L_wm_107
    s_load_dwordx2 s[8:9], s[0:1], 40
    s_mov_b32 s10, 4194304
    s_mov_b32 s11, 0x20000
    s_waitcnt lgkmcnt(0)
    s_mov_b32 s16, s17
L_wm_108:
    buffer_load_dwordx4 v[16:19], v0, s[8:11], s16 offen
    s_add_u32 s16, s16, 0x40000
    s_waitcnt vmcnt(24)
    s_cmp_lt_u32 s16, 4194304
    s_cbranch_scc1 L_wm_108
    s_load_dwordx2 s[8:9], s[0:1], 16
    s_mov_b32 s10, 4194304
    s_mov_b32 s11, 0x20000
    s_waitcnt lgkmcnt(0)
    s_mov_b32 s16, s17
L_wm_109:
    buffer_load_dwordx4 v[16:19], v0, s[8:11], s16 offen
    s_add_u32 s16, s16, 0x40000
    s_waitcnt vmcnt(24)
    s_cmp_lt_u32 s16, 4194304
    s_cbranch_scc1 L_wm_109
    s_load_dwordx2 s[8:9], s[0:1], 24
    s_mov_b32 s10, 4194304
    s_mov_b32 s11, 0x20000
    s_waitcnt lgkmcnt(0)
    s_mov_b32 s16, s17
L_wm_110:
    buffer_load_dwordx4 v[16:19], v0, s[8:11], s16 offen
    s_add_u32 s16, s16, 0x40000
    s_waitcnt vmcnt(24)
    s_cmp_lt_u32 s16, 4194304
    s_cbranch_scc1 L_wm_110
    s_waitcnt vmcnt(0)
    s_cmp_lg_u32 s59, 0
    s_cbranch_scc1 L_vok_112
L_vp_111:
    v_and_b32 v102, 0xf0, v0
    global_load_dwordx2 v[100:101], v102, s[56:57] sc1
    s_waitcnt vmcnt(0)
L_vc_114:
    v_lshrrev_b32 v103, 8, v101
    s_nop 1
    v_add_u32_dpp v103, v103, v103 quad_perm:[1,0,3,2] row_mask:0xf bank_mask:0xf
    s_nop 1
    v_add_u32_dpp v103, v103, v103 quad_perm:[2,3,0,1] row_mask:0xf bank_mask:0xf
    s_nop 1
    v_add_u32_dpp v103, v103, v103 row_half_mirror row_mask:0xf bank_mask:0xf
    s_nop 1
    v_add_u32_dpp v103, v103, v103 row_mirror row_mask:0xf bank_mask:0xf
    v_cmp_ne_u32 vcc, 0x100, v103
    s_cbranch_vccz L_vgo_113
    s_add_u32 s40, s40, 1
    s_cmp_gt_u32 s40, 262144
    s_cbranch_scc1 L_abort
    s_sleep 2
    s_branch L_vp_111
L_vgo_113:
    s_mov_b32 s59, 1
    v_cmp_ne_u32 vcc, -1, v100
    s_and_b32 s16, vcc_lo, 0x5555
    v_cmp_ne_u32 vcc, 0x2000, v101
    s_and_b32 s17, vcc_lo, 0x5555
    s_or_b32 s16, s16, s17
    s_cbranch_scc0 L_vok_112
    v_lshrrev_b32 v103, 8, v101
    v_cmp_ne_u32 vcc, 32, v103
    s_and_b32 s60, vcc_lo, 0x5555
    s_branch L_redo
L_vok_112:
    v_lshlrev_b32 v124, 16, v0
    s_lshl_b32 s16, s13, 26
    s_add_u32 s16, s16, 1048448
    buffer_load_dword v124, v124, s[4:7], s16 offen sc1
    s_and_b32 s44, s58, 3
    s_lshl_b32 s44, s44, 8
    s_load_dwordx2 s[8:9], s[0:1], 72
    s_mov_b32 s10, 524288
    s_mov_b32 s11, 0x20000
    s_waitcnt lgkmcnt(0)
    v_lshrrev_b32 v19, 8, v0
    v_lshl_add_u32 v19, s13, 4, v19
    v_mul_u32_u24 v19, 1024, v19
    v_and_b32 v16, 0xf0, v0
    v_add_u32 v16, v19, v16
    s_mul_i32 s19, s13, 4160
    s_add_u32 m0, s19, 0
    s_add_u32 s16, s44, 0
    buffer_load_dwordx4 v16, s[8:11], s16 offen lds
    s_add_u32 m0, s19, 1040
    s_add_u32 s16, s44, 4096
    buffer_load_dwordx4 v16, s[8:11], s16 offen lds
    s_add_u32 m0, s19, 2080
    s_add_u32 s16, s44, 8192
    buffer_load_dwordx4 v16, s[8:11], s16 offen lds
    s_add_u32 m0, s19, 3120
    s_add_u32 s16, s44, 12288
    buffer_load_dwordx4 v16, s[8:11], s16 offen lds
    s_mul_i32 s19, s13, 4160
    s_add_u32 m0, s19, 16640
    s_add_u32 s16, s44, 65536
    buffer_load_dwordx4 v16, s[8:11], s16 offen lds
    s_add_u32 m0, s19, 17680
    s_add_u32 s16, s44, 69632
    buffer_load_dwordx4 v16, s[8:11], s16 offen lds
    s_add_u32 m0, s19, 18720
    s_add_u32 s16, s44, 73728
    buffer_load_dwordx4 v16, s[8:11], s16 offen lds
    s_add_u32 m0, s19, 19760
    s_add_u32 s16, s44, 77824
    buffer_load_dwordx4 v16, s[8:11], s16 offen lds
    s_mul_i32 s19, s13, 4160
    s_add_u32 m0, s19, 33280
    s_add_u32 s16, s44, 131072
    buffer_load_dwordx4 v16, s[8:11], s16 offen lds
    s_add_u32 m0, s19, 34320
    s_add_u32 s16, s44, 135168
    buffer_load_dwordx4 v16, s[8:11], s16 offen lds
    s_add_u32 m0, s19, 35360
    s_add_u32 s16, s44, 139264
    buffer_load_dwordx4 v16, s[8:11], s16 offen lds
    s_add_u32 m0, s19, 36400
    s_add_u32 s16, s44, 143360
    buffer_load_dwordx4 v16, s[8:11], s16 offen lds
    s_mul_i32 s19, s13, 4160
    s_add_u32 m0, s19, 49920
    s_add_u32 s16, s44, 196608
    buffer_load_dwordx4 v16, s[8:11], s16 offen lds
    s_add_u32 m0, s19, 50960
    s_add_u32 s16, s44, 200704
    buffer_load_dwordx4 v16, s[8:11], s16 offen lds
    s_add_u32 m0, s19, 52000
    s_add_u32 s16, s44, 204800
    buffer_load_dwordx4 v16, s[8:11], s16 offen lds
    s_add_u32 m0, s19, 53040
    s_add_u32 s16, s44, 208896
    buffer_load_dwordx4 v16, s[8:11], s16 offen lds
    s_mul_i32 s19, s13, 4160
    s_add_u32 m0, s19, 66560
    s_add_u32 s16, s44, 262144
    buffer_load_dwordx4 v16, s[8:11], s16 offen lds
    s_add_u32 m0, s19, 67600
    s_add_u32 s16, s44, 266240
    buffer_load_dwordx4 v16, s[8:11], s16 offen lds
    s_add_u32 m0, s19, 68640
    s_add_u32 s16, s44, 270336
    buffer_load_dwordx4 v16, s[8:11], s16 offen lds
    s_add_u32 m0, s19, 69680
    s_add_u32 s16, s44, 274432
    buffer_load_dwordx4 v16, s[8:11], s16 offen lds
    s_mul_i32 s19, s13, 4160
    s_add_u32 m0, s19, 83200
    s_add_u32 s16, s44, 327680
    buffer_load_dwordx4 v16, s[8:11], s16 offen lds
    s_add_u32 m0, s19, 84240
    s_add_u32 s16, s44, 331776
    buffer_load_dwordx4 v16, s[8:11], s16 offen lds
    s_add_u32 m0, s19, 85280
    s_add_u32 s16, s44, 335872
    buffer_load_dwordx4 v16, s[8:11], s16 offen lds
    s_add_u32 m0, s19, 86320
    s_add_u32 s16, s44, 339968
    buffer_load_dwordx4 v16, s[8:11], s16 offen lds
    s_waitcnt vmcnt(20)
    s_waitcnt lgkmcnt(0)
    s_barrier
    s_mul_i32 s19, s13, 4160
    s_add_u32 m0, s19, 99840
    s_add_u32 s16, s44, 393216
    buffer_load_dwordx4 v16, s[8:11], s16 offen lds
    s_add_u32 m0, s19, 100880
    s_add_u32 s16, s44, 397312
    buffer_load_dwordx4 v16, s[8:11], s16 offen lds
    s_add_u32 m0, s19, 101920
    s_add_u32 s16, s44, 401408
    buffer_load_dwordx4 v16, s[8:11], s16 offen lds
    s_add_u32 m0, s19, 102960
    s_add_u32 s16, s44, 405504
    buffer_load_dwordx4 v16, s[8:11], s16 offen lds
    v_bfe_u32 v19, v0, 9, 1
    v_mul_u32_u24 v19, 1040, v19
    v_bfe_u32 v20, v0, 6, 2
    v_lshl_add_u32 v19, v20, 8, v19
    v_lshl_add_u32 v19, s13, 6, v19
    v_bfe_u32 v20, v0, 8, 1
    v_lshl_add_u32 v19, v20, 4, v19
    v_bfe_u32 v20, v0, 4, 1
    v_lshl_add_u32 v19, v20, 5, v19
    v_bfe_u32 v20, v0, 5, 1
    v_lshl_add_u32 v17, v20, 3, v19
    v_add_u32 v18, 0x10000, v17
    ds_read_b64_tr_b16 a[128:129], v17 offset:0
    ds_read_b64_tr_b16 a[130:131], v17 offset:2080
    ds_read_b64_tr_b16 a[132:133], v17 offset:4160
    ds_read_b64_tr_b16 a[134:135], v17 offset:6240
    ds_read_b64_tr_b16 a[136:137], v17 offset:8320
    ds_read_b64_tr_b16 a[138:139], v17 offset:10400
    ds_read_b64_tr_b16 a[140:141], v17 offset:12480
    ds_read_b64_tr_b16 a[142:143], v17 offset:14560
    s_waitcnt vmcnt(20)
    s_waitcnt lgkmcnt(0)
    s_barrier
    s_mul_i32 s19, s13, 4160
    s_add_u32 m0, s19, 0
    s_add_u32 s16, s44, 458752
    buffer_load_dwordx4 v16, s[8:11], s16 offen lds
    s_add_u32 m0, s19, 1040
    s_add_u32 s16, s44, 462848
    buffer_load_dwordx4 v16, s[8:11], s16 offen lds
    s_add_u32 m0, s19, 2080
    s_add_u32 s16, s44, 466944
    buffer_load_dwordx4 v16, s[8:11], s16 offen lds
    s_add_u32 m0, s19, 3120
    s_add_u32 s16, s44, 471040
    buffer_load_dwordx4 v16, s[8:11], s16 offen lds
    ds_read_b64_tr_b16 a[144:145], v17 offset:16640
    ds_read_b64_tr_b16 a[146:147], v17 offset:18720
    ds_read_b64_tr_b16 a[148:149], v17 offset:20800
    ds_read_b64_tr_b16 a[150:151], v17 offset:22880
    ds_read_b64_tr_b16 a[152:153], v17 offset:24960
    ds_read_b64_tr_b16 a[154:155], v17 offset:27040
    ds_read_b64_tr_b16 a[156:157], v17 offset:29120
    ds_read_b64_tr_b16 a[158:159], v17 offset:31200
    s_waitcnt vmcnt(20)
    s_waitcnt lgkmcnt(0)
    s_barrier
    ds_read_b64_tr_b16 a[160:161], v17 offset:33280
    ds_read_b64_tr_b16 a[162:163], v17 offset:35360
    ds_read_b64_tr_b16 a[164:165], v17 offset:37440
    ds_read_b64_tr_b16 a[166:167], v17 offset:39520
    ds_read_b64_tr_b16 a[168:169], v17 offset:41600
    ds_read_b64_tr_b16 a[170:171], v17 offset:43680
    ds_read_b64_tr_b16 a[172:173], v17 offset:45760
    ds_read_b64_tr_b16 a[174:175], v17 offset:47840
    s_waitcnt vmcnt(16)
    s_waitcnt lgkmcnt(0)
    s_barrier
    ds_read_b64_tr_b16 a[176:177], v17 offset:49920
    ds_read_b64_tr_b16 a[178:179], v17 offset:52000
    ds_read_b64_tr_b16 a[180:181], v17 offset:54080
    ds_read_b64_tr_b16 a[182:183], v17 offset:56160
    ds_read_b64_tr_b16 a[184:185], v17 offset:58240
    ds_read_b64_tr_b16 a[186:187], v17 offset:60320
    ds_read_b64_tr_b16 a[188:189], v17 offset:62400
    ds_read_b64_tr_b16 a[190:191], v17 offset:64480
    s_waitcnt vmcnt(12)
    s_waitcnt lgkmcnt(0)
    s_barrier
    ds_read_b64_tr_b16 a[192:193], v18 offset:1024
    ds_read_b64_tr_b16 a[194:195], v18 offset:3104
    ds_read_b64_tr_b16 a[196:197], v18 offset:5184
    ds_read_b64_tr_b16 a[198:199], v18 offset:7264
    ds_read_b64_tr_b16 a[200:201], v18 offset:9344
    ds_read_b64_tr_b16 a[202:203], v18 offset:11424
    ds_read_b64_tr_b16 a[204:205], v18 offset:13504
    ds_read_b64_tr_b16 a[206:207], v18 offset:15584
    s_waitcnt vmcnt(8)
    s_waitcnt lgkmcnt(0)
    s_barrier
    ds_read_b64_tr_b16 a[208:209], v18 offset:17664
    ds_read_b64_tr_b16 a[210:211], v18 offset:19744
    ds_read_b64_tr_b16 a[212:213], v18 offset:21824
    ds_read_b64_tr_b16 a[214:215], v18 offset:23904
    ds_read_b64_tr_b16 a[216:217], v18 offset:25984
    ds_read_b64_tr_b16 a[218:219], v18 offset:28064
    ds_read_b64_tr_b16 a[220:221], v18 offset:30144
    ds_read_b64_tr_b16 a[222:223], v18 offset:32224
    s_waitcnt vmcnt(4)
    s_waitcnt lgkmcnt(0)
    s_barrier
    ds_read_b64_tr_b16 a[224:225], v18 offset:34304
    ds_read_b64_tr_b16 a[226:227], v18 offset:36384
    ds_read_b64_tr_b16 a[228:229], v18 offset:38464
    ds_read_b64_tr_b16 a[230:231], v18 offset:40544
    ds_read_b64_tr_b16 a[232:233], v18 offset:42624
    ds_read_b64_tr_b16 a[234:235], v18 offset:44704
    ds_read_b64_tr_b16 a[236:237], v18 offset:46784
    ds_read_b64_tr_b16 a[238:239], v18 offset:48864
    s_waitcnt vmcnt(0)
    s_waitcnt lgkmcnt(0)
    s_barrier
    ds_read_b64_tr_b16 a[240:241], v17 offset:0
    ds_read_b64_tr_b16 a[242:243], v17 offset:2080
    ds_read_b64_tr_b16 a[244:245], v17 offset:4160
    ds_read_b64_tr_b16 a[246:247], v17 offset:6240
    ds_read_b64_tr_b16 a[248:249], v17 offset:8320
    ds_read_b64_tr_b16 a[250:251], v17 offset:10400
    ds_read_b64_tr_b16 a[252:253], v17 offset:12480
    ds_read_b64_tr_b16 a[254:255], v17 offset:14560
    s_waitcnt lgkmcnt(0)
    s_barrier
    s_sub_u32 s16, s58, 192
    s_lshr_b32 s12, s16, 1
    s_and_b32 s14, s16, 1
    s_mov_b32 s15, 0
    s_mov_b32 s32, 0
    v_bfe_u32 v2, v0, 4, 2
    v_min_u32 v2, 2, v2
    v_lshlrev_b32 v2, 7, v2
    v_bfe_u32 v1, v0, 6, 1
    v_lshl_add_u32 v2, v1, 13, v2
    s_lshr_b32 s31, s12, 1
    s_lshl_b32 s31, s31, 9
    s_add_u32 s31, s31, 147456
    v_bfe_u32 v1, v0, 9, 1
    v_and_b32 v3, 0xf0, v0
    v_lshl_add_u32 v3, v1, 8, v3
    v_add_u32 v3, 98304, v3
    v_bfe_u32 v1, v0, 8, 1
    v_mov_b32 v7, 3072
    v_cmp_eq_u32 vcc, 1, v1
    v_add_u32 v9, -1, v1
    v_and_b32 v10, 0x4000, v9
    v_and_b32 v15, 0xb0, v0
    v_min_u32 v15, 16, v15
    v_add_u32 v15, v15, v7
    v_cndmask_b32 v3, v3, v15, vcc
    v_add_u32 v15, 32768, v0
    v_mov_b32 v8, 0xdddd
    v_mov_b32 v11, 0
    v_mov_b32 v52, 0x3f803f80
    v_mov_b32 v56, 0
    v_mov_b32 v53, 0x3f803f80
    v_mov_b32 v57, 0
    v_mov_b32 v54, 0x3f803f80
    v_mov_b32 v58, 0
    v_mov_b32 v55, 0x3f803f80
    v_mov_b32 v59, 0
    ds_write_b128 v7, v[52:55] offset:0
    ds_write_b128 v7, v[56:59] offset:16
    ds_write_b128 v7, v[52:55] offset:512
    ds_write_b128 v7, v[56:59] offset:528
    ds_write_b128 v7, v[52:55] offset:4096
    ds_write_b128 v7, v[56:59] offset:4112
    ds_write_b128 v7, v[52:55] offset:4608
    ds_write_b128 v7, v[56:59] offset:4624
    ds_write_b128 v7, v[52:55] offset:8192
    ds_write_b128 v7, v[56:59] offset:8208
    ds_write_b128 v7, v[52:55] offset:8704
    ds_write_b128 v7, v[56:59] offset:8720
    ds_write_b128 v7, v[52:55] offset:12288
    ds_write_b128 v7, v[56:59] offset:12304
    ds_write_b128 v7, v[52:55] offset:12800
    ds_write_b128 v7, v[56:59] offset:12816
    ds_write_b128 v7, v[52:55] offset:16384
    ds_write_b128 v7, v[56:59] offset:16400
    ds_write_b128 v7, v[52:55] offset:16896
    ds_write_b128 v7, v[56:59] offset:16912
    v_add_u32 v7, 0, v0
    s_lshl_b32 s16, s13, 12
    v_add_u32 v6, s16, v7
    s_mov_b32 s26, 0x5d800000
    s_waitcnt lgkmcnt(0)
    s_lshl_b32 s46, 0x55555555, s14
    s_mul_i32 s35, s12, 3072
    s_add_u32 s35, s35, 150995968
    s_mov_b32 s37, 0
    s_mov_b32 s38, 15
    v_lshrrev_b32 v14, 4, v10
L_bl_115:
    s_mov_b32 s20, 0
    s_mov_b32 s22, 0
    s_mov_b32 s36, 0
    s_lshl_b32 s16, s15, 2
    s_lshr_b32 s47, 0x555555, s16
    s_lshl_b32 s47, s47, s14
    s_cmp_lg_u32 s13, 3
    s_cselect_b32 s30, 1, 0
    v_mov_b32 v12, v15
    v_mov_b32 v13, v3
    s_lshl_b32 s16, s15, 6
    s_lshl_b32 s17, s13, 1
    s_add_u32 s16, s16, s17
    s_add_u32 s16, s16, s14
    s_lshl_b32 s16, s16, 5
    s_add_u32 s16, s16, s12
    s_lshl_b32 s27, s16, 10
    s_add_u32 s27, s27, 167772160
    s_lshl_b32 s28, s14, 2
    s_add_u32 s28, s28, s13
    s_lshl_b32 s28, s28, 5
    s_add_u32 s28, s28, s12
    s_lshl_b32 s28, s28, 7
    s_add_u32 s28, s28, 65536
    s_cmp_lg_u32 s15, 0
    s_cbranch_scc1 L_btop_116
    s_add_u32 s17, s27, 0
    v_mov_b64 v[80:81], -1
    v_mov_b64 v[82:83], -1
    buffer_store_dwordx4 v[80:83], v0, s[4:7], s17 offen offset:0 sc1
    s_nop 0
    s_add_u32 s17, s27, 2097152
    v_mov_b64 v[92:93], -1
    v_mov_b64 v[94:95], -1
    buffer_store_dwordx4 v[92:95], v0, s[4:7], s17 offen offset:0 sc1
    s_nop 0
    s_add_u32 s17, s27, 2359296
    v_mov_b64 v[96:97], -1
    v_mov_b64 v[98:99], -1
    buffer_store_dwordx4 v[96:99], v0, s[4:7], s17 offen offset:0 sc1
    s_nop 0
    s_add_u32 s17, s27, 3670016
    v_mov_b64 v[96:97], -1
    v_mov_b64 v[98:99], -1
    buffer_store_dwordx4 v[96:99], v0, s[4:7], s17 offen offset:0 sc1
    s_nop 0
    s_add_u32 s17, s27, 3932160
    v_mov_b64 v[80:81], -1
    v_mov_b64 v[82:83], -1
    buffer_store_dwordx4 v[80:83], v0, s[4:7], s17 offen offset:0 sc1
    s_nop 0
    s_lshl_b32 s17, s15, 3
    s_add_u32 s17, s17, 1
    s_waitcnt vmcnt(0)
    v_mov_b32 v1, s17
    s_mov_b64 exec, 1
    buffer_store_dword v1, off, s[4:7], s28 sc1
    s_mov_b64 exec, -1
    s_branch L_btop_116
L_bblk_120:
    s_cmp_eq_u32 s20, 63
    s_cbranch_scc1 L_bsp_129
    s_mov_b64 exec, 0xff
    buffer_load_dword v11, v2, s[4:7], s31 offen sc1
    s_mov_b64 exec, -1
    s_add_u32 s40, s40, 1
    s_cmp_gt_u32 s40, 262144
    s_cbranch_scc1 L_abort
    s_waitcnt vmcnt(0)
    v_cmp_ge_u32 vcc, s37, v11
    s_and_b32 s16, s38, vcc_lo
    s_cbranch_scc1 L_bblk_120
    s_add_u32 m0, s36, 32768
    s_lshr_b32 s18, s36, 1
    buffer_load_dwordx4 v0, s[4:7], s35 offen sc1 lds
    s_and_b32 s18, s18, 0x1c00
    s_lshr_b32 s16, s38, 7
    s_cmp_eq_u32 s16, s14
    s_cselect_b32 s18, s18, 0x2000
    s_add_u32 m0, s36, 97280
    s_sub_u32 s17, s35, 1024
    buffer_load_dwordx4 v0, s[4:7], s35 offen offset:1024 sc1 lds
    s_add_u32 m0, s18, 20480
    s_mov_b32 s30, 1
    buffer_load_dwordx4 v0, s[4:7], s17 offen sc1 lds
    s_add_u32 s35, s35, 98304
    s_add_u32 s36, s36, 1024
    s_add_u32 s37, s37, s16
    s_xor_b32 s38, s38, 0xff
    s_branch L_bb2_121
L_bsp_129:
    s_sub_u32 s17, s35, 1024
L_p3_131:
    s_mov_b64 exec, 0xff
    buffer_load_dword v11, v2, s[4:7], s31 offen sc1
    s_mov_b64 exec, -1
    buffer_load_dwordx4 v[80:83], v0, s[4:7], s17 offen offset:0 sc1
    buffer_load_dwordx4 v[84:87], v0, s[4:7], s17 offen offset:1024 sc1
    buffer_load_dwordx4 v[88:91], v0, s[4:7], s17 offen offset:2048 sc1
    s_add_u32 s40, s40, 1
    s_cmp_gt_u32 s40, 262144
    s_cbranch_scc1 L_abort
    s_waitcnt vmcnt(0)
    v_max_u32 v1, v80, v81
    v_max3_u32 v1, v1, v82, v83
    v_max3_u32 v1, v1, v84, v85
    v_max3_u32 v1, v1, v86, v87
    v_max3_u32 v1, v1, v88, v89
    v_max3_u32 v1, v1, v90, v91
    v_cmp_eq_u32 vcc, -1, v1
    s_cbranch_vccz L_p3o_132
    v_cmp_ge_u32 vcc, s37, v11
    s_and_b32 s16, s38, vcc_lo
    s_cbranch_scc1 L_p3_131
    s_branch L_bsq_130
L_p3o_132:
    v_add_u32 v1, 65536, v12
    s_cmp_eq_u32 s14, 1
    s_cselect_b32 s16, 0, 0x400
    v_add_u32 v4, s16, v0
    ds_write_b128 v12, v[84:87]
    ds_write_b128 v1, v[88:91]
    ds_write_b128 v4, v[80:83] offset:27648
    s_add_u32 s35, s35, 98304
    s_add_u32 s37, s37, 1
    s_xor_b32 s38, s38, 0xff
    s_waitcnt lgkmcnt(0)
    s_branch L_bb2_121
L_bsq_130:
    s_add_u32 m0, s36, 32768
    s_lshr_b32 s18, s36, 1
    buffer_load_dwordx4 v0, s[4:7], s35 offen sc1 lds
    s_and_b32 s18, s18, 0x1c00
    s_lshr_b32 s16, s38, 7
    s_cmp_eq_u32 s16, s14
    s_cselect_b32 s18, s18, 0x2000
    s_add_u32 m0, s36, 97280
    s_sub_u32 s17, s35, 1024
    buffer_load_dwordx4 v0, s[4:7], s35 offen offset:1024 sc1 lds
    s_add_u32 m0, s18, 20480
    s_mov_b32 s30, 1
    buffer_load_dwordx4 v0, s[4:7], s17 offen sc1 lds
    s_add_u32 s35, s35, 98304
    s_add_u32 s36, s36, 1024
    s_add_u32 s37, s37, s16
    s_xor_b32 s38, s38, 0xff
    s_branch L_bb2_121
L_bre_124:
    s_waitcnt vmcnt(0)
    v_cmp_ge_u32 vcc, s37, v11
    s_and_b32 s16, s38, vcc_lo
    s_cbranch_scc1 L_bp2_118
    s_add_u32 m0, s36, 32768
    s_lshr_b32 s18, s36, 1
    buffer_load_dwordx4 v0, s[4:7], s35 offen sc1 lds
    s_and_b32 s18, s18, 0x1c00
    s_lshr_b32 s16, s38, 7
    s_cmp_eq_u32 s16, s14
    s_cselect_b32 s18, s18, 0x2000
    s_add_u32 m0, s36, 97280
    s_sub_u32 s17, s35, 1024
    buffer_load_dwordx4 v0, s[4:7], s35 offen offset:1024 sc1 lds
    s_add_u32 m0, s18, 20480
    s_mov_b32 s30, 1
    buffer_load_dwordx4 v0, s[4:7], s17 offen sc1 lds
    s_add_u32 s35, s35, 98304
    s_add_u32 s36, s36, 1024
    s_add_u32 s37, s37, s16
    s_xor_b32 s38, s38, 0xff
    s_branch L_bp2_118
L_bld_122:
    s_mov_b32 s30, 0
    v_cmp_ge_u32 vcc, s37, v11
    s_and_b32 s16, s38, vcc_lo
    s_cbranch_scc1 L_bz_133
    s_add_u32 m0, s36, 32768
    s_lshr_b32 s18, s36, 1
    buffer_load_dwordx4 v0, s[4:7], s35 offen sc1 lds
    s_and_b32 s18, s18, 0x1c00
    s_lshr_b32 s16, s38, 7
    s_cmp_eq_u32 s16, s14
    s_cselect_b32 s18, s18, 0x2000
    s_add_u32 m0, s36, 97280
    s_sub_u32 s17, s35, 1024
    buffer_load_dwordx4 v0, s[4:7], s35 offen offset:1024 sc1 lds
    s_add_u32 m0, s18, 20480
    s_mov_b32 s30, 1
    buffer_load_dwordx4 v0, s[4:7], s17 offen sc1 lds
    s_add_u32 s35, s35, 98304
    s_add_u32 s36, s36, 1024
    s_add_u32 s37, s37, s16
    s_xor_b32 s38, s38, 0xff
L_bz_133:
    s_mov_b64 exec, 0xff
    buffer_load_dword v11, v2, s[4:7], s31 offen sc1
    s_mov_b64 exec, -1
    s_branch L_bldr_123
L_bpost_117:
    s_cmp_eq_u32 s30, 0
    s_cbranch_scc1 L_bre_124
L_bp2_118:
    s_bitcmp1_b64 s[46:47], s20
    s_cbranch_scc1 L_bnew_125
L_bnx_119:
    v_add_u32 v12, 0x400, v12
    s_add_u32 s20, s20, 1
    v_add_u32 v13, v14, v13
L_btop_116:
    s_cmp_eq_u32 s30, 0
    s_cbranch_scc1 L_bblk_120
L_bb2_121:
    s_waitcnt vmcnt(0)
    s_barrier
    ds_read_b128 v[48:51], v12
    ds_read_b128 v[52:55], v13
    ds_read_b128 v[56:59], v13 offset:512
    v_mov_b32 v1, v1
    s_nop 2
    v_mov_b32 v1, v1
    s_nop 2
    v_mov_b32 v1, v1
    s_cmp_eq_u32 s20, 63
    s_waitcnt lgkmcnt(2)
    v_mfma_f32_32x32x16_bf16 v[16:31], v[48:51], a[0:3], 0
    s_cbranch_scc1 L_blast_126
    s_cmp_eq_u32 s13, 3
    s_cbranch_scc1 L_bld_122
    s_nop 5
L_bldr_123:
    s_waitcnt lgkmcnt(0)
    s_cmp_eq_u32 s22, 7
    s_cbranch_scc1 L_ch_141
    s_cmp_eq_u32 s22, 6
    s_cbranch_scc1 L_ch_140
    s_cmp_eq_u32 s22, 5
    s_cbranch_scc1 L_ch_139
    s_cmp_eq_u32 s22, 4
    s_cbranch_scc1 L_ch_138
    s_cmp_eq_u32 s22, 3
    s_cbranch_scc1 L_ch_137
    s_cmp_eq_u32 s22, 2
    s_cbranch_scc1 L_ch_136
    s_cmp_eq_u32 s22, 1
    s_cbranch_scc1 L_ch_135
    s_branch L_bpost_117
L_ch_135:
    v_exp_f32 v16, v16
    v_exp_f32 v17, v17
    v_exp_f32 v18, v18
    v_exp_f32 v19, v19
    v_exp_f32 v20, v20
    v_exp_f32 v21, v21
    v_exp_f32 v22, v22
    v_exp_f32 v23, v23
    v_exp_f32 v24, v24
    v_exp_f32 v25, v25
    v_exp_f32 v26, v26
    v_smfmac_f32_32x32x32_bf16 v[128:143], v[52:55], v[16:23], v8
    v_exp_f32 v27, v27
    v_exp_f32 v28, v28
    v_exp_f32 v29, v29
    v_exp_f32 v30, v30
    v_exp_f32 v31, v31
    s_nop 1
    v_smfmac_f32_32x32x32_bf16 v[128:143], v[56:59], v[24:31], v8
    s_branch L_bpost_117
L_ch_136:
    v_exp_f32 v16, v16
    v_exp_f32 v17, v17
    v_exp_f32 v18, v18
    v_exp_f32 v19, v19
    v_exp_f32 v20, v20
    v_exp_f32 v21, v21
    v_mfma_f32_32x32x16_bf16 v[32:47], v[48:51], a[4:7], 0
    s_nop 0
    v_exp_f32 v22, v22
    v_exp_f32 v23, v23
    v_exp_f32 v24, v24
    v_exp_f32 v25, v25
    v_exp_f32 v26, v26
    v_smfmac_f32_32x32x32_bf16 v[128:143], v[52:55], v[16:23], v8
    v_exp_f32 v27, v27
    v_exp_f32 v28, v28
    v_exp_f32 v29, v29
    v_exp_f32 v30, v30
    v_exp_f32 v31, v31
    v_exp_f32 v32, v32
    v_exp_f32 v33, v33
    v_smfmac_f32_32x32x32_bf16 v[128:143], v[56:59], v[24:31], v8
    v_exp_f32 v34, v34
    v_exp_f32 v35, v35
    v_exp_f32 v36, v36
    v_exp_f32 v37, v37
    v_exp_f32 v38, v38
    v_exp_f32 v39, v39
    v_exp_f32 v40, v40
    v_exp_f32 v41, v41
    v_exp_f32 v42, v42
    v_smfmac_f32_32x32x32_bf16 v[144:159], v[52:55], v[32:39], v8
    v_exp_f32 v43, v43
    v_exp_f32 v44, v44
    v_exp_f32 v45, v45
    v_exp_f32 v46, v46
    v_exp_f32 v47, v47
    s_nop 1
    v_smfmac_f32_32x32x32_bf16 v[144:159], v[56:59], v[40:47], v8
    s_branch L_bpost_117
L_ch_137:
    v_exp_f32 v16, v16
    v_exp_f32 v17, v17
    v_exp_f32 v18, v18
    v_exp_f32 v19, v19
    v_exp_f32 v20, v20
    v_exp_f32 v21, v21
    v_mfma_f32_32x32x16_bf16 v[32:47], v[48:51], a[4:7], 0
    s_nop 0
    v_exp_f32 v22, v22
    v_exp_f32 v23, v23
    v_exp_f32 v24, v24
    v_exp_f32 v25, v25
    v_exp_f32 v26, v26
    v_smfmac_f32_32x32x32_bf16 v[128:143], v[52:55], v[16:23], v8
    v_exp_f32 v27, v27
    v_exp_f32 v28, v28
    v_exp_f32 v29, v29
    v_exp_f32 v30, v30
    v_exp_f32 v31, v31
    v_exp_f32 v32, v32
    v_exp_f32 v33, v33
    v_smfmac_f32_32x32x32_bf16 v[128:143], v[56:59], v[24:31], v8
    v_exp_f32 v34, v34
    v_exp_f32 v35, v35
    v_exp_f32 v36, v36
    v_exp_f32 v37, v37
    v_mfma_f32_32x32x16_bf16 v[16:31], v[48:51], a[8:11], 0
    s_nop 0
    v_exp_f32 v38, v38
    v_exp_f32 v39, v39
    v_exp_f32 v40, v40
    v_exp_f32 v41, v41
    v_exp_f32 v42, v42
    v_smfmac_f32_32x32x32_bf16 v[144:159], v[52:55], v[32:39], v8
    v_exp_f32 v43, v43
    v_exp_f32 v44, v44
    v_exp_f32 v45, v45
    v_exp_f32 v46, v46
    v_exp_f32 v47, v47
    v_exp_f32 v16, v16
    v_exp_f32 v17, v17
    v_smfmac_f32_32x32x32_bf16 v[144:159], v[56:59], v[40:47], v8
    v_exp_f32 v18, v18
    v_exp_f32 v19, v19
    v_exp_f32 v20, v20
    v_exp_f32 v21, v21
    v_exp_f32 v22, v22
    v_exp_f32 v23, v23
    v_exp_f32 v24, v24
    v_exp_f32 v25, v25
    v_exp_f32 v26, v26
    v_smfmac_f32_32x32x32_bf16 v[160:175], v[52:55], v[16:23], v8
    v_exp_f32 v27, v27
    v_exp_f32 v28, v28
    v_exp_f32 v29, v29
    v_exp_f32 v30, v30
    v_exp_f32 v31, v31
    s_nop 1
    v_smfmac_f32_32x32x32_bf16 v[160:175], v[56:59], v[24:31], v8
    s_branch L_bpost_117
L_ch_138:
    v_exp_f32 v16, v16
    v_exp_f32 v17, v17
    v_exp_f32 v18, v18
    v_exp_f32 v19, v19
    v_exp_f32 v20, v20
    v_exp_f32 v21, v21
    v_mfma_f32_32x32x16_bf16 v[32:47], v[48:51], a[4:7], 0
    s_nop 0
    v_exp_f32 v22, v22
    v_exp_f32 v23, v23
    v_exp_f32 v24, v24
    v_exp_f32 v25, v25
    v_exp_f32 v26, v26
    v_smfmac_f32_32x32x32_bf16 v[128:143], v[52:55], v[16:23], v8
    v_exp_f32 v27, v27
    v_exp_f32 v28, v28
    v_exp_f32 v29, v29
    v_exp_f32 v30, v30
    v_exp_f32 v31, v31
    v_exp_f32 v32, v32
    v_exp_f32 v33, v33
    v_smfmac_f32_32x32x32_bf16 v[128:143], v[56:59], v[24:31], v8
    v_exp_f32 v34, v34
    v_exp_f32 v35, v35
    v_exp_f32 v36, v36
    v_exp_f32 v37, v37
    v_mfma_f32_32x32x16_bf16 v[16:31], v[48:51], a[8:11], 0
    s_nop 0
    v_exp_f32 v38, v38
    v_exp_f32 v39, v39
    v_exp_f32 v40, v40
    v_exp_f32 v41, v41
    v_exp_f32 v42, v42
    v_smfmac_f32_32x32x32_bf16 v[144:159], v[52:55], v[32:39], v8
    v_exp_f32 v43, v43
    v_exp_f32 v44, v44
    v_exp_f32 v45, v45
    v_exp_f32 v46, v46
    v_exp_f32 v47, v47
    v_exp_f32 v16, v16
    v_exp_f32 v17, v17
    v_smfmac_f32_32x32x32_bf16 v[144:159], v[56:59], v[40:47], v8
    v_exp_f32 v18, v18
    v_exp_f32 v19, v19
    v_exp_f32 v20, v20
    v_exp_f32 v21, v21
    v_mfma_f32_32x32x16_bf16 v[32:47], v[48:51], a[12:15], 0
    s_nop 0
    v_exp_f32 v22, v22
    v_exp_f32 v23, v23
    v_exp_f32 v24, v24
    v_exp_f32 v25, v25
    v_exp_f32 v26, v26
    v_smfmac_f32_32x32x32_bf16 v[160:175], v[52:55], v[16:23], v8
    v_exp_f32 v27, v27
    v_exp_f32 v28, v28
    v_exp_f32 v29, v29
    v_exp_f32 v30, v30
    v_exp_f32 v31, v31
    v_exp_f32 v32, v32
    v_exp_f32 v33, v33
    v_smfmac_f32_32x32x32_bf16 v[160:175], v[56:59], v[24:31], v8
    v_exp_f32 v34, v34
    v_exp_f32 v35, v35
    v_exp_f32 v36, v36
    v_exp_f32 v37, v37
    v_exp_f32 v38, v38
    v_exp_f32 v39, v39
    v_exp_f32 v40, v40
    v_exp_f32 v41, v41
    v_exp_f32 v42, v42
    v_smfmac_f32_32x32x32_bf16 v[176:191], v[52:55], v[32:39], v8
    v_exp_f32 v43, v43
    v_exp_f32 v44, v44
    v_exp_f32 v45, v45
    v_exp_f32 v46, v46
    v_exp_f32 v47, v47
    s_nop 1
    v_smfmac_f32_32x32x32_bf16 v[176:191], v[56:59], v[40:47], v8
    s_branch L_bpost_117
L_ch_139:
    v_exp_f32 v16, v16
    v_exp_f32 v17, v17
    v_exp_f32 v18, v18
    v_exp_f32 v19, v19
    v_exp_f32 v20, v20
    v_exp_f32 v21, v21
    v_mfma_f32_32x32x16_bf16 v[32:47], v[48:51], a[4:7], 0
    s_nop 0
    v_exp_f32 v22, v22
    v_exp_f32 v23, v23
    v_exp_f32 v24, v24
    v_exp_f32 v25, v25
    v_exp_f32 v26, v26
    v_smfmac_f32_32x32x32_bf16 v[128:143], v[52:55], v[16:23], v8
    v_exp_f32 v27, v27
    v_exp_f32 v28, v28
    v_exp_f32 v29, v29
    v_exp_f32 v30, v30
    v_exp_f32 v31, v31
    v_exp_f32 v32, v32
    v_exp_f32 v33, v33
    v_smfmac_f32_32x32x32_bf16 v[128:143], v[56:59], v[24:31], v8
    v_exp_f32 v34, v34
    v_exp_f32 v35, v35
    v_exp_f32 v36, v36
    v_exp_f32 v37, v37
    v_mfma_f32_32x32x16_bf16 v[16:31], v[48:51], a[8:11], 0
    s_nop 0
    v_exp_f32 v38, v38
    v_exp_f32 v39, v39
    v_exp_f32 v40, v40
    v_exp_f32 v41, v41
    v_exp_f32 v42, v42
    v_smfmac_f32_32x32x32_bf16 v[144:159], v[52:55], v[32:39], v8
    v_exp_f32 v43, v43
    v_exp_f32 v44, v44
    v_exp_f32 v45, v45
    v_exp_f32 v46, v46
    v_exp_f32 v47, v47
    v_exp_f32 v16, v16
    v_exp_f32 v17, v17
    v_smfmac_f32_32x32x32_bf16 v[144:159], v[56:59], v[40:47], v8
    v_exp_f32 v18, v18
    v_exp_f32 v19, v19
    v_exp_f32 v20, v20
    v_exp_f32 v21, v21
    v_mfma_f32_32x32x16_bf16 v[32:47], v[48:51], a[12:15], 0
    s_nop 0
    v_exp_f32 v22, v22
    v_exp_f32 v23, v23
    v_exp_f32 v24, v24
    v_exp_f32 v25, v25
    v_exp_f32 v26, v26
    v_smfmac_f32_32x32x32_bf16 v[160:175], v[52:55], v[16:23], v8
    v_exp_f32 v27, v27
    v_exp_f32 v28, v28
    v_exp_f32 v29, v29
    v_exp_f32 v30, v30
    v_exp_f32 v31, v31
    v_exp_f32 v32, v32
    v_exp_f32 v33, v33
    v_smfmac_f32_32x32x32_bf16 v[160:175], v[56:59], v[24:31], v8
    v_exp_f32 v34, v34
    v_exp_f32 v35, v35
    v_exp_f32 v36, v36
    v_exp_f32 v37, v37
    v_mfma_f32_32x32x16_bf16 v[16:31], v[48:51], a[16:19], 0
    s_nop 0
    v_exp_f32 v38, v38
    v_exp_f32 v39, v39
    v_exp_f32 v40, v40
    v_exp_f32 v41, v41
    v_exp_f32 v42, v42
    v_smfmac_f32_32x32x32_bf16 v[176:191], v[52:55], v[32:39], v8
    v_exp_f32 v43, v43
    v_exp_f32 v44, v44
    v_exp_f32 v45, v45
    v_exp_f32 v46, v46
    v_exp_f32 v47, v47
    v_exp_f32 v16, v16
    v_exp_f32 v17, v17
    v_smfmac_f32_32x32x32_bf16 v[176:191], v[56:59], v[40:47], v8
    v_exp_f32 v18, v18
    v_exp_f32 v19, v19
    v_exp_f32 v20, v20
    v_exp_f32 v21, v21
    v_exp_f32 v22, v22
    v_exp_f32 v23, v23
    v_exp_f32 v24, v24
    v_exp_f32 v25, v25
    v_exp_f32 v26, v26
    v_smfmac_f32_32x32x32_bf16 v[192:207], v[52:55], v[16:23], v8
    v_exp_f32 v27, v27
    v_exp_f32 v28, v28
    v_exp_f32 v29, v29
    v_exp_f32 v30, v30
    v_exp_f32 v31, v31
    s_nop 1
    v_smfmac_f32_32x32x32_bf16 v[192:207], v[56:59], v[24:31], v8
    s_branch L_bpost_117
L_ch_140:
    v_exp_f32 v16, v16
    v_exp_f32 v17, v17
    v_exp_f32 v18, v18
    v_exp_f32 v19, v19
    v_exp_f32 v20, v20
    v_exp_f32 v21, v21
    v_mfma_f32_32x32x16_bf16 v[32:47], v[48:51], a[4:7], 0
    s_nop 0
    v_exp_f32 v22, v22
    v_exp_f32 v23, v23
    v_exp_f32 v24, v24
    v_exp_f32 v25, v25
    v_exp_f32 v26, v26
    v_smfmac_f32_32x32x32_bf16 v[128:143], v[52:55], v[16:23], v8
    v_exp_f32 v27, v27
    v_exp_f32 v28, v28
    v_exp_f32 v29, v29
    v_exp_f32 v30, v30
    v_exp_f32 v31, v31
    v_exp_f32 v32, v32
    v_exp_f32 v33, v33
    v_smfmac_f32_32x32x32_bf16 v[128:143], v[56:59], v[24:31], v8
    v_exp_f32 v34, v34
    v_exp_f32 v35, v35
    v_exp_f32 v36, v36
    v_exp_f32 v37, v37
    v_mfma_f32_32x32x16_bf16 v[16:31], v[48:51], a[8:11], 0
    s_nop 0
    v_exp_f32 v38, v38
    v_exp_f32 v39, v39
    v_exp_f32 v40, v40
    v_exp_f32 v41, v41
    v_exp_f32 v42, v42
    v_smfmac_f32_32x32x32_bf16 v[144:159], v[52:55], v[32:39], v8
    v_exp_f32 v43, v43
    v_exp_f32 v44, v44
    v_exp_f32 v45, v45
    v_exp_f32 v46, v46
    v_exp_f32 v47, v47
    v_exp_f32 v16, v16
    v_exp_f32 v17, v17
    v_smfmac_f32_32x32x32_bf16 v[144:159], v[56:59], v[40:47], v8
    v_exp_f32 v18, v18
    v_exp_f32 v19, v19
    v_exp_f32 v20, v20
    v_exp_f32 v21, v21
    v_mfma_f32_32x32x16_bf16 v[32:47], v[48:51], a[12:15], 0
    s_nop 0
    v_exp_f32 v22, v22
    v_exp_f32 v23, v23
    v_exp_f32 v24, v24
    v_exp_f32 v25, v25
    v_exp_f32 v26, v26
    v_smfmac_f32_32x32x32_bf16 v[160:175], v[52:55], v[16:23], v8
    v_exp_f32 v27, v27
    v_exp_f32 v28, v28
    v_exp_f32 v29, v29
    v_exp_f32 v30, v30
    v_exp_f32 v31, v31
    v_exp_f32 v32, v32
    v_exp_f32 v33, v33
    v_smfmac_f32_32x32x32_bf16 v[160:175], v[56:59], v[24:31], v8
    v_exp_f32 v34, v34
    v_exp_f32 v35, v35
    v_exp_f32 v36, v36
    v_exp_f32 v37, v37
    v_mfma_f32_32x32x16_bf16 v[16:31], v[48:51], a[16:19], 0
    s_nop 0
    v_exp_f32 v38, v38
    v_exp_f32 v39, v39
    v_exp_f32 v40, v40
    v_exp_f32 v41, v41
    v_exp_f32 v42, v42
    v_smfmac_f32_32x32x32_bf16 v[176:191], v[52:55], v[32:39], v8
    v_exp_f32 v43, v43
    v_exp_f32 v44, v44
    v_exp_f32 v45, v45
    v_exp_f32 v46, v46
    v_exp_f32 v47, v47
    v_exp_f32 v16, v16
    v_exp_f32 v17, v17
    v_smfmac_f32_32x32x32_bf16 v[176:191], v[56:59], v[40:47], v8
    v_exp_f32 v18, v18
    v_exp_f32 v19, v19
    v_exp_f32 v20, v20
    v_exp_f32 v21, v21
    v_mfma_f32_32x32x16_bf16 v[32:47], v[48:51], a[20:23], 0
    s_nop 0
    v_exp_f32 v22, v22
    v_exp_f32 v23, v23
    v_exp_f32 v24, v24
    v_exp_f32 v25, v25
    v_exp_f32 v26, v26
    v_smfmac_f32_32x32x32_bf16 v[192:207], v[52:55], v[16:23], v8
    v_exp_f32 v27, v27
    v_exp_f32 v28, v28
    v_exp_f32 v29, v29
    v_exp_f32 v30, v30
    v_exp_f32 v31, v31
    v_exp_f32 v32, v32
    v_exp_f32 v33, v33
    v_smfmac_f32_32x32x32_bf16 v[192:207], v[56:59], v[24:31], v8
    v_exp_f32 v34, v34
    v_exp_f32 v35, v35
    v_exp_f32 v36, v36
    v_exp_f32 v37, v37
    v_exp_f32 v38, v38
    v_exp_f32 v39, v39
    v_exp_f32 v40, v40
    v_exp_f32 v41, v41
    v_exp_f32 v42, v42
    v_smfmac_f32_32x32x32_bf16 v[208:223], v[52:55], v[32:39], v8
    v_exp_f32 v43, v43
    v_exp_f32 v44, v44
    v_exp_f32 v45, v45
    v_exp_f32 v46, v46
    v_exp_f32 v47, v47
    s_nop 1
    v_smfmac_f32_32x32x32_bf16 v[208:223], v[56:59], v[40:47], v8
    s_branch L_bpost_117
L_ch_141:
    v_exp_f32 v16, v16
    v_exp_f32 v17, v17
    v_exp_f32 v18, v18
    v_exp_f32 v19, v19
    v_exp_f32 v20, v20
    v_exp_f32 v21, v21
    v_mfma_f32_32x32x16_bf16 v[32:47], v[48:51], a[4:7], 0
    s_nop 0
    v_exp_f32 v22, v22
    v_exp_f32 v23, v23
    v_exp_f32 v24, v24
    v_exp_f32 v25, v25
    v_exp_f32 v26, v26
    v_smfmac_f32_32x32x32_bf16 v[128:143], v[52:55], v[16:23], v8
    v_exp_f32 v27, v27
    v_exp_f32 v28, v28
    v_exp_f32 v29, v29
    v_exp_f32 v30, v30
    v_exp_f32 v31, v31
    v_exp_f32 v32, v32
    v_exp_f32 v33, v33
    v_smfmac_f32_32x32x32_bf16 v[128:143], v[56:59], v[24:31], v8
    v_exp_f32 v34, v34
    v_exp_f32 v35, v35
    v_exp_f32 v36, v36
    v_exp_f32 v37, v37
    v_mfma_f32_32x32x16_bf16 v[16:31], v[48:51], a[8:11], 0
    s_nop 0
    v_exp_f32 v38, v38
    v_exp_f32 v39, v39
    v_exp_f32 v40, v40
    v_exp_f32 v41, v41
    v_exp_f32 v42, v42
    v_smfmac_f32_32x32x32_bf16 v[144:159], v[52:55], v[32:39], v8
    v_exp_f32 v43, v43
    v_exp_f32 v44, v44
    v_exp_f32 v45, v45
    v_exp_f32 v46, v46
    v_exp_f32 v47, v47
    v_exp_f32 v16, v16
    v_exp_f32 v17, v17
    v_smfmac_f32_32x32x32_bf16 v[144:159], v[56:59], v[40:47], v8
    v_exp_f32 v18, v18
    v_exp_f32 v19, v19
    v_exp_f32 v20, v20
    v_exp_f32 v21, v21
    v_mfma_f32_32x32x16_bf16 v[32:47], v[48:51], a[12:15], 0
    s_nop 0
    v_exp_f32 v22, v22
    v_exp_f32 v23, v23
    v_exp_f32 v24, v24
    v_exp_f32 v25, v25
    v_exp_f32 v26, v26
    v_smfmac_f32_32x32x32_bf16 v[160:175], v[52:55], v[16:23], v8
    v_exp_f32 v27, v27
    v_exp_f32 v28, v28
    v_exp_f32 v29, v29
    v_exp_f32 v30, v30
    v_exp_f32 v31, v31
    v_exp_f32 v32, v32
    v_exp_f32 v33, v33
    v_smfmac_f32_32x32x32_bf16 v[160:175], v[56:59], v[24:31], v8
    v_exp_f32 v34, v34
    v_exp_f32 v35, v35
    v_exp_f32 v36, v36
    v_exp_f32 v37, v37
    v_mfma_f32_32x32x16_bf16 v[16:31], v[48:51], a[16:19], 0
    s_nop 0
    v_exp_f32 v38, v38
    v_exp_f32 v39, v39
    v_exp_f32 v40, v40
    v_exp_f32 v41, v41
    v_exp_f32 v42, v42
    v_smfmac_f32_32x32x32_bf16 v[176:191], v[52:55], v[32:39], v8
    v_exp_f32 v43, v43
    v_exp_f32 v44, v44
    v_exp_f32 v45, v45
    v_exp_f32 v46, v46
    v_exp_f32 v47, v47
    v_exp_f32 v16, v16
    v_exp_f32 v17, v17
    v_smfmac_f32_32x32x32_bf16 v[176:191], v[56:59], v[40:47], v8
    v_exp_f32 v18, v18
    v_exp_f32 v19, v19
    v_exp_f32 v20, v20
    v_exp_f32 v21, v21
    v_mfma_f32_32x32x16_bf16 v[32:47], v[48:51], a[20:23], 0
    s_nop 0
    v_exp_f32 v22, v22
    v_exp_f32 v23, v23
    v_exp_f32 v24, v24
    v_exp_f32 v25, v25
    v_exp_f32 v26, v26
    v_smfmac_f32_32x32x32_bf16 v[192:207], v[52:55], v[16:23], v8
    v_exp_f32 v27, v27
    v_exp_f32 v28, v28
    v_exp_f32 v29, v29
    v_exp_f32 v30, v30
    v_exp_f32 v31, v31
    v_exp_f32 v32, v32
    v_exp_f32 v33, v33
    v_smfmac_f32_32x32x32_bf16 v[192:207], v[56:59], v[24:31], v8
    v_exp_f32 v34, v34
    v_exp_f32 v35, v35
    v_exp_f32 v36, v36
    v_exp_f32 v37, v37
    v_mfma_f32_32x32x16_bf16 v[16:31], v[48:51], a[24:27], 0
    s_nop 0
    v_exp_f32 v38, v38
    v_exp_f32 v39, v39
    v_exp_f32 v40, v40
    v_exp_f32 v41, v41
    v_exp_f32 v42, v42
    v_smfmac_f32_32x32x32_bf16 v[208:223], v[52:55], v[32:39], v8
    v_exp_f32 v43, v43
    v_exp_f32 v44, v44
    v_exp_f32 v45, v45
    v_exp_f32 v46, v46
    v_exp_f32 v47, v47
    v_exp_f32 v16, v16
    v_exp_f32 v17, v17
    v_smfmac_f32_32x32x32_bf16 v[208:223], v[56:59], v[40:47], v8
    v_exp_f32 v18, v18
    v_exp_f32 v19, v19
    v_exp_f32 v20, v20
    v_exp_f32 v21, v21
    v_exp_f32 v22, v22
    v_exp_f32 v23, v23
    v_exp_f32 v24, v24
    v_exp_f32 v25, v25
    v_exp_f32 v26, v26
    v_smfmac_f32_32x32x32_bf16 v[224:239], v[52:55], v[16:23], v8
    v_exp_f32 v27, v27
    v_exp_f32 v28, v28
    v_exp_f32 v29, v29
    v_exp_f32 v30, v30
    v_exp_f32 v31, v31
    s_nop 1
    v_smfmac_f32_32x32x32_bf16 v[224:239], v[56:59], v[24:31], v8
    s_branch L_bpost_117
L_blast_126:
    s_nop 9
    s_waitcnt lgkmcnt(0)
    v_exp_f32 v16, v16
    v_exp_f32 v17, v17
    v_exp_f32 v18, v18
    v_exp_f32 v19, v19
    v_exp_f32 v20, v20
    v_exp_f32 v21, v21
    v_exp_f32 v22, v22
    v_exp_f32 v23, v23
    v_exp_f32 v24, v24
    v_exp_f32 v25, v25
    v_exp_f32 v26, v26
    v_smfmac_f32_32x32x32_bf16 v[128:143], v[52:55], v[16:23], v8
    v_exp_f32 v27, v27
    v_exp_f32 v28, v28
    v_exp_f32 v29, v29
    v_exp_f32 v30, v30
    v_exp_f32 v31, v31
    s_nop 1
    v_smfmac_f32_32x32x32_bf16 v[128:143], v[56:59], v[24:31], v8
    s_nop 11
    v_rcp_f32 v80, v136
    s_nop 0
    v_max_f32 v1, v80, v136
    v_mov_b32 v81, v136
    v_cmp_ngt_f32 vcc, s26, v1
    v_cmp_u_f32 s[16:17], v81, v81
    s_mov_b32 s24, 0
    s_mov_b32 s25, 1
    s_mov_b32 s29, 0
    s_or_b64 vcc, vcc, s[16:17]
    s_cbranch_scc1 L_bslow
L_bf0:
    v_pk_mul_f32 v[128:129], v[128:129], v[80:81] op_sel_hi:[1,0]
    v_pk_mul_f32 v[130:131], v[130:131], v[80:81] op_sel_hi:[1,0]
    v_pk_mul_f32 v[132:133], v[132:133], v[80:81] op_sel_hi:[1,0]
    v_pk_mul_f32 v[134:135], v[134:135], v[80:81] op_sel_hi:[1,0]
    v_cvt_pk_bf16_f32 v128, v128, v129
    v_cvt_pk_bf16_f32 v129, v130, v131
    v_cvt_pk_bf16_f32 v130, v132, v133
    v_cvt_pk_bf16_f32 v131, v134, v135
    s_add_u32 s16, s27, 0
    buffer_store_dwordx4 v[128:131], v0, s[4:7], s16 offen sc1
    v_mfma_f32_32x32x16_bf16 v[32:47], v[48:51], a[4:7], 0
    s_nop 11
    v_exp_f32 v32, v32
    v_exp_f32 v33, v33
    v_exp_f32 v34, v34
    v_exp_f32 v35, v35
    v_exp_f32 v36, v36
    v_exp_f32 v37, v37
    v_exp_f32 v38, v38
    v_exp_f32 v39, v39
    v_exp_f32 v40, v40
    v_exp_f32 v41, v41
    v_exp_f32 v42, v42
    v_smfmac_f32_32x32x32_bf16 v[144:159], v[52:55], v[32:39], v8
    v_exp_f32 v43, v43
    v_exp_f32 v44, v44
    v_exp_f32 v45, v45
    v_exp_f32 v46, v46
    v_exp_f32 v47, v47
    s_nop 1
    v_smfmac_f32_32x32x32_bf16 v[144:159], v[56:59], v[40:47], v8
    s_nop 11
    v_rcp_f32 v82, v152
    s_nop 0
    v_max_f32 v1, v82, v152
    v_mov_b32 v81, v152
    v_cmp_ngt_f32 vcc, s26, v1
    v_cmp_u_f32 s[16:17], v81, v81
    s_mov_b32 s24, 1
    s_mov_b32 s25, 2
    s_mov_b32 s29, 1
    s_or_b64 vcc, vcc, s[16:17]
    s_cbranch_scc1 L_bslow
L_bf1:
    v_pk_mul_f32 v[144:145], v[144:145], v[82:83] op_sel_hi:[1,0]
    v_pk_mul_f32 v[146:147], v[146:147], v[82:83] op_sel_hi:[1,0]
    v_pk_mul_f32 v[148:149], v[148:149], v[82:83] op_sel_hi:[1,0]
    v_pk_mul_f32 v[150:151], v[150:151], v[82:83] op_sel_hi:[1,0]
    v_cvt_pk_bf16_f32 v144, v144, v145
    v_cvt_pk_bf16_f32 v145, v146, v147
    v_cvt_pk_bf16_f32 v146, v148, v149
    v_cvt_pk_bf16_f32 v147, v150, v151
    s_add_u32 s16, s27, 262144
    buffer_store_dwordx4 v[144:147], v0, s[4:7], s16 offen sc1
    s_cmp_eq_u32 s22, 6
    s_cbranch_scc1 L_b6_142
    v_mfma_f32_32x32x16_bf16 v[16:31], v[48:51], a[8:11], 0
    s_nop 11
    v_exp_f32 v16, v16
    v_exp_f32 v17, v17
    v_exp_f32 v18, v18
    v_exp_f32 v19, v19
    v_exp_f32 v20, v20
    v_exp_f32 v21, v21
    v_mfma_f32_32x32x16_bf16 v[32:47], v[48:51], a[12:15], 0
    s_nop 0
    v_exp_f32 v22, v22
    v_exp_f32 v23, v23
    v_exp_f32 v24, v24
    v_exp_f32 v25, v25
    v_exp_f32 v26, v26
    v_smfmac_f32_32x32x32_bf16 v[160:175], v[52:55], v[16:23], v8
    v_exp_f32 v27, v27
    v_exp_f32 v28, v28
    v_exp_f32 v29, v29
    v_exp_f32 v30, v30
    v_exp_f32 v31, v31
    v_exp_f32 v32, v32
    v_exp_f32 v33, v33
    v_smfmac_f32_32x32x32_bf16 v[160:175], v[56:59], v[24:31], v8
    v_exp_f32 v34, v34
    v_exp_f32 v35, v35
    v_exp_f32 v36, v36
    v_exp_f32 v37, v37
    v_mfma_f32_32x32x16_bf16 v[16:31], v[48:51], a[16:19], 0
    s_nop 0
    v_exp_f32 v38, v38
    v_exp_f32 v39, v39
    v_exp_f32 v40, v40
    v_exp_f32 v41, v41
    v_exp_f32 v42, v42
    v_smfmac_f32_32x32x32_bf16 v[176:191], v[52:55], v[32:39], v8
    v_exp_f32 v43, v43
    v_exp_f32 v44, v44
    v_exp_f32 v45, v45
    v_exp_f32 v46, v46
    v_exp_f32 v47, v47
    v_exp_f32 v16, v16
    v_exp_f32 v17, v17
    v_smfmac_f32_32x32x32_bf16 v[176:191], v[56:59], v[40:47], v8
    v_exp_f32 v18, v18
    v_exp_f32 v19, v19
    v_exp_f32 v20, v20
    v_exp_f32 v21, v21
    v_mfma_f32_32x32x16_bf16 v[32:47], v[48:51], a[20:23], 0
    s_nop 0
    v_exp_f32 v22, v22
    v_exp_f32 v23, v23
    v_exp_f32 v24, v24
    v_exp_f32 v25, v25
    v_exp_f32 v26, v26
    v_smfmac_f32_32x32x32_bf16 v[192:207], v[52:55], v[16:23], v8
    v_exp_f32 v27, v27
    v_exp_f32 v28, v28
    v_exp_f32 v29, v29
    v_exp_f32 v30, v30
    v_exp_f32 v31, v31
    v_exp_f32 v32, v32
    v_exp_f32 v33, v33
    v_smfmac_f32_32x32x32_bf16 v[192:207], v[56:59], v[24:31], v8
    v_exp_f32 v34, v34
    v_exp_f32 v35, v35
    v_exp_f32 v36, v36
    v_exp_f32 v37, v37
    v_mfma_f32_32x32x16_bf16 v[16:31], v[48:51], a[24:27], 0
    s_nop 0
    v_exp_f32 v38, v38
    v_exp_f32 v39, v39
    v_exp_f32 v40, v40
    v_exp_f32 v41, v41
    v_exp_f32 v42, v42
    v_smfmac_f32_32x32x32_bf16 v[208:223], v[52:55], v[32:39], v8
    v_exp_f32 v43, v43
    v_exp_f32 v44, v44
    v_exp_f32 v45, v45
    v_exp_f32 v46, v46
    v_exp_f32 v47, v47
    v_exp_f32 v16, v16
    v_exp_f32 v17, v17
    v_smfmac_f32_32x32x32_bf16 v[208:223], v[56:59], v[40:47], v8
    v_exp_f32 v18, v18
    v_exp_f32 v19, v19
    v_exp_f32 v20, v20
    v_exp_f32 v21, v21
    v_exp_f32 v22, v22
    v_exp_f32 v23, v23
    v_exp_f32 v24, v24
    v_exp_f32 v25, v25
    v_exp_f32 v26, v26
    v_smfmac_f32_32x32x32_bf16 v[224:239], v[52:55], v[16:23], v8
    v_exp_f32 v27, v27
    v_exp_f32 v28, v28
    v_exp_f32 v29, v29
    v_exp_f32 v30, v30
    v_exp_f32 v31, v31
    s_nop 1
    v_smfmac_f32_32x32x32_bf16 v[224:239], v[56:59], v[24:31], v8
    s_lshl_b32 s17, s15, 3
    s_add_u32 s17, s17, 3
    s_waitcnt vmcnt(0)
    v_mov_b32 v1, s17
    s_mov_b64 exec, 1
    buffer_store_dword v1, off, s[4:7], s28 sc1
    s_mov_b64 exec, -1
    s_nop 5
    v_rcp_f32 v84, v168
    v_rcp_f32 v86, v184
    v_rcp_f32 v88, v200
    v_rcp_f32 v90, v216
    v_rcp_f32 v92, v232
    s_nop 0
    v_max_f32 v1, v84, v168
    v_max3_f32 v1, v1, v86, v184
    v_max3_f32 v1, v1, v88, v200
    v_max3_f32 v1, v1, v90, v216
    v_max3_f32 v1, v1, v92, v232
    v_mov_b32 v81, v168
    v_add_f32 v81, v81, v184
    v_add_f32 v81, v81, v200
    v_add_f32 v81, v81, v216
    v_add_f32 v81, v81, v232
    v_cmp_ngt_f32 vcc, s26, v1
    v_cmp_u_f32 s[16:17], v81, v81
    s_mov_b32 s24, 2
    s_mov_b32 s25, 7
    s_mov_b32 s29, 2
    s_or_b64 vcc, vcc, s[16:17]
    s_cbranch_scc1 L_bslow
L_bf2:
    v_pk_mul_f32 v[160:161], v[160:161], v[84:85] op_sel_hi:[1,0]
    v_pk_mul_f32 v[162:163], v[162:163], v[84:85] op_sel_hi:[1,0]
    v_pk_mul_f32 v[164:165], v[164:165], v[84:85] op_sel_hi:[1,0]
    v_pk_mul_f32 v[166:167], v[166:167], v[84:85] op_sel_hi:[1,0]
    v_cvt_pk_bf16_f32 v160, v160, v161
    v_cvt_pk_bf16_f32 v161, v162, v163
    v_cvt_pk_bf16_f32 v162, v164, v165
    v_cvt_pk_bf16_f32 v163, v166, v167
    s_add_u32 s16, s27, 524288
    buffer_store_dwordx4 v[160:163], v0, s[4:7], s16 offen sc1
    v_pk_mul_f32 v[176:177], v[176:177], v[86:87] op_sel_hi:[1,0]
    v_pk_mul_f32 v[178:179], v[178:179], v[86:87] op_sel_hi:[1,0]
    v_pk_mul_f32 v[180:181], v[180:181], v[86:87] op_sel_hi:[1,0]
    v_pk_mul_f32 v[182:183], v[182:183], v[86:87] op_sel_hi:[1,0]
    v_cvt_pk_bf16_f32 v176, v176, v177
    v_cvt_pk_bf16_f32 v177, v178, v179
    v_cvt_pk_bf16_f32 v178, v180, v181
    v_cvt_pk_bf16_f32 v179, v182, v183
    s_add_u32 s16, s27, 786432
    buffer_store_dwordx4 v[176:179], v0, s[4:7], s16 offen sc1
    v_pk_mul_f32 v[192:193], v[192:193], v[88:89] op_sel_hi:[1,0]
    v_pk_mul_f32 v[194:195], v[194:195], v[88:89] op_sel_hi:[1,0]
    v_pk_mul_f32 v[196:197], v[196:197], v[88:89] op_sel_hi:[1,0]
    v_pk_mul_f32 v[198:199], v[198:199], v[88:89] op_sel_hi:[1,0]
    v_cvt_pk_bf16_f32 v192, v192, v193
    v_cvt_pk_bf16_f32 v193, v194, v195
    v_cvt_pk_bf16_f32 v194, v196, v197
    v_cvt_pk_bf16_f32 v195, v198, v199
    s_add_u32 s16, s27, 1048576
    buffer_store_dwordx4 v[192:195], v0, s[4:7], s16 offen sc1
    v_pk_mul_f32 v[208:209], v[208:209], v[90:91] op_sel_hi:[1,0]
    v_pk_mul_f32 v[210:211], v[210:211], v[90:91] op_sel_hi:[1,0]
    v_pk_mul_f32 v[212:213], v[212:213], v[90:91] op_sel_hi:[1,0]
    v_pk_mul_f32 v[214:215], v[214:215], v[90:91] op_sel_hi:[1,0]
    v_cvt_pk_bf16_f32 v208, v208, v209
    v_cvt_pk_bf16_f32 v209, v210, v211
    v_cvt_pk_bf16_f32 v210, v212, v213
    v_cvt_pk_bf16_f32 v211, v214, v215
    s_add_u32 s16, s27, 1310720
    buffer_store_dwordx4 v[208:211], v0, s[4:7], s16 offen sc1
    v_pk_mul_f32 v[224:225], v[224:225], v[92:93] op_sel_hi:[1,0]
    v_pk_mul_f32 v[226:227], v[226:227], v[92:93] op_sel_hi:[1,0]
    v_pk_mul_f32 v[228:229], v[228:229], v[92:93] op_sel_hi:[1,0]
    v_pk_mul_f32 v[230:231], v[230:231], v[92:93] op_sel_hi:[1,0]
    v_cvt_pk_bf16_f32 v224, v224, v225
    v_cvt_pk_bf16_f32 v225, v226, v227
    v_cvt_pk_bf16_f32 v226, v228, v229
    v_cvt_pk_bf16_f32 v227, v230, v231
    s_add_u32 s16, s27, 1572864
    buffer_store_dwordx4 v[224:227], v0, s[4:7], s16 offen sc1
    s_lshl_b32 s17, s15, 3
    s_add_u32 s17, s17, 4
    s_waitcnt vmcnt(0)
    v_mov_b32 v1, s17
    s_mov_b64 exec, 1
    buffer_store_dword v1, off, s[4:7], s28 sc1
    s_mov_b64 exec, -1
    s_branch L_b7_143
L_b6_142:
    v_mfma_f32_32x32x16_bf16 v[16:31], v[48:51], a[8:11], 0
    s_nop 11
    v_exp_f32 v16, v16
    v_exp_f32 v17, v17
    v_exp_f32 v18, v18
    v_exp_f32 v19, v19
    v_exp_f32 v20, v20
    v_exp_f32 v21, v21
    v_mfma_f32_32x32x16_bf16 v[32:47], v[48:51], a[12:15], 0
    s_nop 0
    v_exp_f32 v22, v22
    v_exp_f32 v23, v23
    v_exp_f32 v24, v24
    v_exp_f32 v25, v25
    v_exp_f32 v26, v26
    v_smfmac_f32_32x32x32_bf16 v[160:175], v[52:55], v[16:23], v8
    v_exp_f32 v27, v27
    v_exp_f32 v28, v28
    v_exp_f32 v29, v29
    v_exp_f32 v30, v30
    v_exp_f32 v31, v31
    v_exp_f32 v32, v32
    v_exp_f32 v33, v33
    v_smfmac_f32_32x32x32_bf16 v[160:175], v[56:59], v[24:31], v8
    v_exp_f32 v34, v34
    v_exp_f32 v35, v35
    v_exp_f32 v36, v36
    v_exp_f32 v37, v37
    v_mfma_f32_32x32x16_bf16 v[16:31], v[48:51], a[16:19], 0
    s_nop 0
    v_exp_f32 v38, v38
    v_exp_f32 v39, v39
    v_exp_f32 v40, v40
    v_exp_f32 v41, v41
    v_exp_f32 v42, v42
    v_smfmac_f32_32x32x32_bf16 v[176:191], v[52:55], v[32:39], v8
    v_exp_f32 v43, v43
    v_exp_f32 v44, v44
    v_exp_f32 v45, v45
    v_exp_f32 v46, v46
    v_exp_f32 v47, v47
    v_exp_f32 v16, v16
    v_exp_f32 v17, v17
    v_smfmac_f32_32x32x32_bf16 v[176:191], v[56:59], v[40:47], v8
    v_exp_f32 v18, v18
    v_exp_f32 v19, v19
    v_exp_f32 v20, v20
    v_exp_f32 v21, v21
    v_mfma_f32_32x32x16_bf16 v[32:47], v[48:51], a[20:23], 0
    s_nop 0
    v_exp_f32 v22, v22
    v_exp_f32 v23, v23
    v_exp_f32 v24, v24
    v_exp_f32 v25, v25
    v_exp_f32 v26, v26
    v_smfmac_f32_32x32x32_bf16 v[192:207], v[52:55], v[16:23], v8
    v_exp_f32 v27, v27
    v_exp_f32 v28, v28
    v_exp_f32 v29, v29
    v_exp_f32 v30, v30
    v_exp_f32 v31, v31
    v_exp_f32 v32, v32
    v_exp_f32 v33, v33
    v_smfmac_f32_32x32x32_bf16 v[192:207], v[56:59], v[24:31], v8
    v_exp_f32 v34, v34
    v_exp_f32 v35, v35
    v_exp_f32 v36, v36
    v_exp_f32 v37, v37
    v_exp_f32 v38, v38
    v_exp_f32 v39, v39
    v_exp_f32 v40, v40
    v_exp_f32 v41, v41
    v_exp_f32 v42, v42
    v_smfmac_f32_32x32x32_bf16 v[208:223], v[52:55], v[32:39], v8
    v_exp_f32 v43, v43
    v_exp_f32 v44, v44
    v_exp_f32 v45, v45
    v_exp_f32 v46, v46
    v_exp_f32 v47, v47
    s_nop 1
    v_smfmac_f32_32x32x32_bf16 v[208:223], v[56:59], v[40:47], v8
    s_lshl_b32 s17, s15, 3
    s_add_u32 s17, s17, 3
    s_waitcnt vmcnt(0)
    v_mov_b32 v1, s17
    s_mov_b64 exec, 1
    buffer_store_dword v1, off, s[4:7], s28 sc1
    s_mov_b64 exec, -1
    s_nop 5
    v_rcp_f32 v84, v168
    v_rcp_f32 v86, v184
    v_rcp_f32 v88, v200
    v_rcp_f32 v90, v216
    s_nop 0
    v_max_f32 v1, v84, v168
    v_max3_f32 v1, v1, v86, v184
    v_max3_f32 v1, v1, v88, v200
    v_max3_f32 v1, v1, v90, v216
    v_mov_b32 v81, v168
    v_add_f32 v81, v81, v184
    v_add_f32 v81, v81, v200
    v_add_f32 v81, v81, v216
    v_cmp_ngt_f32 vcc, s26, v1
    v_cmp_u_f32 s[16:17], v81, v81
    s_mov_b32 s24, 2
    s_mov_b32 s25, 6
    s_mov_b32 s29, 3
    s_or_b64 vcc, vcc, s[16:17]
    s_cbranch_scc1 L_bslow
L_bf3:
    v_pk_mul_f32 v[160:161], v[160:161], v[84:85] op_sel_hi:[1,0]
    v_pk_mul_f32 v[162:163], v[162:163], v[84:85] op_sel_hi:[1,0]
    v_pk_mul_f32 v[164:165], v[164:165], v[84:85] op_sel_hi:[1,0]
    v_pk_mul_f32 v[166:167], v[166:167], v[84:85] op_sel_hi:[1,0]
    v_cvt_pk_bf16_f32 v160, v160, v161
    v_cvt_pk_bf16_f32 v161, v162, v163
    v_cvt_pk_bf16_f32 v162, v164, v165
    v_cvt_pk_bf16_f32 v163, v166, v167
    s_add_u32 s16, s27, 524288
    buffer_store_dwordx4 v[160:163], v0, s[4:7], s16 offen sc1
    v_pk_mul_f32 v[176:177], v[176:177], v[86:87] op_sel_hi:[1,0]
    v_pk_mul_f32 v[178:179], v[178:179], v[86:87] op_sel_hi:[1,0]
    v_pk_mul_f32 v[180:181], v[180:181], v[86:87] op_sel_hi:[1,0]
    v_pk_mul_f32 v[182:183], v[182:183], v[86:87] op_sel_hi:[1,0]
    v_cvt_pk_bf16_f32 v176, v176, v177
    v_cvt_pk_bf16_f32 v177, v178, v179
    v_cvt_pk_bf16_f32 v178, v180, v181
    v_cvt_pk_bf16_f32 v179, v182, v183
    s_add_u32 s16, s27, 786432
    buffer_store_dwordx4 v[176:179], v0, s[4:7], s16 offen sc1
    v_pk_mul_f32 v[192:193], v[192:193], v[88:89] op_sel_hi:[1,0]
    v_pk_mul_f32 v[194:195], v[194:195], v[88:89] op_sel_hi:[1,0]
    v_pk_mul_f32 v[196:197], v[196:197], v[88:89] op_sel_hi:[1,0]
    v_pk_mul_f32 v[198:199], v[198:199], v[88:89] op_sel_hi:[1,0]
    v_cvt_pk_bf16_f32 v192, v192, v193
    v_cvt_pk_bf16_f32 v193, v194, v195
    v_cvt_pk_bf16_f32 v194, v196, v197
    v_cvt_pk_bf16_f32 v195, v198, v199
    s_add_u32 s16, s27, 1048576
    buffer_store_dwordx4 v[192:195], v0, s[4:7], s16 offen sc1
    v_pk_mul_f32 v[208:209], v[208:209], v[90:91] op_sel_hi:[1,0]
    v_pk_mul_f32 v[210:211], v[210:211], v[90:91] op_sel_hi:[1,0]
    v_pk_mul_f32 v[212:213], v[212:213], v[90:91] op_sel_hi:[1,0]
    v_pk_mul_f32 v[214:215], v[214:215], v[90:91] op_sel_hi:[1,0]
    v_cvt_pk_bf16_f32 v208, v208, v209
    v_cvt_pk_bf16_f32 v209, v210, v211
    v_cvt_pk_bf16_f32 v210, v212, v213
    v_cvt_pk_bf16_f32 v211, v214, v215
    s_add_u32 s16, s27, 1310720
    buffer_store_dwordx4 v[208:211], v0, s[4:7], s16 offen sc1
    s_lshl_b32 s17, s15, 3
    s_add_u32 s17, s17, 4
    s_waitcnt vmcnt(0)
    v_mov_b32 v1, s17
    s_mov_b64 exec, 1
    buffer_store_dword v1, off, s[4:7], s28 sc1
    s_mov_b64 exec, -1
L_b7_143:
    s_cmp_eq_u32 s15, 1
    s_cbranch_scc1 L_bend_128
    s_add_u32 s20, s14, 120
L_bnew_125:
    s_min_u32 s23, s20, 63
    s_and_b32 s33, s20, 14
    s_lshl_b32 s33, s33, 9
L_loop2:
    v_add_u32 v1, s33, v7
    s_lshl_b32 s16, s13, 10
    v_add_u32 v4, s16, v15
    ds_read_b128 v[60:63], v1 offset:20480
    ds_read_b128 v[48:51], v4
    v_mov_b64 v[64:65], 0
    v_mov_b64 v[66:67], 0
    v_mov_b64 v[68:69], 0
    v_mov_b64 v[70:71], 0
    v_mov_b64 v[72:73], 0
    s_sub_u32 s23, s23, s13
    s_cbranch_scc1 L_bm_144
    s_bfe_u32 s19, s23, 0x20002
    s_xor_b32 s19, s19, 3
    s_lshr_b32 s23, s23, 4
    s_lshl_b32 s25, s19, 12
    s_sub_u32 s16, s16, s25
    v_add_u32 v4, s16, v15
    v_and_b32 v5, s16, v9
    v_add_u32 v5, v5, v3
    s_cmp_eq_u32 s19, 1
    s_cbranch_scc1 L_bpr_150
    s_cmp_eq_u32 s19, 2
    s_cbranch_scc1 L_bpr_151
    s_cmp_eq_u32 s19, 3
    s_cbranch_scc1 L_bpr_152
    s_waitcnt lgkmcnt(0)
    v_mfma_f32_32x32x16_bf16 v[16:31], v[48:51], v[60:63], 0
    s_nop 0
    ds_read_b128 v[48:51], v4 offset:4096
    ds_read_b128 v[52:55], v5 offset:0
    v_mov_b64 v[40:41], 0
    v_mov_b64 v[42:43], 0
    v_mov_b64 v[44:45], 0
    v_mov_b64 v[46:47], 0
    s_nop 4
L_bt_145:
    v_exp_f32 v16, v16
    v_exp_f32 v17, v17
    v_smfmac_f32_32x32x32_bf16 v[64:79], v[56:59], v[40:47], v8
    s_waitcnt lgkmcnt(1)
    ds_read_b128 v[56:59], v5 offset:512
    v_exp_f32 v18, v18
    v_exp_f32 v19, v19
    v_exp_f32 v20, v20
    v_exp_f32 v21, v21
    v_mfma_f32_32x32x16_bf16 v[32:47], v[48:51], v[60:63], 0
    s_waitcnt lgkmcnt(1)
    ds_read_b128 v[48:51], v4 offset:8192
    v_exp_f32 v22, v22
    v_exp_f32 v23, v23
    v_exp_f32 v24, v24
    v_exp_f32 v25, v25
    v_exp_f32 v26, v26
    v_smfmac_f32_32x32x32_bf16 v[64:79], v[52:55], v[16:23], v8
    s_waitcnt lgkmcnt(1)
    ds_read_b128 v[52:55], v5 offset:4096
    v_exp_f32 v27, v27
    v_exp_f32 v28, v28
    v_exp_f32 v29, v29
    v_exp_f32 v30, v30
    v_exp_f32 v31, v31
L_bt_146:
    v_exp_f32 v32, v32
    v_exp_f32 v33, v33
    v_smfmac_f32_32x32x32_bf16 v[64:79], v[56:59], v[24:31], v8
    s_waitcnt lgkmcnt(1)
    ds_read_b128 v[56:59], v5 offset:4608
    v_exp_f32 v34, v34
    v_exp_f32 v35, v35
    v_exp_f32 v36, v36
    v_exp_f32 v37, v37
    v_mfma_f32_32x32x16_bf16 v[16:31], v[48:51], v[60:63], 0
    s_waitcnt lgkmcnt(1)
    ds_read_b128 v[48:51], v4 offset:12288
    v_exp_f32 v38, v38
    v_exp_f32 v39, v39
    v_exp_f32 v40, v40
    v_exp_f32 v41, v41
    v_exp_f32 v42, v42
    v_smfmac_f32_32x32x32_bf16 v[64:79], v[52:55], v[32:39], v8
    s_waitcnt lgkmcnt(1)
    ds_read_b128 v[52:55], v5 offset:8192
    v_exp_f32 v43, v43
    v_exp_f32 v44, v44
    v_exp_f32 v45, v45
    v_exp_f32 v46, v46
    v_exp_f32 v47, v47
L_bt_147:
    v_exp_f32 v16, v16
    v_exp_f32 v17, v17
    v_smfmac_f32_32x32x32_bf16 v[64:79], v[56:59], v[40:47], v8
    s_waitcnt lgkmcnt(1)
    ds_read_b128 v[56:59], v5 offset:8704
    v_exp_f32 v18, v18
    v_exp_f32 v19, v19
    v_exp_f32 v20, v20
    v_exp_f32 v21, v21
    v_mfma_f32_32x32x16_bf16 v[32:47], v[48:51], v[60:63], 0
    s_waitcnt lgkmcnt(1)
    ds_read_b128 v[48:51], v4 offset:16384
    v_exp_f32 v22, v22
    v_exp_f32 v23, v23
    v_exp_f32 v24, v24
    v_exp_f32 v25, v25
    v_exp_f32 v26, v26
    v_smfmac_f32_32x32x32_bf16 v[64:79], v[52:55], v[16:23], v8
    s_waitcnt lgkmcnt(1)
    ds_read_b128 v[52:55], v5 offset:12288
    v_exp_f32 v27, v27
    v_exp_f32 v28, v28
    v_exp_f32 v29, v29
    v_exp_f32 v30, v30
    v_exp_f32 v31, v31
L_bt_148:
    v_exp_f32 v32, v32
    v_exp_f32 v33, v33
    v_smfmac_f32_32x32x32_bf16 v[64:79], v[56:59], v[24:31], v8
    s_waitcnt lgkmcnt(1)
    ds_read_b128 v[56:59], v5 offset:12800
    v_exp_f32 v34, v34
    v_exp_f32 v35, v35
    v_exp_f32 v36, v36
    v_exp_f32 v37, v37
    v_mfma_f32_32x32x16_bf16 v[16:31], v[48:51], v[60:63], 0
    s_waitcnt lgkmcnt(1)
    ds_read_b128 v[48:51], v4 offset:20480
    v_exp_f32 v38, v38
    v_exp_f32 v39, v39
    v_exp_f32 v40, v40
    v_exp_f32 v41, v41
    v_exp_f32 v42, v42
    v_smfmac_f32_32x32x32_bf16 v[64:79], v[52:55], v[32:39], v8
    s_waitcnt lgkmcnt(1)
    ds_read_b128 v[52:55], v5 offset:16384
    v_add_u32 v4, 0x4000, v4
    v_add_u32 v5, v10, v5
    s_sub_u32 s23, s23, 1
    v_exp_f32 v43, v43
    v_exp_f32 v44, v44
    v_exp_f32 v45, v45
    v_exp_f32 v46, v46
    v_exp_f32 v47, v47
    s_cbranch_scc0 L_bt_145
    s_nop 0
    v_smfmac_f32_32x32x32_bf16 v[64:79], v[56:59], v[40:47], v8
    s_nop 8
    s_branch L_bm_144
L_bpr_150:
    s_waitcnt lgkmcnt(0)
    v_mfma_f32_32x32x16_bf16 v[32:47], v[48:51], v[60:63], 0
    s_nop 0
    ds_read_b128 v[48:51], v4 offset:8192
    ds_read_b128 v[52:55], v5 offset:4096
    v_mov_b64 v[24:25], 0
    v_mov_b64 v[26:27], 0
    v_mov_b64 v[28:29], 0
    v_mov_b64 v[30:31], 0
    s_nop 3
    s_branch L_bt_146
L_bpr_151:
    s_waitcnt lgkmcnt(0)
    v_mfma_f32_32x32x16_bf16 v[16:31], v[48:51], v[60:63], 0
    s_nop 0
    ds_read_b128 v[48:51], v4 offset:12288
    ds_read_b128 v[52:55], v5 offset:8192
    v_mov_b64 v[40:41], 0
    v_mov_b64 v[42:43], 0
    v_mov_b64 v[44:45], 0
    v_mov_b64 v[46:47], 0
    s_nop 3
    s_branch L_bt_147
L_bpr_152:
    s_waitcnt lgkmcnt(0)
    v_mfma_f32_32x32x16_bf16 v[32:47], v[48:51], v[60:63], 0
    s_nop 0
    ds_read_b128 v[48:51], v4 offset:16384
    ds_read_b128 v[52:55], v5 offset:12288
    v_mov_b64 v[24:25], 0
    v_mov_b64 v[26:27], 0
    v_mov_b64 v[28:29], 0
    v_mov_b64 v[30:31], 0
    s_nop 3
    s_branch L_bt_148
L_bm_144:
    s_cmp_lg_u32 s32, 0
    s_cbranch_scc1 L_hret
    ds_write_b128 v6, v[64:67] offset:0
    ds_write_b128 v6, v[68:71] offset:1024
    ds_write_b32 v6, v72 offset:2048
    s_bfe_u32 s16, s20, 0x20001
    s_cmp_eq_u32 s16, s13
    s_waitcnt lgkmcnt(0)
    s_barrier
    s_cbranch_scc0 L_bn2_153
    ds_read_b128 v[64:67], v7 offset:0
    ds_read_b128 v[68:71], v7 offset:1024
    ds_read_b32 v72, v7 offset:2048
    ds_read_b128 v[80:83], v7 offset:4096
    ds_read_b128 v[84:87], v7 offset:5120
    ds_read_b32 v88, v7 offset:6144
    ds_read_b128 v[92:95], v7 offset:8192
    ds_read_b128 v[96:99], v7 offset:9216
    ds_read_b32 v100, v7 offset:10240
    ds_read_b128 v[104:107], v7 offset:12288
    ds_read_b128 v[108:111], v7 offset:13312
    ds_read_b32 v112, v7 offset:14336
    s_waitcnt lgkmcnt(6)
    v_pk_add_f32 v[64:65], v[64:65], v[80:81]
    v_pk_add_f32 v[66:67], v[66:67], v[82:83]
    v_pk_add_f32 v[68:69], v[68:69], v[84:85]
    v_pk_add_f32 v[70:71], v[70:71], v[86:87]
    v_pk_add_f32 v[72:73], v[72:73], v[88:89]
    s_waitcnt lgkmcnt(0)
    v_pk_add_f32 v[92:93], v[92:93], v[104:105]
    v_pk_add_f32 v[94:95], v[94:95], v[106:107]
    v_pk_add_f32 v[96:97], v[96:97], v[108:109]
    v_pk_add_f32 v[98:99], v[98:99], v[110:111]
    v_pk_add_f32 v[100:101], v[100:101], v[112:113]
    s_cmp_eq_u32 s22, 7
    s_cbranch_scc1 L_put7_161
    s_cmp_eq_u32 s22, 6
    s_cbranch_scc1 L_put6_160
    s_cmp_eq_u32 s22, 5
    s_cbranch_scc1 L_put5_159
    s_cmp_eq_u32 s22, 4
    s_cbranch_scc1 L_put4_158
    s_cmp_eq_u32 s22, 3
    s_cbranch_scc1 L_put3_157
    s_cmp_eq_u32 s22, 2
    s_cbranch_scc1 L_put2_156
    s_cmp_eq_u32 s22, 1
    s_cbranch_scc1 L_put1_155
L_put0_154:
    v_pk_add_f32 v[128:129], v[64:65], v[92:93]
    v_pk_add_f32 v[130:131], v[66:67], v[94:95]
    v_pk_add_f32 v[132:133], v[68:69], v[96:97]
    v_pk_add_f32 v[134:135], v[70:71], v[98:99]
    v_pk_add_f32 v[136:137], v[72:73], v[100:101]
    v_accvgpr_write_b32 a0, v60
    v_accvgpr_write_b32 a1, v61
    v_accvgpr_write_b32 a2, v62
    v_accvgpr_write_b32 a3, v63
    s_branch L_pute_162
L_put1_155:
    v_pk_add_f32 v[144:145], v[64:65], v[92:93]
    v_pk_add_f32 v[146:147], v[66:67], v[94:95]
    v_pk_add_f32 v[148:149], v[68:69], v[96:97]
    v_pk_add_f32 v[150:151], v[70:71], v[98:99]
    v_pk_add_f32 v[152:153], v[72:73], v[100:101]
    v_accvgpr_write_b32 a4, v60
    v_accvgpr_write_b32 a5, v61
    v_accvgpr_write_b32 a6, v62
    v_accvgpr_write_b32 a7, v63
    s_branch L_pute_162
L_put2_156:
    v_pk_add_f32 v[160:161], v[64:65], v[92:93]
    v_pk_add_f32 v[162:163], v[66:67], v[94:95]
    v_pk_add_f32 v[164:165], v[68:69], v[96:97]
    v_pk_add_f32 v[166:167], v[70:71], v[98:99]
    v_pk_add_f32 v[168:169], v[72:73], v[100:101]
    v_accvgpr_write_b32 a8, v60
    v_accvgpr_write_b32 a9, v61
    v_accvgpr_write_b32 a10, v62
    v_accvgpr_write_b32 a11, v63
    s_branch L_pute_162
L_put3_157:
    v_pk_add_f32 v[176:177], v[64:65], v[92:93]
    v_pk_add_f32 v[178:179], v[66:67], v[94:95]
    v_pk_add_f32 v[180:181], v[68:69], v[96:97]
    v_pk_add_f32 v[182:183], v[70:71], v[98:99]
    v_pk_add_f32 v[184:185], v[72:73], v[100:101]
    v_accvgpr_write_b32 a12, v60
    v_accvgpr_write_b32 a13, v61
    v_accvgpr_write_b32 a14, v62
    v_accvgpr_write_b32 a15, v63
    s_branch L_pute_162
L_put4_158:
    v_pk_add_f32 v[192:193], v[64:65], v[92:93]
    v_pk_add_f32 v[194:195], v[66:67], v[94:95]
    v_pk_add_f32 v[196:197], v[68:69], v[96:97]
    v_pk_add_f32 v[198:199], v[70:71], v[98:99]
    v_pk_add_f32 v[200:201], v[72:73], v[100:101]
    v_accvgpr_write_b32 a16, v60
    v_accvgpr_write_b32 a17, v61
    v_accvgpr_write_b32 a18, v62
    v_accvgpr_write_b32 a19, v63
    s_branch L_pute_162
L_put5_159:
    v_pk_add_f32 v[208:209], v[64:65], v[92:93]
    v_pk_add_f32 v[210:211], v[66:67], v[94:95]
    v_pk_add_f32 v[212:213], v[68:69], v[96:97]
    v_pk_add_f32 v[214:215], v[70:71], v[98:99]
    v_pk_add_f32 v[216:217], v[72:73], v[100:101]
    v_accvgpr_write_b32 a20, v60
    v_accvgpr_write_b32 a21, v61
    v_accvgpr_write_b32 a22, v62
    v_accvgpr_write_b32 a23, v63
    s_branch L_pute_162
L_put6_160:
    v_pk_add_f32 v[224:225], v[64:65], v[92:93]
    v_pk_add_f32 v[226:227], v[66:67], v[94:95]
    v_pk_add_f32 v[228:229], v[68:69], v[96:97]
    v_pk_add_f32 v[230:231], v[70:71], v[98:99]
    v_pk_add_f32 v[232:233], v[72:73], v[100:101]
    v_accvgpr_write_b32 a24, v60
    v_accvgpr_write_b32 a25, v61
    v_accvgpr_write_b32 a26, v62
    v_accvgpr_write_b32 a27, v63
    s_branch L_pute_162
L_put7_161:
    v_pk_add_f32 v[240:241], v[64:65], v[92:93]
    v_pk_add_f32 v[242:243], v[66:67], v[94:95]
    v_pk_add_f32 v[244:245], v[68:69], v[96:97]
    v_pk_add_f32 v[246:247], v[70:71], v[98:99]
    v_pk_add_f32 v[248:249], v[72:73], v[100:101]
    v_accvgpr_write_b32 a28, v60
    v_accvgpr_write_b32 a29, v61
    v_accvgpr_write_b32 a30, v62
    v_accvgpr_write_b32 a31, v63
L_pute_162:
    s_add_u32 s22, s22, 1
L_bn2_153:
    s_cmp_lt_u32 s20, 64
    s_cbranch_scc1 L_bnx_119
    s_barrier
    s_add_u32 s20, s20, 2
    s_cmp_lt_u32 s20, 128
    s_cbranch_scc1 L_bnew_125
L_bfin7:
    v_rcp_f32 v94, v248
    s_nop 0
    v_max_f32 v1, v94, v248
    v_mov_b32 v81, v248
    v_cmp_ngt_f32 vcc, s26, v1
    v_cmp_u_f32 s[16:17], v81, v81
    s_mov_b32 s24, 7
    s_mov_b32 s25, 8
    s_mov_b32 s29, 4
    s_or_b64 vcc, vcc, s[16:17]
    s_cbranch_scc1 L_bslow
L_bf4:
    v_pk_mul_f32 v[240:241], v[240:241], v[94:95] op_sel_hi:[1,0]
    v_pk_mul_f32 v[242:243], v[242:243], v[94:95] op_sel_hi:[1,0]
    v_pk_mul_f32 v[244:245], v[244:245], v[94:95] op_sel_hi:[1,0]
    v_pk_mul_f32 v[246:247], v[246:247], v[94:95] op_sel_hi:[1,0]
    v_cvt_pk_bf16_f32 v240, v240, v241
    v_cvt_pk_bf16_f32 v241, v242, v243
    v_cvt_pk_bf16_f32 v242, v244, v245
    v_cvt_pk_bf16_f32 v243, v246, v247
    s_add_u32 s16, s27, 1835008
    buffer_store_dwordx4 v[240:243], v0, s[4:7], s16 offen sc1
    s_lshl_b32 s17, s15, 3
    s_add_u32 s17, s17, 5
    s_waitcnt vmcnt(0)
    v_mov_b32 v1, s17
    s_mov_b64 exec, 1
    buffer_store_dword v1, off, s[4:7], s28 sc1
    s_mov_b64 exec, -1
    s_cmp_lg_u32 s32, 0
    s_cbranch_scc1 L_fin
    s_barrier
    s_add_u32 s15, s15, 1
    s_cmp_lt_u32 s15, 2
    s_cbranch_scc1 L_bl_115
    s_branch L_fin
L_bslow:
    s_cmp_eq_u32 s24, 7
    s_cbranch_scc1 L_get7_172
    s_cmp_eq_u32 s24, 6
    s_cbranch_scc1 L_get6_171
    s_cmp_eq_u32 s24, 5
    s_cbranch_scc1 L_get5_170
    s_cmp_eq_u32 s24, 4
    s_cbranch_scc1 L_get4_169
    s_cmp_eq_u32 s24, 3
    s_cbranch_scc1 L_get3_168
    s_cmp_eq_u32 s24, 2
    s_cbranch_scc1 L_get2_167
    s_cmp_eq_u32 s24, 1
    s_cbranch_scc1 L_get1_166
L_get0_165:
    v_accvgpr_read_b32 v96, a0
    v_accvgpr_read_b32 v97, a1
    v_accvgpr_read_b32 v98, a2
    v_accvgpr_read_b32 v99, a3
    s_branch L_gete_173
L_get1_166:
    v_accvgpr_read_b32 v96, a4
    v_accvgpr_read_b32 v97, a5
    v_accvgpr_read_b32 v98, a6
    v_accvgpr_read_b32 v99, a7
    s_branch L_gete_173
L_get2_167:
    v_accvgpr_read_b32 v96, a8
    v_accvgpr_read_b32 v97, a9
    v_accvgpr_read_b32 v98, a10
    v_accvgpr_read_b32 v99, a11
    s_branch L_gete_173
L_get3_168:
    v_accvgpr_read_b32 v96, a12
    v_accvgpr_read_b32 v97, a13
    v_accvgpr_read_b32 v98, a14
    v_accvgpr_read_b32 v99, a15
    s_branch L_gete_173
L_get4_169:
    v_accvgpr_read_b32 v96, a16
    v_accvgpr_read_b32 v97, a17
    v_accvgpr_read_b32 v98, a18
    v_accvgpr_read_b32 v99, a19
    s_branch L_gete_173
L_get5_170:
    v_accvgpr_read_b32 v96, a20
    v_accvgpr_read_b32 v97, a21
    v_accvgpr_read_b32 v98, a22
    v_accvgpr_read_b32 v99, a23
    s_branch L_gete_173
L_get6_171:
    v_accvgpr_read_b32 v96, a24
    v_accvgpr_read_b32 v97, a25
    v_accvgpr_read_b32 v98, a26
    v_accvgpr_read_b32 v99, a27
    s_branch L_gete_173
L_get7_172:
    v_accvgpr_read_b32 v96, a28
    v_accvgpr_read_b32 v97, a29
    v_accvgpr_read_b32 v98, a30
    v_accvgpr_read_b32 v99, a31
L_gete_173:
    v_mov_b32 v4, v15
    v_mov_b32 v1, 0xff800000
    s_mov_b32 s23, 64
L_sp1_163:
    ds_read_b128 v[48:51], v4
    v_add_u32 v4, 0x400, v4
    s_waitcnt lgkmcnt(0)
    v_mfma_f32_32x32x16_bf16 v[16:31], v[48:51], v[96:99], 0
    s_nop 11
    v_max3_f32 v1, v1, v16, v17
    v_max3_f32 v1, v1, v18, v19
    v_max3_f32 v1, v1, v20, v21
    v_max3_f32 v1, v1, v22, v23
    v_max3_f32 v1, v1, v24, v25
    v_max3_f32 v1, v1, v26, v27
    v_max3_f32 v1, v1, v28, v29
    v_max3_f32 v1, v1, v30, v31
    s_sub_u32 s23, s23, 1
    s_cmp_lg_u32 s23, 0
    s_cbranch_scc1 L_sp1_163
    v_mov_b32 v32, v1
    s_nop 1
    v_permlane32_swap_b32 v1, v32
    v_max_f32 v1, v1, v32
    v_sub_f32 v32, 0, v1
    v_sub_f32 v33, 0, v1
    v_sub_f32 v34, 0, v1
    v_sub_f32 v35, 0, v1
    v_sub_f32 v36, 0, v1
    v_sub_f32 v37, 0, v1
    v_sub_f32 v38, 0, v1
    v_sub_f32 v39, 0, v1
    v_sub_f32 v40, 0, v1
    v_sub_f32 v41, 0, v1
    v_sub_f32 v42, 0, v1
    v_sub_f32 v43, 0, v1
    v_sub_f32 v44, 0, v1
    v_sub_f32 v45, 0, v1
    v_sub_f32 v46, 0, v1
    v_sub_f32 v47, 0, v1
    v_mov_b64 v[64:65], 0
    v_mov_b64 v[66:67], 0
    v_mov_b64 v[68:69], 0
    v_mov_b64 v[70:71], 0
    v_mov_b64 v[72:73], 0
    v_mov_b64 v[74:75], 0
    v_mov_b64 v[76:77], 0
    v_mov_b64 v[78:79], 0
    v_mov_b32 v4, v15
    v_mov_b32 v5, v3
    v_lshrrev_b32 v1, 4, v10
    s_mov_b32 s23, 64
L_sp2_164:
    ds_read_b128 v[48:51], v4
    ds_read_b128 v[52:55], v5
    ds_read_b128 v[56:59], v5 offset:512
    v_add_u32 v4, 0x400, v4
    v_add_u32 v5, v1, v5
    s_waitcnt lgkmcnt(0)
    v_mfma_f32_32x32x16_bf16 v[16:31], v[48:51], v[96:99], v[32:47]
    s_nop 11
    v_exp_f32 v16, v16
    v_exp_f32 v17, v17
    v_exp_f32 v18, v18
    v_exp_f32 v19, v19
    v_exp_f32 v20, v20
    v_exp_f32 v21, v21
    v_exp_f32 v22, v22
    v_exp_f32 v23, v23
    v_exp_f32 v24, v24
    v_exp_f32 v25, v25
    v_exp_f32 v26, v26
    v_exp_f32 v27, v27
    v_exp_f32 v28, v28
    v_exp_f32 v29, v29
    v_exp_f32 v30, v30
    v_exp_f32 v31, v31
    s_nop 1
    v_smfmac_f32_32x32x32_bf16 v[64:79], v[52:55], v[16:23], v8
    v_smfmac_f32_32x32x32_bf16 v[64:79], v[56:59], v[24:31], v8
    s_sub_u32 s23, s23, 1
    s_cmp_lg_u32 s23, 0
    s_cbranch_scc1 L_sp2_164
    s_nop 11
    s_cmp_eq_u32 s24, 7
    s_cbranch_scc1 L_pu27_181
    s_cmp_eq_u32 s24, 6
    s_cbranch_scc1 L_pu26_180
    s_cmp_eq_u32 s24, 5
    s_cbranch_scc1 L_pu25_179
    s_cmp_eq_u32 s24, 4
    s_cbranch_scc1 L_pu24_178
    s_cmp_eq_u32 s24, 3
    s_cbranch_scc1 L_pu23_177
    s_cmp_eq_u32 s24, 2
    s_cbranch_scc1 L_pu22_176
    s_cmp_eq_u32 s24, 1
    s_cbranch_scc1 L_pu21_175
L_pu20_174:
    v_mov_b64 v[128:129], v[64:65]
    v_mov_b64 v[130:131], v[66:67]
    v_mov_b64 v[132:133], v[68:69]
    v_mov_b64 v[134:135], v[70:71]
    v_mov_b64 v[136:137], v[72:73]
    v_rcp_f32 v80, v72
    s_branch L_pu2e_182
L_pu21_175:
    v_mov_b64 v[144:145], v[64:65]
    v_mov_b64 v[146:147], v[66:67]
    v_mov_b64 v[148:149], v[68:69]
    v_mov_b64 v[150:151], v[70:71]
    v_mov_b64 v[152:153], v[72:73]
    v_rcp_f32 v82, v72
    s_branch L_pu2e_182
L_pu22_176:
    v_mov_b64 v[160:161], v[64:65]
    v_mov_b64 v[162:163], v[66:67]
    v_mov_b64 v[164:165], v[68:69]
    v_mov_b64 v[166:167], v[70:71]
    v_mov_b64 v[168:169], v[72:73]
    v_rcp_f32 v84, v72
    s_branch L_pu2e_182
L_pu23_177:
    v_mov_b64 v[176:177], v[64:65]
    v_mov_b64 v[178:179], v[66:67]
    v_mov_b64 v[180:181], v[68:69]
    v_mov_b64 v[182:183], v[70:71]
    v_mov_b64 v[184:185], v[72:73]
    v_rcp_f32 v86, v72
    s_branch L_pu2e_182
L_pu24_178:
    v_mov_b64 v[192:193], v[64:65]
    v_mov_b64 v[194:195], v[66:67]
    v_mov_b64 v[196:197], v[68:69]
    v_mov_b64 v[198:199], v[70:71]
    v_mov_b64 v[200:201], v[72:73]
    v_rcp_f32 v88, v72
    s_branch L_pu2e_182
L_pu25_179:
    v_mov_b64 v[208:209], v[64:65]
    v_mov_b64 v[210:211], v[66:67]
    v_mov_b64 v[212:213], v[68:69]
    v_mov_b64 v[214:215], v[70:71]
    v_mov_b64 v[216:217], v[72:73]
    v_rcp_f32 v90, v72
    s_branch L_pu2e_182
L_pu26_180:
    v_mov_b64 v[224:225], v[64:65]
    v_mov_b64 v[226:227], v[66:67]
    v_mov_b64 v[228:229], v[68:69]
    v_mov_b64 v[230:231], v[70:71]
    v_mov_b64 v[232:233], v[72:73]
    v_rcp_f32 v92, v72
    s_branch L_pu2e_182
L_pu27_181:
    v_mov_b64 v[240:241], v[64:65]
    v_mov_b64 v[242:243], v[66:67]
    v_mov_b64 v[244:245], v[68:69]
    v_mov_b64 v[246:247], v[70:71]
    v_mov_b64 v[248:249], v[72:73]
    v_rcp_f32 v94, v72
L_pu2e_182:
    s_add_u32 s24, s24, 1
    s_cmp_lt_u32 s24, s25
    s_cbranch_scc1 L_bslow
    s_cmp_eq_u32 s29, 0
    s_cbranch_scc1 L_bf0
    s_cmp_eq_u32 s29, 1
    s_cbranch_scc1 L_bf1
    s_cmp_eq_u32 s29, 2
    s_cbranch_scc1 L_bf2
    s_cmp_eq_u32 s29, 3
    s_cbranch_scc1 L_bf3
    s_branch L_bf4
L_help:
    s_waitcnt vmcnt(0) lgkmcnt(0)
    s_barrier
    s_lshr_b32 s12, s58, 2
    s_and_b32 s24, s58, 3
    s_mov_b32 s15, 1
    v_bfe_u32 v2, v0, 4, 2
    v_min_u32 v2, 2, v2
    v_lshlrev_b32 v2, 7, v2
    v_bfe_u32 v1, v0, 6, 1
    v_lshl_add_u32 v2, v1, 13, v2
    s_lshr_b32 s31, s12, 1
    s_lshl_b32 s31, s31, 9
    s_add_u32 s31, s31, 147456
    v_bfe_u32 v1, v0, 9, 1
    v_and_b32 v3, 0xf0, v0
    v_lshl_add_u32 v3, v1, 8, v3
    v_add_u32 v3, 98304, v3
    v_bfe_u32 v1, v0, 8, 1
    v_mov_b32 v7, 3072
    v_cmp_eq_u32 vcc, 1, v1
    v_add_u32 v9, -1, v1
    v_and_b32 v10, 0x4000, v9
    v_and_b32 v15, 0xb0, v0
    v_min_u32 v15, 16, v15
    v_add_u32 v15, v15, v7
    v_cndmask_b32 v3, v3, v15, vcc
    v_add_u32 v15, 32768, v0
    v_mov_b32 v8, 0xdddd
    v_mov_b32 v11, 0
    v_mov_b32 v52, 0x3f803f80
    v_mov_b32 v56, 0
    v_mov_b32 v53, 0x3f803f80
    v_mov_b32 v57, 0
    v_mov_b32 v54, 0x3f803f80
    v_mov_b32 v58, 0
    v_mov_b32 v55, 0x3f803f80
    v_mov_b32 v59, 0
    ds_write_b128 v7, v[52:55] offset:0
    ds_write_b128 v7, v[56:59] offset:16
    ds_write_b128 v7, v[52:55] offset:512
    ds_write_b128 v7, v[56:59] offset:528
    ds_write_b128 v7, v[52:55] offset:4096
    ds_write_b128 v7, v[56:59] offset:4112
    ds_write_b128 v7, v[52:55] offset:4608
    ds_write_b128 v7, v[56:59] offset:4624
    ds_write_b128 v7, v[52:55] offset:8192
    ds_write_b128 v7, v[56:59] offset:8208
    ds_write_b128 v7, v[52:55] offset:8704
    ds_write_b128 v7, v[56:59] offset:8720
    ds_write_b128 v7, v[52:55] offset:12288
    ds_write_b128 v7, v[56:59] offset:12304
    ds_write_b128 v7, v[52:55] offset:12800
    ds_write_b128 v7, v[56:59] offset:12816
    ds_write_b128 v7, v[52:55] offset:16384
    ds_write_b128 v7, v[56:59] offset:16400
    ds_write_b128 v7, v[52:55] offset:16896
    ds_write_b128 v7, v[56:59] offset:16912
    v_add_u32 v7, 0, v0
    s_lshl_b32 s16, s13, 12
    v_add_u32 v6, s16, v7
    s_mov_b32 s26, 0x5d800000
    s_waitcnt lgkmcnt(0)
    s_add_u32 s16, s13, 64
    v_lshrrev_b32 v13, 2, v0
    s_lshl_b32 s35, s16, 5
    s_add_u32 s35, s35, s12
    s_mul_i32 s35, s35, 3072
    s_add_u32 s35, s35, 150994944
    s_add_u32 s35, s35, 1024
    s_lshl_b32 s36, s13, 10
    s_mov_b32 s19, 60
    s_cmp_eq_u32 s13, 0
    s_cbranch_scc0 L_wfo_188
    s_mov_b64 exec, 0xff
L_wf_187:
    buffer_load_dword v1, v2, s[4:7], s31 offen offset:0 sc1
    s_add_u32 s40, s40, 1
    s_cmp_gt_u32 s40, 262144
    s_cbranch_scc1 L_abort
    s_waitcnt vmcnt(0)
    v_cmp_gt_u32 vcc, s19, v1
    s_cbranch_vccnz L_wf_187
L_wfo_188:
    s_mov_b64 exec, -1
    s_barrier
    s_cmp_eq_u32 s13, 0
    s_cbranch_scc0 L_hq_183
    s_add_u32 s16, s24, 116
    s_mov_b32 m0, 20480
    s_lshl_b32 s16, s16, 5
    s_add_u32 s16, s16, s12
    s_mul_i32 s16, s16, 3072
    s_add_u32 s16, s16, 150994944
    buffer_load_dwordx4 v0, s[4:7], s16 offen sc1 lds
L_hq_183:
    v_add_u32 v4, s36, v15
    v_and_b32 v5, s36, v9
    v_add_u32 v5, v5, v3
L_hk_184:
    s_add_u32 m0, s36, 32768
    s_nop 0
    buffer_load_dwordx4 v0, s[4:7], s35 offen sc1 lds
    s_add_u32 m0, s36, 97280
    s_add_u32 s36, s36, 4096
    buffer_load_dwordx4 v0, s[4:7], s35 offen offset:1024 sc1 lds
    s_add_u32 s35, s35, 393216
    s_cmp_lt_u32 s36, 57344
    s_cbranch_scc1 L_hk_184
L_hy_186:
    s_mov_b32 s23, 55
    s_mov_b32 s33, 0
    s_mov_b32 s32, 1
    s_waitcnt vmcnt(0) lgkmcnt(0)
    s_barrier
    s_branch L_loop2
L_hret:
    s_cmp_eq_u32 s32, 3
    s_cbranch_scc1 L_h2
    s_cmp_eq_u32 s32, 2
    s_cbranch_scc1 L_h1
L_h0:
    s_waitcnt lgkmcnt(0)
    v_mov_b64 v[128:129], v[64:65]
    v_mov_b64 v[130:131], v[66:67]
    v_mov_b64 v[132:133], v[68:69]
    v_mov_b64 v[134:135], v[70:71]
    v_mov_b64 v[136:137], v[72:73]
    v_accvgpr_write_b32 a0, v60
    v_accvgpr_write_b32 a1, v61
    v_accvgpr_write_b32 a2, v62
    v_accvgpr_write_b32 a3, v63
    s_mov_b32 s19, 62
    s_cmp_eq_u32 s13, 0
    s_cbranch_scc0 L_wfo_195
    s_mov_b64 exec, 0xff
L_wf_194:
    buffer_load_dword v1, v2, s[4:7], s31 offen offset:0 sc1
    s_add_u32 s40, s40, 1
    s_cmp_gt_u32 s40, 262144
    s_cbranch_scc1 L_abort
    s_waitcnt vmcnt(0)
    v_cmp_gt_u32 vcc, s19, v1
    s_cbranch_vccnz L_wf_194
L_wfo_195:
    s_mov_b64 exec, -1
    s_barrier
    s_cmp_eq_u32 s13, 0
    s_cbranch_scc0 L_hq_190
    s_add_u32 s16, s24, 120
    s_mov_b32 m0, 21504
    s_lshl_b32 s16, s16, 5
    s_add_u32 s16, s16, s12
    s_mul_i32 s16, s16, 3072
    s_add_u32 s16, s16, 150994944
    buffer_load_dwordx4 v0, s[4:7], s16 offen sc1 lds
L_hq_190:
    v_add_u32 v4, s36, v15
    v_and_b32 v5, s36, v9
    v_add_u32 v5, v5, v3
L_hk_191:
    s_add_u32 m0, s36, 32768
    s_nop 0
    buffer_load_dwordx4 v0, s[4:7], s35 offen sc1 lds
    s_add_u32 m0, s36, 97280
    s_add_u32 s36, s36, 4096
    buffer_load_dwordx4 v0, s[4:7], s35 offen offset:1024 sc1 lds
    s_add_u32 s35, s35, 393216
L_hy_193:
    s_mov_b32 s23, 59
    s_mov_b32 s33, 1024
    s_mov_b32 s32, 2
    s_waitcnt vmcnt(0) lgkmcnt(0)
    s_barrier
    ds_read_b128 v[48:51], v4
    ds_read_b128 v[52:55], v5
    ds_read_b128 v[56:59], v5 offset:512
    s_waitcnt lgkmcnt(0)
    v_mfma_f32_32x32x16_bf16 v[16:31], v[48:51], a[0:3], 0
    s_nop 11
    v_exp_f32 v16, v16
    v_exp_f32 v17, v17
    v_exp_f32 v18, v18
    v_exp_f32 v19, v19
    v_exp_f32 v20, v20
    v_exp_f32 v21, v21
    v_exp_f32 v22, v22
    v_exp_f32 v23, v23
    v_exp_f32 v24, v24
    v_exp_f32 v25, v25
    v_exp_f32 v26, v26
    v_smfmac_f32_32x32x32_bf16 v[128:143], v[52:55], v[16:23], v8
    v_exp_f32 v27, v27
    v_exp_f32 v28, v28
    v_exp_f32 v29, v29
    v_exp_f32 v30, v30
    v_exp_f32 v31, v31
    s_nop 1
    v_smfmac_f32_32x32x32_bf16 v[128:143], v[56:59], v[24:31], v8
    s_branch L_loop2
L_h1:
    s_waitcnt lgkmcnt(0)
    v_mov_b64 v[144:145], v[64:65]
    v_mov_b64 v[146:147], v[66:67]
    v_mov_b64 v[148:149], v[68:69]
    v_mov_b64 v[150:151], v[70:71]
    v_mov_b64 v[152:153], v[72:73]
    v_accvgpr_write_b32 a4, v60
    v_accvgpr_write_b32 a5, v61
    v_accvgpr_write_b32 a6, v62
    v_accvgpr_write_b32 a7, v63
    s_mov_b32 s19, 63
    s_cmp_eq_u32 s13, 0
    s_cbranch_scc0 L_wfo_202
    s_mov_b64 exec, 0xff
L_wf_201:
    buffer_load_dword v1, v2, s[4:7], s31 offen offset:0 sc1
    s_add_u32 s40, s40, 1
    s_cmp_gt_u32 s40, 262144
    s_cbranch_scc1 L_abort
    s_waitcnt vmcnt(0)
    v_cmp_gt_u32 vcc, s19, v1
    s_cbranch_vccnz L_wf_201
L_wfo_202:
    s_mov_b64 exec, -1
    s_barrier
    s_mov_b32 s19, 64
    s_cmp_eq_u32 s13, 3
    s_cbranch_scc0 L_hx_199
    s_sub_u32 s17, s35, 1024
    v_add_u32 v4, s36, v15
    v_and_b32 v5, s36, v9
    v_add_u32 v5, v5, v3
L_p3_205:
    s_mov_b64 exec, 0xff
    buffer_load_dword v11, v2, s[4:7], s31 offen sc1
    s_mov_b64 exec, -1
    buffer_load_dwordx4 v[80:83], v0, s[4:7], s17 offen offset:0 sc1
    buffer_load_dwordx4 v[84:87], v0, s[4:7], s17 offen offset:1024 sc1
    buffer_load_dwordx4 v[88:91], v0, s[4:7], s17 offen offset:2048 sc1
    s_add_u32 s40, s40, 1
    s_cmp_gt_u32 s40, 262144
    s_cbranch_scc1 L_abort
    s_waitcnt vmcnt(0)
    v_max_u32 v1, v80, v81
    v_max3_u32 v1, v1, v82, v83
    v_max3_u32 v1, v1, v84, v85
    v_max3_u32 v1, v1, v86, v87
    v_max3_u32 v1, v1, v88, v89
    v_max3_u32 v1, v1, v90, v91
    v_cmp_eq_u32 vcc, -1, v1
    s_cbranch_vccz L_p3o_206
    v_cmp_gt_u32 vcc, s19, v11
    s_and_b32 s16, 0xf0, vcc_lo
    s_cbranch_scc1 L_p3_205
    s_branch L_hz_204
L_p3o_206:
    s_branch L_hw_207
L_hz_204:
    buffer_load_dwordx4 v[80:83], v0, s[4:7], s17 offen offset:0 sc1
    buffer_load_dwordx4 v[84:87], v0, s[4:7], s17 offen offset:1024 sc1
    buffer_load_dwordx4 v[88:91], v0, s[4:7], s17 offen offset:2048 sc1
    s_waitcnt vmcnt(0)
L_hw_207:
    v_add_u32 v1, 65536, v4
    ds_write_b128 v4, v[84:87]
    ds_write_b128 v1, v[88:91]
    s_cmp_eq_u32 s24, 3
    s_cbranch_scc0 L_hy_200
    ds_write_b128 v0, v[80:83] offset:22528
    s_branch L_hy_200
L_hx_199:
    s_mov_b64 exec, 0xf
L_wf_208:
    buffer_load_dword v1, v2, s[4:7], s31 offen offset:0 sc1
    s_add_u32 s40, s40, 1
    s_cmp_gt_u32 s40, 262144
    s_cbranch_scc1 L_abort
    s_waitcnt vmcnt(0)
    v_cmp_gt_u32 vcc, s19, v1
    s_cbranch_vccnz L_wf_208
L_wfo_209:
    s_mov_b64 exec, -1
    s_cmp_eq_u32 s24, 3
    s_cbranch_scc1 L_hq_197
    s_cmp_eq_u32 s13, 0
    s_cbranch_scc0 L_hq_197
    s_add_u32 s16, s24, 124
    s_mov_b32 m0, 22528
    s_lshl_b32 s16, s16, 5
    s_add_u32 s16, s16, s12
    s_mul_i32 s16, s16, 3072
    s_add_u32 s16, s16, 150994944
    buffer_load_dwordx4 v0, s[4:7], s16 offen sc1 lds
L_hq_197:
    v_add_u32 v4, s36, v15
    v_and_b32 v5, s36, v9
    v_add_u32 v5, v5, v3
L_hk_198:
    s_add_u32 m0, s36, 32768
    s_nop 0
    buffer_load_dwordx4 v0, s[4:7], s35 offen sc1 lds
    s_add_u32 m0, s36, 97280
    s_add_u32 s36, s36, 4096
    buffer_load_dwordx4 v0, s[4:7], s35 offen offset:1024 sc1 lds
    s_add_u32 s35, s35, 393216
L_hy_200:
    s_mov_b32 s23, 63
    s_mov_b32 s33, 2048
    s_mov_b32 s32, 3
    s_waitcnt vmcnt(0) lgkmcnt(0)
    s_barrier
    ds_read_b128 v[48:51], v4
    ds_read_b128 v[52:55], v5
    ds_read_b128 v[56:59], v5 offset:512
    s_waitcnt lgkmcnt(0)
    v_mfma_f32_32x32x16_bf16 v[16:31], v[48:51], a[0:3], 0
    s_nop 11
    v_exp_f32 v16, v16
    v_exp_f32 v17, v17
    v_exp_f32 v18, v18
    v_exp_f32 v19, v19
    v_exp_f32 v20, v20
    v_exp_f32 v21, v21
    v_mfma_f32_32x32x16_bf16 v[32:47], v[48:51], a[4:7], 0
    s_nop 0
    v_exp_f32 v22, v22
    v_exp_f32 v23, v23
    v_exp_f32 v24, v24
    v_exp_f32 v25, v25
    v_exp_f32 v26, v26
    v_smfmac_f32_32x32x32_bf16 v[128:143], v[52:55], v[16:23], v8
    v_exp_f32 v27, v27
    v_exp_f32 v28, v28
    v_exp_f32 v29, v29
    v_exp_f32 v30, v30
    v_exp_f32 v31, v31
    v_exp_f32 v32, v32
    v_exp_f32 v33, v33
    v_smfmac_f32_32x32x32_bf16 v[128:143], v[56:59], v[24:31], v8
    v_exp_f32 v34, v34
    v_exp_f32 v35, v35
    v_exp_f32 v36, v36
    v_exp_f32 v37, v37
    v_exp_f32 v38, v38
    v_exp_f32 v39, v39
    v_exp_f32 v40, v40
    v_exp_f32 v41, v41
    v_exp_f32 v42, v42
    v_smfmac_f32_32x32x32_bf16 v[144:159], v[52:55], v[32:39], v8
    v_exp_f32 v43, v43
    v_exp_f32 v44, v44
    v_exp_f32 v45, v45
    v_exp_f32 v46, v46
    v_exp_f32 v47, v47
    s_nop 1
    v_smfmac_f32_32x32x32_bf16 v[144:159], v[56:59], v[40:47], v8
    s_nop 9
    s_cmp_eq_u32 s13, 0
    s_cbranch_scc1 L_pw_211
    s_mov_b32 s18, 0
    s_sub_u32 s16, s13, 1
    s_and_b32 s16, s16, 3
    s_cselect_b32 s17, 4096, 0
    s_cmp_eq_u32 s16, 2
    s_cselect_b32 s17, 8192, s17
    v_add_u32 v1, s17, v0
    v_add_u32 v12, s17, v13
    ds_write_b128 v1, v[128:131] offset:0
    ds_write_b128 v1, v[132:135] offset:1024
    ds_write_b32 v12, v136 offset:2048
L_pw_211:
    s_cmp_eq_u32 s13, 1
    s_cbranch_scc1 L_pw_212
    s_mov_b32 s18, 12288
    s_sub_u32 s16, s13, 2
    s_and_b32 s16, s16, 3
    s_cselect_b32 s17, 16384, s18
    s_cmp_eq_u32 s16, 2
    s_cselect_b32 s17, 23552, s17
    v_add_u32 v1, s17, v0
    v_add_u32 v12, s17, v13
    ds_write_b128 v1, v[144:147] offset:0
    ds_write_b128 v1, v[148:151] offset:1024
    ds_write_b32 v12, v152 offset:2048
L_pw_212:
    s_branch L_loop2
L_h2:
    s_waitcnt lgkmcnt(0)
    s_cmp_eq_u32 s13, 2
    s_cbranch_scc1 L_pw_213
    s_mov_b32 s18, 25856
    s_sub_u32 s16, s13, 3
    s_and_b32 s16, s16, 3
    s_cselect_b32 s17, 28160, s18
    s_cmp_eq_u32 s16, 2
    s_cselect_b32 s17, 30464, s17
    v_add_u32 v1, s17, v0
    v_add_u32 v12, s17, v13
    ds_write_b128 v1, v[64:67] offset:0
    ds_write_b128 v1, v[68:71] offset:1024
    ds_write_b32 v12, v72 offset:2048
L_pw_213:
    v_mov_b64 v[160:161], v[64:65]
    v_mov_b64 v[162:163], v[66:67]
    v_mov_b64 v[164:165], v[68:69]
    v_mov_b64 v[166:167], v[70:71]
    v_mov_b64 v[168:169], v[72:73]
    v_accvgpr_write_b32 a8, v60
    v_accvgpr_write_b32 a9, v61
    v_accvgpr_write_b32 a10, v62
    v_accvgpr_write_b32 a11, v63
    s_lshl_b32 s17, s13, 2
    s_add_u32 s17, s17, s24
    s_lshl_b32 s17, s17, 5
    s_add_u32 s17, s17, s12
    s_lshl_b32 s27, s17, 10
    s_add_u32 s27, s27, 169738240
    s_lshl_b32 s28, s17, 7
    s_add_u32 s28, s28, 98304
    s_waitcnt lgkmcnt(0)
    s_barrier
    s_cmp_lt_u32 s13, 3
    s_cbranch_scc0 L_fin
    s_cmp_eq_u32 s13, 2
    s_cbranch_scc1 L_own2_216
    s_cmp_eq_u32 s13, 1
    s_cbranch_scc1 L_own1_215
L_own0_214:
    ds_read_b128 v[80:83], v0 offset:0
    ds_read_b128 v[84:87], v0 offset:1024
    ds_read_b32 v88, v13 offset:2048
    ds_read_b128 v[92:95], v0 offset:4096
    ds_read_b128 v[96:99], v0 offset:5120
    ds_read_b32 v100, v13 offset:6144
    ds_read_b128 v[104:107], v0 offset:8192
    ds_read_b128 v[108:111], v0 offset:9216
    ds_read_b32 v112, v13 offset:10240
    v_accvgpr_read_b32 v60, a0
    v_accvgpr_read_b32 v61, a1
    v_accvgpr_read_b32 v62, a2
    v_accvgpr_read_b32 v63, a3
    s_waitcnt lgkmcnt(6)
    v_pk_add_f32 v[64:65], v[128:129], v[80:81]
    v_pk_add_f32 v[66:67], v[130:131], v[82:83]
    v_pk_add_f32 v[68:69], v[132:133], v[84:85]
    v_pk_add_f32 v[70:71], v[134:135], v[86:87]
    v_pk_add_f32 v[72:73], v[136:137], v[88:89]
    s_branch L_owne_217
L_own1_215:
    ds_read_b128 v[80:83], v0 offset:12288
    ds_read_b128 v[84:87], v0 offset:13312
    ds_read_b32 v88, v13 offset:14336
    ds_read_b128 v[92:95], v0 offset:16384
    ds_read_b128 v[96:99], v0 offset:17408
    ds_read_b32 v100, v13 offset:18432
    ds_read_b128 v[104:107], v0 offset:23552
    ds_read_b128 v[108:111], v0 offset:24576
    ds_read_b32 v112, v13 offset:25600
    v_accvgpr_read_b32 v60, a4
    v_accvgpr_read_b32 v61, a5
    v_accvgpr_read_b32 v62, a6
    v_accvgpr_read_b32 v63, a7
    s_waitcnt lgkmcnt(6)
    v_pk_add_f32 v[64:65], v[144:145], v[80:81]
    v_pk_add_f32 v[66:67], v[146:147], v[82:83]
    v_pk_add_f32 v[68:69], v[148:149], v[84:85]
    v_pk_add_f32 v[70:71], v[150:151], v[86:87]
    v_pk_add_f32 v[72:73], v[152:153], v[88:89]
    s_branch L_owne_217
L_own2_216:
    ds_read_b128 v[80:83], v0 offset:25856
    ds_read_b128 v[84:87], v0 offset:26880
    ds_read_b32 v88, v13 offset:27904
    ds_read_b128 v[92:95], v0 offset:28160
    ds_read_b128 v[96:99], v0 offset:29184
    ds_read_b32 v100, v13 offset:30208
    ds_read_b128 v[104:107], v0 offset:30464
    ds_read_b128 v[108:111], v0 offset:31488
    ds_read_b32 v112, v13 offset:32512
    v_accvgpr_read_b32 v60, a8
    v_accvgpr_read_b32 v61, a9
    v_accvgpr_read_b32 v62, a10
    v_accvgpr_read_b32 v63, a11
    s_waitcnt lgkmcnt(6)
    v_pk_add_f32 v[64:65], v[160:161], v[80:81]
    v_pk_add_f32 v[66:67], v[162:163], v[82:83]
    v_pk_add_f32 v[68:69], v[164:165], v[84:85]
    v_pk_add_f32 v[70:71], v[166:167], v[86:87]
    v_pk_add_f32 v[72:73], v[168:169], v[88:89]
L_owne_217:
    s_waitcnt lgkmcnt(0)
    v_pk_add_f32 v[92:93], v[92:93], v[104:105]
    v_pk_add_f32 v[94:95], v[94:95], v[106:107]
    v_pk_add_f32 v[96:97], v[96:97], v[108:109]
    v_pk_add_f32 v[98:99], v[98:99], v[110:111]
    v_pk_add_f32 v[100:101], v[100:101], v[112:113]
    v_pk_add_f32 v[240:241], v[64:65], v[92:93]
    v_pk_add_f32 v[242:243], v[66:67], v[94:95]
    v_pk_add_f32 v[244:245], v[68:69], v[96:97]
    v_pk_add_f32 v[246:247], v[70:71], v[98:99]
    v_pk_add_f32 v[248:249], v[72:73], v[100:101]
    v_accvgpr_write_b32 a28, v60
    v_accvgpr_write_b32 a29, v61
    v_accvgpr_write_b32 a30, v62
    v_accvgpr_write_b32 a31, v63
    s_branch L_bfin7
L_bend_128:
    v_accvgpr_read_b32 v128, a128
    v_accvgpr_read_b32 v129, a129
    v_accvgpr_read_b32 v130, a130
    v_accvgpr_read_b32 v131, a131
    v_accvgpr_read_b32 v132, a132
    v_accvgpr_read_b32 v133, a133
    v_accvgpr_read_b32 v134, a134
    v_accvgpr_read_b32 v135, a135
    v_accvgpr_read_b32 v136, a136
    v_accvgpr_read_b32 v137, a137
    v_accvgpr_read_b32 v138, a138
    v_accvgpr_read_b32 v139, a139
    v_accvgpr_read_b32 v140, a140
    v_accvgpr_read_b32 v141, a141
    v_accvgpr_read_b32 v142, a142
    v_accvgpr_read_b32 v143, a143
    v_accvgpr_read_b32 v144, a144
    v_accvgpr_read_b32 v145, a145
    v_accvgpr_read_b32 v146, a146
    v_accvgpr_read_b32 v147, a147
    v_accvgpr_read_b32 v148, a148
    v_accvgpr_read_b32 v149, a149
    v_accvgpr_read_b32 v150, a150
    v_accvgpr_read_b32 v151, a151
    v_accvgpr_read_b32 v152, a152
    v_accvgpr_read_b32 v153, a153
    v_accvgpr_read_b32 v154, a154
    v_accvgpr_read_b32 v155, a155
    v_accvgpr_read_b32 v156, a156
    v_accvgpr_read_b32 v157, a157
    v_accvgpr_read_b32 v158, a158
    v_accvgpr_read_b32 v159, a159
    v_accvgpr_read_b32 v160, a160
    v_accvgpr_read_b32 v161, a161
    v_accvgpr_read_b32 v162, a162
    v_accvgpr_read_b32 v163, a163
    v_accvgpr_read_b32 v164, a164
    v_accvgpr_read_b32 v165, a165
    v_accvgpr_read_b32 v166, a166
    v_accvgpr_read_b32 v167, a167
    v_accvgpr_read_b32 v168, a168
    v_accvgpr_read_b32 v169, a169
    v_accvgpr_read_b32 v170, a170
    v_accvgpr_read_b32 v171, a171
    v_accvgpr_read_b32 v172, a172
    v_accvgpr_read_b32 v173, a173
    v_accvgpr_read_b32 v174, a174
    v_accvgpr_read_b32 v175, a175
    v_accvgpr_read_b32 v176, a176
    v_accvgpr_read_b32 v177, a177
    v_accvgpr_read_b32 v178, a178
    v_accvgpr_read_b32 v179, a179
    v_accvgpr_read_b32 v180, a180
    v_accvgpr_read_b32 v181, a181
    v_accvgpr_read_b32 v182, a182
    v_accvgpr_read_b32 v183, a183
    v_accvgpr_read_b32 v184, a184
    v_accvgpr_read_b32 v185, a185
    v_accvgpr_read_b32 v186, a186
    v_accvgpr_read_b32 v187, a187
    v_accvgpr_read_b32 v188, a188
    v_accvgpr_read_b32 v189, a189
    v_accvgpr_read_b32 v190, a190
    v_accvgpr_read_b32 v191, a191
    v_accvgpr_read_b32 v192, a192
    v_accvgpr_read_b32 v193, a193
    v_accvgpr_read_b32 v194, a194
    v_accvgpr_read_b32 v195, a195
    v_accvgpr_read_b32 v196, a196
    v_accvgpr_read_b32 v197, a197
    v_accvgpr_read_b32 v198, a198
    v_accvgpr_read_b32 v199, a199
    v_accvgpr_read_b32 v200, a200
    v_accvgpr_read_b32 v201, a201
    v_accvgpr_read_b32 v202, a202
    v_accvgpr_read_b32 v203, a203
    v_accvgpr_read_b32 v204, a204
    v_accvgpr_read_b32 v205, a205
    v_accvgpr_read_b32 v206, a206
    v_accvgpr_read_b32 v207, a207
    v_accvgpr_read_b32 v208, a208
    v_accvgpr_read_b32 v209, a209
    v_accvgpr_read_b32 v210, a210
    v_accvgpr_read_b32 v211, a211
    v_accvgpr_read_b32 v212, a212
    v_accvgpr_read_b32 v213, a213
    v_accvgpr_read_b32 v214, a214
    v_accvgpr_read_b32 v215, a215
    v_accvgpr_read_b32 v216, a216
    v_accvgpr_read_b32 v217, a217
    v_accvgpr_read_b32 v218, a218
    v_accvgpr_read_b32 v219, a219
    v_accvgpr_read_b32 v220, a220
    v_accvgpr_read_b32 v221, a221
    v_accvgpr_read_b32 v222, a222
    v_accvgpr_read_b32 v223, a223
    v_accvgpr_read_b32 v224, a224
    v_accvgpr_read_b32 v225, a225
    v_accvgpr_read_b32 v226, a226
    v_accvgpr_read_b32 v227, a227
    v_accvgpr_read_b32 v228, a228
    v_accvgpr_read_b32 v229, a229
    v_accvgpr_read_b32 v230, a230
    v_accvgpr_read_b32 v231, a231
    v_accvgpr_read_b32 v232, a232
    v_accvgpr_read_b32 v233, a233
    v_accvgpr_read_b32 v234, a234
    v_accvgpr_read_b32 v235, a235
    v_accvgpr_read_b32 v236, a236
    v_accvgpr_read_b32 v237, a237
    v_accvgpr_read_b32 v238, a238
    v_accvgpr_read_b32 v239, a239
    v_accvgpr_read_b32 v240, a240
    v_accvgpr_read_b32 v241, a241
    v_accvgpr_read_b32 v242, a242
    v_accvgpr_read_b32 v243, a243
    v_accvgpr_read_b32 v244, a244
    v_accvgpr_read_b32 v245, a245
    v_accvgpr_read_b32 v246, a246
    v_accvgpr_read_b32 v247, a247
    v_accvgpr_read_b32 v248, a248
    v_accvgpr_read_b32 v249, a249
    v_accvgpr_read_b32 v250, a250
    v_accvgpr_read_b32 v251, a251
    v_accvgpr_read_b32 v252, a252
    v_accvgpr_read_b32 v253, a253
    v_accvgpr_read_b32 v254, a254
    v_accvgpr_read_b32 v255, a255
    s_bfe_u32 s12, s58, 0x10005
    s_and_b32 s14, s58, 15
    s_lshr_b32 s26, s14, 2
    s_and_b32 s27, s14, 3
    s_lshl_b32 s29, s12, 4
    s_add_u32 s29, s29, s14
    s_lshl_b32 s29, s29, 7
    s_lshl_b32 s20, s13, 13
    s_mul_i32 s31, s13, 8320
    s_lshl_b32 s44, s27, 8
    s_lshl_b32 s16, s13, 6
    s_add_u32 s25, s44, s16
    v_bfe_u32 v3, v0, 4, 5
    v_lshlrev_b32 v5, 10, v3
    v_lshlrev_b32 v4, 2, v3
    v_lshlrev_b32 v3, 7, v3
    v_bfe_u32 v1, v0, 9, 1
    v_lshl_add_u32 v4, v1, 15, v4
    v_lshl_add_u32 v5, v1, 5, v5
    v_bfe_u32 v2, v0, 4, 3
    v_mul_u32_u24 v2, 384, v2
    s_mov_b32 s15, 0
    s_load_dwordx2 s[36:37], s[0:1], 80
    s_mov_b32 s38, 2097152
    s_mov_b32 s39, 0x20000
    s_waitcnt lgkmcnt(0)
    s_mov_b32 s15, 1
    s_lshl_b32 s21, s26, 1
    s_add_u32 s21, s21, s12
    s_and_b32 s16, s58, 16
    s_lshr_b32 s16, s16, 1
    s_add_u32 s21, s21, s16
    s_add_u32 s21, s21, 48
    s_mov_b32 s41, 16
    s_mov_b32 s49, 64
    s_branch L_g3
    s_branch L_fin
L_abort:
    s_mov_b64 exec, -1
    s_waitcnt vmcnt(0) lgkmcnt(0)
    v_mov_b32 v1, 0
    s_lshl_b32 s16, s58, 16
    s_or_b32 s16, s16, 0xdead
    v_mov_b32 v2, s16
    global_store_dword v1, v2, s[56:57] offset:24
    s_branch L_end
L_fin:
L_end:
    s_endpgm
L_r1:
L_r1c:
    s_cmp_eq_u32 s13, 3
    s_cbranch_scc0 L_ar_218
    s_cmp_lg_u32 s59, 0
    s_cbranch_scc1 L_ar_218
    s_lshr_b32 s16, s2, 3
    s_lshl_b32 s16, 1, s16
    v_mov_b32 v100, s16
    s_and_b32 s16, s61, 7
    s_lshl_b32 s16, s16, 5
    s_and_b32 s17, s61, 8
    s_lshl_b32 s17, s17, 1
    s_or_b32 s16, s16, s17
    v_mov_b32 v101, 0x100
    v_mov_b32 v102, s16
    s_mov_b64 exec, 1
    s_waitcnt vmcnt(0)
    global_atomic_add_x2 v[126:127], v102, v[100:101], s[56:57] sc0 sc1
    s_mov_b64 exec, -1
L_ar_218:
    s_sub_u32 s16, s58, 32
    s_mul_i32 s12, s16, 21846
    s_lshr_b32 s12, s12, 16
    s_mul_i32 s17, s12, 3
    s_sub_u32 s14, s16, s17
    s_lshl_b32 s28, s12, 8
    s_load_dwordx2 s[8:9], s[0:1], 24
    s_mov_b32 s10, 4194304
    s_mov_b32 s11, 0x20000
    s_waitcnt lgkmcnt(0)
    v_lshrrev_b32 v23, 8, v0
    v_lshl_add_u32 v23, s13, 4, v23
    v_mul_u32_u24 v23, 8192, v23
    v_and_b32 v20, 0xf0, v0
    v_add_u32 v20, v23, v20
    s_mul_i32 s19, s13, 4160
    s_add_u32 m0, s19, 0
    s_add_u32 s16, s28, 0
    buffer_load_dwordx4 v20, s[8:11], s16 offen lds
    s_add_u32 m0, s19, 1040
    s_add_u32 s16, s28, 32768
    buffer_load_dwordx4 v20, s[8:11], s16 offen lds
    s_add_u32 m0, s19, 2080
    s_add_u32 s16, s28, 65536
    buffer_load_dwordx4 v20, s[8:11], s16 offen lds
    s_add_u32 m0, s19, 3120
    s_add_u32 s16, s28, 98304
    buffer_load_dwordx4 v20, s[8:11], s16 offen lds
    s_mul_i32 s19, s13, 4160
    s_add_u32 m0, s19, 16640
    s_add_u32 s16, s28, 524288
    buffer_load_dwordx4 v20, s[8:11], s16 offen lds
    s_add_u32 m0, s19, 17680
    s_add_u32 s16, s28, 557056
    buffer_load_dwordx4 v20, s[8:11], s16 offen lds
    s_add_u32 m0, s19, 18720
    s_add_u32 s16, s28, 589824
    buffer_load_dwordx4 v20, s[8:11], s16 offen lds
    s_add_u32 m0, s19, 19760
    s_add_u32 s16, s28, 622592
    buffer_load_dwordx4 v20, s[8:11], s16 offen lds
    s_mul_i32 s19, s13, 4160
    s_add_u32 m0, s19, 33280
    s_add_u32 s16, s28, 1048576
    buffer_load_dwordx4 v20, s[8:11], s16 offen lds
    s_add_u32 m0, s19, 34320
    s_add_u32 s16, s28, 1081344
    buffer_load_dwordx4 v20, s[8:11], s16 offen lds
    s_add_u32 m0, s19, 35360
    s_add_u32 s16, s28, 1114112
    buffer_load_dwordx4 v20, s[8:11], s16 offen lds
    s_add_u32 m0, s19, 36400
    s_add_u32 s16, s28, 1146880
    buffer_load_dwordx4 v20, s[8:11], s16 offen lds
    s_mul_i32 s19, s13, 4160
    s_add_u32 m0, s19, 49920
    s_add_u32 s16, s28, 1572864
    buffer_load_dwordx4 v20, s[8:11], s16 offen lds
    s_add_u32 m0, s19, 50960
    s_add_u32 s16, s28, 1605632
    buffer_load_dwordx4 v20, s[8:11], s16 offen lds
    s_add_u32 m0, s19, 52000
    s_add_u32 s16, s28, 1638400
    buffer_load_dwordx4 v20, s[8:11], s16 offen lds
    s_add_u32 m0, s19, 53040
    s_add_u32 s16, s28, 1671168
    buffer_load_dwordx4 v20, s[8:11], s16 offen lds
    s_mul_i32 s19, s13, 4160
    s_add_u32 m0, s19, 66560
    s_add_u32 s16, s28, 2097152
    buffer_load_dwordx4 v20, s[8:11], s16 offen lds
    s_add_u32 m0, s19, 67600
    s_add_u32 s16, s28, 2129920
    buffer_load_dwordx4 v20, s[8:11], s16 offen lds
    s_add_u32 m0, s19, 68640
    s_add_u32 s16, s28, 2162688
    buffer_load_dwordx4 v20, s[8:11], s16 offen lds
    s_add_u32 m0, s19, 69680
    s_add_u32 s16, s28, 2195456
    buffer_load_dwordx4 v20, s[8:11], s16 offen lds
    s_mul_i32 s19, s13, 4160
    s_add_u32 m0, s19, 83200
    s_add_u32 s16, s28, 2621440
    buffer_load_dwordx4 v20, s[8:11], s16 offen lds
    s_add_u32 m0, s19, 84240
    s_add_u32 s16, s28, 2654208
    buffer_load_dwordx4 v20, s[8:11], s16 offen lds
    s_add_u32 m0, s19, 85280
    s_add_u32 s16, s28, 2686976
    buffer_load_dwordx4 v20, s[8:11], s16 offen lds
    s_add_u32 m0, s19, 86320
    s_add_u32 s16, s28, 2719744
    buffer_load_dwordx4 v20, s[8:11], s16 offen lds
    s_waitcnt vmcnt(20)
    s_waitcnt lgkmcnt(0)
    s_barrier
    s_mul_i32 s19, s13, 4160
    s_add_u32 m0, s19, 99840
    s_add_u32 s16, s28, 3145728
    buffer_load_dwordx4 v20, s[8:11], s16 offen lds
    s_add_u32 m0, s19, 100880
    s_add_u32 s16, s28, 3178496
    buffer_load_dwordx4 v20, s[8:11], s16 offen lds
    s_add_u32 m0, s19, 101920
    s_add_u32 s16, s28, 3211264
    buffer_load_dwordx4 v20, s[8:11], s16 offen lds
    s_add_u32 m0, s19, 102960
    s_add_u32 s16, s28, 3244032
    buffer_load_dwordx4 v20, s[8:11], s16 offen lds
    v_bfe_u32 v23, v0, 9, 1
    v_mul_u32_u24 v23, 2080, v23
    v_bfe_u32 v24, v0, 6, 2
    v_lshl_add_u32 v23, v24, 8, v23
    v_lshl_add_u32 v23, s13, 6, v23
    v_bfe_u32 v24, v0, 8, 1
    v_lshl_add_u32 v23, v24, 5, v23
    v_bfe_u32 v24, v0, 4, 2
    v_lshl_add_u32 v21, v24, 3, v23
    v_add_u32 v22, 0x10000, v21
    ds_read_b64_tr_b16 a[0:1], v21 offset:0
    ds_read_b64_tr_b16 a[2:3], v21 offset:1040
    ds_read_b64_tr_b16 a[4:5], v21 offset:4160
    ds_read_b64_tr_b16 a[6:7], v21 offset:5200
    ds_read_b64_tr_b16 a[8:9], v21 offset:8320
    ds_read_b64_tr_b16 a[10:11], v21 offset:9360
    ds_read_b64_tr_b16 a[12:13], v21 offset:12480
    ds_read_b64_tr_b16 a[14:15], v21 offset:13520
    s_waitcnt vmcnt(20)
    s_waitcnt lgkmcnt(0)
    s_barrier
    s_mul_i32 s19, s13, 4160
    s_add_u32 m0, s19, 0
    s_add_u32 s16, s28, 3670016
    buffer_load_dwordx4 v20, s[8:11], s16 offen lds
    s_add_u32 m0, s19, 1040
    s_add_u32 s16, s28, 3702784
    buffer_load_dwordx4 v20, s[8:11], s16 offen lds
    s_add_u32 m0, s19, 2080
    s_add_u32 s16, s28, 3735552
    buffer_load_dwordx4 v20, s[8:11], s16 offen lds
    s_add_u32 m0, s19, 3120
    s_add_u32 s16, s28, 3768320
    buffer_load_dwordx4 v20, s[8:11], s16 offen lds
    ds_read_b64_tr_b16 a[16:17], v21 offset:16640
    ds_read_b64_tr_b16 a[18:19], v21 offset:17680
    ds_read_b64_tr_b16 a[20:21], v21 offset:20800
    ds_read_b64_tr_b16 a[22:23], v21 offset:21840
    ds_read_b64_tr_b16 a[24:25], v21 offset:24960
    ds_read_b64_tr_b16 a[26:27], v21 offset:26000
    ds_read_b64_tr_b16 a[28:29], v21 offset:29120
    ds_read_b64_tr_b16 a[30:31], v21 offset:30160
    s_waitcnt vmcnt(20)
    s_waitcnt lgkmcnt(0)
    s_barrier
    s_load_dwordx2 s[8:9], s[0:1], 32
    s_mov_b32 s10, 4194304
    s_mov_b32 s11, 0x20000
    s_waitcnt lgkmcnt(0)
    v_lshrrev_b32 v23, 8, v0
    v_lshl_add_u32 v23, s13, 4, v23
    v_mul_u32_u24 v23, 8192, v23
    v_and_b32 v20, 0xf0, v0
    v_add_u32 v20, v23, v20
    s_mul_i32 s19, s13, 4160
    s_add_u32 m0, s19, 16640
    s_add_u32 s16, s28, 0
    buffer_load_dwordx4 v20, s[8:11], s16 offen lds
    s_add_u32 m0, s19, 17680
    s_add_u32 s16, s28, 32768
    buffer_load_dwordx4 v20, s[8:11], s16 offen lds
    s_add_u32 m0, s19, 18720
    s_add_u32 s16, s28, 65536
    buffer_load_dwordx4 v20, s[8:11], s16 offen lds
    s_add_u32 m0, s19, 19760
    s_add_u32 s16, s28, 98304
    buffer_load_dwordx4 v20, s[8:11], s16 offen lds
    ds_read_b64_tr_b16 a[32:33], v21 offset:33280
    ds_read_b64_tr_b16 a[34:35], v21 offset:34320
    ds_read_b64_tr_b16 a[36:37], v21 offset:37440
    ds_read_b64_tr_b16 a[38:39], v21 offset:38480
    ds_read_b64_tr_b16 a[40:41], v21 offset:41600
    ds_read_b64_tr_b16 a[42:43], v21 offset:42640
    ds_read_b64_tr_b16 a[44:45], v21 offset:45760
    ds_read_b64_tr_b16 a[46:47], v21 offset:46800
    s_waitcnt vmcnt(20)
    s_waitcnt lgkmcnt(0)
    s_barrier
    s_mul_i32 s19, s13, 4160
    s_add_u32 m0, s19, 33280
    s_add_u32 s16, s28, 524288
    buffer_load_dwordx4 v20, s[8:11], s16 offen lds
    s_add_u32 m0, s19, 34320
    s_add_u32 s16, s28, 557056
    buffer_load_dwordx4 v20, s[8:11], s16 offen lds
    s_add_u32 m0, s19, 35360
    s_add_u32 s16, s28, 589824
    buffer_load_dwordx4 v20, s[8:11], s16 offen lds
    s_add_u32 m0, s19, 36400
    s_add_u32 s16, s28, 622592
    buffer_load_dwordx4 v20, s[8:11], s16 offen lds
    ds_read_b64_tr_b16 a[48:49], v21 offset:49920
    ds_read_b64_tr_b16 a[50:51], v21 offset:50960
    ds_read_b64_tr_b16 a[52:53], v21 offset:54080
    ds_read_b64_tr_b16 a[54:55], v21 offset:55120
    ds_read_b64_tr_b16 a[56:57], v21 offset:58240
    ds_read_b64_tr_b16 a[58:59], v21 offset:59280
    ds_read_b64_tr_b16 a[60:61], v21 offset:62400
    ds_read_b64_tr_b16 a[62:63], v21 offset:63440
    s_waitcnt vmcnt(20)
    s_waitcnt lgkmcnt(0)
    s_barrier
    s_mul_i32 s19, s13, 4160
    s_add_u32 m0, s19, 49920
    s_add_u32 s16, s28, 1048576
    buffer_load_dwordx4 v20, s[8:11], s16 offen lds
    s_add_u32 m0, s19, 50960
    s_add_u32 s16, s28, 1081344
    buffer_load_dwordx4 v20, s[8:11], s16 offen lds
    s_add_u32 m0, s19, 52000
    s_add_u32 s16, s28, 1114112
    buffer_load_dwordx4 v20, s[8:11], s16 offen lds
    s_add_u32 m0, s19, 53040
    s_add_u32 s16, s28, 1146880
    buffer_load_dwordx4 v20, s[8:11], s16 offen lds
    ds_read_b64_tr_b16 a[64:65], v22 offset:1024
    ds_read_b64_tr_b16 a[66:67], v22 offset:2064
    ds_read_b64_tr_b16 a[68:69], v22 offset:5184
    ds_read_b64_tr_b16 a[70:71], v22 offset:6224
    ds_read_b64_tr_b16 a[72:73], v22 offset:9344
    ds_read_b64_tr_b16 a[74:75], v22 offset:10384
    ds_read_b64_tr_b16 a[76:77], v22 offset:13504
    ds_read_b64_tr_b16 a[78:79], v22 offset:14544
    s_waitcnt vmcnt(20)
    s_waitcnt lgkmcnt(0)
    s_barrier
    s_mul_i32 s19, s13, 4160
    s_add_u32 m0, s19, 66560
    s_add_u32 s16, s28, 1572864
    buffer_load_dwordx4 v20, s[8:11], s16 offen lds
    s_add_u32 m0, s19, 67600
    s_add_u32 s16, s28, 1605632
    buffer_load_dwordx4 v20, s[8:11], s16 offen lds
    s_add_u32 m0, s19, 68640
    s_add_u32 s16, s28, 1638400
    buffer_load_dwordx4 v20, s[8:11], s16 offen lds
    s_add_u32 m0, s19, 69680
    s_add_u32 s16, s28, 1671168
    buffer_load_dwordx4 v20, s[8:11], s16 offen lds
    ds_read_b64_tr_b16 a[80:81], v22 offset:17664
    ds_read_b64_tr_b16 a[82:83], v22 offset:18704
    ds_read_b64_tr_b16 a[84:85], v22 offset:21824
    ds_read_b64_tr_b16 a[86:87], v22 offset:22864
    ds_read_b64_tr_b16 a[88:89], v22 offset:25984
    ds_read_b64_tr_b16 a[90:91], v22 offset:27024
    ds_read_b64_tr_b16 a[92:93], v22 offset:30144
    ds_read_b64_tr_b16 a[94:95], v22 offset:31184
    s_waitcnt vmcnt(20)
    s_waitcnt lgkmcnt(0)
    s_barrier
    s_mul_i32 s19, s13, 4160
    s_add_u32 m0, s19, 83200
    s_add_u32 s16, s28, 2097152
    buffer_load_dwordx4 v20, s[8:11], s16 offen lds
    s_add_u32 m0, s19, 84240
    s_add_u32 s16, s28, 2129920
    buffer_load_dwordx4 v20, s[8:11], s16 offen lds
    s_add_u32 m0, s19, 85280
    s_add_u32 s16, s28, 2162688
    buffer_load_dwordx4 v20, s[8:11], s16 offen lds
    s_add_u32 m0, s19, 86320
    s_add_u32 s16, s28, 2195456
    buffer_load_dwordx4 v20, s[8:11], s16 offen lds
    ds_read_b64_tr_b16 a[96:97], v22 offset:34304
    ds_read_b64_tr_b16 a[98:99], v22 offset:35344
    ds_read_b64_tr_b16 a[100:101], v22 offset:38464
    ds_read_b64_tr_b16 a[102:103], v22 offset:39504
    ds_read_b64_tr_b16 a[104:105], v22 offset:42624
    ds_read_b64_tr_b16 a[106:107], v22 offset:43664
    ds_read_b64_tr_b16 a[108:109], v22 offset:46784
    ds_read_b64_tr_b16 a[110:111], v22 offset:47824
    v_lshlrev_b32 v124, 16, v0
    s_lshl_b32 s16, s13, 26
    s_add_u32 s16, s16, 1048448
    buffer_load_dword v124, v124, s[4:7], s16 offen sc1
    s_waitcnt vmcnt(21)
    s_waitcnt lgkmcnt(0)
    s_barrier
    s_mul_i32 s19, s13, 4160
    s_add_u32 m0, s19, 99840
    s_add_u32 s16, s28, 2621440
    buffer_load_dwordx4 v20, s[8:11], s16 offen lds
    s_add_u32 m0, s19, 100880
    s_add_u32 s16, s28, 2654208
    buffer_load_dwordx4 v20, s[8:11], s16 offen lds
    s_add_u32 m0, s19, 101920
    s_add_u32 s16, s28, 2686976
    buffer_load_dwordx4 v20, s[8:11], s16 offen lds
    s_add_u32 m0, s19, 102960
    s_add_u32 s16, s28, 2719744
    buffer_load_dwordx4 v20, s[8:11], s16 offen lds
    ds_read_b64_tr_b16 a[112:113], v21 offset:0
    ds_read_b64_tr_b16 a[114:115], v21 offset:1040
    ds_read_b64_tr_b16 a[116:117], v21 offset:4160
    ds_read_b64_tr_b16 a[118:119], v21 offset:5200
    ds_read_b64_tr_b16 a[120:121], v21 offset:8320
    ds_read_b64_tr_b16 a[122:123], v21 offset:9360
    ds_read_b64_tr_b16 a[124:125], v21 offset:12480
    ds_read_b64_tr_b16 a[126:127], v21 offset:13520
    s_waitcnt vmcnt(21)
    s_waitcnt lgkmcnt(0)
    s_barrier
    s_mul_i32 s19, s13, 4160
    s_add_u32 m0, s19, 0
    s_add_u32 s16, s28, 3145728
    buffer_load_dwordx4 v20, s[8:11], s16 offen lds
    s_add_u32 m0, s19, 1040
    s_add_u32 s16, s28, 3178496
    buffer_load_dwordx4 v20, s[8:11], s16 offen lds
    s_add_u32 m0, s19, 2080
    s_add_u32 s16, s28, 3211264
    buffer_load_dwordx4 v20, s[8:11], s16 offen lds
    s_add_u32 m0, s19, 3120
    s_add_u32 s16, s28, 3244032
    buffer_load_dwordx4 v20, s[8:11], s16 offen lds
    ds_read_b64_tr_b16 a[128:129], v21 offset:16640
    ds_read_b64_tr_b16 a[130:131], v21 offset:17680
    ds_read_b64_tr_b16 a[132:133], v21 offset:20800
    ds_read_b64_tr_b16 a[134:135], v21 offset:21840
    ds_read_b64_tr_b16 a[136:137], v21 offset:24960
    ds_read_b64_tr_b16 a[138:139], v21 offset:26000
    ds_read_b64_tr_b16 a[140:141], v21 offset:29120
    ds_read_b64_tr_b16 a[142:143], v21 offset:30160
    s_waitcnt vmcnt(21)
    s_waitcnt lgkmcnt(0)
    s_barrier
    s_mul_i32 s19, s13, 4160
    s_add_u32 m0, s19, 16640
    s_add_u32 s16, s28, 3670016
    buffer_load_dwordx4 v20, s[8:11], s16 offen lds
    s_add_u32 m0, s19, 17680
    s_add_u32 s16, s28, 3702784
    buffer_load_dwordx4 v20, s[8:11], s16 offen lds
    s_add_u32 m0, s19, 18720
    s_add_u32 s16, s28, 3735552
    buffer_load_dwordx4 v20, s[8:11], s16 offen lds
    s_add_u32 m0, s19, 19760
    s_add_u32 s16, s28, 3768320
    buffer_load_dwordx4 v20, s[8:11], s16 offen lds
    ds_read_b64_tr_b16 a[144:145], v21 offset:33280
    ds_read_b64_tr_b16 a[146:147], v21 offset:34320
    ds_read_b64_tr_b16 a[148:149], v21 offset:37440
    ds_read_b64_tr_b16 a[150:151], v21 offset:38480
    ds_read_b64_tr_b16 a[152:153], v21 offset:41600
    ds_read_b64_tr_b16 a[154:155], v21 offset:42640
    ds_read_b64_tr_b16 a[156:157], v21 offset:45760
    ds_read_b64_tr_b16 a[158:159], v21 offset:46800
    s_waitcnt vmcnt(21)
    s_waitcnt lgkmcnt(0)
    s_barrier
    s_load_dwordx2 s[8:9], s[0:1], 16
    s_mov_b32 s10, 4194304
    s_mov_b32 s11, 0x20000
    s_waitcnt lgkmcnt(0)
    v_lshrrev_b32 v23, 8, v0
    v_lshl_add_u32 v23, s13, 4, v23
    v_mul_u32_u24 v23, 8192, v23
    v_and_b32 v20, 0xf0, v0
    v_add_u32 v20, v23, v20
    s_mul_i32 s19, s13, 4160
    s_add_u32 m0, s19, 33280
    s_add_u32 s16, s28, 0
    buffer_load_dwordx4 v20, s[8:11], s16 offen lds
    s_add_u32 m0, s19, 34320
    s_add_u32 s16, s28, 32768
    buffer_load_dwordx4 v20, s[8:11], s16 offen lds
    s_add_u32 m0, s19, 35360
    s_add_u32 s16, s28, 65536
    buffer_load_dwordx4 v20, s[8:11], s16 offen lds
    s_add_u32 m0, s19, 36400
    s_add_u32 s16, s28, 98304
    buffer_load_dwordx4 v20, s[8:11], s16 offen lds
    ds_read_b64_tr_b16 a[160:161], v21 offset:49920
    ds_read_b64_tr_b16 a[162:163], v21 offset:50960
    ds_read_b64_tr_b16 a[164:165], v21 offset:54080
    ds_read_b64_tr_b16 a[166:167], v21 offset:55120
    ds_read_b64_tr_b16 a[168:169], v21 offset:58240
    ds_read_b64_tr_b16 a[170:171], v21 offset:59280
    ds_read_b64_tr_b16 a[172:173], v21 offset:62400
    ds_read_b64_tr_b16 a[174:175], v21 offset:63440
    s_waitcnt vmcnt(21)
    s_waitcnt lgkmcnt(0)
    s_barrier
    s_mul_i32 s19, s13, 4160
    s_add_u32 m0, s19, 49920
    s_add_u32 s16, s28, 524288
    buffer_load_dwordx4 v20, s[8:11], s16 offen lds
    s_add_u32 m0, s19, 50960
    s_add_u32 s16, s28, 557056
    buffer_load_dwordx4 v20, s[8:11], s16 offen lds
    s_add_u32 m0, s19, 52000
    s_add_u32 s16, s28, 589824
    buffer_load_dwordx4 v20, s[8:11], s16 offen lds
    s_add_u32 m0, s19, 53040
    s_add_u32 s16, s28, 622592
    buffer_load_dwordx4 v20, s[8:11], s16 offen lds
    ds_read_b64_tr_b16 a[176:177], v22 offset:1024
    ds_read_b64_tr_b16 a[178:179], v22 offset:2064
    ds_read_b64_tr_b16 a[180:181], v22 offset:5184
    ds_read_b64_tr_b16 a[182:183], v22 offset:6224
    ds_read_b64_tr_b16 a[184:185], v22 offset:9344
    ds_read_b64_tr_b16 a[186:187], v22 offset:10384
    ds_read_b64_tr_b16 a[188:189], v22 offset:13504
    ds_read_b64_tr_b16 a[190:191], v22 offset:14544
    s_waitcnt vmcnt(21)
    s_waitcnt lgkmcnt(0)
    s_barrier
    s_mul_i32 s19, s13, 4160
    s_add_u32 m0, s19, 66560
    s_add_u32 s16, s28, 1048576
    buffer_load_dwordx4 v20, s[8:11], s16 offen lds
    s_add_u32 m0, s19, 67600
    s_add_u32 s16, s28, 1081344
    buffer_load_dwordx4 v20, s[8:11], s16 offen lds
    s_add_u32 m0, s19, 68640
    s_add_u32 s16, s28, 1114112
    buffer_load_dwordx4 v20, s[8:11], s16 offen lds
    s_add_u32 m0, s19, 69680
    s_add_u32 s16, s28, 1146880
    buffer_load_dwordx4 v20, s[8:11], s16 offen lds
    ds_read_b64_tr_b16 a[192:193], v22 offset:17664
    ds_read_b64_tr_b16 a[194:195], v22 offset:18704
    ds_read_b64_tr_b16 a[196:197], v22 offset:21824
    ds_read_b64_tr_b16 a[198:199], v22 offset:22864
    ds_read_b64_tr_b16 a[200:201], v22 offset:25984
    ds_read_b64_tr_b16 a[202:203], v22 offset:27024
    ds_read_b64_tr_b16 a[204:205], v22 offset:30144
    ds_read_b64_tr_b16 a[206:207], v22 offset:31184
    v_and_b32 v102, 0xf0, v0
    global_load_dwordx2 v[100:101], v102, s[56:57] sc1
    s_waitcnt vmcnt(21)
    s_waitcnt lgkmcnt(0)
    s_barrier
    s_mul_i32 s19, s13, 4160
    s_add_u32 m0, s19, 83200
    s_add_u32 s16, s28, 1572864
    buffer_load_dwordx4 v20, s[8:11], s16 offen lds
    s_add_u32 m0, s19, 84240
    s_add_u32 s16, s28, 1605632
    buffer_load_dwordx4 v20, s[8:11], s16 offen lds
    s_add_u32 m0, s19, 85280
    s_add_u32 s16, s28, 1638400
    buffer_load_dwordx4 v20, s[8:11], s16 offen lds
    s_add_u32 m0, s19, 86320
    s_add_u32 s16, s28, 1671168
    buffer_load_dwordx4 v20, s[8:11], s16 offen lds
    ds_read_b64_tr_b16 a[208:209], v22 offset:34304
    ds_read_b64_tr_b16 a[210:211], v22 offset:35344
    ds_read_b64_tr_b16 a[212:213], v22 offset:38464
    ds_read_b64_tr_b16 a[214:215], v22 offset:39504
    ds_read_b64_tr_b16 a[216:217], v22 offset:42624
    ds_read_b64_tr_b16 a[218:219], v22 offset:43664
    ds_read_b64_tr_b16 a[220:221], v22 offset:46784
    ds_read_b64_tr_b16 a[222:223], v22 offset:47824
    s_waitcnt vmcnt(21)
    s_waitcnt lgkmcnt(0)
    s_barrier
    s_mul_i32 s19, s13, 4160
    s_add_u32 m0, s19, 99840
    s_add_u32 s16, s28, 2097152
    buffer_load_dwordx4 v20, s[8:11], s16 offen lds
    s_add_u32 m0, s19, 100880
    s_add_u32 s16, s28, 2129920
    buffer_load_dwordx4 v20, s[8:11], s16 offen lds
    s_add_u32 m0, s19, 101920
    s_add_u32 s16, s28, 2162688
    buffer_load_dwordx4 v20, s[8:11], s16 offen lds
    s_add_u32 m0, s19, 102960
    s_add_u32 s16, s28, 2195456
    buffer_load_dwordx4 v20, s[8:11], s16 offen lds
    ds_read_b64_tr_b16 a[224:225], v21 offset:0
    ds_read_b64_tr_b16 a[226:227], v21 offset:1040
    ds_read_b64_tr_b16 a[228:229], v21 offset:4160
    ds_read_b64_tr_b16 a[230:231], v21 offset:5200
    ds_read_b64_tr_b16 a[232:233], v21 offset:8320
    ds_read_b64_tr_b16 a[234:235], v21 offset:9360
    ds_read_b64_tr_b16 a[236:237], v21 offset:12480
    ds_read_b64_tr_b16 a[238:239], v21 offset:13520
    s_waitcnt vmcnt(21)
    s_waitcnt lgkmcnt(0)
    s_barrier
    s_mul_i32 s19, s13, 4160
    s_add_u32 m0, s19, 0
    s_add_u32 s16, s28, 2621440
    buffer_load_dwordx4 v20, s[8:11], s16 offen lds
    s_add_u32 m0, s19, 1040
    s_add_u32 s16, s28, 2654208
    buffer_load_dwordx4 v20, s[8:11], s16 offen lds
    s_add_u32 m0, s19, 2080
    s_add_u32 s16, s28, 2686976
    buffer_load_dwordx4 v20, s[8:11], s16 offen lds
    s_add_u32 m0, s19, 3120
    s_add_u32 s16, s28, 2719744
    buffer_load_dwordx4 v20, s[8:11], s16 offen lds
    ds_read_b64_tr_b16 a[240:241], v21 offset:16640
    ds_read_b64_tr_b16 a[242:243], v21 offset:17680
    ds_read_b64_tr_b16 a[244:245], v21 offset:20800
    ds_read_b64_tr_b16 a[246:247], v21 offset:21840
    ds_read_b64_tr_b16 a[248:249], v21 offset:24960
    ds_read_b64_tr_b16 a[250:251], v21 offset:26000
    ds_read_b64_tr_b16 a[252:253], v21 offset:29120
    ds_read_b64_tr_b16 a[254:255], v21 offset:30160
    s_waitcnt vmcnt(21)
    s_waitcnt lgkmcnt(0)
    s_barrier
    s_mul_i32 s19, s13, 4160
    s_add_u32 m0, s19, 16640
    s_add_u32 s16, s28, 3145728
    buffer_load_dwordx4 v20, s[8:11], s16 offen lds
    s_add_u32 m0, s19, 17680
    s_add_u32 s16, s28, 3178496
    buffer_load_dwordx4 v20, s[8:11], s16 offen lds
    s_add_u32 m0, s19, 18720
    s_add_u32 s16, s28, 3211264
    buffer_load_dwordx4 v20, s[8:11], s16 offen lds
    s_add_u32 m0, s19, 19760
    s_add_u32 s16, s28, 3244032
    buffer_load_dwordx4 v20, s[8:11], s16 offen lds
    ds_read_b64_tr_b16 v[128:129], v21 offset:33280
    ds_read_b64_tr_b16 v[130:131], v21 offset:34320
    ds_read_b64_tr_b16 v[132:133], v21 offset:37440
    ds_read_b64_tr_b16 v[134:135], v21 offset:38480
    ds_read_b64_tr_b16 v[136:137], v21 offset:41600
    ds_read_b64_tr_b16 v[138:139], v21 offset:42640
    ds_read_b64_tr_b16 v[140:141], v21 offset:45760
    ds_read_b64_tr_b16 v[142:143], v21 offset:46800
    s_waitcnt vmcnt(21)
    s_waitcnt lgkmcnt(0)
    s_barrier
    s_mul_i32 s19, s13, 4160
    s_add_u32 m0, s19, 33280
    s_add_u32 s16, s28, 3670016
    buffer_load_dwordx4 v20, s[8:11], s16 offen lds
    s_add_u32 m0, s19, 34320
    s_add_u32 s16, s28, 3702784
    buffer_load_dwordx4 v20, s[8:11], s16 offen lds
    s_add_u32 m0, s19, 35360
    s_add_u32 s16, s28, 3735552
    buffer_load_dwordx4 v20, s[8:11], s16 offen lds
    s_add_u32 m0, s19, 36400
    s_add_u32 s16, s28, 3768320
    buffer_load_dwordx4 v20, s[8:11], s16 offen lds
    ds_read_b64_tr_b16 v[144:145], v21 offset:49920
    ds_read_b64_tr_b16 v[146:147], v21 offset:50960
    ds_read_b64_tr_b16 v[148:149], v21 offset:54080
    ds_read_b64_tr_b16 v[150:151], v21 offset:55120
    ds_read_b64_tr_b16 v[152:153], v21 offset:58240
    ds_read_b64_tr_b16 v[154:155], v21 offset:59280
    ds_read_b64_tr_b16 v[156:157], v21 offset:62400
    ds_read_b64_tr_b16 v[158:159], v21 offset:63440
    s_waitcnt vmcnt(21)
    s_waitcnt lgkmcnt(0)
    s_barrier
    ds_read_b64_tr_b16 v[160:161], v22 offset:1024
    ds_read_b64_tr_b16 v[162:163], v22 offset:2064
    ds_read_b64_tr_b16 v[164:165], v22 offset:5184
    ds_read_b64_tr_b16 v[166:167], v22 offset:6224
    ds_read_b64_tr_b16 v[168:169], v22 offset:9344
    ds_read_b64_tr_b16 v[170:171], v22 offset:10384
    ds_read_b64_tr_b16 v[172:173], v22 offset:13504
    ds_read_b64_tr_b16 v[174:175], v22 offset:14544
    s_waitcnt vmcnt(16)
    s_waitcnt lgkmcnt(0)
    s_barrier
    ds_read_b64_tr_b16 v[176:177], v22 offset:17664
    ds_read_b64_tr_b16 v[178:179], v22 offset:18704
    ds_read_b64_tr_b16 v[180:181], v22 offset:21824
    ds_read_b64_tr_b16 v[182:183], v22 offset:22864
    ds_read_b64_tr_b16 v[184:185], v22 offset:25984
    ds_read_b64_tr_b16 v[186:187], v22 offset:27024
    ds_read_b64_tr_b16 v[188:189], v22 offset:30144
    ds_read_b64_tr_b16 v[190:191], v22 offset:31184
    s_waitcnt vmcnt(12)
    s_waitcnt lgkmcnt(0)
    s_barrier
    ds_read_b64_tr_b16 v[192:193], v22 offset:34304
    ds_read_b64_tr_b16 v[194:195], v22 offset:35344
    ds_read_b64_tr_b16 v[196:197], v22 offset:38464
    ds_read_b64_tr_b16 v[198:199], v22 offset:39504
    ds_read_b64_tr_b16 v[200:201], v22 offset:42624
    ds_read_b64_tr_b16 v[202:203], v22 offset:43664
    ds_read_b64_tr_b16 v[204:205], v22 offset:46784
    ds_read_b64_tr_b16 v[206:207], v22 offset:47824
    s_waitcnt vmcnt(8)
    s_waitcnt lgkmcnt(0)
    s_barrier
    ds_read_b64_tr_b16 v[208:209], v21 offset:0
    ds_read_b64_tr_b16 v[210:211], v21 offset:1040
    ds_read_b64_tr_b16 v[212:213], v21 offset:4160
    ds_read_b64_tr_b16 v[214:215], v21 offset:5200
    ds_read_b64_tr_b16 v[216:217], v21 offset:8320
    ds_read_b64_tr_b16 v[218:219], v21 offset:9360
    ds_read_b64_tr_b16 v[220:221], v21 offset:12480
    ds_read_b64_tr_b16 v[222:223], v21 offset:13520
    s_waitcnt vmcnt(4)
    s_waitcnt lgkmcnt(0)
    s_barrier
    ds_read_b64_tr_b16 v[224:225], v21 offset:16640
    ds_read_b64_tr_b16 v[226:227], v21 offset:17680
    ds_read_b64_tr_b16 v[228:229], v21 offset:20800
    ds_read_b64_tr_b16 v[230:231], v21 offset:21840
    ds_read_b64_tr_b16 v[232:233], v21 offset:24960
    ds_read_b64_tr_b16 v[234:235], v21 offset:26000
    ds_read_b64_tr_b16 v[236:237], v21 offset:29120
    ds_read_b64_tr_b16 v[238:239], v21 offset:30160
    s_waitcnt vmcnt(0)
    s_waitcnt lgkmcnt(0)
    s_barrier
    ds_read_b64_tr_b16 v[240:241], v21 offset:33280
    ds_read_b64_tr_b16 v[242:243], v21 offset:34320
    ds_read_b64_tr_b16 v[244:245], v21 offset:37440
    ds_read_b64_tr_b16 v[246:247], v21 offset:38480
    ds_read_b64_tr_b16 v[248:249], v21 offset:41600
    ds_read_b64_tr_b16 v[250:251], v21 offset:42640
    ds_read_b64_tr_b16 v[252:253], v21 offset:45760
    ds_read_b64_tr_b16 v[254:255], v21 offset:46800
    s_waitcnt lgkmcnt(0)
    s_barrier
    s_cmp_lg_u32 s59, 0
    s_cbranch_scc1 L_vok_220
    s_branch L_vc_222
L_vp_219:
    v_and_b32 v102, 0xf0, v0
    global_load_dwordx2 v[100:101], v102, s[56:57] sc1
    s_waitcnt vmcnt(0)
L_vc_222:
    v_lshrrev_b32 v103, 8, v101
    s_nop 1
    v_add_u32_dpp v103, v103, v103 quad_perm:[1,0,3,2] row_mask:0xf bank_mask:0xf
    s_nop 1
    v_add_u32_dpp v103, v103, v103 quad_perm:[2,3,0,1] row_mask:0xf bank_mask:0xf
    s_nop 1
    v_add_u32_dpp v103, v103, v103 row_half_mirror row_mask:0xf bank_mask:0xf
    s_nop 1
    v_add_u32_dpp v103, v103, v103 row_mirror row_mask:0xf bank_mask:0xf
    v_cmp_ne_u32 vcc, 0x100, v103
    s_cbranch_vccz L_vgo_221
    s_add_u32 s40, s40, 1
    s_cmp_gt_u32 s40, 262144
    s_cbranch_scc1 L_abort
    s_sleep 2
    s_branch L_vp_219
L_vgo_221:
    s_mov_b32 s59, 1
    v_cmp_ne_u32 vcc, -1, v100
    s_and_b32 s16, vcc_lo, 0x5555
    v_cmp_ne_u32 vcc, 0x2000, v101
    s_and_b32 s17, vcc_lo, 0x5555
    s_or_b32 s16, s16, s17
    s_cbranch_scc0 L_vok_220
    v_lshrrev_b32 v103, 8, v101
    v_cmp_ne_u32 vcc, 32, v103
    s_and_b32 s60, vcc_lo, 0x5555
    s_branch L_redo
L_vok_220:
    v_bfe_u32 v20, v0, 4, 5
    v_mul_u32_u24 v15, 1040, v20
    v_bfe_u32 v20, v0, 9, 1
    v_lshl_add_u32 v15, v20, 4, v15
    s_lshl_b32 s20, s13, 13
    s_mul_i32 s31, s13, 8320
    s_mov_b32 s32, 0
    s_mov_b32 s33, 0
    s_mov_b32 s42, 0xffff
    s_mov_b32 s43, 0xffff
    s_mov_b32 s39, 0
    s_mov_b32 s37, 33280
    v_bfe_u32 v20, v0, 9, 1
    v_lshlrev_b32 v21, 8, v20
    v_and_b32 v22, 0x70, v0
    v_add_u32 v22, v21, v22
    v_bfe_u32 v23, v0, 7, 1
    v_lshl_add_u32 v22, v23, 10, v22
    v_bfe_u32 v23, v0, 8, 1
    v_lshl_add_u32 v10, v23, 7, v22
    v_and_b32 v22, 0xf0, v0
    v_add_u32 v12, v21, v22
    v_lshl_add_u32 v11, v23, 10, v12
    v_bfe_u32 v22, v0, 7, 1
    v_mul_u32_u24 v13, 0xaaaa, v22
    v_add_u32 v13, 0x4444, v13
    s_lshl_b32 s16, s13, 10
    s_add_u32 s16, s16, 12288
    v_and_b32 v22, 0x1f0, v0
    v_lshl_add_u32 v22, v20, 3, v22
    v_add_u32 v120, s16, v22
    v_bfe_u32 v22, v0, 6, 2
    v_lshl_add_u32 v22, v20, 2, v22
    v_lshlrev_b32 v22, 4, v22
    v_bfe_u32 v23, v0, 4, 1
    v_lshl_add_u32 v22, v23, 3, v22
    v_add_u32 v121, s16, v22
    s_lshl_b32 s29, s58, 7
    s_add_u32 s29, s29, 28672
    v_bfe_u32 v22, v0, 4, 5
    v_lshlrev_b32 v20, 2, v20
    v_sub_u32 v22, v22, v20
    v_mov_b32 v23, 0xf149f2ca
    s_mov_b32 s27, 0x3e0293ee
    v_cmp_gt_i32 vcc, 0, v22
    s_nop 1
    v_cndmask_b32 v80, 0, v23, vcc
    v_cmp_gt_i32 vcc, 1, v22
    s_nop 1
    v_cndmask_b32 v81, 0, v23, vcc
    v_cmp_gt_i32 vcc, 2, v22
    s_nop 1
    v_cndmask_b32 v82, 0, v23, vcc
    v_cmp_gt_i32 vcc, 3, v22
    s_nop 1
    v_cndmask_b32 v83, 0, v23, vcc
    v_cmp_gt_i32 vcc, 8, v22
    s_nop 1
    v_cndmask_b32 v84, 0, v23, vcc
    v_cmp_gt_i32 vcc, 9, v22
    s_nop 1
    v_cndmask_b32 v85, 0, v23, vcc
    v_cmp_gt_i32 vcc, 10, v22
    s_nop 1
    v_cndmask_b32 v86, 0, v23, vcc
    v_cmp_gt_i32 vcc, 11, v22
    s_nop 1
    v_cndmask_b32 v87, 0, v23, vcc
    v_cmp_gt_i32 vcc, 16, v22
    s_nop 1
    v_cndmask_b32 v88, 0, v23, vcc
    v_cmp_gt_i32 vcc, 17, v22
    s_nop 1
    v_cndmask_b32 v89, 0, v23, vcc
    v_cmp_gt_i32 vcc, 18, v22
    s_nop 1
    v_cndmask_b32 v90, 0, v23, vcc
    v_cmp_gt_i32 vcc, 19, v22
    s_nop 1
    v_cndmask_b32 v91, 0, v23, vcc
    v_cmp_gt_i32 vcc, 24, v22
    s_nop 1
    v_cndmask_b32 v92, 0, v23, vcc
    v_cmp_gt_i32 vcc, 25, v22
    s_nop 1
    v_cndmask_b32 v93, 0, v23, vcc
    v_cmp_gt_i32 vcc, 26, v22
    s_nop 1
    v_cndmask_b32 v94, 0, v23, vcc
    v_cmp_gt_i32 vcc, 27, v22
    s_nop 1
    v_cndmask_b32 v95, 0, v23, vcc
    ds_write_b128 v0, v[80:83] offset:0
    ds_write_b128 v0, v[84:87] offset:1024
    ds_write_b128 v0, v[88:91] offset:2048
    ds_write_b128 v0, v[92:95] offset:3072
    s_cmp_eq_u32 s14, 0
    s_cbranch_scc0 L_r1nf_223
    s_lshl_b32 s17, s12, 2
    s_add_u32 s17, s17, s13
    s_lshl_b32 s18, s17, 12
    s_add_u32 s18, s18, 50331648
    v_mov_b64 v[32:33], -1
    v_mov_b64 v[34:35], -1
    buffer_store_dwordx4 v[32:35], v0, s[4:7], s18 offen offset:0 sc1
    buffer_store_dwordx4 v[32:35], v0, s[4:7], s18 offen offset:1024 sc1
    buffer_store_dwordx4 v[32:35], v0, s[4:7], s18 offen offset:2048 sc1
    buffer_store_dwordx4 v[32:35], v0, s[4:7], s18 offen offset:3072 sc1
    s_lshl_b32 s18, s17, 11
    s_add_u32 s18, s18, 133955584
    v_mov_b64 v[36:37], -1
    v_mov_b64 v[38:39], -1
    buffer_store_dwordx4 v[36:39], v0, s[4:7], s18 offen offset:0 sc1
    buffer_store_dwordx4 v[36:39], v0, s[4:7], s18 offen offset:1024 sc1
    s_lshl_b32 s18, s17, 11
    s_add_u32 s18, s18, 150732800
    v_mov_b64 v[40:41], -1
    v_mov_b64 v[42:43], -1
    buffer_store_dwordx4 v[40:43], v0, s[4:7], s18 offen offset:0 sc1
    buffer_store_dwordx4 v[40:43], v0, s[4:7], s18 offen offset:1024 sc1
L_r1nf_223:
    s_mov_b32 s15, 0
    s_mov_b32 s44, 0
L_r1l_224:
    s_mov_b32 s21, 0
    s_cmp_eq_u32 s14, 0
    s_cselect_b32 s22, 22, 21
    s_mov_b32 s23, s14
    s_mov_b32 s24, s14
    s_mov_b32 s25, 82944
    s_mov_b32 s26, 82944
    s_lshl_b32 s30, s15, 5
L_r1i_225:
    s_cmp_lt_u32 s21, s22
    s_cbranch_scc0 L_r1nx_226
    s_lshl_b32 s17, s15, 6
    s_add_u32 s17, s17, s23
    s_lshl_b32 s17, s17, 5
    s_add_u32 s17, s17, s12
    s_lshl_b32 s17, s17, 2
    s_add_u32 s17, s17, s13
    s_lshl_b32 s17, s17, 12
    s_add_u32 s17, s17, 16777216
    s_lshl_b32 s18, s13, 11
    v_add_u32 v17, s18, v0
    v_add_u32 v16, s25, v0
    s_cmp_lg_u32 s33, 0
    s_cbranch_scc1 L_r1q_229
L_h0_230:
    s_add_u32 s16, s23, 0
    s_lshl_b32 s36, s15, 6
    s_add_u32 s36, s36, s16
    s_and_b32 s34, s16, 1
    s_lshl_b32 s34, s34, 2
    s_bfe_u32 s16, s16, 0x20001
    s_add_u32 s34, s34, s16
    s_lshl_b32 s34, s34, 2
    s_add_u32 s34, s34, s13
    s_lshl_b32 s34, s34, 7
    s_add_u32 s34, s34, 28672
    s_lshr_b32 s35, s36, 3
    s_add_u32 s35, s35, 1
    s_lshl_b32 s36, s36, 15
    s_add_u32 s36, s36, s20
    s_add_u32 s36, s36, 4194304
    s_cmp_lg_u32 s44, 0
    s_cbranch_scc1 L_h1_231
    s_mov_b64 exec, 0x1
L_wf_233:
    buffer_load_dword v14, off, s[4:7], s34 offset:0 sc1
    s_add_u32 s40, s40, 1
    s_cmp_gt_u32 s40, 262144
    s_cbranch_scc1 L_abort
    s_waitcnt vmcnt(0)
    v_cmp_gt_u32 vcc, s35, v14
    s_cbranch_vccnz L_wf_233
L_wfo_234:
    s_mov_b64 exec, -1
    s_branch L_h2_232
L_h1_231:
    v_lshlrev_b32 v1, 6, v0
    s_mov_b64 exec, 0xff
L_pr_236:
    buffer_load_dword v14, v1, s[4:7], s36 offen offset:1020 sc1
    s_add_u32 s40, s40, 1
    s_cmp_gt_u32 s40, 262144
    s_cbranch_scc1 L_abort
    s_waitcnt vmcnt(0)
    v_cmp_eq_u32 vcc, -1, v14
    s_cbranch_vccnz L_pr_236
    s_mov_b64 exec, -1
L_h2_232:
    s_add_u32 m0, s31, 16384
    s_add_u32 s16, s36, 0
    buffer_load_dwordx4 v0, s[4:7], s16 offen offset:0 sc1 lds
    s_add_u32 m0, s31, 16400
    s_nop 0
    buffer_load_dwordx4 v0, s[4:7], s16 offen offset:1024 sc1 lds
    s_add_u32 m0, s31, 16416
    s_nop 0
    buffer_load_dwordx4 v0, s[4:7], s16 offen offset:2048 sc1 lds
    s_add_u32 m0, s31, 16432
    s_nop 0
    buffer_load_dwordx4 v0, s[4:7], s16 offen offset:3072 sc1 lds
    s_add_u32 m0, s31, 20544
    s_add_u32 s16, s36, 4096
    buffer_load_dwordx4 v0, s[4:7], s16 offen offset:0 sc1 lds
    s_add_u32 m0, s31, 20560
    s_nop 0
    buffer_load_dwordx4 v0, s[4:7], s16 offen offset:1024 sc1 lds
    s_add_u32 m0, s31, 20576
    s_nop 0
    buffer_load_dwordx4 v0, s[4:7], s16 offen offset:2048 sc1 lds
    s_add_u32 m0, s31, 20592
    s_nop 0
    buffer_load_dwordx4 v0, s[4:7], s16 offen offset:3072 sc1 lds
    s_waitcnt vmcnt(0)
L_r1q_229:
    s_mov_b32 s33, 0
    s_add_u32 s31, s31, s37
    s_waitcnt lgkmcnt(0)
    s_barrier
    ds_read_b128 v[20:23], v15 offset:16384
    ds_read_b128 v[24:27], v15 offset:16416
    s_waitcnt lgkmcnt(1)
    v_mfma_f32_32x32x16_bf16 v[32:47], a[0:3], v[20:23], 0
    s_nop 0
    ds_read_b128 v[28:31], v15 offset:16448
    v_mfma_f32_32x32x16_bf16 v[48:63], v[20:23], a[128:131], 0
    s_add_u32 s16, s23, 3
    s_lshl_b32 s36, s15, 6
    s_add_u32 s36, s36, s16
    s_and_b32 s34, s16, 1
    s_lshl_b32 s34, s34, 2
    s_bfe_u32 s16, s16, 0x20001
    s_add_u32 s34, s34, s16
    s_lshl_b32 s34, s34, 2
    s_add_u32 s34, s34, s13
    s_lshl_b32 s34, s34, 7
    s_add_u32 s34, s34, 28672
    s_lshr_b32 s35, s36, 3
    s_add_u32 s35, s35, 1
    s_lshl_b32 s36, s36, 15
    s_add_u32 s36, s36, s20
    s_add_u32 s36, s36, 4194304
    buffer_load_dword v1, off, s[4:7], s34 sc1
    s_waitcnt lgkmcnt(1)
    v_mfma_f32_32x32x16_bf16 v[32:47], a[4:7], v[24:27], v[32:47]
    s_nop 0
    ds_read_b128 v[20:23], v15 offset:16480
    v_mfma_f32_32x32x16_bf16 v[48:63], v[24:27], a[132:135], v[48:63]
    s_waitcnt lgkmcnt(1)
    v_mfma_f32_32x32x16_bf16 v[32:47], a[8:11], v[28:31], v[32:47]
    s_nop 0
    ds_read_b128 v[24:27], v15 offset:16512
    v_mfma_f32_32x32x16_bf16 v[48:63], v[28:31], a[136:139], v[48:63]
    s_waitcnt lgkmcnt(1)
    v_mfma_f32_32x32x16_bf16 v[32:47], a[12:15], v[20:23], v[32:47]
    s_nop 0
    ds_read_b128 v[28:31], v15 offset:16544
    v_mfma_f32_32x32x16_bf16 v[48:63], v[20:23], a[140:143], v[48:63]
    s_waitcnt lgkmcnt(1)
    v_mfma_f32_32x32x16_bf16 v[32:47], a[16:19], v[24:27], v[32:47]
    s_nop 0
    ds_read_b128 v[20:23], v15 offset:16576
    v_mfma_f32_32x32x16_bf16 v[48:63], v[24:27], a[144:147], v[48:63]
    s_waitcnt lgkmcnt(1)
    v_mfma_f32_32x32x16_bf16 v[32:47], a[20:23], v[28:31], v[32:47]
    s_nop 0
    ds_read_b128 v[24:27], v15 offset:16608
    v_mfma_f32_32x32x16_bf16 v[48:63], v[28:31], a[148:151], v[48:63]
    s_waitcnt lgkmcnt(1)
    v_mfma_f32_32x32x16_bf16 v[32:47], a[24:27], v[20:23], v[32:47]
    s_nop 0
    ds_read_b128 v[28:31], v15 offset:16640
    v_mfma_f32_32x32x16_bf16 v[48:63], v[20:23], a[152:155], v[48:63]
    s_waitcnt lgkmcnt(1)
    v_mfma_f32_32x32x16_bf16 v[32:47], a[28:31], v[24:27], v[32:47]
    s_nop 0
    ds_read_b128 v[20:23], v15 offset:16672
    v_mfma_f32_32x32x16_bf16 v[48:63], v[24:27], a[156:159], v[48:63]
    s_waitcnt lgkmcnt(1)
    v_mfma_f32_32x32x16_bf16 v[32:47], a[32:35], v[28:31], v[32:47]
    s_nop 0
    ds_read_b128 v[24:27], v15 offset:16704
    v_mfma_f32_32x32x16_bf16 v[48:63], v[28:31], a[160:163], v[48:63]
    s_waitcnt lgkmcnt(1)
    v_mfma_f32_32x32x16_bf16 v[32:47], a[36:39], v[20:23], v[32:47]
    s_nop 0
    ds_read_b128 v[28:31], v15 offset:16736
    v_mfma_f32_32x32x16_bf16 v[48:63], v[20:23], a[164:167], v[48:63]
    s_waitcnt lgkmcnt(1)
    v_mfma_f32_32x32x16_bf16 v[32:47], a[40:43], v[24:27], v[32:47]
    s_nop 0
    ds_read_b128 v[20:23], v15 offset:16768
    v_mfma_f32_32x32x16_bf16 v[48:63], v[24:27], a[168:171], v[48:63]
    s_waitcnt lgkmcnt(1)
    v_mfma_f32_32x32x16_bf16 v[32:47], a[44:47], v[28:31], v[32:47]
    s_nop 0
    ds_read_b128 v[24:27], v15 offset:16800
    v_mfma_f32_32x32x16_bf16 v[48:63], v[28:31], a[172:175], v[48:63]
    s_waitcnt lgkmcnt(1)
    v_mfma_f32_32x32x16_bf16 v[32:47], a[48:51], v[20:23], v[32:47]
    s_nop 0
    ds_read_b128 v[28:31], v15 offset:16832
    v_mfma_f32_32x32x16_bf16 v[48:63], v[20:23], a[176:179], v[48:63]
    s_waitcnt lgkmcnt(1)
    v_mfma_f32_32x32x16_bf16 v[32:47], a[52:55], v[24:27], v[32:47]
    s_nop 0
    ds_read_b128 v[20:23], v15 offset:16864
    v_mfma_f32_32x32x16_bf16 v[48:63], v[24:27], a[180:183], v[48:63]
    s_waitcnt lgkmcnt(1)
    v_mfma_f32_32x32x16_bf16 v[32:47], a[56:59], v[28:31], v[32:47]
    s_nop 0
    ds_read_b128 v[24:27], v15 offset:16896
    v_mfma_f32_32x32x16_bf16 v[48:63], v[28:31], a[184:187], v[48:63]
    s_waitcnt vmcnt(0)
    s_cmp_lg_u32 s32, 0
    s_cbranch_scc0 L_fl_237
    s_waitcnt vmcnt(0)
    s_barrier
    s_cmp_eq_u32 s13, 3
    s_cbranch_scc0 L_pub_238
    v_mov_b32 v14, s30
    s_mov_b64 exec, 1
    buffer_store_dword v14, off, s[4:7], s29 sc1
    s_mov_b64 exec, -1
L_pub_238:
    s_mov_b32 s32, 0
L_fl_237:
    s_waitcnt lgkmcnt(1)
    v_mfma_f32_32x32x16_bf16 v[32:47], a[60:63], v[20:23], v[32:47]
    s_nop 0
    ds_read_b128 v[28:31], v15 offset:16928
    v_mfma_f32_32x32x16_bf16 v[48:63], v[20:23], a[188:191], v[48:63]
    v_cmp_gt_u32 vcc, s35, v1
    s_cmp_lt_u32 s23, 61
    s_cbranch_scc0 L_pf_239
    s_cbranch_vccnz L_pf_239
    s_mov_b32 s33, 1
    s_add_u32 m0, s31, 16384
    s_add_u32 s16, s36, 0
    buffer_load_dwordx4 v0, s[4:7], s16 offen offset:0 sc1 lds
    s_add_u32 m0, s31, 16400
    s_nop 0
    buffer_load_dwordx4 v0, s[4:7], s16 offen offset:1024 sc1 lds
    s_add_u32 m0, s31, 16416
    s_nop 0
    buffer_load_dwordx4 v0, s[4:7], s16 offen offset:2048 sc1 lds
    s_add_u32 m0, s31, 16432
    s_nop 0
    buffer_load_dwordx4 v0, s[4:7], s16 offen offset:3072 sc1 lds
    s_add_u32 m0, s31, 20544
    s_add_u32 s16, s36, 4096
    buffer_load_dwordx4 v0, s[4:7], s16 offen offset:0 sc1 lds
    s_add_u32 m0, s31, 20560
    s_nop 0
    buffer_load_dwordx4 v0, s[4:7], s16 offen offset:1024 sc1 lds
    s_add_u32 m0, s31, 20576
    s_nop 0
    buffer_load_dwordx4 v0, s[4:7], s16 offen offset:2048 sc1 lds
    s_add_u32 m0, s31, 20592
    s_nop 0
    buffer_load_dwordx4 v0, s[4:7], s16 offen offset:3072 sc1 lds
L_pf_239:
    s_waitcnt lgkmcnt(1)
    v_mfma_f32_32x32x16_bf16 v[32:47], a[64:67], v[24:27], v[32:47]
    s_nop 0
    ds_read_b128 v[20:23], v15 offset:16960
    v_mfma_f32_32x32x16_bf16 v[48:63], v[24:27], a[192:195], v[48:63]
    s_waitcnt lgkmcnt(1)
    v_mfma_f32_32x32x16_bf16 v[32:47], a[68:71], v[28:31], v[32:47]
    s_nop 0
    ds_read_b128 v[24:27], v15 offset:16992
    v_mfma_f32_32x32x16_bf16 v[48:63], v[28:31], a[196:199], v[48:63]
    s_waitcnt lgkmcnt(1)
    v_mfma_f32_32x32x16_bf16 v[32:47], a[72:75], v[20:23], v[32:47]
    s_nop 0
    ds_read_b128 v[28:31], v15 offset:17024
    v_mfma_f32_32x32x16_bf16 v[48:63], v[20:23], a[200:203], v[48:63]
    s_waitcnt lgkmcnt(1)
    v_mfma_f32_32x32x16_bf16 v[32:47], a[76:79], v[24:27], v[32:47]
    s_nop 0
    ds_read_b128 v[20:23], v15 offset:17056
    v_mfma_f32_32x32x16_bf16 v[48:63], v[24:27], a[204:207], v[48:63]
    s_waitcnt lgkmcnt(1)
    v_mfma_f32_32x32x16_bf16 v[32:47], a[80:83], v[28:31], v[32:47]
    s_nop 0
    ds_read_b128 v[24:27], v15 offset:17088
    v_mfma_f32_32x32x16_bf16 v[48:63], v[28:31], a[208:211], v[48:63]
    s_lshl_b32 s38, s15, 6
    s_add_u32 s38, s38, s24
    s_lshl_b32 s38, s38, 2
    s_add_u32 s38, s38, s13
    s_lshl_b32 s38, s38, 11
    s_add_u32 s38, s38, 174063616
    s_waitcnt lgkmcnt(1)
    v_mfma_f32_32x32x16_bf16 v[32:47], a[84:87], v[20:23], v[32:47]
    s_nop 0
    ds_read_b128 v[28:31], v15 offset:17120
    v_mfma_f32_32x32x16_bf16 v[48:63], v[20:23], a[212:215], v[48:63]
    s_waitcnt lgkmcnt(1)
    v_mfma_f32_32x32x16_bf16 v[32:47], a[88:91], v[24:27], v[32:47]
    s_nop 0
    ds_read_b128 v[20:23], v15 offset:17152
    v_mfma_f32_32x32x16_bf16 v[48:63], v[24:27], a[216:219], v[48:63]
    s_waitcnt lgkmcnt(1)
    v_mfma_f32_32x32x16_bf16 v[32:47], a[92:95], v[28:31], v[32:47]
    s_nop 0
    ds_read_b128 v[24:27], v15 offset:17184
    v_mfma_f32_32x32x16_bf16 v[48:63], v[28:31], a[220:223], v[48:63]
    s_waitcnt lgkmcnt(1)
    v_mfma_f32_32x32x16_bf16 v[32:47], a[96:99], v[20:23], v[32:47]
    s_nop 0
    ds_read_b128 v[28:31], v15 offset:17216
    v_mfma_f32_32x32x16_bf16 v[48:63], v[20:23], a[224:227], v[48:63]
    s_waitcnt lgkmcnt(1)
    v_mfma_f32_32x32x16_bf16 v[32:47], a[100:103], v[24:27], v[32:47]
    s_nop 0
    ds_read_b128 v[20:23], v15 offset:17248
    v_mfma_f32_32x32x16_bf16 v[48:63], v[24:27], a[228:231], v[48:63]
    s_waitcnt lgkmcnt(1)
    v_mfma_f32_32x32x16_bf16 v[32:47], a[104:107], v[28:31], v[32:47]
    s_nop 0
    ds_read_b128 v[24:27], v15 offset:17280
    v_mfma_f32_32x32x16_bf16 v[48:63], v[28:31], a[232:235], v[48:63]
    s_waitcnt lgkmcnt(1)
    v_mfma_f32_32x32x16_bf16 v[32:47], a[108:111], v[20:23], v[32:47]
    s_nop 0
    ds_read_b128 v[28:31], v15 offset:17312
    v_mfma_f32_32x32x16_bf16 v[48:63], v[20:23], a[236:239], v[48:63]
    s_waitcnt lgkmcnt(1)
    v_mfma_f32_32x32x16_bf16 v[32:47], a[112:115], v[24:27], v[32:47]
    s_nop 0
    ds_read_b128 v[20:23], v15 offset:17344
    v_mfma_f32_32x32x16_bf16 v[48:63], v[24:27], a[240:243], v[48:63]
    s_waitcnt lgkmcnt(1)
    v_mfma_f32_32x32x16_bf16 v[32:47], a[116:119], v[28:31], v[32:47]
    s_nop 0
    ds_read_b128 v[24:27], v15 offset:17376
    v_mfma_f32_32x32x16_bf16 v[48:63], v[28:31], a[244:247], v[48:63]
    s_waitcnt lgkmcnt(1)
    v_mfma_f32_32x32x16_bf16 v[32:47], a[120:123], v[20:23], v[32:47]
    v_mfma_f32_32x32x16_bf16 v[48:63], v[20:23], a[248:251], v[48:63]
    s_waitcnt lgkmcnt(0)
    v_mfma_f32_32x32x16_bf16 v[32:47], a[124:127], v[24:27], v[32:47]
    v_mfma_f32_32x32x16_bf16 v[48:63], v[24:27], a[252:255], v[48:63]
    s_cmp_lg_u32 s44, 0
    s_cbranch_scc0 L_hv_240
    s_mov_b32 s44, 0
    s_nop 9
    v_cmp_u_f32 vcc, v32, v32
    s_cbranch_vccz L_hv_240
    s_add_u32 s16, s23, 0
    s_lshl_b32 s36, s15, 6
    s_add_u32 s36, s36, s16
    s_and_b32 s34, s16, 1
    s_lshl_b32 s34, s34, 2
    s_bfe_u32 s16, s16, 0x20001
    s_add_u32 s34, s34, s16
    s_lshl_b32 s34, s34, 2
    s_add_u32 s34, s34, s13
    s_lshl_b32 s34, s34, 7
    s_add_u32 s34, s34, 28672
    s_lshr_b32 s35, s36, 3
    s_add_u32 s35, s35, 1
    s_lshl_b32 s36, s36, 15
    s_add_u32 s36, s36, s20
    s_add_u32 s36, s36, 4194304
    s_and_b32 s34, s34, 0xfffffe00
    v_lshlrev_b32 v1, 3, v0
    s_sub_u32 s36, s36, s20
    s_sub_u32 s18, 0, s37
    s_max_i32 s18, s18, 0
    s_add_u32 s18, s18, 16384
    s_mov_b64 exec, 0xf
    s_branch L_wg_243
L_wf_241:
    s_sleep 1
L_wg_243:
    buffer_load_dword v14, v1, s[4:7], s34 offen offset:0 sc1
    s_add_u32 s40, s40, 1
    s_cmp_gt_u32 s40, 262144
    s_cbranch_scc1 L_abort
    s_waitcnt vmcnt(0)
    v_cmp_gt_u32 vcc, s35, v14
    s_cbranch_vccnz L_wf_241
L_wfo_242:
    s_mov_b64 exec, -1
    s_mov_b32 m0, s18
    s_mov_b32 s16, 32
L_da_244:
    buffer_load_dwordx4 v0, s[4:7], s36 offen sc1 lds
    s_add_u32 s36, s36, 1024
    s_add_u32 m0, m0, 1040
    s_waitcnt vmcnt(16)
    s_sub_u32 s16, s16, 1
    s_cmp_lg_u32 s16, 0
    s_cbranch_scc1 L_da_244
    s_waitcnt vmcnt(0)
    ds_read_b128 v[20:23], v15 offset:16384
    ds_read_b128 v[24:27], v15 offset:16416
    s_waitcnt lgkmcnt(1)
    v_mfma_f32_32x32x16_bf16 v[32:47], a[0:3], v[20:23], 0
    s_nop 0
    ds_read_b128 v[28:31], v15 offset:16448
    v_mfma_f32_32x32x16_bf16 v[48:63], v[20:23], a[128:131], 0
    s_waitcnt lgkmcnt(1)
    v_mfma_f32_32x32x16_bf16 v[32:47], a[4:7], v[24:27], v[32:47]
    s_nop 0
    ds_read_b128 v[20:23], v15 offset:16480
    v_mfma_f32_32x32x16_bf16 v[48:63], v[24:27], a[132:135], v[48:63]
    s_waitcnt lgkmcnt(1)
    v_mfma_f32_32x32x16_bf16 v[32:47], a[8:11], v[28:31], v[32:47]
    s_nop 0
    ds_read_b128 v[24:27], v15 offset:16512
    v_mfma_f32_32x32x16_bf16 v[48:63], v[28:31], a[136:139], v[48:63]
    s_waitcnt lgkmcnt(1)
    v_mfma_f32_32x32x16_bf16 v[32:47], a[12:15], v[20:23], v[32:47]
    s_nop 0
    ds_read_b128 v[28:31], v15 offset:16544
    v_mfma_f32_32x32x16_bf16 v[48:63], v[20:23], a[140:143], v[48:63]
    s_waitcnt lgkmcnt(1)
    v_mfma_f32_32x32x16_bf16 v[32:47], a[16:19], v[24:27], v[32:47]
    s_nop 0
    ds_read_b128 v[20:23], v15 offset:16576
    v_mfma_f32_32x32x16_bf16 v[48:63], v[24:27], a[144:147], v[48:63]
    s_waitcnt lgkmcnt(1)
    v_mfma_f32_32x32x16_bf16 v[32:47], a[20:23], v[28:31], v[32:47]
    s_nop 0
    ds_read_b128 v[24:27], v15 offset:16608
    v_mfma_f32_32x32x16_bf16 v[48:63], v[28:31], a[148:151], v[48:63]
    s_waitcnt lgkmcnt(1)
    v_mfma_f32_32x32x16_bf16 v[32:47], a[24:27], v[20:23], v[32:47]
    s_nop 0
    ds_read_b128 v[28:31], v15 offset:16640
    v_mfma_f32_32x32x16_bf16 v[48:63], v[20:23], a[152:155], v[48:63]
    s_waitcnt lgkmcnt(1)
    v_mfma_f32_32x32x16_bf16 v[32:47], a[28:31], v[24:27], v[32:47]
    s_nop 0
    ds_read_b128 v[20:23], v15 offset:16672
    v_mfma_f32_32x32x16_bf16 v[48:63], v[24:27], a[156:159], v[48:63]
    s_waitcnt lgkmcnt(1)
    v_mfma_f32_32x32x16_bf16 v[32:47], a[32:35], v[28:31], v[32:47]
    s_nop 0
    ds_read_b128 v[24:27], v15 offset:16704
    v_mfma_f32_32x32x16_bf16 v[48:63], v[28:31], a[160:163], v[48:63]
    s_waitcnt lgkmcnt(1)
    v_mfma_f32_32x32x16_bf16 v[32:47], a[36:39], v[20:23], v[32:47]
    s_nop 0
    ds_read_b128 v[28:31], v15 offset:16736
    v_mfma_f32_32x32x16_bf16 v[48:63], v[20:23], a[164:167], v[48:63]
    s_waitcnt lgkmcnt(1)
    v_mfma_f32_32x32x16_bf16 v[32:47], a[40:43], v[24:27], v[32:47]
    s_nop 0
    ds_read_b128 v[20:23], v15 offset:16768
    v_mfma_f32_32x32x16_bf16 v[48:63], v[24:27], a[168:171], v[48:63]
    s_waitcnt lgkmcnt(1)
    v_mfma_f32_32x32x16_bf16 v[32:47], a[44:47], v[28:31], v[32:47]
    s_nop 0
    ds_read_b128 v[24:27], v15 offset:16800
    v_mfma_f32_32x32x16_bf16 v[48:63], v[28:31], a[172:175], v[48:63]
    s_waitcnt lgkmcnt(1)
    v_mfma_f32_32x32x16_bf16 v[32:47], a[48:51], v[20:23], v[32:47]
    s_nop 0
    ds_read_b128 v[28:31], v15 offset:16832
    v_mfma_f32_32x32x16_bf16 v[48:63], v[20:23], a[176:179], v[48:63]
    s_waitcnt lgkmcnt(1)
    v_mfma_f32_32x32x16_bf16 v[32:47], a[52:55], v[24:27], v[32:47]
    s_nop 0
    ds_read_b128 v[20:23], v15 offset:16864
    v_mfma_f32_32x32x16_bf16 v[48:63], v[24:27], a[180:183], v[48:63]
    s_waitcnt lgkmcnt(1)
    v_mfma_f32_32x32x16_bf16 v[32:47], a[56:59], v[28:31], v[32:47]
    s_nop 0
    ds_read_b128 v[24:27], v15 offset:16896
    v_mfma_f32_32x32x16_bf16 v[48:63], v[28:31], a[184:187], v[48:63]
    s_waitcnt lgkmcnt(1)
    v_mfma_f32_32x32x16_bf16 v[32:47], a[60:63], v[20:23], v[32:47]
    s_nop 0
    ds_read_b128 v[28:31], v15 offset:16928
    v_mfma_f32_32x32x16_bf16 v[48:63], v[20:23], a[188:191], v[48:63]
    s_waitcnt lgkmcnt(1)
    v_mfma_f32_32x32x16_bf16 v[32:47], a[64:67], v[24:27], v[32:47]
    s_nop 0
    ds_read_b128 v[20:23], v15 offset:16960
    v_mfma_f32_32x32x16_bf16 v[48:63], v[24:27], a[192:195], v[48:63]
    s_waitcnt lgkmcnt(1)
    v_mfma_f32_32x32x16_bf16 v[32:47], a[68:71], v[28:31], v[32:47]
    s_nop 0
    ds_read_b128 v[24:27], v15 offset:16992
    v_mfma_f32_32x32x16_bf16 v[48:63], v[28:31], a[196:199], v[48:63]
    s_waitcnt lgkmcnt(1)
    v_mfma_f32_32x32x16_bf16 v[32:47], a[72:75], v[20:23], v[32:47]
    s_nop 0
    ds_read_b128 v[28:31], v15 offset:17024
    v_mfma_f32_32x32x16_bf16 v[48:63], v[20:23], a[200:203], v[48:63]
    s_waitcnt lgkmcnt(1)
    v_mfma_f32_32x32x16_bf16 v[32:47], a[76:79], v[24:27], v[32:47]
    s_nop 0
    ds_read_b128 v[20:23], v15 offset:17056
    v_mfma_f32_32x32x16_bf16 v[48:63], v[24:27], a[204:207], v[48:63]
    s_waitcnt lgkmcnt(1)
    v_mfma_f32_32x32x16_bf16 v[32:47], a[80:83], v[28:31], v[32:47]
    s_nop 0
    ds_read_b128 v[24:27], v15 offset:17088
    v_mfma_f32_32x32x16_bf16 v[48:63], v[28:31], a[208:211], v[48:63]
    s_waitcnt lgkmcnt(1)
    v_mfma_f32_32x32x16_bf16 v[32:47], a[84:87], v[20:23], v[32:47]
    s_nop 0
    ds_read_b128 v[28:31], v15 offset:17120
    v_mfma_f32_32x32x16_bf16 v[48:63], v[20:23], a[212:215], v[48:63]
    s_waitcnt lgkmcnt(1)
    v_mfma_f32_32x32x16_bf16 v[32:47], a[88:91], v[24:27], v[32:47]
    s_nop 0
    ds_read_b128 v[20:23], v15 offset:17152
    v_mfma_f32_32x32x16_bf16 v[48:63], v[24:27], a[216:219], v[48:63]
    s_waitcnt lgkmcnt(1)
    v_mfma_f32_32x32x16_bf16 v[32:47], a[92:95], v[28:31], v[32:47]
    s_nop 0
    ds_read_b128 v[24:27], v15 offset:17184
    v_mfma_f32_32x32x16_bf16 v[48:63], v[28:31], a[220:223], v[48:63]
    s_waitcnt lgkmcnt(1)
    v_mfma_f32_32x32x16_bf16 v[32:47], a[96:99], v[20:23], v[32:47]
    s_nop 0
    ds_read_b128 v[28:31], v15 offset:17216
    v_mfma_f32_32x32x16_bf16 v[48:63], v[20:23], a[224:227], v[48:63]
    s_waitcnt lgkmcnt(1)
    v_mfma_f32_32x32x16_bf16 v[32:47], a[100:103], v[24:27], v[32:47]
    s_nop 0
    ds_read_b128 v[20:23], v15 offset:17248
    v_mfma_f32_32x32x16_bf16 v[48:63], v[24:27], a[228:231], v[48:63]
    s_waitcnt lgkmcnt(1)
    v_mfma_f32_32x32x16_bf16 v[32:47], a[104:107], v[28:31], v[32:47]
    s_nop 0
    ds_read_b128 v[24:27], v15 offset:17280
    v_mfma_f32_32x32x16_bf16 v[48:63], v[28:31], a[232:235], v[48:63]
    s_waitcnt lgkmcnt(1)
    v_mfma_f32_32x32x16_bf16 v[32:47], a[108:111], v[20:23], v[32:47]
    s_nop 0
    ds_read_b128 v[28:31], v15 offset:17312
    v_mfma_f32_32x32x16_bf16 v[48:63], v[20:23], a[236:239], v[48:63]
    s_waitcnt lgkmcnt(1)
    v_mfma_f32_32x32x16_bf16 v[32:47], a[112:115], v[24:27], v[32:47]
    s_nop 0
    ds_read_b128 v[20:23], v15 offset:17344
    v_mfma_f32_32x32x16_bf16 v[48:63], v[24:27], a[240:243], v[48:63]
    s_waitcnt lgkmcnt(1)
    v_mfma_f32_32x32x16_bf16 v[32:47], a[116:119], v[28:31], v[32:47]
    s_nop 0
    ds_read_b128 v[24:27], v15 offset:17376
    v_mfma_f32_32x32x16_bf16 v[48:63], v[28:31], a[244:247], v[48:63]
    s_waitcnt lgkmcnt(1)
    v_mfma_f32_32x32x16_bf16 v[32:47], a[120:123], v[20:23], v[32:47]
    v_mfma_f32_32x32x16_bf16 v[48:63], v[20:23], a[248:251], v[48:63]
    s_waitcnt lgkmcnt(0)
    v_mfma_f32_32x32x16_bf16 v[32:47], a[124:127], v[24:27], v[32:47]
    v_mfma_f32_32x32x16_bf16 v[48:63], v[24:27], a[252:255], v[48:63]
L_hv_240:
    ds_read_b128 v[20:23], v15 offset:16384
    ds_read_b128 v[24:27], v15 offset:16416
    s_waitcnt lgkmcnt(1)
    v_mfma_f32_32x32x16_bf16 v[64:79], v[128:131], v[20:23], 0
    s_nop 0
    ds_read_b128 v[28:31], v15 offset:16448
    s_nop 4
    v_cvt_pk_bf16_f32 v96, v32, v33
    v_cvt_pk_bf16_f32 v97, v34, v35
    v_cvt_pk_bf16_f32 v98, v36, v37
    v_cvt_pk_bf16_f32 v99, v38, v39
    v_cvt_pk_bf16_f32 v100, v40, v41
    v_cvt_pk_bf16_f32 v101, v42, v43
    v_cvt_pk_bf16_f32 v102, v44, v45
    v_cvt_pk_bf16_f32 v103, v46, v47
    s_waitcnt lgkmcnt(1)
    v_mfma_f32_32x32x16_bf16 v[64:79], v[132:135], v[24:27], v[64:79]
    s_nop 0
    ds_read_b128 v[20:23], v15 offset:16480
    buffer_store_dwordx4 v[96:99], v10, s[4:7], s17 offen sc1
    v_cvt_pk_bf16_f32 v104, v48, v49
    v_cvt_pk_bf16_f32 v105, v50, v51
    v_cvt_pk_bf16_f32 v106, v52, v53
    v_cvt_pk_bf16_f32 v107, v54, v55
    s_waitcnt lgkmcnt(1)
    v_mfma_f32_32x32x16_bf16 v[64:79], v[136:139], v[28:31], v[64:79]
    s_nop 0
    ds_read_b128 v[24:27], v15 offset:16512
    buffer_store_dwordx4 v[100:103], v10, s[4:7], s17 offen offset:512 sc1
    v_cvt_pk_bf16_f32 v108, v56, v57
    v_cvt_pk_bf16_f32 v109, v58, v59
    v_cvt_pk_bf16_f32 v110, v60, v61
    v_cvt_pk_bf16_f32 v111, v62, v63
    s_waitcnt lgkmcnt(1)
    v_mfma_f32_32x32x16_bf16 v[64:79], v[140:143], v[20:23], v[64:79]
    s_nop 0
    ds_read_b128 v[28:31], v15 offset:16544
    buffer_store_dwordx4 v[104:107], v11, s[4:7], s17 offen offset:2048 sc1
    s_waitcnt lgkmcnt(1)
    v_mfma_f32_32x32x16_bf16 v[64:79], v[144:147], v[24:27], v[64:79]
    s_nop 0
    ds_read_b128 v[20:23], v15 offset:16576
    buffer_store_dwordx4 v[108:111], v11, s[4:7], s17 offen offset:2560 sc1
    s_waitcnt lgkmcnt(1)
    v_mfma_f32_32x32x16_bf16 v[64:79], v[148:151], v[28:31], v[64:79]
    s_nop 0
    ds_read_b128 v[24:27], v15 offset:16608
    s_waitcnt lgkmcnt(1)
    v_mfma_f32_32x32x16_bf16 v[64:79], v[152:155], v[20:23], v[64:79]
    s_nop 0
    ds_read_b128 v[28:31], v15 offset:16640
    buffer_load_dword v1, off, s[4:7], s38 offset:1020 sc1
    s_waitcnt lgkmcnt(1)
    v_mfma_f32_32x32x16_bf16 v[64:79], v[156:159], v[24:27], v[64:79]
    s_nop 0
    ds_read_b128 v[20:23], v15 offset:16672
    s_waitcnt lgkmcnt(1)
    v_mfma_f32_32x32x16_bf16 v[64:79], v[160:163], v[28:31], v[64:79]
    s_nop 0
    ds_read_b128 v[24:27], v15 offset:16704
    ds_write_b128 v17, v[96:99] offset:4096
    s_waitcnt lgkmcnt(2)
    v_mfma_f32_32x32x16_bf16 v[64:79], v[164:167], v[20:23], v[64:79]
    s_nop 0
    ds_read_b128 v[28:31], v15 offset:16736
    s_waitcnt lgkmcnt(2)
    v_mfma_f32_32x32x16_bf16 v[64:79], v[168:171], v[24:27], v[64:79]
    s_nop 0
    ds_read_b128 v[20:23], v15 offset:16768
    ds_write_b128 v17, v[100:103] offset:5120
    s_waitcnt lgkmcnt(2)
    v_mfma_f32_32x32x16_bf16 v[64:79], v[172:175], v[28:31], v[64:79]
    s_nop 0
    ds_read_b128 v[24:27], v15 offset:16800
    s_waitcnt lgkmcnt(2)
    v_mfma_f32_32x32x16_bf16 v[64:79], v[176:179], v[20:23], v[64:79]
    s_nop 0
    ds_read_b128 v[28:31], v15 offset:16832
    ds_read_b128 v[80:83], v0 offset:0
    s_waitcnt lgkmcnt(2)
    v_mfma_f32_32x32x16_bf16 v[64:79], v[180:183], v[24:27], v[64:79]
    s_nop 0
    ds_read_b128 v[20:23], v15 offset:16864
    s_waitcnt lgkmcnt(2)
    v_mfma_f32_32x32x16_bf16 v[64:79], v[184:187], v[28:31], v[64:79]
    s_nop 0
    ds_read_b128 v[24:27], v15 offset:16896
    ds_read_b128 v[84:87], v0 offset:1024
    s_waitcnt lgkmcnt(2)
    v_mfma_f32_32x32x16_bf16 v[64:79], v[188:191], v[20:23], v[64:79]
    s_nop 0
    ds_read_b128 v[28:31], v15 offset:16928
    s_waitcnt lgkmcnt(2)
    v_mfma_f32_32x32x16_bf16 v[64:79], v[192:195], v[24:27], v[64:79]
    s_nop 0
    ds_read_b128 v[20:23], v15 offset:16960
    ds_read_b128 v[88:91], v0 offset:2048
    s_waitcnt lgkmcnt(2)
    v_mfma_f32_32x32x16_bf16 v[64:79], v[196:199], v[28:31], v[64:79]
    s_nop 0
    ds_read_b128 v[24:27], v15 offset:16992
    s_waitcnt lgkmcnt(2)
    v_mfma_f32_32x32x16_bf16 v[64:79], v[200:203], v[20:23], v[64:79]
    s_nop 0
    ds_read_b128 v[28:31], v15 offset:17024
    ds_read_b128 v[92:95], v0 offset:3072
    s_waitcnt lgkmcnt(2)
    v_mfma_f32_32x32x16_bf16 v[64:79], v[204:207], v[24:27], v[64:79]
    s_nop 0
    ds_read_b128 v[20:23], v15 offset:17056
    s_waitcnt lgkmcnt(2)
    v_mfma_f32_32x32x16_bf16 v[64:79], v[208:211], v[28:31], v[64:79]
    s_nop 0
    ds_read_b128 v[24:27], v15 offset:17088
    s_lshl_b32 s18, s15, 5
    s_add_u32 s18, s18, s12
    s_lshl_b32 s18, s18, 6
    s_waitcnt lgkmcnt(1)
    v_mfma_f32_32x32x16_bf16 v[64:79], v[212:215], v[20:23], v[64:79]
    s_nop 0
    ds_read_b128 v[28:31], v15 offset:17120
    s_add_u32 s18, s18, s23
    s_lshl_b32 s18, s18, 2
    s_add_u32 s18, s18, 0
    v_add_u32 v17, s25, v17
    s_waitcnt lgkmcnt(1)
    v_mfma_f32_32x32x16_bf16 v[64:79], v[216:219], v[24:27], v[64:79]
    s_nop 0
    ds_read_b128 v[20:23], v15 offset:17152
    s_lshl_b32 s19, s15, 6
    s_add_u32 s19, s19, s23
    s_add_u32 s19, s19, 1
    s_waitcnt lgkmcnt(1)
    v_mfma_f32_32x32x16_bf16 v[64:79], v[220:223], v[28:31], v[64:79]
    s_nop 0
    ds_read_b128 v[24:27], v15 offset:17184
    s_waitcnt lgkmcnt(1)
    v_mfma_f32_32x32x16_bf16 v[64:79], v[224:227], v[20:23], v[64:79]
    s_nop 0
    ds_read_b128 v[28:31], v15 offset:17216
    s_waitcnt lgkmcnt(1)
    v_mfma_f32_32x32x16_bf16 v[64:79], v[228:231], v[24:27], v[64:79]
    s_nop 0
    ds_read_b128 v[20:23], v15 offset:17248
    s_waitcnt lgkmcnt(1)
    v_mfma_f32_32x32x16_bf16 v[64:79], v[232:235], v[28:31], v[64:79]
    s_nop 0
    ds_read_b128 v[24:27], v15 offset:17280
    s_waitcnt lgkmcnt(1)
    v_mfma_f32_32x32x16_bf16 v[64:79], v[236:239], v[20:23], v[64:79]
    s_nop 0
    ds_read_b128 v[28:31], v15 offset:17312
    s_waitcnt lgkmcnt(1)
    v_mfma_f32_32x32x16_bf16 v[64:79], v[240:243], v[24:27], v[64:79]
    s_nop 0
    ds_read_b128 v[20:23], v15 offset:17344
    s_waitcnt lgkmcnt(1)
    v_mfma_f32_32x32x16_bf16 v[64:79], v[244:247], v[28:31], v[64:79]
    s_nop 0
    ds_read_b128 v[24:27], v15 offset:17376
    s_waitcnt lgkmcnt(1)
    v_mfma_f32_32x32x16_bf16 v[64:79], v[248:251], v[20:23], v[64:79]
    s_waitcnt lgkmcnt(0)
    v_mfma_f32_32x32x16_bf16 v[64:79], v[252:255], v[24:27], v[64:79]
    s_nop 11
    v_cvt_pk_bf16_f32 v112, v64, v65
    v_cvt_pk_bf16_f32 v113, v66, v67
    v_cvt_pk_bf16_f32 v114, v68, v69
    v_cvt_pk_bf16_f32 v115, v70, v71
    v_cvt_pk_bf16_f32 v116, v72, v73
    v_cvt_pk_bf16_f32 v117, v74, v75
    v_cvt_pk_bf16_f32 v118, v76, v77
    v_cvt_pk_bf16_f32 v119, v78, v79
    ds_write_b128 v17, v[112:115] offset:0
    ds_write_b128 v17, v[116:119] offset:1024
    s_waitcnt lgkmcnt(0)
    s_waitcnt vmcnt(0)
    s_barrier
    s_cmp_eq_u32 s13, 3
    s_cbranch_scc0 L_pub_245
    v_mov_b32 v14, s19
    s_mov_b64 exec, 1
    buffer_store_dword v14, off, s[4:7], s18 sc1
    s_mov_b64 exec, -1
L_pub_245:
    ds_read_b128 v[32:35], v0 offset:4096
    ds_read_b128 v[64:67], v16 offset:0
    ds_read_b128 v[36:39], v0 offset:5120
    ds_read_b128 v[68:71], v16 offset:1024
    ds_read_b128 v[40:43], v0 offset:6144
    ds_read_b128 v[72:75], v16 offset:2048
    s_waitcnt lgkmcnt(4)
    v_mfma_f32_32x32x16_bf16 v[80:95], v[32:35], v[64:67], v[80:95]
    s_nop 0
    ds_read_b128 v[44:47], v0 offset:7168
    ds_read_b128 v[76:79], v16 offset:3072
    s_waitcnt lgkmcnt(4)
    v_mfma_f32_32x32x16_bf16 v[80:95], v[36:39], v[68:71], v[80:95]
    s_nop 0
    ds_read_b128 v[48:51], v0 offset:8192
    ds_read_b128 v[96:99], v16 offset:4096
    s_waitcnt lgkmcnt(4)
    v_mfma_f32_32x32x16_bf16 v[80:95], v[40:43], v[72:75], v[80:95]
    s_nop 0
    ds_read_b128 v[52:55], v0 offset:9216
    ds_read_b128 v[100:103], v16 offset:5120
    s_waitcnt lgkmcnt(4)
    v_mfma_f32_32x32x16_bf16 v[80:95], v[44:47], v[76:79], v[80:95]
    s_nop 0
    ds_read_b128 v[56:59], v0 offset:10240
    ds_read_b128 v[112:115], v16 offset:6144
    s_waitcnt lgkmcnt(4)
    v_mfma_f32_32x32x16_bf16 v[80:95], v[48:51], v[96:99], v[80:95]
    s_nop 0
    ds_read_b128 v[60:63], v0 offset:11264
    ds_read_b128 v[116:119], v16 offset:7168
    s_waitcnt lgkmcnt(4)
    v_mfma_f32_32x32x16_bf16 v[80:95], v[52:55], v[100:103], v[80:95]
    s_waitcnt lgkmcnt(2)
    v_mfma_f32_32x32x16_bf16 v[80:95], v[56:59], v[112:115], v[80:95]
    s_waitcnt lgkmcnt(0)
    v_mfma_f32_32x32x16_bf16 v[80:95], v[60:63], v[116:119], v[80:95]
    s_add_u32 s23, s23, 3
    v_add_u32 v15, s37, v15
    s_sub_u32 s37, 0, s37
    v_cmp_eq_u32 vcc, -1, v1
    s_cmp_ge_u32 s21, 2
    s_cbranch_scc0 L_r1np_228
    s_cbranch_vccnz L_r1np_228
    s_mov_b32 s39, 1
    buffer_load_dwordx4 v[2:5], v0, s[4:7], s38 offen offset:0 sc1
    buffer_load_dwordx4 v[6:9], v0, s[4:7], s38 offen offset:1024 sc1
L_r1np_228:
    s_lshl_b32 s18, s13, 12
    v_add_u32 v17, s18, v16
    s_lshl_b32 s18, s13, 9
    s_add_u32 s18, s18, s25
    v_lshrrev_b32 v14, 1, v0
    v_add_u32 v14, s18, v14
    v_max3_f32 v18, v80, v81, v82
    v_max3_f32 v18, v18, v83, v84
    v_max3_f32 v18, v18, v85, v86
    v_max3_f32 v18, v18, v87, v88
    v_max3_f32 v18, v18, v89, v90
    v_max3_f32 v18, v18, v91, v92
    v_max3_f32 v18, v18, v93, v94
    v_max_f32 v18, v18, v95
    v_mov_b32 v19, v18
    s_nop 1
    v_permlane32_swap_b32 v18, v19
    v_max_f32 v18, v18, v19
    v_mul_f32 v18, s27, v18
    v_fma_f32 v80, v80, s27, -v18
    v_fma_f32 v81, v81, s27, -v18
    v_fma_f32 v82, v82, s27, -v18
    v_fma_f32 v83, v83, s27, -v18
    v_fma_f32 v84, v84, s27, -v18
    v_fma_f32 v85, v85, s27, -v18
    v_fma_f32 v86, v86, s27, -v18
    v_fma_f32 v87, v87, s27, -v18
    v_fma_f32 v88, v88, s27, -v18
    v_fma_f32 v89, v89, s27, -v18
    v_fma_f32 v90, v90, s27, -v18
    v_fma_f32 v91, v91, s27, -v18
    v_fma_f32 v92, v92, s27, -v18
    v_fma_f32 v93, v93, s27, -v18
    v_fma_f32 v94, v94, s27, -v18
    v_fma_f32 v95, v95, s27, -v18
    v_exp_f32 v80, v80
    v_exp_f32 v81, v81
    v_exp_f32 v82, v82
    v_exp_f32 v83, v83
    v_exp_f32 v84, v84
    v_exp_f32 v85, v85
    v_exp_f32 v86, v86
    v_exp_f32 v87, v87
    v_exp_f32 v88, v88
    v_exp_f32 v89, v89
    v_exp_f32 v90, v90
    v_exp_f32 v91, v91
    v_exp_f32 v92, v92
    v_exp_f32 v93, v93
    v_exp_f32 v94, v94
    v_exp_f32 v95, v95
    v_cvt_pk_bf16_f32 v96, v80, v81
    v_cvt_pk_bf16_f32 v97, v82, v83
    v_cvt_pk_bf16_f32 v98, v84, v85
    v_cvt_pk_bf16_f32 v99, v86, v87
    v_cvt_pk_bf16_f32 v100, v88, v89
    v_cvt_pk_bf16_f32 v101, v90, v91
    v_cvt_pk_bf16_f32 v102, v92, v93
    v_cvt_pk_bf16_f32 v103, v94, v95
    v_mfma_f32_32x32x16_bf16 v[64:79], v[104:107], v[96:99], 0
    s_nop 0
    v_mfma_f32_32x32x16_bf16 v[64:79], v[108:111], v[100:103], v[64:79]
    v_add_f32 v80, v80, v88
    v_add_f32 v81, v81, v89
    v_add_f32 v82, v82, v90
    v_add_f32 v83, v83, v91
    v_add_f32 v84, v84, v92
    v_add_f32 v85, v85, v93
    v_add_f32 v86, v86, v94
    v_add_f32 v87, v87, v95
    v_add_f32 v80, v80, v84
    v_add_f32 v81, v81, v85
    v_add_f32 v82, v82, v86
    v_add_f32 v83, v83, v87
    v_add_f32 v80, v80, v82
    v_add_f32 v81, v81, v83
    v_add_f32 v19, v80, v81
    ds_write_b128 v17, v[64:67] offset:8192
    ds_write_b128 v17, v[68:71] offset:9216
    ds_write_b128 v17, v[72:75] offset:10240
    ds_write_b128 v17, v[76:79] offset:11264
    ds_write_b64 v14, v[18:19] offset:24576
    s_add_u32 s25, s25, 26624
    s_cmp_eq_u32 s25, 162816
    s_cselect_b32 s25, 82944, s25
L_r1nx_226:
    s_cmp_ge_u32 s21, 2
    s_cbranch_scc0 L_r1nm_227
    s_lshl_b32 s18, s13, 11
    s_add_u32 s18, s18, s26
    v_add_u32 v16, s18, v0
    s_lshl_b32 s18, s13, 12
    s_add_u32 s18, s18, s26
    v_add_u32 v17, s18, v0
    s_lshl_b32 s18, s13, 9
    s_add_u32 s18, s18, s26
    v_lshrrev_b32 v14, 1, v0
    v_add_u32 v14, s18, v14
    ds_read_b128 v[112:115], v16 offset:0
    ds_read_b128 v[116:119], v16 offset:1024
    ds_read_b128 v[64:67], v17 offset:8192
    ds_read_b128 v[68:71], v17 offset:9216
    ds_read_b128 v[72:75], v17 offset:10240
    ds_read_b128 v[76:79], v17 offset:11264
    ds_read_b64 v[18:19], v14 offset:24576
    s_lshl_b32 s17, s15, 6
    s_add_u32 s17, s17, s24
    s_lshl_b32 s16, s13, 10
    v_add_u32 v16, s16, v0
    s_add_u32 s30, s30, 1
    s_lshl_b32 s38, s15, 6
    s_add_u32 s38, s38, s24
    s_lshl_b32 s38, s38, 2
    s_add_u32 s38, s38, s13
    s_lshl_b32 s38, s38, 11
    s_add_u32 s38, s38, 174063616
    v_mov_b64 v[32:33], 0
    v_mov_b64 v[48:49], 0
    v_mov_b64 v[34:35], 0
    v_mov_b64 v[50:51], 0
    v_mov_b64 v[36:37], 0
    v_mov_b64 v[52:53], 0
    v_mov_b64 v[38:39], 0
    v_mov_b64 v[54:55], 0
    v_mov_b64 v[20:21], 0
    v_mov_b64 v[22:23], 0
    v_mov_b64 v[24:25], 0
    v_mov_b64 v[26:27], 0
    v_mov_b64 v[28:29], 0
    v_mov_b64 v[30:31], 0
    s_lshl_b32 s18, s17, 5
    s_add_u32 s18, s18, s12
    s_lshl_b32 s18, s18, 2
    s_add_u32 s18, s18, s13
    s_lshl_b32 s18, s18, 11
    s_add_u32 s18, s18, 117440512
    v_add_u32 v17, s16, v16
    s_barrier
    s_cmp_lg_u32 s39, 0
    s_mov_b32 s39, 0
    s_cbranch_scc1 L_km1_248
    s_cmp_ge_u32 s24, 61
    s_cbranch_scc1 L_km_246
    s_mov_b64 exec, 1
L_km0_247:
    s_sleep 2
    buffer_load_dword v1, off, s[4:7], s38 offset:1020 sc1
    s_add_u32 s40, s40, 1
    s_cmp_gt_u32 s40, 262144
    s_cbranch_scc1 L_abort
    s_waitcnt vmcnt(0)
    v_cmp_eq_u32 vcc, -1, v1
    s_cbranch_vccnz L_km0_247
    s_mov_b64 exec, -1
L_km_246:
    buffer_load_dwordx4 v[2:5], v0, s[4:7], s38 offen offset:0 sc1
    buffer_load_dwordx4 v[6:9], v0, s[4:7], s38 offen offset:1024 sc1
    s_add_u32 s40, s40, 1
    s_cmp_gt_u32 s40, 262144
    s_cbranch_scc1 L_abort
L_km1_248:
    s_waitcnt vmcnt(0)
    ds_write_b128 v17, v[2:5] offset:4096
    ds_write_b128 v17, v[6:9] offset:5120
    v_max_u32 v14, v2, v3
    v_max3_u32 v14, v14, v4, v5
    v_max3_u32 v14, v14, v6, v7
    v_max3_u32 v14, v14, v8, v9
    v_cmp_eq_u32 vcc, -1, v14
    s_cbranch_vccnz L_km_246
    s_waitcnt lgkmcnt(0)
    s_barrier
    s_mov_b64 exec, s[42:43]
    ds_read_b128 v[20:23], v12 offset:4096
    ds_read_b128 v[24:27], v12 offset:4608
    s_waitcnt lgkmcnt(1)
    v_smfmac_f32_32x32x32_bf16 v[32:47], v[20:23], a[0:7], v13
    s_mov_b64 exec, s[42:43]
    ds_read_b128 v[28:31], v12 offset:5120
    s_waitcnt lgkmcnt(1)
    v_smfmac_f32_32x32x32_bf16 v[32:47], v[24:27], a[8:15], v13
    s_mov_b64 exec, s[42:43]
    ds_read_b128 v[20:23], v12 offset:5632
    s_waitcnt lgkmcnt(1)
    v_smfmac_f32_32x32x32_bf16 v[32:47], v[28:31], a[16:23], v13
    s_mov_b64 exec, s[42:43]
    ds_read_b128 v[24:27], v12 offset:6144
    s_waitcnt lgkmcnt(1)
    v_smfmac_f32_32x32x32_bf16 v[32:47], v[20:23], a[24:31], v13
    s_mov_b64 exec, s[42:43]
    ds_read_b128 v[28:31], v12 offset:6656
    s_waitcnt lgkmcnt(1)
    v_smfmac_f32_32x32x32_bf16 v[32:47], v[24:27], a[32:39], v13
    s_mov_b64 exec, s[42:43]
    ds_read_b128 v[20:23], v12 offset:7168
    s_waitcnt lgkmcnt(1)
    v_smfmac_f32_32x32x32_bf16 v[32:47], v[28:31], a[40:47], v13
    s_mov_b64 exec, s[42:43]
    ds_read_b128 v[24:27], v12 offset:7680
    s_waitcnt lgkmcnt(1)
    v_smfmac_f32_32x32x32_bf16 v[32:47], v[20:23], a[48:55], v13
    s_mov_b64 exec, s[42:43]
    ds_read_b128 v[28:31], v12 offset:8192
    s_waitcnt lgkmcnt(1)
    v_smfmac_f32_32x32x32_bf16 v[32:47], v[24:27], a[56:63], v13
    s_mov_b64 exec, s[42:43]
    ds_read_b128 v[20:23], v12 offset:8704
    s_waitcnt lgkmcnt(1)
    v_smfmac_f32_32x32x32_bf16 v[32:47], v[28:31], a[64:71], v13
    s_mov_b64 exec, s[42:43]
    ds_read_b128 v[24:27], v12 offset:9216
    s_waitcnt lgkmcnt(1)
    v_smfmac_f32_32x32x32_bf16 v[32:47], v[20:23], a[72:79], v13
    s_mov_b64 exec, s[42:43]
    ds_read_b128 v[28:31], v12 offset:9728
    s_waitcnt lgkmcnt(1)
    v_smfmac_f32_32x32x32_bf16 v[32:47], v[24:27], a[80:87], v13
    s_mov_b64 exec, s[42:43]
    ds_read_b128 v[20:23], v12 offset:10240
    s_waitcnt lgkmcnt(1)
    v_smfmac_f32_32x32x32_bf16 v[32:47], v[28:31], a[88:95], v13
    s_mov_b64 exec, s[42:43]
    ds_read_b128 v[24:27], v12 offset:10752
    s_waitcnt lgkmcnt(1)
    v_smfmac_f32_32x32x32_bf16 v[32:47], v[20:23], a[96:103], v13
    s_mov_b64 exec, s[42:43]
    ds_read_b128 v[28:31], v12 offset:11264
    s_waitcnt lgkmcnt(1)
    v_smfmac_f32_32x32x32_bf16 v[32:47], v[24:27], a[104:111], v13
    s_mov_b64 exec, s[42:43]
    ds_read_b128 v[20:23], v12 offset:11776
    s_waitcnt lgkmcnt(1)
    v_smfmac_f32_32x32x32_bf16 v[32:47], v[28:31], a[112:119], v13
    s_mov_b64 exec, s[42:43]
    ds_read_b128 v[24:27], v12 offset:4096
    s_waitcnt lgkmcnt(1)
    v_smfmac_f32_32x32x32_bf16 v[32:47], v[20:23], a[120:127], v13
    s_mov_b64 exec, s[42:43]
    ds_read_b128 v[28:31], v12 offset:4608
    s_waitcnt lgkmcnt(1)
    v_smfmac_f32_32x32x32_bf16 v[48:63], v[24:27], a[128:135], v13
    s_mov_b64 exec, s[42:43]
    ds_read_b128 v[20:23], v12 offset:5120
    s_mov_b64 exec, -1
    s_nop 2
    s_waitcnt lgkmcnt(1)
    v_smfmac_f32_32x32x32_bf16 v[48:63], v[28:31], a[136:143], v13
    s_mov_b64 exec, s[42:43]
    ds_read_b128 v[24:27], v12 offset:5632
    s_mov_b64 exec, -1
    v_add_f32 v32, v32, v36
    v_add_f32 v33, v33, v37
    v_add_f32 v34, v34, v38
    v_add_f32 v35, v35, v39
    s_waitcnt lgkmcnt(1)
    v_smfmac_f32_32x32x32_bf16 v[48:63], v[20:23], a[144:151], v13
    s_mov_b64 exec, s[42:43]
    ds_read_b128 v[28:31], v12 offset:6144
    s_mov_b64 exec, -1
    v_cvt_pk_bf16_f32 v32, v32, v33
    v_cvt_pk_bf16_f32 v33, v34, v35
    s_nop 0
    ds_write_b64 v120, v[32:33]
    s_waitcnt lgkmcnt(2)
    v_smfmac_f32_32x32x32_bf16 v[48:63], v[24:27], a[152:159], v13
    s_mov_b64 exec, s[42:43]
    ds_read_b128 v[20:23], v12 offset:6656
    s_mov_b64 exec, -1
    ds_read_b64_tr_b16 v[96:97], v121 offset:0
    ds_read_b64_tr_b16 v[98:99], v121 offset:128
    ds_read_b64_tr_b16 v[100:101], v121 offset:256
    ds_read_b64_tr_b16 v[102:103], v121 offset:384
    s_waitcnt lgkmcnt(6)
    v_smfmac_f32_32x32x32_bf16 v[48:63], v[28:31], a[160:167], v13
    s_mov_b64 exec, s[42:43]
    ds_read_b128 v[24:27], v12 offset:7168
    s_waitcnt lgkmcnt(5)
    v_smfmac_f32_32x32x32_bf16 v[48:63], v[20:23], a[168:175], v13
    s_mov_b64 exec, s[42:43]
    ds_read_b128 v[28:31], v12 offset:7680
    s_mov_b64 exec, -1
    s_waitcnt lgkmcnt(2)
    v_mfma_f32_32x32x16_bf16 v[80:95], v[96:99], v[112:115], 0
    v_mfma_f32_32x32x16_bf16 v[80:95], v[100:103], v[116:119], v[80:95]
    s_nop 4
    s_waitcnt lgkmcnt(1)
    v_smfmac_f32_32x32x32_bf16 v[48:63], v[24:27], a[176:183], v13
    s_mov_b64 exec, s[42:43]
    ds_read_b128 v[20:23], v12 offset:8192
    s_waitcnt lgkmcnt(1)
    v_smfmac_f32_32x32x32_bf16 v[48:63], v[28:31], a[184:191], v13
    s_mov_b64 exec, s[42:43]
    ds_read_b128 v[24:27], v12 offset:8704
    s_mov_b64 exec, -1
    ds_write_b128 v16, v[80:83] offset:12288
    s_waitcnt lgkmcnt(2)
    v_smfmac_f32_32x32x32_bf16 v[48:63], v[20:23], a[192:199], v13
    s_mov_b64 exec, s[42:43]
    ds_read_b128 v[28:31], v12 offset:9216
    s_waitcnt lgkmcnt(2)
    v_smfmac_f32_32x32x32_bf16 v[48:63], v[24:27], a[200:207], v13
    s_mov_b64 exec, s[42:43]
    ds_read_b128 v[20:23], v12 offset:9728
    s_waitcnt lgkmcnt(1)
    v_smfmac_f32_32x32x32_bf16 v[48:63], v[28:31], a[208:215], v13
    s_mov_b64 exec, s[42:43]
    ds_read_b128 v[24:27], v12 offset:10240
    s_mov_b64 exec, -1
    s_waitcnt lgkmcnt(3)
    s_barrier
    ds_read_b128 v[80:83], v0 offset:12288
    ds_read_b128 v[84:87], v0 offset:13312
    s_waitcnt lgkmcnt(3)
    v_smfmac_f32_32x32x32_bf16 v[48:63], v[20:23], a[216:223], v13
    s_mov_b64 exec, s[42:43]
    ds_read_b128 v[28:31], v12 offset:10752
    s_mov_b64 exec, -1
    ds_read_b128 v[88:91], v0 offset:14336
    ds_read_b128 v[92:95], v0 offset:15360
    s_waitcnt lgkmcnt(5)
    v_smfmac_f32_32x32x32_bf16 v[48:63], v[24:27], a[224:231], v13
    s_mov_b64 exec, s[42:43]
    ds_read_b128 v[20:23], v12 offset:11264
    s_waitcnt lgkmcnt(3)
    v_smfmac_f32_32x32x32_bf16 v[48:63], v[28:31], a[232:239], v13
    s_mov_b64 exec, s[42:43]
    ds_read_b128 v[24:27], v12 offset:11776
    s_mov_b64 exec, -1
    s_waitcnt lgkmcnt(1)
    v_smfmac_f32_32x32x32_bf16 v[48:63], v[20:23], a[240:247], v13
    s_waitcnt lgkmcnt(2)
    v_add_f32 v80, v80, v84
    v_add_f32 v81, v81, v85
    v_add_f32 v82, v82, v86
    v_add_f32 v83, v83, v87
    v_add_f32 v88, v88, v92
    s_waitcnt lgkmcnt(0)
    v_smfmac_f32_32x32x32_bf16 v[48:63], v[24:27], a[248:255], v13
    v_add_f32 v89, v89, v93
    v_add_f32 v90, v90, v94
    v_add_f32 v91, v91, v95
    v_add_f32 v80, v80, v88
    v_add_f32 v81, v81, v89
    v_add_f32 v82, v82, v90
    v_add_f32 v83, v83, v91
    v_max3_f32 v108, v80, v81, v82
    v_max_f32 v108, v108, v83
    v_mov_b32 v109, v108
    s_nop 1
    v_permlane32_swap_b32 v108, v109
    v_max_f32 v108, v108, v109
    v_mul_f32 v108, s27, v108
    v_max_f32 v108, v108, v18
    v_sub_f32 v110, v18, v108
    v_fma_f32 v80, v80, s27, -v108
    v_fma_f32 v81, v81, s27, -v108
    v_fma_f32 v82, v82, s27, -v108
    v_fma_f32 v83, v83, s27, -v108
    v_exp_f32 v110, v110
    v_exp_f32 v80, v80
    v_exp_f32 v81, v81
    v_exp_f32 v82, v82
    v_exp_f32 v83, v83
    v_fma_f32 v19, v19, v110, v80
    v_add_f32 v19, v19, v81
    v_add_f32 v108, v82, v83
    v_add_f32 v19, v19, v108
    v_mov_b32 v108, v19
    v_pk_add_f32 v[48:49], v[48:49], v[52:53]
    v_pk_add_f32 v[50:51], v[50:51], v[54:55]
    v_permlane32_swap_b32 v19, v108
    v_add_f32 v19, v19, v108
    v_rcp_f32 v108, v19
    v_cvt_pk_bf16_f32 v106, v48, v49
    v_cvt_pk_bf16_f32 v107, v50, v51
    v_mul_f32 v110, v110, v108
    v_pk_mul_f32 v[80:81], v[80:81], v[108:109] op_sel_hi:[1,0]
    v_pk_mul_f32 v[82:83], v[82:83], v[108:109] op_sel_hi:[1,0]
    v_cvt_pk_bf16_f32 v104, v80, v81
    v_cvt_pk_bf16_f32 v105, v82, v83
    v_pk_mul_f32 v[64:65], v[64:65], v[110:111] op_sel_hi:[1,0]
    v_pk_mul_f32 v[66:67], v[66:67], v[110:111] op_sel_hi:[1,0]
    v_pk_mul_f32 v[68:69], v[68:69], v[110:111] op_sel_hi:[1,0]
    v_pk_mul_f32 v[70:71], v[70:71], v[110:111] op_sel_hi:[1,0]
    v_pk_mul_f32 v[72:73], v[72:73], v[110:111] op_sel_hi:[1,0]
    v_pk_mul_f32 v[74:75], v[74:75], v[110:111] op_sel_hi:[1,0]
    v_pk_mul_f32 v[76:77], v[76:77], v[110:111] op_sel_hi:[1,0]
    v_pk_mul_f32 v[78:79], v[78:79], v[110:111] op_sel_hi:[1,0]
    s_nop 1
    v_mfma_f32_32x32x8_bf16 v[64:79], v[106:107], v[104:105], v[64:79]
    s_add_u32 s24, s24, 3
    s_add_u32 s26, s26, 26624
    s_cmp_eq_u32 s26, 162816
    s_cselect_b32 s26, 82944, s26
    s_nop 7
    v_cvt_pk_bf16_f32 v112, v64, v65
    v_cvt_pk_bf16_f32 v113, v66, v67
    v_cvt_pk_bf16_f32 v114, v68, v69
    v_cvt_pk_bf16_f32 v115, v70, v71
    v_cvt_pk_bf16_f32 v116, v72, v73
    v_cvt_pk_bf16_f32 v117, v74, v75
    v_cvt_pk_bf16_f32 v118, v76, v77
    v_cvt_pk_bf16_f32 v119, v78, v79
    buffer_store_dwordx4 v[112:115], v0, s[4:7], s18 offen offset:0 sc1
    buffer_store_dwordx4 v[116:119], v0, s[4:7], s18 offen offset:1024 sc1
    s_or_b32 s32, s17, 0x8000000
    s_add_u32 s16, s21, 1
    s_cmp_lt_u32 s16, s22
    s_cbranch_scc1 L_r1nm_227
    s_cmp_lg_u32 s32, 0
    s_cbranch_scc0 L_fl_249
    s_waitcnt vmcnt(0)
    s_barrier
    s_cmp_eq_u32 s13, 3
    s_cbranch_scc0 L_pub_250
    v_mov_b32 v14, s30
    s_mov_b64 exec, 1
    buffer_store_dword v14, off, s[4:7], s29 sc1
    s_mov_b64 exec, -1
L_pub_250:
    s_mov_b32 s32, 0
L_fl_249:
L_r1nm_227:
    s_add_u32 s21, s21, 1
    s_add_u32 s16, s22, 2
    s_cmp_lt_u32 s21, s16
    s_cbranch_scc1 L_r1i_225
    s_mov_b32 s44, 1
    s_add_u32 s15, s15, 1
    s_cmp_lt_u32 s15, 2
    s_cbranch_scc1 L_r1l_224
    s_branch L_help
L_team:
L_tc:
    s_mov_b32 s12, s58
    v_lshrrev_b32 v21, 4, v0
    v_and_b32 v22, 15, v21
    v_lshrrev_b32 v23, 4, v21
    v_add_u32 v1, 0x10000, v0
    s_mul_i32 s16, s13, 2688
    s_add_u32 s16, s16, 150528
    v_mul_u32_u24 v24, 40, v22
    v_add_u32 v24, s16, v24
    v_lshl_add_u32 v2, v23, 2, v24
    v_lshl_add_u32 v3, v23, 3, v24
    v_lshrrev_b32 v24, 1, v23
    v_lshlrev_b32 v24, 4, v24
    v_and_b32 v25, 1, v23
    v_lshl_add_u32 v24, v25, 2, v24
    v_lshrrev_b32 v25, 2, v22
    v_add_u32 v24, v24, v25
    v_mul_u32_u24 v24, 40, v24
    v_and_b32 v25, 3, v22
    v_lshl_add_u32 v24, v25, 3, v24
    v_add_u32 v4, s16, v24
    v_add_u32 v5, 131072, v0
    v_lshlrev_b32 v24, 7, v23
    v_add_u32 v24, 131072, v24
    v_and_b32 v25, 7, v22
    v_lshl_add_u32 v8, v25, 4, v24
    v_and_b32 v25, 8, v22
    v_add_u32 v7, v25, v8
    v_bfe_u32 v26, v21, 1, 1
    v_lshrrev_b32 v24, 3, v21
    v_lshlrev_b32 v24, 11, v24
    v_and_b32 v25, 7, v21
    v_lshl_add_u32 v9, v25, 3, v24
    v_and_b32 v25, 3, v21
    v_lshrrev_b32 v24, 1, v23
    v_lshlrev_b32 v24, 6, v24
    v_lshl_add_u32 v24, v25, 2, v24
    v_and_b32 v25, 1, v23
    v_lshl_add_u32 v11, v25, 4, v24
    v_mov_b32 v24, 0x4444
    v_mov_b32 v25, 0xeeee
    v_cmp_eq_u32 vcc, 1, v26
    s_nop 1
    v_cndmask_b32 v10, v24, v25, vcc
    v_cmp_lt_u32 vcc, 7, v22
    s_nop 1
    v_cndmask_b32 v24, v24, v25, vcc
    v_lshl_or_b32 v10, v24, 16, v10
    v_lshlrev_b32 v24, 2, v21
    v_add_u32 v6, 139264, v24
    v_mov_b32 v12, 0x3f803f80
    v_mov_b32 v13, 0x3f803f80
    v_mov_b32 v14, 0x3f803f80
    v_mov_b32 v15, 0x3f803f80
    s_lshl_b32 s16, s13, 14
    s_lshl_b32 s17, s12, 6
    s_add_u32 s16, s16, s17
    s_add_u32 s20, s16, 262144
    s_add_u32 s21, s16, 327680
    s_add_u32 s25, s16, 393216
    s_add_u32 s37, s16, 458752
    s_lshl_b32 s24, s12, 11
    s_lshl_b32 s16, s13, 16
    s_add_u32 s24, s24, s16
    s_add_u32 s24, s24, 262144
    s_mov_b32 s52, 0x33333333
    s_mov_b32 s53, 0x33333333
    s_mov_b32 s38, 0xff00ff00
    s_mov_b32 s39, 0xff00ff00
    s_mov_b32 s46, 0x000f000f
    s_mov_b32 s47, 0x000f000f
    s_mov_b32 s22, 1
    s_mov_b32 s23, 0x3f7f4880
    s_lshr_b32 s17, s12, 1
    s_lshl_b32 s17, s17, 7
    s_and_b32 s18, s12, 1
    s_lshl_b32 s18, s18, 5
    s_add_u32 s30, s17, s18
    s_lshl_b32 s18, s13, 11
    s_add_u32 s30, s30, s18
    s_lshl_b32 s29, s13, 11
    s_mov_b32 s26, 163840
    s_mov_b32 s27, 172032
    s_mov_b32 s28, 180224
    s_mov_b32 s41, 0x3e0293ee
    s_mov_b32 s42, 0x4e800000
    s_lshl_b32 s43, s13, 8
    s_add_u32 s43, s43, 149504
    s_cmp_eq_u32 s13, 3
    s_cbranch_scc0 L_ar_251
    s_cmp_lg_u32 s59, 0
    s_cbranch_scc1 L_ar_251
    s_lshr_b32 s16, s2, 3
    s_lshl_b32 s16, 1, s16
    v_mov_b32 v116, s16
    s_and_b32 s16, s61, 7
    s_lshl_b32 s16, s16, 5
    s_and_b32 s17, s61, 8
    s_lshl_b32 s17, s17, 1
    s_or_b32 s16, s16, s17
    v_mov_b32 v117, 0x100
    v_mov_b32 v118, s16
    s_mov_b64 exec, 1
    s_waitcnt vmcnt(0)
    global_atomic_add_x2 v[126:127], v118, v[116:117], s[56:57] sc0 sc1
    s_mov_b64 exec, -1
L_ar_251:
    s_lshl_b32 s48, s12, 8
    s_lshl_b32 s49, s12, 17
    v_bfe_u32 v40, v0, 6, 1
    v_bfe_u32 v41, v0, 7, 1
    v_bfe_u32 v42, v0, 8, 1
    v_bfe_u32 v43, v0, 9, 1
    v_bfe_u32 v44, v0, 4, 2
    v_lshlrev_b32 v44, 3, v44
    v_lshl_add_u32 v45, v41, 1, v42
    v_lshl_add_u32 v45, v43, 2, v45
    v_mul_u32_u24 v45, 1040, v45
    v_lshl_add_u32 v45, v40, 8, v45
    v_add_u32 v113, v45, v44
    v_lshl_add_u32 v45, v42, 3, v40
    v_lshl_add_u32 v45, v43, 2, v45
    v_mul_u32_u24 v45, 1040, v45
    v_lshl_add_u32 v45, v41, 5, v45
    v_add_u32 v114, v45, v44
    s_cmp_eq_u32 s13, 1
    s_cbranch_scc1 L_lw1_253
    s_cmp_eq_u32 s13, 2
    s_cbranch_scc1 L_lw2_254
    s_cmp_eq_u32 s13, 3
    s_cbranch_scc1 L_lw3_255
L_lw0_252:
    s_load_dwordx2 s[8:9], s[0:1], 32
    s_mov_b32 s10, 4194304
    s_mov_b32 s11, 0x20000
    s_waitcnt lgkmcnt(0)
    v_lshrrev_b32 v123, 8, v0
    v_lshl_add_u32 v123, s13, 4, v123
    v_mul_u32_u24 v123, 8192, v123
    v_and_b32 v112, 0xf0, v0
    v_add_u32 v112, v123, v112
    s_mul_i32 s19, s13, 4160
    s_add_u32 m0, s19, 47360
    s_add_u32 s16, s48, 0
    buffer_load_dwordx4 v112, s[8:11], s16 offen lds
    s_add_u32 m0, s19, 48400
    s_add_u32 s16, s48, 32768
    buffer_load_dwordx4 v112, s[8:11], s16 offen lds
    s_add_u32 m0, s19, 49440
    s_add_u32 s16, s48, 65536
    buffer_load_dwordx4 v112, s[8:11], s16 offen lds
    s_add_u32 m0, s19, 50480
    s_add_u32 s16, s48, 98304
    buffer_load_dwordx4 v112, s[8:11], s16 offen lds
    s_mul_i32 s19, s13, 4160
    s_add_u32 m0, s19, 64000
    s_add_u32 s16, s48, 524288
    buffer_load_dwordx4 v112, s[8:11], s16 offen lds
    s_add_u32 m0, s19, 65040
    s_add_u32 s16, s48, 557056
    buffer_load_dwordx4 v112, s[8:11], s16 offen lds
    s_add_u32 m0, s19, 66080
    s_add_u32 s16, s48, 589824
    buffer_load_dwordx4 v112, s[8:11], s16 offen lds
    s_add_u32 m0, s19, 67120
    s_add_u32 s16, s48, 622592
    buffer_load_dwordx4 v112, s[8:11], s16 offen lds
    s_mul_i32 s19, s13, 4160
    s_add_u32 m0, s19, 80640
    s_add_u32 s16, s48, 1048576
    buffer_load_dwordx4 v112, s[8:11], s16 offen lds
    s_add_u32 m0, s19, 81680
    s_add_u32 s16, s48, 1081344
    buffer_load_dwordx4 v112, s[8:11], s16 offen lds
    s_add_u32 m0, s19, 82720
    s_add_u32 s16, s48, 1114112
    buffer_load_dwordx4 v112, s[8:11], s16 offen lds
    s_add_u32 m0, s19, 83760
    s_add_u32 s16, s48, 1146880
    buffer_load_dwordx4 v112, s[8:11], s16 offen lds
    s_mul_i32 s19, s13, 4160
    s_add_u32 m0, s19, 97280
    s_add_u32 s16, s48, 1572864
    buffer_load_dwordx4 v112, s[8:11], s16 offen lds
    s_add_u32 m0, s19, 98320
    s_add_u32 s16, s48, 1605632
    buffer_load_dwordx4 v112, s[8:11], s16 offen lds
    s_add_u32 m0, s19, 99360
    s_add_u32 s16, s48, 1638400
    buffer_load_dwordx4 v112, s[8:11], s16 offen lds
    s_add_u32 m0, s19, 100400
    s_add_u32 s16, s48, 1671168
    buffer_load_dwordx4 v112, s[8:11], s16 offen lds
    s_mul_i32 s19, s13, 4160
    s_add_u32 m0, s19, 113920
    s_add_u32 s16, s48, 2097152
    buffer_load_dwordx4 v112, s[8:11], s16 offen lds
    s_add_u32 m0, s19, 114960
    s_add_u32 s16, s48, 2129920
    buffer_load_dwordx4 v112, s[8:11], s16 offen lds
    s_add_u32 m0, s19, 116000
    s_add_u32 s16, s48, 2162688
    buffer_load_dwordx4 v112, s[8:11], s16 offen lds
    s_add_u32 m0, s19, 117040
    s_add_u32 s16, s48, 2195456
    buffer_load_dwordx4 v112, s[8:11], s16 offen lds
    s_mul_i32 s19, s13, 4160
    s_add_u32 m0, s19, 130560
    s_add_u32 s16, s48, 2621440
    buffer_load_dwordx4 v112, s[8:11], s16 offen lds
    s_add_u32 m0, s19, 131600
    s_add_u32 s16, s48, 2654208
    buffer_load_dwordx4 v112, s[8:11], s16 offen lds
    s_add_u32 m0, s19, 132640
    s_add_u32 s16, s48, 2686976
    buffer_load_dwordx4 v112, s[8:11], s16 offen lds
    s_add_u32 m0, s19, 133680
    s_add_u32 s16, s48, 2719744
    buffer_load_dwordx4 v112, s[8:11], s16 offen lds
    s_waitcnt vmcnt(20)
    s_waitcnt lgkmcnt(0)
    s_barrier
    s_mul_i32 s19, s13, 4160
    s_add_u32 m0, s19, 147200
    s_add_u32 s16, s48, 3145728
    buffer_load_dwordx4 v112, s[8:11], s16 offen lds
    s_add_u32 m0, s19, 148240
    s_add_u32 s16, s48, 3178496
    buffer_load_dwordx4 v112, s[8:11], s16 offen lds
    s_add_u32 m0, s19, 149280
    s_add_u32 s16, s48, 3211264
    buffer_load_dwordx4 v112, s[8:11], s16 offen lds
    s_add_u32 m0, s19, 150320
    s_add_u32 s16, s48, 3244032
    buffer_load_dwordx4 v112, s[8:11], s16 offen lds
    v_add_u32 v115, 47360, v113
    ds_read_b64_tr_b16 v[64:65], v115 offset:0
    ds_read_b64_tr_b16 v[66:67], v115 offset:512
    ds_read_b64_tr_b16 v[68:69], v115 offset:8320
    ds_read_b64_tr_b16 v[70:71], v115 offset:8832
    ds_read_b64_tr_b16 a[168:169], v115 offset:32
    ds_read_b64_tr_b16 a[170:171], v115 offset:544
    ds_read_b64_tr_b16 a[172:173], v115 offset:8352
    ds_read_b64_tr_b16 a[174:175], v115 offset:8864
    s_waitcnt vmcnt(20)
    s_waitcnt lgkmcnt(0)
    s_barrier
    s_mul_i32 s19, s13, 4160
    s_add_u32 m0, s19, 47360
    s_add_u32 s16, s48, 3670016
    buffer_load_dwordx4 v112, s[8:11], s16 offen lds
    s_add_u32 m0, s19, 48400
    s_add_u32 s16, s48, 3702784
    buffer_load_dwordx4 v112, s[8:11], s16 offen lds
    s_add_u32 m0, s19, 49440
    s_add_u32 s16, s48, 3735552
    buffer_load_dwordx4 v112, s[8:11], s16 offen lds
    s_add_u32 m0, s19, 50480
    s_add_u32 s16, s48, 3768320
    buffer_load_dwordx4 v112, s[8:11], s16 offen lds
    v_add_u32 v115, 64000, v113
    ds_read_b64_tr_b16 a[176:177], v115 offset:0
    ds_read_b64_tr_b16 a[178:179], v115 offset:512
    ds_read_b64_tr_b16 a[180:181], v115 offset:8320
    ds_read_b64_tr_b16 a[182:183], v115 offset:8832
    ds_read_b64_tr_b16 a[184:185], v115 offset:32
    ds_read_b64_tr_b16 a[186:187], v115 offset:544
    ds_read_b64_tr_b16 a[188:189], v115 offset:8352
    ds_read_b64_tr_b16 a[190:191], v115 offset:8864
    s_waitcnt vmcnt(20)
    s_waitcnt lgkmcnt(0)
    s_barrier
    s_load_dwordx2 s[8:9], s[0:1], 40
    s_mov_b32 s10, 4194304
    s_mov_b32 s11, 0x20000
    s_waitcnt lgkmcnt(0)
    v_mov_b32 v112, v0
    s_mul_i32 s19, s13, 4160
    s_add_u32 m0, s19, 64000
    s_add_u32 s16, s49, 0
    buffer_load_dwordx4 v112, s[8:11], s16 offen lds
    s_add_u32 m0, s19, 65040
    s_add_u32 s16, s49, 1024
    buffer_load_dwordx4 v112, s[8:11], s16 offen lds
    s_add_u32 m0, s19, 66080
    s_add_u32 s16, s49, 2048
    buffer_load_dwordx4 v112, s[8:11], s16 offen lds
    s_add_u32 m0, s19, 67120
    s_add_u32 s16, s49, 3072
    buffer_load_dwordx4 v112, s[8:11], s16 offen lds
    v_add_u32 v115, 80640, v113
    ds_read_b64_tr_b16 a[192:193], v115 offset:0
    ds_read_b64_tr_b16 a[194:195], v115 offset:512
    ds_read_b64_tr_b16 a[196:197], v115 offset:8320
    ds_read_b64_tr_b16 a[198:199], v115 offset:8832
    ds_read_b64_tr_b16 a[200:201], v115 offset:32
    ds_read_b64_tr_b16 a[202:203], v115 offset:544
    ds_read_b64_tr_b16 a[204:205], v115 offset:8352
    ds_read_b64_tr_b16 a[206:207], v115 offset:8864
    s_waitcnt vmcnt(20)
    s_waitcnt lgkmcnt(0)
    s_barrier
    s_mul_i32 s19, s13, 4160
    s_add_u32 m0, s19, 80640
    s_add_u32 s16, s49, 8192
    buffer_load_dwordx4 v112, s[8:11], s16 offen lds
    s_add_u32 m0, s19, 81680
    s_add_u32 s16, s49, 9216
    buffer_load_dwordx4 v112, s[8:11], s16 offen lds
    s_add_u32 m0, s19, 82720
    s_add_u32 s16, s49, 10240
    buffer_load_dwordx4 v112, s[8:11], s16 offen lds
    s_add_u32 m0, s19, 83760
    s_add_u32 s16, s49, 11264
    buffer_load_dwordx4 v112, s[8:11], s16 offen lds
    v_add_u32 v115, 97280, v113
    ds_read_b64_tr_b16 a[208:209], v115 offset:0
    ds_read_b64_tr_b16 a[210:211], v115 offset:512
    ds_read_b64_tr_b16 a[212:213], v115 offset:8320
    ds_read_b64_tr_b16 a[214:215], v115 offset:8832
    ds_read_b64_tr_b16 a[216:217], v115 offset:32
    ds_read_b64_tr_b16 a[218:219], v115 offset:544
    ds_read_b64_tr_b16 a[220:221], v115 offset:8352
    ds_read_b64_tr_b16 a[222:223], v115 offset:8864
    s_waitcnt vmcnt(20)
    s_waitcnt lgkmcnt(0)
    s_barrier
    s_mul_i32 s19, s13, 4160
    s_add_u32 m0, s19, 97280
    s_add_u32 s16, s49, 32768
    buffer_load_dwordx4 v112, s[8:11], s16 offen lds
    s_add_u32 m0, s19, 98320
    s_add_u32 s16, s49, 33792
    buffer_load_dwordx4 v112, s[8:11], s16 offen lds
    s_add_u32 m0, s19, 99360
    s_add_u32 s16, s49, 34816
    buffer_load_dwordx4 v112, s[8:11], s16 offen lds
    s_add_u32 m0, s19, 100400
    s_add_u32 s16, s49, 35840
    buffer_load_dwordx4 v112, s[8:11], s16 offen lds
    v_add_u32 v115, 113920, v113
    ds_read_b64_tr_b16 a[224:225], v115 offset:0
    ds_read_b64_tr_b16 a[226:227], v115 offset:512
    ds_read_b64_tr_b16 a[228:229], v115 offset:8320
    ds_read_b64_tr_b16 a[230:231], v115 offset:8832
    ds_read_b64_tr_b16 a[232:233], v115 offset:32
    ds_read_b64_tr_b16 a[234:235], v115 offset:544
    ds_read_b64_tr_b16 a[236:237], v115 offset:8352
    ds_read_b64_tr_b16 a[238:239], v115 offset:8864
    s_waitcnt vmcnt(20)
    s_waitcnt lgkmcnt(0)
    s_barrier
    s_mul_i32 s19, s13, 4160
    s_add_u32 m0, s19, 113920
    s_add_u32 s16, s49, 40960
    buffer_load_dwordx4 v112, s[8:11], s16 offen lds
    s_add_u32 m0, s19, 114960
    s_add_u32 s16, s49, 41984
    buffer_load_dwordx4 v112, s[8:11], s16 offen lds
    s_add_u32 m0, s19, 116000
    s_add_u32 s16, s49, 43008
    buffer_load_dwordx4 v112, s[8:11], s16 offen lds
    s_add_u32 m0, s19, 117040
    s_add_u32 s16, s49, 44032
    buffer_load_dwordx4 v112, s[8:11], s16 offen lds
    v_add_u32 v115, 130560, v113
    ds_read_b64_tr_b16 a[240:241], v115 offset:0
    ds_read_b64_tr_b16 a[242:243], v115 offset:512
    ds_read_b64_tr_b16 a[244:245], v115 offset:8320
    ds_read_b64_tr_b16 a[246:247], v115 offset:8832
    ds_read_b64_tr_b16 a[248:249], v115 offset:32
    ds_read_b64_tr_b16 a[250:251], v115 offset:544
    ds_read_b64_tr_b16 a[252:253], v115 offset:8352
    ds_read_b64_tr_b16 a[254:255], v115 offset:8864
    v_and_b32 v118, 0xf0, v0
    global_load_dwordx2 v[116:117], v118, s[56:57] sc1
    s_waitcnt vmcnt(21)
    s_waitcnt lgkmcnt(0)
    s_barrier
    s_mul_i32 s19, s13, 4160
    s_add_u32 m0, s19, 130560
    s_add_u32 s16, s49, 65536
    buffer_load_dwordx4 v112, s[8:11], s16 offen lds
    s_add_u32 m0, s19, 131600
    s_add_u32 s16, s49, 66560
    buffer_load_dwordx4 v112, s[8:11], s16 offen lds
    s_add_u32 m0, s19, 132640
    s_add_u32 s16, s49, 67584
    buffer_load_dwordx4 v112, s[8:11], s16 offen lds
    s_add_u32 m0, s19, 133680
    s_add_u32 s16, s49, 68608
    buffer_load_dwordx4 v112, s[8:11], s16 offen lds
    v_add_u32 v115, 147200, v113
    ds_read_b64_tr_b16 v[128:129], v115 offset:0
    ds_read_b64_tr_b16 v[130:131], v115 offset:512
    ds_read_b64_tr_b16 v[132:133], v115 offset:8320
    ds_read_b64_tr_b16 v[134:135], v115 offset:8832
    ds_read_b64_tr_b16 v[136:137], v115 offset:32
    ds_read_b64_tr_b16 v[138:139], v115 offset:544
    ds_read_b64_tr_b16 v[140:141], v115 offset:8352
    ds_read_b64_tr_b16 v[142:143], v115 offset:8864
    s_waitcnt vmcnt(21)
    s_waitcnt lgkmcnt(0)
    s_barrier
    s_mul_i32 s19, s13, 4160
    s_add_u32 m0, s19, 147200
    s_add_u32 s16, s49, 73728
    buffer_load_dwordx4 v112, s[8:11], s16 offen lds
    s_add_u32 m0, s19, 148240
    s_add_u32 s16, s49, 74752
    buffer_load_dwordx4 v112, s[8:11], s16 offen lds
    s_add_u32 m0, s19, 149280
    s_add_u32 s16, s49, 75776
    buffer_load_dwordx4 v112, s[8:11], s16 offen lds
    s_add_u32 m0, s19, 150320
    s_add_u32 s16, s49, 76800
    buffer_load_dwordx4 v112, s[8:11], s16 offen lds
    v_add_u32 v115, 47360, v113
    ds_read_b64_tr_b16 v[144:145], v115 offset:0
    ds_read_b64_tr_b16 v[146:147], v115 offset:512
    ds_read_b64_tr_b16 v[148:149], v115 offset:8320
    ds_read_b64_tr_b16 v[150:151], v115 offset:8832
    ds_read_b64_tr_b16 v[152:153], v115 offset:32
    ds_read_b64_tr_b16 v[154:155], v115 offset:544
    ds_read_b64_tr_b16 v[156:157], v115 offset:8352
    ds_read_b64_tr_b16 v[158:159], v115 offset:8864
    s_waitcnt vmcnt(21)
    s_waitcnt lgkmcnt(0)
    s_barrier
    s_mul_i32 s19, s13, 4160
    s_add_u32 m0, s19, 47360
    s_add_u32 s16, s49, 98304
    buffer_load_dwordx4 v112, s[8:11], s16 offen lds
    s_add_u32 m0, s19, 48400
    s_add_u32 s16, s49, 99328
    buffer_load_dwordx4 v112, s[8:11], s16 offen lds
    s_add_u32 m0, s19, 49440
    s_add_u32 s16, s49, 100352
    buffer_load_dwordx4 v112, s[8:11], s16 offen lds
    s_add_u32 m0, s19, 50480
    s_add_u32 s16, s49, 101376
    buffer_load_dwordx4 v112, s[8:11], s16 offen lds
    v_add_u32 v115, 64000, v114
    ds_read_b64_tr_b16 v[160:161], v115 offset:0
    ds_read_b64_tr_b16 v[162:163], v115 offset:2080
    ds_read_b64_tr_b16 v[192:193], v115 offset:256
    ds_read_b64_tr_b16 v[194:195], v115 offset:2336
    ds_read_b64_tr_b16 v[224:225], v115 offset:512
    ds_read_b64_tr_b16 v[226:227], v115 offset:2592
    ds_read_b64_tr_b16 v[16:17], v115 offset:768
    ds_read_b64_tr_b16 v[18:19], v115 offset:2848
    s_waitcnt vmcnt(21)
    s_waitcnt lgkmcnt(0)
    s_barrier
    s_mul_i32 s19, s13, 4160
    s_add_u32 m0, s19, 64000
    s_add_u32 s16, s49, 106496
    buffer_load_dwordx4 v112, s[8:11], s16 offen lds
    s_add_u32 m0, s19, 65040
    s_add_u32 s16, s49, 107520
    buffer_load_dwordx4 v112, s[8:11], s16 offen lds
    s_add_u32 m0, s19, 66080
    s_add_u32 s16, s49, 108544
    buffer_load_dwordx4 v112, s[8:11], s16 offen lds
    s_add_u32 m0, s19, 67120
    s_add_u32 s16, s49, 109568
    buffer_load_dwordx4 v112, s[8:11], s16 offen lds
    v_add_u32 v115, 80640, v114
    ds_read_b64_tr_b16 v[164:165], v115 offset:0
    ds_read_b64_tr_b16 v[166:167], v115 offset:2080
    ds_read_b64_tr_b16 v[196:197], v115 offset:256
    ds_read_b64_tr_b16 v[198:199], v115 offset:2336
    ds_read_b64_tr_b16 v[228:229], v115 offset:512
    ds_read_b64_tr_b16 v[230:231], v115 offset:2592
    ds_read_b64_tr_b16 v[20:21], v115 offset:768
    ds_read_b64_tr_b16 v[22:23], v115 offset:2848
    s_waitcnt vmcnt(21)
    s_waitcnt lgkmcnt(0)
    s_barrier
    s_load_dwordx2 s[8:9], s[0:1], 16
    s_mov_b32 s10, 4194304
    s_mov_b32 s11, 0x20000
    s_waitcnt lgkmcnt(0)
    v_lshrrev_b32 v123, 8, v0
    v_lshl_add_u32 v123, s13, 4, v123
    v_mul_u32_u24 v123, 8192, v123
    v_and_b32 v112, 0xf0, v0
    v_add_u32 v112, v123, v112
    s_mul_i32 s19, s13, 4160
    s_add_u32 m0, s19, 80640
    s_add_u32 s16, s48, 0
    buffer_load_dwordx4 v112, s[8:11], s16 offen lds
    s_add_u32 m0, s19, 81680
    s_add_u32 s16, s48, 32768
    buffer_load_dwordx4 v112, s[8:11], s16 offen lds
    s_add_u32 m0, s19, 82720
    s_add_u32 s16, s48, 65536
    buffer_load_dwordx4 v112, s[8:11], s16 offen lds
    s_add_u32 m0, s19, 83760
    s_add_u32 s16, s48, 98304
    buffer_load_dwordx4 v112, s[8:11], s16 offen lds
    v_add_u32 v115, 97280, v114
    ds_read_b64_tr_b16 v[168:169], v115 offset:0
    ds_read_b64_tr_b16 v[170:171], v115 offset:2080
    ds_read_b64_tr_b16 v[200:201], v115 offset:256
    ds_read_b64_tr_b16 v[202:203], v115 offset:2336
    ds_read_b64_tr_b16 v[232:233], v115 offset:512
    ds_read_b64_tr_b16 v[234:235], v115 offset:2592
    ds_read_b64_tr_b16 v[24:25], v115 offset:768
    ds_read_b64_tr_b16 v[26:27], v115 offset:2848
    s_waitcnt vmcnt(21)
    s_waitcnt lgkmcnt(0)
    s_barrier
    s_mul_i32 s19, s13, 4160
    s_add_u32 m0, s19, 97280
    s_add_u32 s16, s48, 524288
    buffer_load_dwordx4 v112, s[8:11], s16 offen lds
    s_add_u32 m0, s19, 98320
    s_add_u32 s16, s48, 557056
    buffer_load_dwordx4 v112, s[8:11], s16 offen lds
    s_add_u32 m0, s19, 99360
    s_add_u32 s16, s48, 589824
    buffer_load_dwordx4 v112, s[8:11], s16 offen lds
    s_add_u32 m0, s19, 100400
    s_add_u32 s16, s48, 622592
    buffer_load_dwordx4 v112, s[8:11], s16 offen lds
    v_add_u32 v115, 113920, v114
    ds_read_b64_tr_b16 v[172:173], v115 offset:0
    ds_read_b64_tr_b16 v[174:175], v115 offset:2080
    ds_read_b64_tr_b16 v[204:205], v115 offset:256
    ds_read_b64_tr_b16 v[206:207], v115 offset:2336
    ds_read_b64_tr_b16 v[236:237], v115 offset:512
    ds_read_b64_tr_b16 v[238:239], v115 offset:2592
    ds_read_b64_tr_b16 v[28:29], v115 offset:768
    ds_read_b64_tr_b16 v[30:31], v115 offset:2848
    s_waitcnt vmcnt(20)
    s_waitcnt lgkmcnt(0)
    s_barrier
    s_mul_i32 s19, s13, 4160
    s_add_u32 m0, s19, 113920
    s_add_u32 s16, s48, 1048576
    buffer_load_dwordx4 v112, s[8:11], s16 offen lds
    s_add_u32 m0, s19, 114960
    s_add_u32 s16, s48, 1081344
    buffer_load_dwordx4 v112, s[8:11], s16 offen lds
    s_add_u32 m0, s19, 116000
    s_add_u32 s16, s48, 1114112
    buffer_load_dwordx4 v112, s[8:11], s16 offen lds
    s_add_u32 m0, s19, 117040
    s_add_u32 s16, s48, 1146880
    buffer_load_dwordx4 v112, s[8:11], s16 offen lds
    v_add_u32 v115, 130560, v114
    ds_read_b64_tr_b16 v[176:177], v115 offset:0
    ds_read_b64_tr_b16 v[178:179], v115 offset:2080
    ds_read_b64_tr_b16 v[208:209], v115 offset:256
    ds_read_b64_tr_b16 v[210:211], v115 offset:2336
    ds_read_b64_tr_b16 v[240:241], v115 offset:512
    ds_read_b64_tr_b16 v[242:243], v115 offset:2592
    ds_read_b64_tr_b16 v[32:33], v115 offset:768
    ds_read_b64_tr_b16 v[34:35], v115 offset:2848
    s_cmp_lg_u32 s59, 0
    s_cbranch_scc1 L_vok_258
    s_branch L_vc_260
L_vp_257:
    v_and_b32 v118, 0xf0, v0
    global_load_dwordx2 v[116:117], v118, s[56:57] sc1
    s_waitcnt vmcnt(0)
L_vc_260:
    v_lshrrev_b32 v119, 8, v117
    s_nop 1
    v_add_u32_dpp v119, v119, v119 quad_perm:[1,0,3,2] row_mask:0xf bank_mask:0xf
    s_nop 1
    v_add_u32_dpp v119, v119, v119 quad_perm:[2,3,0,1] row_mask:0xf bank_mask:0xf
    s_nop 1
    v_add_u32_dpp v119, v119, v119 row_half_mirror row_mask:0xf bank_mask:0xf
    s_nop 1
    v_add_u32_dpp v119, v119, v119 row_mirror row_mask:0xf bank_mask:0xf
    v_cmp_ne_u32 vcc, 0x100, v119
    s_cbranch_vccz L_vgo_259
    s_add_u32 s40, s40, 1
    s_cmp_gt_u32 s40, 262144
    s_cbranch_scc1 L_abort
    s_sleep 2
    s_branch L_vp_257
L_vgo_259:
    s_mov_b32 s59, 1
    v_cmp_ne_u32 vcc, -1, v116
    s_and_b32 s16, vcc_lo, 0x5555
    v_cmp_ne_u32 vcc, 0x2000, v117
    s_and_b32 s17, vcc_lo, 0x5555
    s_or_b32 s16, s16, s17
    s_cbranch_scc0 L_vok_258
    v_lshrrev_b32 v119, 8, v117
    v_cmp_ne_u32 vcc, 32, v119
    s_and_b32 s60, vcc_lo, 0x5555
    s_branch L_redo
L_vok_258:
    v_mov_b32 v116, 0
    v_mov_b32 v117, 0
    v_mov_b32 v118, 0
    v_mov_b32 v119, 0
    v_mov_b32 v120, -1
    buffer_store_dwordx2 v[116:117], v9, s[4:7], s20 offen sc1
    buffer_store_dwordx2 v[116:117], v9, s[4:7], s21 offen sc1
    buffer_store_dwordx2 v[116:117], v9, s[4:7], s25 offen sc1
    buffer_store_dwordx2 v[116:117], v9, s[4:7], s37 offen sc1
    s_add_u32 s16, s26, s30
    buffer_store_dword v120, v11, s[4:7], s16 offen sc1
    s_add_u32 s16, s27, s30
    buffer_store_dword v120, v11, s[4:7], s16 offen sc1
    s_add_u32 s16, s28, s30
    buffer_store_dword v120, v11, s[4:7], s16 offen sc1
    s_waitcnt vmcnt(27)
    s_waitcnt lgkmcnt(0)
    s_barrier
    s_mul_i32 s19, s13, 4160
    s_add_u32 m0, s19, 130560
    s_add_u32 s16, s48, 1572864
    buffer_load_dwordx4 v112, s[8:11], s16 offen lds
    s_add_u32 m0, s19, 131600
    s_add_u32 s16, s48, 1605632
    buffer_load_dwordx4 v112, s[8:11], s16 offen lds
    s_add_u32 m0, s19, 132640
    s_add_u32 s16, s48, 1638400
    buffer_load_dwordx4 v112, s[8:11], s16 offen lds
    s_add_u32 m0, s19, 133680
    s_add_u32 s16, s48, 1671168
    buffer_load_dwordx4 v112, s[8:11], s16 offen lds
    v_add_u32 v115, 147200, v114
    ds_read_b64_tr_b16 v[180:181], v115 offset:0
    ds_read_b64_tr_b16 v[182:183], v115 offset:2080
    ds_read_b64_tr_b16 v[212:213], v115 offset:256
    ds_read_b64_tr_b16 v[214:215], v115 offset:2336
    ds_read_b64_tr_b16 v[244:245], v115 offset:512
    ds_read_b64_tr_b16 v[246:247], v115 offset:2592
    ds_read_b64_tr_b16 v[36:37], v115 offset:768
    ds_read_b64_tr_b16 v[38:39], v115 offset:2848
    s_waitcnt vmcnt(27)
    s_waitcnt lgkmcnt(0)
    s_barrier
    s_mul_i32 s19, s13, 4160
    s_add_u32 m0, s19, 147200
    s_add_u32 s16, s48, 2097152
    buffer_load_dwordx4 v112, s[8:11], s16 offen lds
    s_add_u32 m0, s19, 148240
    s_add_u32 s16, s48, 2129920
    buffer_load_dwordx4 v112, s[8:11], s16 offen lds
    s_add_u32 m0, s19, 149280
    s_add_u32 s16, s48, 2162688
    buffer_load_dwordx4 v112, s[8:11], s16 offen lds
    s_add_u32 m0, s19, 150320
    s_add_u32 s16, s48, 2195456
    buffer_load_dwordx4 v112, s[8:11], s16 offen lds
    v_add_u32 v115, 47360, v114
    ds_read_b64_tr_b16 v[184:185], v115 offset:0
    ds_read_b64_tr_b16 v[186:187], v115 offset:2080
    ds_read_b64_tr_b16 v[216:217], v115 offset:256
    ds_read_b64_tr_b16 v[218:219], v115 offset:2336
    ds_read_b64_tr_b16 v[248:249], v115 offset:512
    ds_read_b64_tr_b16 v[250:251], v115 offset:2592
    ds_read_b64_tr_b16 v[40:41], v115 offset:768
    ds_read_b64_tr_b16 v[42:43], v115 offset:2848
    s_waitcnt vmcnt(27)
    s_waitcnt lgkmcnt(0)
    s_barrier
    s_mul_i32 s19, s13, 4160
    s_add_u32 m0, s19, 47360
    s_add_u32 s16, s48, 2621440
    buffer_load_dwordx4 v112, s[8:11], s16 offen lds
    s_add_u32 m0, s19, 48400
    s_add_u32 s16, s48, 2654208
    buffer_load_dwordx4 v112, s[8:11], s16 offen lds
    s_add_u32 m0, s19, 49440
    s_add_u32 s16, s48, 2686976
    buffer_load_dwordx4 v112, s[8:11], s16 offen lds
    s_add_u32 m0, s19, 50480
    s_add_u32 s16, s48, 2719744
    buffer_load_dwordx4 v112, s[8:11], s16 offen lds
    v_add_u32 v115, 64000, v114
    ds_read_b64_tr_b16 v[188:189], v115 offset:0
    ds_read_b64_tr_b16 v[190:191], v115 offset:2080
    ds_read_b64_tr_b16 v[220:221], v115 offset:256
    ds_read_b64_tr_b16 v[222:223], v115 offset:2336
    ds_read_b64_tr_b16 v[252:253], v115 offset:512
    ds_read_b64_tr_b16 v[254:255], v115 offset:2592
    ds_read_b64_tr_b16 v[44:45], v115 offset:768
    ds_read_b64_tr_b16 v[46:47], v115 offset:2848
    s_waitcnt lgkmcnt(0)
    ds_write_b128 v0, v[16:19] offset:0
    ds_write_b128 v0, v[20:23] offset:1024
    ds_write_b128 v0, v[24:27] offset:8192
    ds_write_b128 v0, v[28:31] offset:9216
    ds_write_b128 v0, v[32:35] offset:16384
    ds_write_b128 v0, v[36:39] offset:17408
    ds_write_b128 v0, v[40:43] offset:24576
    ds_write_b128 v0, v[44:47] offset:25600
    s_waitcnt vmcnt(27)
    s_waitcnt lgkmcnt(0)
    s_barrier
    s_mul_i32 s19, s13, 4160
    s_add_u32 m0, s19, 64000
    s_add_u32 s16, s48, 3145728
    buffer_load_dwordx4 v112, s[8:11], s16 offen lds
    s_add_u32 m0, s19, 65040
    s_add_u32 s16, s48, 3178496
    buffer_load_dwordx4 v112, s[8:11], s16 offen lds
    s_add_u32 m0, s19, 66080
    s_add_u32 s16, s48, 3211264
    buffer_load_dwordx4 v112, s[8:11], s16 offen lds
    s_add_u32 m0, s19, 67120
    s_add_u32 s16, s48, 3244032
    buffer_load_dwordx4 v112, s[8:11], s16 offen lds
    v_add_u32 v115, 80640, v113
    ds_read_b64_tr_b16 v[16:17], v115 offset:0
    ds_read_b64_tr_b16 v[18:19], v115 offset:512
    ds_read_b64_tr_b16 v[20:21], v115 offset:8320
    ds_read_b64_tr_b16 v[22:23], v115 offset:8832
    ds_read_b64_tr_b16 v[24:25], v115 offset:32
    ds_read_b64_tr_b16 v[26:27], v115 offset:544
    ds_read_b64_tr_b16 v[28:29], v115 offset:8352
    ds_read_b64_tr_b16 v[30:31], v115 offset:8864
    v_lshlrev_b32 v124, 16, v0
    s_lshl_b32 s16, s13, 26
    s_add_u32 s16, s16, 1048448
    buffer_load_dword v124, v124, s[4:7], s16 offen sc1
    s_waitcnt vmcnt(28)
    s_waitcnt lgkmcnt(0)
    s_barrier
    s_mul_i32 s19, s13, 4160
    s_add_u32 m0, s19, 80640
    s_add_u32 s16, s48, 3670016
    buffer_load_dwordx4 v112, s[8:11], s16 offen lds
    s_add_u32 m0, s19, 81680
    s_add_u32 s16, s48, 3702784
    buffer_load_dwordx4 v112, s[8:11], s16 offen lds
    s_add_u32 m0, s19, 82720
    s_add_u32 s16, s48, 3735552
    buffer_load_dwordx4 v112, s[8:11], s16 offen lds
    s_add_u32 m0, s19, 83760
    s_add_u32 s16, s48, 3768320
    buffer_load_dwordx4 v112, s[8:11], s16 offen lds
    v_add_u32 v115, 97280, v113
    ds_read_b64_tr_b16 v[32:33], v115 offset:0
    ds_read_b64_tr_b16 v[34:35], v115 offset:512
    ds_read_b64_tr_b16 v[36:37], v115 offset:8320
    ds_read_b64_tr_b16 v[38:39], v115 offset:8832
    ds_read_b64_tr_b16 v[40:41], v115 offset:32
    ds_read_b64_tr_b16 v[42:43], v115 offset:544
    ds_read_b64_tr_b16 v[44:45], v115 offset:8352
    ds_read_b64_tr_b16 v[46:47], v115 offset:8864
    s_waitcnt vmcnt(28)
    s_waitcnt lgkmcnt(0)
    s_barrier
    s_load_dwordx2 s[8:9], s[0:1], 24
    s_mov_b32 s10, 4194304
    s_mov_b32 s11, 0x20000
    s_waitcnt lgkmcnt(0)
    v_lshrrev_b32 v123, 8, v0
    v_lshl_add_u32 v123, s13, 4, v123
    v_mul_u32_u24 v123, 8192, v123
    v_and_b32 v112, 0xf0, v0
    v_add_u32 v112, v123, v112
    s_mul_i32 s19, s13, 4160
    s_add_u32 m0, s19, 97280
    s_add_u32 s16, s48, 0
    buffer_load_dwordx4 v112, s[8:11], s16 offen lds
    s_add_u32 m0, s19, 98320
    s_add_u32 s16, s48, 32768
    buffer_load_dwordx4 v112, s[8:11], s16 offen lds
    s_add_u32 m0, s19, 99360
    s_add_u32 s16, s48, 65536
    buffer_load_dwordx4 v112, s[8:11], s16 offen lds
    s_add_u32 m0, s19, 100400
    s_add_u32 s16, s48, 98304
    buffer_load_dwordx4 v112, s[8:11], s16 offen lds
    v_add_u32 v115, 113920, v113
    ds_read_b64_tr_b16 a[0:1], v115 offset:0
    ds_read_b64_tr_b16 a[2:3], v115 offset:512
    ds_read_b64_tr_b16 a[4:5], v115 offset:8320
    ds_read_b64_tr_b16 a[6:7], v115 offset:8832
    ds_read_b64_tr_b16 a[8:9], v115 offset:32
    ds_read_b64_tr_b16 a[10:11], v115 offset:544
    ds_read_b64_tr_b16 a[12:13], v115 offset:8352
    ds_read_b64_tr_b16 a[14:15], v115 offset:8864
    s_waitcnt vmcnt(21)
    s_waitcnt lgkmcnt(0)
    s_barrier
    s_mul_i32 s19, s13, 4160
    s_add_u32 m0, s19, 113920
    s_add_u32 s16, s48, 524288
    buffer_load_dwordx4 v112, s[8:11], s16 offen lds
    s_add_u32 m0, s19, 114960
    s_add_u32 s16, s48, 557056
    buffer_load_dwordx4 v112, s[8:11], s16 offen lds
    s_add_u32 m0, s19, 116000
    s_add_u32 s16, s48, 589824
    buffer_load_dwordx4 v112, s[8:11], s16 offen lds
    s_add_u32 m0, s19, 117040
    s_add_u32 s16, s48, 622592
    buffer_load_dwordx4 v112, s[8:11], s16 offen lds
    v_add_u32 v115, 130560, v113
    ds_read_b64_tr_b16 a[16:17], v115 offset:0
    ds_read_b64_tr_b16 a[18:19], v115 offset:512
    ds_read_b64_tr_b16 a[20:21], v115 offset:8320
    ds_read_b64_tr_b16 a[22:23], v115 offset:8832
    ds_read_b64_tr_b16 a[24:25], v115 offset:32
    ds_read_b64_tr_b16 a[26:27], v115 offset:544
    ds_read_b64_tr_b16 a[28:29], v115 offset:8352
    ds_read_b64_tr_b16 a[30:31], v115 offset:8864
    s_lshl_b32 s16, s12, 2
    s_add_u32 s16, s16, s13
    s_lshl_b32 s16, s16, 2
    s_add_u32 s16, s16, 24576
    v_mov_b32 v121, 1
    s_mov_b64 exec, 1
    buffer_store_dword v121, off, s[4:7], s16 sc1
    s_mov_b64 exec, -1
    s_waitcnt vmcnt(22)
    s_waitcnt lgkmcnt(0)
    s_barrier
    s_mul_i32 s19, s13, 4160
    s_add_u32 m0, s19, 130560
    s_add_u32 s16, s48, 1048576
    buffer_load_dwordx4 v112, s[8:11], s16 offen lds
    s_add_u32 m0, s19, 131600
    s_add_u32 s16, s48, 1081344
    buffer_load_dwordx4 v112, s[8:11], s16 offen lds
    s_add_u32 m0, s19, 132640
    s_add_u32 s16, s48, 1114112
    buffer_load_dwordx4 v112, s[8:11], s16 offen lds
    s_add_u32 m0, s19, 133680
    s_add_u32 s16, s48, 1146880
    buffer_load_dwordx4 v112, s[8:11], s16 offen lds
    v_add_u32 v115, 147200, v113
    ds_read_b64_tr_b16 a[32:33], v115 offset:0
    ds_read_b64_tr_b16 a[34:35], v115 offset:512
    ds_read_b64_tr_b16 a[36:37], v115 offset:8320
    ds_read_b64_tr_b16 a[38:39], v115 offset:8832
    ds_read_b64_tr_b16 a[40:41], v115 offset:32
    ds_read_b64_tr_b16 a[42:43], v115 offset:544
    ds_read_b64_tr_b16 a[44:45], v115 offset:8352
    ds_read_b64_tr_b16 a[46:47], v115 offset:8864
    s_waitcnt vmcnt(22)
    s_waitcnt lgkmcnt(0)
    s_barrier
    s_mul_i32 s19, s13, 4160
    s_add_u32 m0, s19, 147200
    s_add_u32 s16, s48, 1572864
    buffer_load_dwordx4 v112, s[8:11], s16 offen lds
    s_add_u32 m0, s19, 148240
    s_add_u32 s16, s48, 1605632
    buffer_load_dwordx4 v112, s[8:11], s16 offen lds
    s_add_u32 m0, s19, 149280
    s_add_u32 s16, s48, 1638400
    buffer_load_dwordx4 v112, s[8:11], s16 offen lds
    s_add_u32 m0, s19, 150320
    s_add_u32 s16, s48, 1671168
    buffer_load_dwordx4 v112, s[8:11], s16 offen lds
    v_add_u32 v115, 47360, v113
    ds_read_b64_tr_b16 a[48:49], v115 offset:0
    ds_read_b64_tr_b16 a[50:51], v115 offset:512
    ds_read_b64_tr_b16 a[52:53], v115 offset:8320
    ds_read_b64_tr_b16 a[54:55], v115 offset:8832
    ds_read_b64_tr_b16 a[56:57], v115 offset:32
    ds_read_b64_tr_b16 a[58:59], v115 offset:544
    ds_read_b64_tr_b16 a[60:61], v115 offset:8352
    ds_read_b64_tr_b16 a[62:63], v115 offset:8864
    s_waitcnt vmcnt(22)
    s_waitcnt lgkmcnt(0)
    s_barrier
    s_mul_i32 s19, s13, 4160
    s_add_u32 m0, s19, 47360
    s_add_u32 s16, s48, 2097152
    buffer_load_dwordx4 v112, s[8:11], s16 offen lds
    s_add_u32 m0, s19, 48400
    s_add_u32 s16, s48, 2129920
    buffer_load_dwordx4 v112, s[8:11], s16 offen lds
    s_add_u32 m0, s19, 49440
    s_add_u32 s16, s48, 2162688
    buffer_load_dwordx4 v112, s[8:11], s16 offen lds
    s_add_u32 m0, s19, 50480
    s_add_u32 s16, s48, 2195456
    buffer_load_dwordx4 v112, s[8:11], s16 offen lds
    v_add_u32 v115, 64000, v113
    ds_read_b64_tr_b16 a[64:65], v115 offset:0
    ds_read_b64_tr_b16 a[66:67], v115 offset:512
    ds_read_b64_tr_b16 a[68:69], v115 offset:8320
    ds_read_b64_tr_b16 a[70:71], v115 offset:8832
    ds_read_b64_tr_b16 a[72:73], v115 offset:32
    ds_read_b64_tr_b16 a[74:75], v115 offset:544
    ds_read_b64_tr_b16 a[76:77], v115 offset:8352
    ds_read_b64_tr_b16 a[78:79], v115 offset:8864
    s_waitcnt vmcnt(21)
    s_waitcnt lgkmcnt(0)
    s_barrier
    s_mul_i32 s19, s13, 4160
    s_add_u32 m0, s19, 64000
    s_add_u32 s16, s48, 2621440
    buffer_load_dwordx4 v112, s[8:11], s16 offen lds
    s_add_u32 m0, s19, 65040
    s_add_u32 s16, s48, 2654208
    buffer_load_dwordx4 v112, s[8:11], s16 offen lds
    s_add_u32 m0, s19, 66080
    s_add_u32 s16, s48, 2686976
    buffer_load_dwordx4 v112, s[8:11], s16 offen lds
    s_add_u32 m0, s19, 67120
    s_add_u32 s16, s48, 2719744
    buffer_load_dwordx4 v112, s[8:11], s16 offen lds
    v_add_u32 v115, 80640, v113
    ds_read_b64_tr_b16 a[80:81], v115 offset:0
    ds_read_b64_tr_b16 a[82:83], v115 offset:512
    ds_read_b64_tr_b16 a[84:85], v115 offset:8320
    ds_read_b64_tr_b16 a[86:87], v115 offset:8832
    ds_read_b64_tr_b16 a[88:89], v115 offset:32
    ds_read_b64_tr_b16 a[90:91], v115 offset:544
    ds_read_b64_tr_b16 a[92:93], v115 offset:8352
    ds_read_b64_tr_b16 a[94:95], v115 offset:8864
    s_waitcnt vmcnt(21)
    s_waitcnt lgkmcnt(0)
    s_barrier
    s_mul_i32 s19, s13, 4160
    s_add_u32 m0, s19, 80640
    s_add_u32 s16, s48, 3145728
    buffer_load_dwordx4 v112, s[8:11], s16 offen lds
    s_add_u32 m0, s19, 81680
    s_add_u32 s16, s48, 3178496
    buffer_load_dwordx4 v112, s[8:11], s16 offen lds
    s_add_u32 m0, s19, 82720
    s_add_u32 s16, s48, 3211264
    buffer_load_dwordx4 v112, s[8:11], s16 offen lds
    s_add_u32 m0, s19, 83760
    s_add_u32 s16, s48, 3244032
    buffer_load_dwordx4 v112, s[8:11], s16 offen lds
    v_add_u32 v115, 97280, v113
    ds_read_b64_tr_b16 v[48:49], v115 offset:0
    ds_read_b64_tr_b16 v[50:51], v115 offset:512
    ds_read_b64_tr_b16 v[52:53], v115 offset:8320
    ds_read_b64_tr_b16 v[54:55], v115 offset:8832
    ds_read_b64_tr_b16 v[56:57], v115 offset:32
    ds_read_b64_tr_b16 v[58:59], v115 offset:544
    ds_read_b64_tr_b16 v[60:61], v115 offset:8352
    ds_read_b64_tr_b16 v[62:63], v115 offset:8864
    s_waitcnt vmcnt(21)
    s_waitcnt lgkmcnt(0)
    s_barrier
    s_mul_i32 s19, s13, 4160
    s_add_u32 m0, s19, 97280
    s_add_u32 s16, s48, 3670016
    buffer_load_dwordx4 v112, s[8:11], s16 offen lds
    s_add_u32 m0, s19, 98320
    s_add_u32 s16, s48, 3702784
    buffer_load_dwordx4 v112, s[8:11], s16 offen lds
    s_add_u32 m0, s19, 99360
    s_add_u32 s16, s48, 3735552
    buffer_load_dwordx4 v112, s[8:11], s16 offen lds
    s_add_u32 m0, s19, 100400
    s_add_u32 s16, s48, 3768320
    buffer_load_dwordx4 v112, s[8:11], s16 offen lds
    v_add_u32 v115, 113920, v113
    ds_read_b64_tr_b16 v[72:73], v115 offset:0
    ds_read_b64_tr_b16 v[74:75], v115 offset:512
    ds_read_b64_tr_b16 v[76:77], v115 offset:8320
    ds_read_b64_tr_b16 v[78:79], v115 offset:8832
    ds_read_b64_tr_b16 a[96:97], v115 offset:32
    ds_read_b64_tr_b16 a[98:99], v115 offset:544
    ds_read_b64_tr_b16 a[100:101], v115 offset:8352
    ds_read_b64_tr_b16 a[102:103], v115 offset:8864
    s_waitcnt vmcnt(20)
    s_waitcnt lgkmcnt(0)
    s_barrier
    v_add_u32 v115, 130560, v113
    ds_read_b64_tr_b16 v[80:81], v115 offset:0
    ds_read_b64_tr_b16 v[82:83], v115 offset:512
    ds_read_b64_tr_b16 v[84:85], v115 offset:8320
    ds_read_b64_tr_b16 v[86:87], v115 offset:8832
    ds_read_b64_tr_b16 a[104:105], v115 offset:32
    ds_read_b64_tr_b16 a[106:107], v115 offset:544
    ds_read_b64_tr_b16 a[108:109], v115 offset:8352
    ds_read_b64_tr_b16 a[110:111], v115 offset:8864
    s_waitcnt vmcnt(16)
    s_waitcnt lgkmcnt(0)
    s_barrier
    v_add_u32 v115, 147200, v113
    ds_read_b64_tr_b16 v[88:89], v115 offset:0
    ds_read_b64_tr_b16 v[90:91], v115 offset:512
    ds_read_b64_tr_b16 v[92:93], v115 offset:8320
    ds_read_b64_tr_b16 v[94:95], v115 offset:8832
    ds_read_b64_tr_b16 a[112:113], v115 offset:32
    ds_read_b64_tr_b16 a[114:115], v115 offset:544
    ds_read_b64_tr_b16 a[116:117], v115 offset:8352
    ds_read_b64_tr_b16 a[118:119], v115 offset:8864
    s_waitcnt vmcnt(12)
    s_waitcnt lgkmcnt(0)
    s_barrier
    v_add_u32 v115, 47360, v113
    ds_read_b64_tr_b16 v[96:97], v115 offset:0
    ds_read_b64_tr_b16 v[98:99], v115 offset:512
    ds_read_b64_tr_b16 v[100:101], v115 offset:8320
    ds_read_b64_tr_b16 v[102:103], v115 offset:8832
    ds_read_b64_tr_b16 a[120:121], v115 offset:32
    ds_read_b64_tr_b16 a[122:123], v115 offset:544
    ds_read_b64_tr_b16 a[124:125], v115 offset:8352
    ds_read_b64_tr_b16 a[126:127], v115 offset:8864
    s_waitcnt vmcnt(8)
    s_waitcnt lgkmcnt(0)
    s_barrier
    v_add_u32 v115, 64000, v113
    ds_read_b64_tr_b16 a[128:129], v115 offset:0
    ds_read_b64_tr_b16 a[130:131], v115 offset:512
    ds_read_b64_tr_b16 a[132:133], v115 offset:8320
    ds_read_b64_tr_b16 a[134:135], v115 offset:8832
    ds_read_b64_tr_b16 a[136:137], v115 offset:32
    ds_read_b64_tr_b16 a[138:139], v115 offset:544
    ds_read_b64_tr_b16 a[140:141], v115 offset:8352
    ds_read_b64_tr_b16 a[142:143], v115 offset:8864
    v_lshrrev_b32 v118, 1, v0
    s_mov_b32 s16, 24576
    buffer_load_dwordx2 v[116:117], v118, s[4:7], s16 offen sc1
    s_load_dwordx2 s[8:9], s[0:1], 8
    s_mov_b32 s10, 8192
    s_mov_b32 s11, 0x20000
    s_waitcnt lgkmcnt(0)
    v_lshlrev_b32 v119, 3, v0
    buffer_load_dword v119, v119, s[8:11], 0 offen
    s_waitcnt vmcnt(6)
    s_waitcnt lgkmcnt(0)
    s_barrier
    v_add_u32 v115, 80640, v113
    ds_read_b64_tr_b16 a[144:145], v115 offset:0
    ds_read_b64_tr_b16 a[146:147], v115 offset:512
    ds_read_b64_tr_b16 a[148:149], v115 offset:8320
    ds_read_b64_tr_b16 a[150:151], v115 offset:8832
    ds_read_b64_tr_b16 a[152:153], v115 offset:32
    ds_read_b64_tr_b16 a[154:155], v115 offset:544
    ds_read_b64_tr_b16 a[156:157], v115 offset:8352
    ds_read_b64_tr_b16 a[158:159], v115 offset:8864
    s_waitcnt vmcnt(2)
    s_waitcnt lgkmcnt(0)
    s_barrier
    v_add_u32 v115, 97280, v113
    ds_read_b64_tr_b16 a[160:161], v115 offset:0
    ds_read_b64_tr_b16 a[162:163], v115 offset:512
    ds_read_b64_tr_b16 a[164:165], v115 offset:8320
    ds_read_b64_tr_b16 a[166:167], v115 offset:8832
    ds_read_b64_tr_b16 v[104:105], v115 offset:32
    ds_read_b64_tr_b16 v[106:107], v115 offset:544
    ds_read_b64_tr_b16 v[108:109], v115 offset:8352
    ds_read_b64_tr_b16 v[110:111], v115 offset:8864
    s_waitcnt lgkmcnt(0)
    s_barrier
    s_waitcnt lgkmcnt(0)
    ds_write_b128 v0, v[16:19] offset:32768
    ds_write_b128 v0, v[20:23] offset:33792
    ds_write_b128 v0, v[24:27] offset:40960
    ds_write_b128 v0, v[28:31] offset:41984
    ds_write_b128 v0, v[32:35] offset:49152
    ds_write_b128 v0, v[36:39] offset:50176
    ds_write_b128 v0, v[40:43] offset:57344
    ds_write_b128 v0, v[44:47] offset:58368
    ds_write_b128 v1, v[48:51] offset:0
    ds_write_b128 v1, v[52:55] offset:1024
    ds_write_b128 v1, v[56:59] offset:8192
    ds_write_b128 v1, v[60:63] offset:9216
    ds_write_b128 v1, v[64:67] offset:16384
    ds_write_b128 v1, v[68:71] offset:17408
    ds_write_b128 v1, v[72:75] offset:24576
    ds_write_b128 v1, v[76:79] offset:25600
    ds_write_b128 v1, v[80:83] offset:32768
    ds_write_b128 v1, v[84:87] offset:33792
    ds_write_b128 v1, v[88:91] offset:40960
    ds_write_b128 v1, v[92:95] offset:41984
    ds_write_b128 v1, v[96:99] offset:49152
    ds_write_b128 v1, v[100:103] offset:50176
    ds_write_b128 v1, v[104:107] offset:57344
    ds_write_b128 v1, v[108:111] offset:58368
    s_branch L_lwe_256
L_lw1_253:
    s_load_dwordx2 s[8:9], s[0:1], 32
    s_mov_b32 s10, 4194304
    s_mov_b32 s11, 0x20000
    s_waitcnt lgkmcnt(0)
    v_lshrrev_b32 v123, 8, v0
    v_lshl_add_u32 v123, s13, 4, v123
    v_mul_u32_u24 v123, 8192, v123
    v_and_b32 v112, 0xf0, v0
    v_add_u32 v112, v123, v112
    s_mul_i32 s19, s13, 4160
    s_add_u32 m0, s19, 47360
    s_add_u32 s16, s48, 0
    buffer_load_dwordx4 v112, s[8:11], s16 offen lds
    s_add_u32 m0, s19, 48400
    s_add_u32 s16, s48, 32768
    buffer_load_dwordx4 v112, s[8:11], s16 offen lds
    s_add_u32 m0, s19, 49440
    s_add_u32 s16, s48, 65536
    buffer_load_dwordx4 v112, s[8:11], s16 offen lds
    s_add_u32 m0, s19, 50480
    s_add_u32 s16, s48, 98304
    buffer_load_dwordx4 v112, s[8:11], s16 offen lds
    s_mul_i32 s19, s13, 4160
    s_add_u32 m0, s19, 64000
    s_add_u32 s16, s48, 524288
    buffer_load_dwordx4 v112, s[8:11], s16 offen lds
    s_add_u32 m0, s19, 65040
    s_add_u32 s16, s48, 557056
    buffer_load_dwordx4 v112, s[8:11], s16 offen lds
    s_add_u32 m0, s19, 66080
    s_add_u32 s16, s48, 589824
    buffer_load_dwordx4 v112, s[8:11], s16 offen lds
    s_add_u32 m0, s19, 67120
    s_add_u32 s16, s48, 622592
    buffer_load_dwordx4 v112, s[8:11], s16 offen lds
    s_mul_i32 s19, s13, 4160
    s_add_u32 m0, s19, 80640
    s_add_u32 s16, s48, 1048576
    buffer_load_dwordx4 v112, s[8:11], s16 offen lds
    s_add_u32 m0, s19, 81680
    s_add_u32 s16, s48, 1081344
    buffer_load_dwordx4 v112, s[8:11], s16 offen lds
    s_add_u32 m0, s19, 82720
    s_add_u32 s16, s48, 1114112
    buffer_load_dwordx4 v112, s[8:11], s16 offen lds
    s_add_u32 m0, s19, 83760
    s_add_u32 s16, s48, 1146880
    buffer_load_dwordx4 v112, s[8:11], s16 offen lds
    s_mul_i32 s19, s13, 4160
    s_add_u32 m0, s19, 97280
    s_add_u32 s16, s48, 1572864
    buffer_load_dwordx4 v112, s[8:11], s16 offen lds
    s_add_u32 m0, s19, 98320
    s_add_u32 s16, s48, 1605632
    buffer_load_dwordx4 v112, s[8:11], s16 offen lds
    s_add_u32 m0, s19, 99360
    s_add_u32 s16, s48, 1638400
    buffer_load_dwordx4 v112, s[8:11], s16 offen lds
    s_add_u32 m0, s19, 100400
    s_add_u32 s16, s48, 1671168
    buffer_load_dwordx4 v112, s[8:11], s16 offen lds
    s_mul_i32 s19, s13, 4160
    s_add_u32 m0, s19, 113920
    s_add_u32 s16, s48, 2097152
    buffer_load_dwordx4 v112, s[8:11], s16 offen lds
    s_add_u32 m0, s19, 114960
    s_add_u32 s16, s48, 2129920
    buffer_load_dwordx4 v112, s[8:11], s16 offen lds
    s_add_u32 m0, s19, 116000
    s_add_u32 s16, s48, 2162688
    buffer_load_dwordx4 v112, s[8:11], s16 offen lds
    s_add_u32 m0, s19, 117040
    s_add_u32 s16, s48, 2195456
    buffer_load_dwordx4 v112, s[8:11], s16 offen lds
    s_mul_i32 s19, s13, 4160
    s_add_u32 m0, s19, 130560
    s_add_u32 s16, s48, 2621440
    buffer_load_dwordx4 v112, s[8:11], s16 offen lds
    s_add_u32 m0, s19, 131600
    s_add_u32 s16, s48, 2654208
    buffer_load_dwordx4 v112, s[8:11], s16 offen lds
    s_add_u32 m0, s19, 132640
    s_add_u32 s16, s48, 2686976
    buffer_load_dwordx4 v112, s[8:11], s16 offen lds
    s_add_u32 m0, s19, 133680
    s_add_u32 s16, s48, 2719744
    buffer_load_dwordx4 v112, s[8:11], s16 offen lds
    s_waitcnt vmcnt(20)
    s_waitcnt lgkmcnt(0)
    s_barrier
    s_mul_i32 s19, s13, 4160
    s_add_u32 m0, s19, 147200
    s_add_u32 s16, s48, 3145728
    buffer_load_dwordx4 v112, s[8:11], s16 offen lds
    s_add_u32 m0, s19, 148240
    s_add_u32 s16, s48, 3178496
    buffer_load_dwordx4 v112, s[8:11], s16 offen lds
    s_add_u32 m0, s19, 149280
    s_add_u32 s16, s48, 3211264
    buffer_load_dwordx4 v112, s[8:11], s16 offen lds
    s_add_u32 m0, s19, 150320
    s_add_u32 s16, s48, 3244032
    buffer_load_dwordx4 v112, s[8:11], s16 offen lds
    v_add_u32 v115, 47424, v113
    ds_read_b64_tr_b16 v[128:129], v115 offset:0
    ds_read_b64_tr_b16 v[130:131], v115 offset:512
    ds_read_b64_tr_b16 v[132:133], v115 offset:8320
    ds_read_b64_tr_b16 v[134:135], v115 offset:8832
    ds_read_b64_tr_b16 v[136:137], v115 offset:32
    ds_read_b64_tr_b16 v[138:139], v115 offset:544
    ds_read_b64_tr_b16 v[140:141], v115 offset:8352
    ds_read_b64_tr_b16 v[142:143], v115 offset:8864
    s_waitcnt vmcnt(20)
    s_waitcnt lgkmcnt(0)
    s_barrier
    s_mul_i32 s19, s13, 4160
    s_add_u32 m0, s19, 47360
    s_add_u32 s16, s48, 3670016
    buffer_load_dwordx4 v112, s[8:11], s16 offen lds
    s_add_u32 m0, s19, 48400
    s_add_u32 s16, s48, 3702784
    buffer_load_dwordx4 v112, s[8:11], s16 offen lds
    s_add_u32 m0, s19, 49440
    s_add_u32 s16, s48, 3735552
    buffer_load_dwordx4 v112, s[8:11], s16 offen lds
    s_add_u32 m0, s19, 50480
    s_add_u32 s16, s48, 3768320
    buffer_load_dwordx4 v112, s[8:11], s16 offen lds
    v_add_u32 v115, 64064, v113
    ds_read_b64_tr_b16 v[144:145], v115 offset:0
    ds_read_b64_tr_b16 v[146:147], v115 offset:512
    ds_read_b64_tr_b16 v[148:149], v115 offset:8320
    ds_read_b64_tr_b16 v[150:151], v115 offset:8832
    ds_read_b64_tr_b16 v[152:153], v115 offset:32
    ds_read_b64_tr_b16 v[154:155], v115 offset:544
    ds_read_b64_tr_b16 v[156:157], v115 offset:8352
    ds_read_b64_tr_b16 v[158:159], v115 offset:8864
    s_waitcnt vmcnt(20)
    s_waitcnt lgkmcnt(0)
    s_barrier
    s_load_dwordx2 s[8:9], s[0:1], 40
    s_mov_b32 s10, 4194304
    s_mov_b32 s11, 0x20000
    s_waitcnt lgkmcnt(0)
    v_mov_b32 v112, v0
    s_mul_i32 s19, s13, 4160
    s_add_u32 m0, s19, 64000
    s_add_u32 s16, s49, 4096
    buffer_load_dwordx4 v112, s[8:11], s16 offen lds
    s_add_u32 m0, s19, 65040
    s_add_u32 s16, s49, 5120
    buffer_load_dwordx4 v112, s[8:11], s16 offen lds
    s_add_u32 m0, s19, 66080
    s_add_u32 s16, s49, 6144
    buffer_load_dwordx4 v112, s[8:11], s16 offen lds
    s_add_u32 m0, s19, 67120
    s_add_u32 s16, s49, 7168
    buffer_load_dwordx4 v112, s[8:11], s16 offen lds
    v_add_u32 v115, 80704, v113
    ds_read_b64_tr_b16 v[64:65], v115 offset:0
    ds_read_b64_tr_b16 v[66:67], v115 offset:512
    ds_read_b64_tr_b16 v[68:69], v115 offset:8320
    ds_read_b64_tr_b16 v[70:71], v115 offset:8832
    ds_read_b64_tr_b16 a[168:169], v115 offset:32
    ds_read_b64_tr_b16 a[170:171], v115 offset:544
    ds_read_b64_tr_b16 a[172:173], v115 offset:8352
    ds_read_b64_tr_b16 a[174:175], v115 offset:8864
    s_waitcnt vmcnt(20)
    s_waitcnt lgkmcnt(0)
    s_barrier
    s_mul_i32 s19, s13, 4160
    s_add_u32 m0, s19, 80640
    s_add_u32 s16, s49, 12288
    buffer_load_dwordx4 v112, s[8:11], s16 offen lds
    s_add_u32 m0, s19, 81680
    s_add_u32 s16, s49, 13312
    buffer_load_dwordx4 v112, s[8:11], s16 offen lds
    s_add_u32 m0, s19, 82720
    s_add_u32 s16, s49, 14336
    buffer_load_dwordx4 v112, s[8:11], s16 offen lds
    s_add_u32 m0, s19, 83760
    s_add_u32 s16, s49, 15360
    buffer_load_dwordx4 v112, s[8:11], s16 offen lds
    v_add_u32 v115, 97344, v113
    ds_read_b64_tr_b16 a[176:177], v115 offset:0
    ds_read_b64_tr_b16 a[178:179], v115 offset:512
    ds_read_b64_tr_b16 a[180:181], v115 offset:8320
    ds_read_b64_tr_b16 a[182:183], v115 offset:8832
    ds_read_b64_tr_b16 a[184:185], v115 offset:32
    ds_read_b64_tr_b16 a[186:187], v115 offset:544
    ds_read_b64_tr_b16 a[188:189], v115 offset:8352
    ds_read_b64_tr_b16 a[190:191], v115 offset:8864
    s_waitcnt vmcnt(20)
    s_waitcnt lgkmcnt(0)
    s_barrier
    s_mul_i32 s19, s13, 4160
    s_add_u32 m0, s19, 97280
    s_add_u32 s16, s49, 36864
    buffer_load_dwordx4 v112, s[8:11], s16 offen lds
    s_add_u32 m0, s19, 98320
    s_add_u32 s16, s49, 37888
    buffer_load_dwordx4 v112, s[8:11], s16 offen lds
    s_add_u32 m0, s19, 99360
    s_add_u32 s16, s49, 38912
    buffer_load_dwordx4 v112, s[8:11], s16 offen lds
    s_add_u32 m0, s19, 100400
    s_add_u32 s16, s49, 39936
    buffer_load_dwordx4 v112, s[8:11], s16 offen lds
    v_add_u32 v115, 113984, v113
    ds_read_b64_tr_b16 a[192:193], v115 offset:0
    ds_read_b64_tr_b16 a[194:195], v115 offset:512
    ds_read_b64_tr_b16 a[196:197], v115 offset:8320
    ds_read_b64_tr_b16 a[198:199], v115 offset:8832
    ds_read_b64_tr_b16 a[200:201], v115 offset:32
    ds_read_b64_tr_b16 a[202:203], v115 offset:544
    ds_read_b64_tr_b16 a[204:205], v115 offset:8352
    ds_read_b64_tr_b16 a[206:207], v115 offset:8864
    s_waitcnt vmcnt(20)
    s_waitcnt lgkmcnt(0)
    s_barrier
    s_mul_i32 s19, s13, 4160
    s_add_u32 m0, s19, 113920
    s_add_u32 s16, s49, 45056
    buffer_load_dwordx4 v112, s[8:11], s16 offen lds
    s_add_u32 m0, s19, 114960
    s_add_u32 s16, s49, 46080
    buffer_load_dwordx4 v112, s[8:11], s16 offen lds
    s_add_u32 m0, s19, 116000
    s_add_u32 s16, s49, 47104
    buffer_load_dwordx4 v112, s[8:11], s16 offen lds
    s_add_u32 m0, s19, 117040
    s_add_u32 s16, s49, 48128
    buffer_load_dwordx4 v112, s[8:11], s16 offen lds
    v_add_u32 v115, 130624, v113
    ds_read_b64_tr_b16 a[208:209], v115 offset:0
    ds_read_b64_tr_b16 a[210:211], v115 offset:512
    ds_read_b64_tr_b16 a[212:213], v115 offset:8320
    ds_read_b64_tr_b16 a[214:215], v115 offset:8832
    ds_read_b64_tr_b16 a[216:217], v115 offset:32
    ds_read_b64_tr_b16 a[218:219], v115 offset:544
    ds_read_b64_tr_b16 a[220:221], v115 offset:8352
    ds_read_b64_tr_b16 a[222:223], v115 offset:8864
    v_and_b32 v118, 0xf0, v0
    global_load_dwordx2 v[116:117], v118, s[56:57] sc1
    s_waitcnt vmcnt(21)
    s_waitcnt lgkmcnt(0)
    s_barrier
    s_mul_i32 s19, s13, 4160
    s_add_u32 m0, s19, 130560
    s_add_u32 s16, s49, 69632
    buffer_load_dwordx4 v112, s[8:11], s16 offen lds
    s_add_u32 m0, s19, 131600
    s_add_u32 s16, s49, 70656
    buffer_load_dwordx4 v112, s[8:11], s16 offen lds
    s_add_u32 m0, s19, 132640
    s_add_u32 s16, s49, 71680
    buffer_load_dwordx4 v112, s[8:11], s16 offen lds
    s_add_u32 m0, s19, 133680
    s_add_u32 s16, s49, 72704
    buffer_load_dwordx4 v112, s[8:11], s16 offen lds
    v_add_u32 v115, 147264, v113
    ds_read_b64_tr_b16 a[224:225], v115 offset:0
    ds_read_b64_tr_b16 a[226:227], v115 offset:512
    ds_read_b64_tr_b16 a[228:229], v115 offset:8320
    ds_read_b64_tr_b16 a[230:231], v115 offset:8832
    ds_read_b64_tr_b16 a[232:233], v115 offset:32
    ds_read_b64_tr_b16 a[234:235], v115 offset:544
    ds_read_b64_tr_b16 a[236:237], v115 offset:8352
    ds_read_b64_tr_b16 a[238:239], v115 offset:8864
    s_waitcnt vmcnt(21)
    s_waitcnt lgkmcnt(0)
    s_barrier
    s_mul_i32 s19, s13, 4160
    s_add_u32 m0, s19, 147200
    s_add_u32 s16, s49, 77824
    buffer_load_dwordx4 v112, s[8:11], s16 offen lds
    s_add_u32 m0, s19, 148240
    s_add_u32 s16, s49, 78848
    buffer_load_dwordx4 v112, s[8:11], s16 offen lds
    s_add_u32 m0, s19, 149280
    s_add_u32 s16, s49, 79872
    buffer_load_dwordx4 v112, s[8:11], s16 offen lds
    s_add_u32 m0, s19, 150320
    s_add_u32 s16, s49, 80896
    buffer_load_dwordx4 v112, s[8:11], s16 offen lds
    v_add_u32 v115, 47424, v113
    ds_read_b64_tr_b16 a[240:241], v115 offset:0
    ds_read_b64_tr_b16 a[242:243], v115 offset:512
    ds_read_b64_tr_b16 a[244:245], v115 offset:8320
    ds_read_b64_tr_b16 a[246:247], v115 offset:8832
    ds_read_b64_tr_b16 a[248:249], v115 offset:32
    ds_read_b64_tr_b16 a[250:251], v115 offset:544
    ds_read_b64_tr_b16 a[252:253], v115 offset:8352
    ds_read_b64_tr_b16 a[254:255], v115 offset:8864
    s_waitcnt vmcnt(21)
    s_waitcnt lgkmcnt(0)
    s_barrier
    s_mul_i32 s19, s13, 4160
    s_add_u32 m0, s19, 47360
    s_add_u32 s16, s49, 102400
    buffer_load_dwordx4 v112, s[8:11], s16 offen lds
    s_add_u32 m0, s19, 48400
    s_add_u32 s16, s49, 103424
    buffer_load_dwordx4 v112, s[8:11], s16 offen lds
    s_add_u32 m0, s19, 49440
    s_add_u32 s16, s49, 104448
    buffer_load_dwordx4 v112, s[8:11], s16 offen lds
    s_add_u32 m0, s19, 50480
    s_add_u32 s16, s49, 105472
    buffer_load_dwordx4 v112, s[8:11], s16 offen lds
    v_add_u32 v115, 64064, v114
    ds_read_b64_tr_b16 v[160:161], v115 offset:0
    ds_read_b64_tr_b16 v[162:163], v115 offset:2080
    ds_read_b64_tr_b16 v[192:193], v115 offset:256
    ds_read_b64_tr_b16 v[194:195], v115 offset:2336
    ds_read_b64_tr_b16 v[224:225], v115 offset:512
    ds_read_b64_tr_b16 v[226:227], v115 offset:2592
    ds_read_b64_tr_b16 v[16:17], v115 offset:768
    ds_read_b64_tr_b16 v[18:19], v115 offset:2848
    s_waitcnt vmcnt(21)
    s_waitcnt lgkmcnt(0)
    s_barrier
    s_mul_i32 s19, s13, 4160
    s_add_u32 m0, s19, 64000
    s_add_u32 s16, s49, 110592
    buffer_load_dwordx4 v112, s[8:11], s16 offen lds
    s_add_u32 m0, s19, 65040
    s_add_u32 s16, s49, 111616
    buffer_load_dwordx4 v112, s[8:11], s16 offen lds
    s_add_u32 m0, s19, 66080
    s_add_u32 s16, s49, 112640
    buffer_load_dwordx4 v112, s[8:11], s16 offen lds
    s_add_u32 m0, s19, 67120
    s_add_u32 s16, s49, 113664
    buffer_load_dwordx4 v112, s[8:11], s16 offen lds
    v_add_u32 v115, 80704, v114
    ds_read_b64_tr_b16 v[164:165], v115 offset:0
    ds_read_b64_tr_b16 v[166:167], v115 offset:2080
    ds_read_b64_tr_b16 v[196:197], v115 offset:256
    ds_read_b64_tr_b16 v[198:199], v115 offset:2336
    ds_read_b64_tr_b16 v[228:229], v115 offset:512
    ds_read_b64_tr_b16 v[230:231], v115 offset:2592
    ds_read_b64_tr_b16 v[20:21], v115 offset:768
    ds_read_b64_tr_b16 v[22:23], v115 offset:2848
    s_waitcnt vmcnt(21)
    s_waitcnt lgkmcnt(0)
    s_barrier
    s_load_dwordx2 s[8:9], s[0:1], 16
    s_mov_b32 s10, 4194304
    s_mov_b32 s11, 0x20000
    s_waitcnt lgkmcnt(0)
    v_lshrrev_b32 v123, 8, v0
    v_lshl_add_u32 v123, s13, 4, v123
    v_mul_u32_u24 v123, 8192, v123
    v_and_b32 v112, 0xf0, v0
    v_add_u32 v112, v123, v112
    s_mul_i32 s19, s13, 4160
    s_add_u32 m0, s19, 80640
    s_add_u32 s16, s48, 0
    buffer_load_dwordx4 v112, s[8:11], s16 offen lds
    s_add_u32 m0, s19, 81680
    s_add_u32 s16, s48, 32768
    buffer_load_dwordx4 v112, s[8:11], s16 offen lds
    s_add_u32 m0, s19, 82720
    s_add_u32 s16, s48, 65536
    buffer_load_dwordx4 v112, s[8:11], s16 offen lds
    s_add_u32 m0, s19, 83760
    s_add_u32 s16, s48, 98304
    buffer_load_dwordx4 v112, s[8:11], s16 offen lds
    v_add_u32 v115, 97344, v114
    ds_read_b64_tr_b16 v[168:169], v115 offset:0
    ds_read_b64_tr_b16 v[170:171], v115 offset:2080
    ds_read_b64_tr_b16 v[200:201], v115 offset:256
    ds_read_b64_tr_b16 v[202:203], v115 offset:2336
    ds_read_b64_tr_b16 v[232:233], v115 offset:512
    ds_read_b64_tr_b16 v[234:235], v115 offset:2592
    ds_read_b64_tr_b16 v[24:25], v115 offset:768
    ds_read_b64_tr_b16 v[26:27], v115 offset:2848
    s_waitcnt vmcnt(21)
    s_waitcnt lgkmcnt(0)
    s_barrier
    s_mul_i32 s19, s13, 4160
    s_add_u32 m0, s19, 97280
    s_add_u32 s16, s48, 524288
    buffer_load_dwordx4 v112, s[8:11], s16 offen lds
    s_add_u32 m0, s19, 98320
    s_add_u32 s16, s48, 557056
    buffer_load_dwordx4 v112, s[8:11], s16 offen lds
    s_add_u32 m0, s19, 99360
    s_add_u32 s16, s48, 589824
    buffer_load_dwordx4 v112, s[8:11], s16 offen lds
    s_add_u32 m0, s19, 100400
    s_add_u32 s16, s48, 622592
    buffer_load_dwordx4 v112, s[8:11], s16 offen lds
    v_add_u32 v115, 113984, v114
    ds_read_b64_tr_b16 v[172:173], v115 offset:0
    ds_read_b64_tr_b16 v[174:175], v115 offset:2080
    ds_read_b64_tr_b16 v[204:205], v115 offset:256
    ds_read_b64_tr_b16 v[206:207], v115 offset:2336
    ds_read_b64_tr_b16 v[236:237], v115 offset:512
    ds_read_b64_tr_b16 v[238:239], v115 offset:2592
    ds_read_b64_tr_b16 v[28:29], v115 offset:768
    ds_read_b64_tr_b16 v[30:31], v115 offset:2848
    s_waitcnt vmcnt(20)
    s_waitcnt lgkmcnt(0)
    s_barrier
    s_mul_i32 s19, s13, 4160
    s_add_u32 m0, s19, 113920
    s_add_u32 s16, s48, 1048576
    buffer_load_dwordx4 v112, s[8:11], s16 offen lds
    s_add_u32 m0, s19, 114960
    s_add_u32 s16, s48, 1081344
    buffer_load_dwordx4 v112, s[8:11], s16 offen lds
    s_add_u32 m0, s19, 116000
    s_add_u32 s16, s48, 1114112
    buffer_load_dwordx4 v112, s[8:11], s16 offen lds
    s_add_u32 m0, s19, 117040
    s_add_u32 s16, s48, 1146880
    buffer_load_dwordx4 v112, s[8:11], s16 offen lds
    v_add_u32 v115, 130624, v114
    ds_read_b64_tr_b16 v[176:177], v115 offset:0
    ds_read_b64_tr_b16 v[178:179], v115 offset:2080
    ds_read_b64_tr_b16 v[208:209], v115 offset:256
    ds_read_b64_tr_b16 v[210:211], v115 offset:2336
    ds_read_b64_tr_b16 v[240:241], v115 offset:512
    ds_read_b64_tr_b16 v[242:243], v115 offset:2592
    ds_read_b64_tr_b16 v[32:33], v115 offset:768
    ds_read_b64_tr_b16 v[34:35], v115 offset:2848
    s_cmp_lg_u32 s59, 0
    s_cbranch_scc1 L_vok_262
    s_branch L_vc_264
L_vp_261:
    v_and_b32 v118, 0xf0, v0
    global_load_dwordx2 v[116:117], v118, s[56:57] sc1
    s_waitcnt vmcnt(0)
L_vc_264:
    v_lshrrev_b32 v119, 8, v117
    s_nop 1
    v_add_u32_dpp v119, v119, v119 quad_perm:[1,0,3,2] row_mask:0xf bank_mask:0xf
    s_nop 1
    v_add_u32_dpp v119, v119, v119 quad_perm:[2,3,0,1] row_mask:0xf bank_mask:0xf
    s_nop 1
    v_add_u32_dpp v119, v119, v119 row_half_mirror row_mask:0xf bank_mask:0xf
    s_nop 1
    v_add_u32_dpp v119, v119, v119 row_mirror row_mask:0xf bank_mask:0xf
    v_cmp_ne_u32 vcc, 0x100, v119
    s_cbranch_vccz L_vgo_263
    s_add_u32 s40, s40, 1
    s_cmp_gt_u32 s40, 262144
    s_cbranch_scc1 L_abort
    s_sleep 2
    s_branch L_vp_261
L_vgo_263:
    s_mov_b32 s59, 1
    v_cmp_ne_u32 vcc, -1, v116
    s_and_b32 s16, vcc_lo, 0x5555
    v_cmp_ne_u32 vcc, 0x2000, v117
    s_and_b32 s17, vcc_lo, 0x5555
    s_or_b32 s16, s16, s17
    s_cbranch_scc0 L_vok_262
    v_lshrrev_b32 v119, 8, v117
    v_cmp_ne_u32 vcc, 32, v119
    s_and_b32 s60, vcc_lo, 0x5555
    s_branch L_redo
L_vok_262:
    v_mov_b32 v116, 0
    v_mov_b32 v117, 0
    v_mov_b32 v118, 0
    v_mov_b32 v119, 0
    v_mov_b32 v120, -1
    buffer_store_dwordx2 v[116:117], v9, s[4:7], s20 offen sc1
    buffer_store_dwordx2 v[116:117], v9, s[4:7], s21 offen sc1
    buffer_store_dwordx2 v[116:117], v9, s[4:7], s25 offen sc1
    buffer_store_dwordx2 v[116:117], v9, s[4:7], s37 offen sc1
    s_add_u32 s16, s26, s30
    buffer_store_dword v120, v11, s[4:7], s16 offen sc1
    s_add_u32 s16, s27, s30
    buffer_store_dword v120, v11, s[4:7], s16 offen sc1
    s_add_u32 s16, s28, s30
    buffer_store_dword v120, v11, s[4:7], s16 offen sc1
    s_waitcnt vmcnt(27)
    s_waitcnt lgkmcnt(0)
    s_barrier
    s_mul_i32 s19, s13, 4160
    s_add_u32 m0, s19, 130560
    s_add_u32 s16, s48, 1572864
    buffer_load_dwordx4 v112, s[8:11], s16 offen lds
    s_add_u32 m0, s19, 131600
    s_add_u32 s16, s48, 1605632
    buffer_load_dwordx4 v112, s[8:11], s16 offen lds
    s_add_u32 m0, s19, 132640
    s_add_u32 s16, s48, 1638400
    buffer_load_dwordx4 v112, s[8:11], s16 offen lds
    s_add_u32 m0, s19, 133680
    s_add_u32 s16, s48, 1671168
    buffer_load_dwordx4 v112, s[8:11], s16 offen lds
    v_add_u32 v115, 147264, v114
    ds_read_b64_tr_b16 v[180:181], v115 offset:0
    ds_read_b64_tr_b16 v[182:183], v115 offset:2080
    ds_read_b64_tr_b16 v[212:213], v115 offset:256
    ds_read_b64_tr_b16 v[214:215], v115 offset:2336
    ds_read_b64_tr_b16 v[244:245], v115 offset:512
    ds_read_b64_tr_b16 v[246:247], v115 offset:2592
    ds_read_b64_tr_b16 v[36:37], v115 offset:768
    ds_read_b64_tr_b16 v[38:39], v115 offset:2848
    s_waitcnt vmcnt(27)
    s_waitcnt lgkmcnt(0)
    s_barrier
    s_mul_i32 s19, s13, 4160
    s_add_u32 m0, s19, 147200
    s_add_u32 s16, s48, 2097152
    buffer_load_dwordx4 v112, s[8:11], s16 offen lds
    s_add_u32 m0, s19, 148240
    s_add_u32 s16, s48, 2129920
    buffer_load_dwordx4 v112, s[8:11], s16 offen lds
    s_add_u32 m0, s19, 149280
    s_add_u32 s16, s48, 2162688
    buffer_load_dwordx4 v112, s[8:11], s16 offen lds
    s_add_u32 m0, s19, 150320
    s_add_u32 s16, s48, 2195456
    buffer_load_dwordx4 v112, s[8:11], s16 offen lds
    v_add_u32 v115, 47424, v114
    ds_read_b64_tr_b16 v[184:185], v115 offset:0
    ds_read_b64_tr_b16 v[186:187], v115 offset:2080
    ds_read_b64_tr_b16 v[216:217], v115 offset:256
    ds_read_b64_tr_b16 v[218:219], v115 offset:2336
    ds_read_b64_tr_b16 v[248:249], v115 offset:512
    ds_read_b64_tr_b16 v[250:251], v115 offset:2592
    ds_read_b64_tr_b16 v[40:41], v115 offset:768
    ds_read_b64_tr_b16 v[42:43], v115 offset:2848
    s_waitcnt vmcnt(27)
    s_waitcnt lgkmcnt(0)
    s_barrier
    s_mul_i32 s19, s13, 4160
    s_add_u32 m0, s19, 47360
    s_add_u32 s16, s48, 2621440
    buffer_load_dwordx4 v112, s[8:11], s16 offen lds
    s_add_u32 m0, s19, 48400
    s_add_u32 s16, s48, 2654208
    buffer_load_dwordx4 v112, s[8:11], s16 offen lds
    s_add_u32 m0, s19, 49440
    s_add_u32 s16, s48, 2686976
    buffer_load_dwordx4 v112, s[8:11], s16 offen lds
    s_add_u32 m0, s19, 50480
    s_add_u32 s16, s48, 2719744
    buffer_load_dwordx4 v112, s[8:11], s16 offen lds
    v_add_u32 v115, 64064, v114
    ds_read_b64_tr_b16 v[188:189], v115 offset:0
    ds_read_b64_tr_b16 v[190:191], v115 offset:2080
    ds_read_b64_tr_b16 v[220:221], v115 offset:256
    ds_read_b64_tr_b16 v[222:223], v115 offset:2336
    ds_read_b64_tr_b16 v[252:253], v115 offset:512
    ds_read_b64_tr_b16 v[254:255], v115 offset:2592
    ds_read_b64_tr_b16 v[44:45], v115 offset:768
    ds_read_b64_tr_b16 v[46:47], v115 offset:2848
    s_waitcnt lgkmcnt(0)
    ds_write_b128 v0, v[16:19] offset:2048
    ds_write_b128 v0, v[20:23] offset:3072
    ds_write_b128 v0, v[24:27] offset:10240
    ds_write_b128 v0, v[28:31] offset:11264
    ds_write_b128 v0, v[32:35] offset:18432
    ds_write_b128 v0, v[36:39] offset:19456
    ds_write_b128 v0, v[40:43] offset:26624
    ds_write_b128 v0, v[44:47] offset:27648
    s_waitcnt vmcnt(27)
    s_waitcnt lgkmcnt(0)
    s_barrier
    s_mul_i32 s19, s13, 4160
    s_add_u32 m0, s19, 64000
    s_add_u32 s16, s48, 3145728
    buffer_load_dwordx4 v112, s[8:11], s16 offen lds
    s_add_u32 m0, s19, 65040
    s_add_u32 s16, s48, 3178496
    buffer_load_dwordx4 v112, s[8:11], s16 offen lds
    s_add_u32 m0, s19, 66080
    s_add_u32 s16, s48, 3211264
    buffer_load_dwordx4 v112, s[8:11], s16 offen lds
    s_add_u32 m0, s19, 67120
    s_add_u32 s16, s48, 3244032
    buffer_load_dwordx4 v112, s[8:11], s16 offen lds
    v_add_u32 v115, 80704, v113
    ds_read_b64_tr_b16 a[64:65], v115 offset:0
    ds_read_b64_tr_b16 a[66:67], v115 offset:512
    ds_read_b64_tr_b16 a[68:69], v115 offset:8320
    ds_read_b64_tr_b16 a[70:71], v115 offset:8832
    ds_read_b64_tr_b16 a[72:73], v115 offset:32
    ds_read_b64_tr_b16 a[74:75], v115 offset:544
    ds_read_b64_tr_b16 a[76:77], v115 offset:8352
    ds_read_b64_tr_b16 a[78:79], v115 offset:8864
    v_lshlrev_b32 v124, 16, v0
    s_lshl_b32 s16, s13, 26
    s_add_u32 s16, s16, 1048448
    buffer_load_dword v124, v124, s[4:7], s16 offen sc1
    s_waitcnt vmcnt(28)
    s_waitcnt lgkmcnt(0)
    s_barrier
    s_mul_i32 s19, s13, 4160
    s_add_u32 m0, s19, 80640
    s_add_u32 s16, s48, 3670016
    buffer_load_dwordx4 v112, s[8:11], s16 offen lds
    s_add_u32 m0, s19, 81680
    s_add_u32 s16, s48, 3702784
    buffer_load_dwordx4 v112, s[8:11], s16 offen lds
    s_add_u32 m0, s19, 82720
    s_add_u32 s16, s48, 3735552
    buffer_load_dwordx4 v112, s[8:11], s16 offen lds
    s_add_u32 m0, s19, 83760
    s_add_u32 s16, s48, 3768320
    buffer_load_dwordx4 v112, s[8:11], s16 offen lds
    v_add_u32 v115, 97344, v113
    ds_read_b64_tr_b16 a[80:81], v115 offset:0
    ds_read_b64_tr_b16 a[82:83], v115 offset:512
    ds_read_b64_tr_b16 a[84:85], v115 offset:8320
    ds_read_b64_tr_b16 a[86:87], v115 offset:8832
    ds_read_b64_tr_b16 a[88:89], v115 offset:32
    ds_read_b64_tr_b16 a[90:91], v115 offset:544
    ds_read_b64_tr_b16 a[92:93], v115 offset:8352
    ds_read_b64_tr_b16 a[94:95], v115 offset:8864
    s_waitcnt vmcnt(28)
    s_waitcnt lgkmcnt(0)
    s_barrier
    s_load_dwordx2 s[8:9], s[0:1], 24
    s_mov_b32 s10, 4194304
    s_mov_b32 s11, 0x20000
    s_waitcnt lgkmcnt(0)
    v_lshrrev_b32 v123, 8, v0
    v_lshl_add_u32 v123, s13, 4, v123
    v_mul_u32_u24 v123, 8192, v123
    v_and_b32 v112, 0xf0, v0
    v_add_u32 v112, v123, v112
    s_mul_i32 s19, s13, 4160
    s_add_u32 m0, s19, 97280
    s_add_u32 s16, s48, 0
    buffer_load_dwordx4 v112, s[8:11], s16 offen lds
    s_add_u32 m0, s19, 98320
    s_add_u32 s16, s48, 32768
    buffer_load_dwordx4 v112, s[8:11], s16 offen lds
    s_add_u32 m0, s19, 99360
    s_add_u32 s16, s48, 65536
    buffer_load_dwordx4 v112, s[8:11], s16 offen lds
    s_add_u32 m0, s19, 100400
    s_add_u32 s16, s48, 98304
    buffer_load_dwordx4 v112, s[8:11], s16 offen lds
    v_add_u32 v115, 113984, v113
    ds_read_b64_tr_b16 v[16:17], v115 offset:0
    ds_read_b64_tr_b16 v[18:19], v115 offset:512
    ds_read_b64_tr_b16 v[20:21], v115 offset:8320
    ds_read_b64_tr_b16 v[22:23], v115 offset:8832
    ds_read_b64_tr_b16 v[24:25], v115 offset:32
    ds_read_b64_tr_b16 v[26:27], v115 offset:544
    ds_read_b64_tr_b16 v[28:29], v115 offset:8352
    ds_read_b64_tr_b16 v[30:31], v115 offset:8864
    s_waitcnt vmcnt(21)
    s_waitcnt lgkmcnt(0)
    s_barrier
    s_mul_i32 s19, s13, 4160
    s_add_u32 m0, s19, 113920
    s_add_u32 s16, s48, 524288
    buffer_load_dwordx4 v112, s[8:11], s16 offen lds
    s_add_u32 m0, s19, 114960
    s_add_u32 s16, s48, 557056
    buffer_load_dwordx4 v112, s[8:11], s16 offen lds
    s_add_u32 m0, s19, 116000
    s_add_u32 s16, s48, 589824
    buffer_load_dwordx4 v112, s[8:11], s16 offen lds
    s_add_u32 m0, s19, 117040
    s_add_u32 s16, s48, 622592
    buffer_load_dwordx4 v112, s[8:11], s16 offen lds
    v_add_u32 v115, 130624, v113
    ds_read_b64_tr_b16 v[32:33], v115 offset:0
    ds_read_b64_tr_b16 v[34:35], v115 offset:512
    ds_read_b64_tr_b16 v[36:37], v115 offset:8320
    ds_read_b64_tr_b16 v[38:39], v115 offset:8832
    ds_read_b64_tr_b16 v[40:41], v115 offset:32
    ds_read_b64_tr_b16 v[42:43], v115 offset:544
    ds_read_b64_tr_b16 v[44:45], v115 offset:8352
    ds_read_b64_tr_b16 v[46:47], v115 offset:8864
    s_lshl_b32 s16, s12, 2
    s_add_u32 s16, s16, s13
    s_lshl_b32 s16, s16, 2
    s_add_u32 s16, s16, 24576
    v_mov_b32 v121, 1
    s_mov_b64 exec, 1
    buffer_store_dword v121, off, s[4:7], s16 sc1
    s_mov_b64 exec, -1
    s_waitcnt vmcnt(22)
    s_waitcnt lgkmcnt(0)
    s_barrier
    s_mul_i32 s19, s13, 4160
    s_add_u32 m0, s19, 130560
    s_add_u32 s16, s48, 1048576
    buffer_load_dwordx4 v112, s[8:11], s16 offen lds
    s_add_u32 m0, s19, 131600
    s_add_u32 s16, s48, 1081344
    buffer_load_dwordx4 v112, s[8:11], s16 offen lds
    s_add_u32 m0, s19, 132640
    s_add_u32 s16, s48, 1114112
    buffer_load_dwordx4 v112, s[8:11], s16 offen lds
    s_add_u32 m0, s19, 133680
    s_add_u32 s16, s48, 1146880
    buffer_load_dwordx4 v112, s[8:11], s16 offen lds
    v_add_u32 v115, 147264, v113
    ds_read_b64_tr_b16 a[0:1], v115 offset:0
    ds_read_b64_tr_b16 a[2:3], v115 offset:512
    ds_read_b64_tr_b16 a[4:5], v115 offset:8320
    ds_read_b64_tr_b16 a[6:7], v115 offset:8832
    ds_read_b64_tr_b16 a[8:9], v115 offset:32
    ds_read_b64_tr_b16 a[10:11], v115 offset:544
    ds_read_b64_tr_b16 a[12:13], v115 offset:8352
    ds_read_b64_tr_b16 a[14:15], v115 offset:8864
    s_waitcnt vmcnt(22)
    s_waitcnt lgkmcnt(0)
    s_barrier
    s_mul_i32 s19, s13, 4160
    s_add_u32 m0, s19, 147200
    s_add_u32 s16, s48, 1572864
    buffer_load_dwordx4 v112, s[8:11], s16 offen lds
    s_add_u32 m0, s19, 148240
    s_add_u32 s16, s48, 1605632
    buffer_load_dwordx4 v112, s[8:11], s16 offen lds
    s_add_u32 m0, s19, 149280
    s_add_u32 s16, s48, 1638400
    buffer_load_dwordx4 v112, s[8:11], s16 offen lds
    s_add_u32 m0, s19, 150320
    s_add_u32 s16, s48, 1671168
    buffer_load_dwordx4 v112, s[8:11], s16 offen lds
    v_add_u32 v115, 47424, v113
    ds_read_b64_tr_b16 a[16:17], v115 offset:0
    ds_read_b64_tr_b16 a[18:19], v115 offset:512
    ds_read_b64_tr_b16 a[20:21], v115 offset:8320
    ds_read_b64_tr_b16 a[22:23], v115 offset:8832
    ds_read_b64_tr_b16 a[24:25], v115 offset:32
    ds_read_b64_tr_b16 a[26:27], v115 offset:544
    ds_read_b64_tr_b16 a[28:29], v115 offset:8352
    ds_read_b64_tr_b16 a[30:31], v115 offset:8864
    s_waitcnt vmcnt(22)
    s_waitcnt lgkmcnt(0)
    s_barrier
    s_mul_i32 s19, s13, 4160
    s_add_u32 m0, s19, 47360
    s_add_u32 s16, s48, 2097152
    buffer_load_dwordx4 v112, s[8:11], s16 offen lds
    s_add_u32 m0, s19, 48400
    s_add_u32 s16, s48, 2129920
    buffer_load_dwordx4 v112, s[8:11], s16 offen lds
    s_add_u32 m0, s19, 49440
    s_add_u32 s16, s48, 2162688
    buffer_load_dwordx4 v112, s[8:11], s16 offen lds
    s_add_u32 m0, s19, 50480
    s_add_u32 s16, s48, 2195456
    buffer_load_dwordx4 v112, s[8:11], s16 offen lds
    v_add_u32 v115, 64064, v113
    ds_read_b64_tr_b16 a[32:33], v115 offset:0
    ds_read_b64_tr_b16 a[34:35], v115 offset:512
    ds_read_b64_tr_b16 a[36:37], v115 offset:8320
    ds_read_b64_tr_b16 a[38:39], v115 offset:8832
    ds_read_b64_tr_b16 a[40:41], v115 offset:32
    ds_read_b64_tr_b16 a[42:43], v115 offset:544
    ds_read_b64_tr_b16 a[44:45], v115 offset:8352
    ds_read_b64_tr_b16 a[46:47], v115 offset:8864
    s_waitcnt vmcnt(21)
    s_waitcnt lgkmcnt(0)
    s_barrier
    s_mul_i32 s19, s13, 4160
    s_add_u32 m0, s19, 64000
    s_add_u32 s16, s48, 2621440
    buffer_load_dwordx4 v112, s[8:11], s16 offen lds
    s_add_u32 m0, s19, 65040
    s_add_u32 s16, s48, 2654208
    buffer_load_dwordx4 v112, s[8:11], s16 offen lds
    s_add_u32 m0, s19, 66080
    s_add_u32 s16, s48, 2686976
    buffer_load_dwordx4 v112, s[8:11], s16 offen lds
    s_add_u32 m0, s19, 67120
    s_add_u32 s16, s48, 2719744
    buffer_load_dwordx4 v112, s[8:11], s16 offen lds
    v_add_u32 v115, 80704, v113
    ds_read_b64_tr_b16 a[48:49], v115 offset:0
    ds_read_b64_tr_b16 a[50:51], v115 offset:512
    ds_read_b64_tr_b16 a[52:53], v115 offset:8320
    ds_read_b64_tr_b16 a[54:55], v115 offset:8832
    ds_read_b64_tr_b16 a[56:57], v115 offset:32
    ds_read_b64_tr_b16 a[58:59], v115 offset:544
    ds_read_b64_tr_b16 a[60:61], v115 offset:8352
    ds_read_b64_tr_b16 a[62:63], v115 offset:8864
    s_waitcnt vmcnt(21)
    s_waitcnt lgkmcnt(0)
    s_barrier
    s_mul_i32 s19, s13, 4160
    s_add_u32 m0, s19, 80640
    s_add_u32 s16, s48, 3145728
    buffer_load_dwordx4 v112, s[8:11], s16 offen lds
    s_add_u32 m0, s19, 81680
    s_add_u32 s16, s48, 3178496
    buffer_load_dwordx4 v112, s[8:11], s16 offen lds
    s_add_u32 m0, s19, 82720
    s_add_u32 s16, s48, 3211264
    buffer_load_dwordx4 v112, s[8:11], s16 offen lds
    s_add_u32 m0, s19, 83760
    s_add_u32 s16, s48, 3244032
    buffer_load_dwordx4 v112, s[8:11], s16 offen lds
    v_add_u32 v115, 97344, v113
    ds_read_b64_tr_b16 a[144:145], v115 offset:0
    ds_read_b64_tr_b16 a[146:147], v115 offset:512
    ds_read_b64_tr_b16 a[148:149], v115 offset:8320
    ds_read_b64_tr_b16 a[150:151], v115 offset:8832
    ds_read_b64_tr_b16 a[152:153], v115 offset:32
    ds_read_b64_tr_b16 a[154:155], v115 offset:544
    ds_read_b64_tr_b16 a[156:157], v115 offset:8352
    ds_read_b64_tr_b16 a[158:159], v115 offset:8864
    s_waitcnt vmcnt(21)
    s_waitcnt lgkmcnt(0)
    s_barrier
    s_mul_i32 s19, s13, 4160
    s_add_u32 m0, s19, 97280
    s_add_u32 s16, s48, 3670016
    buffer_load_dwordx4 v112, s[8:11], s16 offen lds
    s_add_u32 m0, s19, 98320
    s_add_u32 s16, s48, 3702784
    buffer_load_dwordx4 v112, s[8:11], s16 offen lds
    s_add_u32 m0, s19, 99360
    s_add_u32 s16, s48, 3735552
    buffer_load_dwordx4 v112, s[8:11], s16 offen lds
    s_add_u32 m0, s19, 100400
    s_add_u32 s16, s48, 3768320
    buffer_load_dwordx4 v112, s[8:11], s16 offen lds
    v_add_u32 v115, 113984, v113
    ds_read_b64_tr_b16 a[160:161], v115 offset:0
    ds_read_b64_tr_b16 a[162:163], v115 offset:512
    ds_read_b64_tr_b16 a[164:165], v115 offset:8320
    ds_read_b64_tr_b16 a[166:167], v115 offset:8832
    ds_read_b64_tr_b16 v[104:105], v115 offset:32
    ds_read_b64_tr_b16 v[106:107], v115 offset:544
    ds_read_b64_tr_b16 v[108:109], v115 offset:8352
    ds_read_b64_tr_b16 v[110:111], v115 offset:8864
    s_waitcnt vmcnt(20)
    s_waitcnt lgkmcnt(0)
    s_barrier
    v_add_u32 v115, 130624, v113
    ds_read_b64_tr_b16 v[48:49], v115 offset:0
    ds_read_b64_tr_b16 v[50:51], v115 offset:512
    ds_read_b64_tr_b16 v[52:53], v115 offset:8320
    ds_read_b64_tr_b16 v[54:55], v115 offset:8832
    ds_read_b64_tr_b16 v[56:57], v115 offset:32
    ds_read_b64_tr_b16 v[58:59], v115 offset:544
    ds_read_b64_tr_b16 v[60:61], v115 offset:8352
    ds_read_b64_tr_b16 v[62:63], v115 offset:8864
    s_waitcnt vmcnt(16)
    s_waitcnt lgkmcnt(0)
    s_barrier
    v_add_u32 v115, 147264, v113
    ds_read_b64_tr_b16 v[72:73], v115 offset:0
    ds_read_b64_tr_b16 v[74:75], v115 offset:512
    ds_read_b64_tr_b16 v[76:77], v115 offset:8320
    ds_read_b64_tr_b16 v[78:79], v115 offset:8832
    ds_read_b64_tr_b16 a[96:97], v115 offset:32
    ds_read_b64_tr_b16 a[98:99], v115 offset:544
    ds_read_b64_tr_b16 a[100:101], v115 offset:8352
    ds_read_b64_tr_b16 a[102:103], v115 offset:8864
    s_waitcnt vmcnt(12)
    s_waitcnt lgkmcnt(0)
    s_barrier
    v_add_u32 v115, 47424, v113
    ds_read_b64_tr_b16 v[80:81], v115 offset:0
    ds_read_b64_tr_b16 v[82:83], v115 offset:512
    ds_read_b64_tr_b16 v[84:85], v115 offset:8320
    ds_read_b64_tr_b16 v[86:87], v115 offset:8832
    ds_read_b64_tr_b16 a[104:105], v115 offset:32
    ds_read_b64_tr_b16 a[106:107], v115 offset:544
    ds_read_b64_tr_b16 a[108:109], v115 offset:8352
    ds_read_b64_tr_b16 a[110:111], v115 offset:8864
    s_waitcnt vmcnt(8)
    s_waitcnt lgkmcnt(0)
    s_barrier
    v_add_u32 v115, 64064, v113
    ds_read_b64_tr_b16 v[88:89], v115 offset:0
    ds_read_b64_tr_b16 v[90:91], v115 offset:512
    ds_read_b64_tr_b16 v[92:93], v115 offset:8320
    ds_read_b64_tr_b16 v[94:95], v115 offset:8832
    ds_read_b64_tr_b16 a[112:113], v115 offset:32
    ds_read_b64_tr_b16 a[114:115], v115 offset:544
    ds_read_b64_tr_b16 a[116:117], v115 offset:8352
    ds_read_b64_tr_b16 a[118:119], v115 offset:8864
    v_lshrrev_b32 v118, 1, v0
    s_mov_b32 s16, 24576
    buffer_load_dwordx2 v[116:117], v118, s[4:7], s16 offen sc1
    s_load_dwordx2 s[8:9], s[0:1], 8
    s_mov_b32 s10, 8192
    s_mov_b32 s11, 0x20000
    s_waitcnt lgkmcnt(0)
    v_lshlrev_b32 v119, 3, v0
    buffer_load_dword v119, v119, s[8:11], 0 offen
    s_waitcnt vmcnt(6)
    s_waitcnt lgkmcnt(0)
    s_barrier
    v_add_u32 v115, 80704, v113
    ds_read_b64_tr_b16 v[96:97], v115 offset:0
    ds_read_b64_tr_b16 v[98:99], v115 offset:512
    ds_read_b64_tr_b16 v[100:101], v115 offset:8320
    ds_read_b64_tr_b16 v[102:103], v115 offset:8832
    ds_read_b64_tr_b16 a[120:121], v115 offset:32
    ds_read_b64_tr_b16 a[122:123], v115 offset:544
    ds_read_b64_tr_b16 a[124:125], v115 offset:8352
    ds_read_b64_tr_b16 a[126:127], v115 offset:8864
    s_waitcnt vmcnt(2)
    s_waitcnt lgkmcnt(0)
    s_barrier
    v_add_u32 v115, 97344, v113
    ds_read_b64_tr_b16 a[128:129], v115 offset:0
    ds_read_b64_tr_b16 a[130:131], v115 offset:512
    ds_read_b64_tr_b16 a[132:133], v115 offset:8320
    ds_read_b64_tr_b16 a[134:135], v115 offset:8832
    ds_read_b64_tr_b16 a[136:137], v115 offset:32
    ds_read_b64_tr_b16 a[138:139], v115 offset:544
    ds_read_b64_tr_b16 a[140:141], v115 offset:8352
    ds_read_b64_tr_b16 a[142:143], v115 offset:8864
    s_waitcnt lgkmcnt(0)
    s_barrier
    s_waitcnt lgkmcnt(0)
    ds_write_b128 v0, v[16:19] offset:34816
    ds_write_b128 v0, v[20:23] offset:35840
    ds_write_b128 v0, v[24:27] offset:43008
    ds_write_b128 v0, v[28:31] offset:44032
    ds_write_b128 v0, v[32:35] offset:51200
    ds_write_b128 v0, v[36:39] offset:52224
    ds_write_b128 v0, v[40:43] offset:59392
    ds_write_b128 v0, v[44:47] offset:60416
    ds_write_b128 v1, v[48:51] offset:2048
    ds_write_b128 v1, v[52:55] offset:3072
    ds_write_b128 v1, v[56:59] offset:10240
    ds_write_b128 v1, v[60:63] offset:11264
    ds_write_b128 v1, v[64:67] offset:18432
    ds_write_b128 v1, v[68:71] offset:19456
    ds_write_b128 v1, v[72:75] offset:26624
    ds_write_b128 v1, v[76:79] offset:27648
    ds_write_b128 v1, v[80:83] offset:34816
    ds_write_b128 v1, v[84:87] offset:35840
    ds_write_b128 v1, v[88:91] offset:43008
    ds_write_b128 v1, v[92:95] offset:44032
    ds_write_b128 v1, v[96:99] offset:51200
    ds_write_b128 v1, v[100:103] offset:52224
    ds_write_b128 v1, v[104:107] offset:59392
    ds_write_b128 v1, v[108:111] offset:60416
    s_branch L_lwe_256
L_lw2_254:
    s_load_dwordx2 s[8:9], s[0:1], 32
    s_mov_b32 s10, 4194304
    s_mov_b32 s11, 0x20000
    s_waitcnt lgkmcnt(0)
    v_lshrrev_b32 v123, 8, v0
    v_lshl_add_u32 v123, s13, 4, v123
    v_mul_u32_u24 v123, 8192, v123
    v_and_b32 v112, 0xf0, v0
    v_add_u32 v112, v123, v112
    s_mul_i32 s19, s13, 4160
    s_add_u32 m0, s19, 47360
    s_add_u32 s16, s48, 0
    buffer_load_dwordx4 v112, s[8:11], s16 offen lds
    s_add_u32 m0, s19, 48400
    s_add_u32 s16, s48, 32768
    buffer_load_dwordx4 v112, s[8:11], s16 offen lds
    s_add_u32 m0, s19, 49440
    s_add_u32 s16, s48, 65536
    buffer_load_dwordx4 v112, s[8:11], s16 offen lds
    s_add_u32 m0, s19, 50480
    s_add_u32 s16, s48, 98304
    buffer_load_dwordx4 v112, s[8:11], s16 offen lds
    s_mul_i32 s19, s13, 4160
    s_add_u32 m0, s19, 64000
    s_add_u32 s16, s48, 524288
    buffer_load_dwordx4 v112, s[8:11], s16 offen lds
    s_add_u32 m0, s19, 65040
    s_add_u32 s16, s48, 557056
    buffer_load_dwordx4 v112, s[8:11], s16 offen lds
    s_add_u32 m0, s19, 66080
    s_add_u32 s16, s48, 589824
    buffer_load_dwordx4 v112, s[8:11], s16 offen lds
    s_add_u32 m0, s19, 67120
    s_add_u32 s16, s48, 622592
    buffer_load_dwordx4 v112, s[8:11], s16 offen lds
    s_mul_i32 s19, s13, 4160
    s_add_u32 m0, s19, 80640
    s_add_u32 s16, s48, 1048576
    buffer_load_dwordx4 v112, s[8:11], s16 offen lds
    s_add_u32 m0, s19, 81680
    s_add_u32 s16, s48, 1081344
    buffer_load_dwordx4 v112, s[8:11], s16 offen lds
    s_add_u32 m0, s19, 82720
    s_add_u32 s16, s48, 1114112
    buffer_load_dwordx4 v112, s[8:11], s16 offen lds
    s_add_u32 m0, s19, 83760
    s_add_u32 s16, s48, 1146880
    buffer_load_dwordx4 v112, s[8:11], s16 offen lds
    s_mul_i32 s19, s13, 4160
    s_add_u32 m0, s19, 97280
    s_add_u32 s16, s48, 1572864
    buffer_load_dwordx4 v112, s[8:11], s16 offen lds
    s_add_u32 m0, s19, 98320
    s_add_u32 s16, s48, 1605632
    buffer_load_dwordx4 v112, s[8:11], s16 offen lds
    s_add_u32 m0, s19, 99360
    s_add_u32 s16, s48, 1638400
    buffer_load_dwordx4 v112, s[8:11], s16 offen lds
    s_add_u32 m0, s19, 100400
    s_add_u32 s16, s48, 1671168
    buffer_load_dwordx4 v112, s[8:11], s16 offen lds
    s_mul_i32 s19, s13, 4160
    s_add_u32 m0, s19, 113920
    s_add_u32 s16, s48, 2097152
    buffer_load_dwordx4 v112, s[8:11], s16 offen lds
    s_add_u32 m0, s19, 114960
    s_add_u32 s16, s48, 2129920
    buffer_load_dwordx4 v112, s[8:11], s16 offen lds
    s_add_u32 m0, s19, 116000
    s_add_u32 s16, s48, 2162688
    buffer_load_dwordx4 v112, s[8:11], s16 offen lds
    s_add_u32 m0, s19, 117040
    s_add_u32 s16, s48, 2195456
    buffer_load_dwordx4 v112, s[8:11], s16 offen lds
    s_mul_i32 s19, s13, 4160
    s_add_u32 m0, s19, 130560
    s_add_u32 s16, s48, 2621440
    buffer_load_dwordx4 v112, s[8:11], s16 offen lds
    s_add_u32 m0, s19, 131600
    s_add_u32 s16, s48, 2654208
    buffer_load_dwordx4 v112, s[8:11], s16 offen lds
    s_add_u32 m0, s19, 132640
    s_add_u32 s16, s48, 2686976
    buffer_load_dwordx4 v112, s[8:11], s16 offen lds
    s_add_u32 m0, s19, 133680
    s_add_u32 s16, s48, 2719744
    buffer_load_dwordx4 v112, s[8:11], s16 offen lds
    s_waitcnt vmcnt(20)
    s_waitcnt lgkmcnt(0)
    s_barrier
    s_mul_i32 s19, s13, 4160
    s_add_u32 m0, s19, 147200
    s_add_u32 s16, s48, 3145728
    buffer_load_dwordx4 v112, s[8:11], s16 offen lds
    s_add_u32 m0, s19, 148240
    s_add_u32 s16, s48, 3178496
    buffer_load_dwordx4 v112, s[8:11], s16 offen lds
    s_add_u32 m0, s19, 149280
    s_add_u32 s16, s48, 3211264
    buffer_load_dwordx4 v112, s[8:11], s16 offen lds
    s_add_u32 m0, s19, 150320
    s_add_u32 s16, s48, 3244032
    buffer_load_dwordx4 v112, s[8:11], s16 offen lds
    v_add_u32 v115, 47488, v113
    ds_read_b64_tr_b16 a[224:225], v115 offset:0
    ds_read_b64_tr_b16 a[226:227], v115 offset:512
    ds_read_b64_tr_b16 a[228:229], v115 offset:8320
    ds_read_b64_tr_b16 a[230:231], v115 offset:8832
    ds_read_b64_tr_b16 a[232:233], v115 offset:32
    ds_read_b64_tr_b16 a[234:235], v115 offset:544
    ds_read_b64_tr_b16 a[236:237], v115 offset:8352
    ds_read_b64_tr_b16 a[238:239], v115 offset:8864
    s_waitcnt vmcnt(20)
    s_waitcnt lgkmcnt(0)
    s_barrier
    s_mul_i32 s19, s13, 4160
    s_add_u32 m0, s19, 47360
    s_add_u32 s16, s48, 3670016
    buffer_load_dwordx4 v112, s[8:11], s16 offen lds
    s_add_u32 m0, s19, 48400
    s_add_u32 s16, s48, 3702784
    buffer_load_dwordx4 v112, s[8:11], s16 offen lds
    s_add_u32 m0, s19, 49440
    s_add_u32 s16, s48, 3735552
    buffer_load_dwordx4 v112, s[8:11], s16 offen lds
    s_add_u32 m0, s19, 50480
    s_add_u32 s16, s48, 3768320
    buffer_load_dwordx4 v112, s[8:11], s16 offen lds
    v_add_u32 v115, 64128, v113
    ds_read_b64_tr_b16 a[240:241], v115 offset:0
    ds_read_b64_tr_b16 a[242:243], v115 offset:512
    ds_read_b64_tr_b16 a[244:245], v115 offset:8320
    ds_read_b64_tr_b16 a[246:247], v115 offset:8832
    ds_read_b64_tr_b16 a[248:249], v115 offset:32
    ds_read_b64_tr_b16 a[250:251], v115 offset:544
    ds_read_b64_tr_b16 a[252:253], v115 offset:8352
    ds_read_b64_tr_b16 a[254:255], v115 offset:8864
    s_waitcnt vmcnt(20)
    s_waitcnt lgkmcnt(0)
    s_barrier
    s_load_dwordx2 s[8:9], s[0:1], 40
    s_mov_b32 s10, 4194304
    s_mov_b32 s11, 0x20000
    s_waitcnt lgkmcnt(0)
    v_mov_b32 v112, v0
    s_mul_i32 s19, s13, 4160
    s_add_u32 m0, s19, 64000
    s_add_u32 s16, s49, 16384
    buffer_load_dwordx4 v112, s[8:11], s16 offen lds
    s_add_u32 m0, s19, 65040
    s_add_u32 s16, s49, 17408
    buffer_load_dwordx4 v112, s[8:11], s16 offen lds
    s_add_u32 m0, s19, 66080
    s_add_u32 s16, s49, 18432
    buffer_load_dwordx4 v112, s[8:11], s16 offen lds
    s_add_u32 m0, s19, 67120
    s_add_u32 s16, s49, 19456
    buffer_load_dwordx4 v112, s[8:11], s16 offen lds
    v_add_u32 v115, 80768, v113
    ds_read_b64_tr_b16 v[128:129], v115 offset:0
    ds_read_b64_tr_b16 v[130:131], v115 offset:512
    ds_read_b64_tr_b16 v[132:133], v115 offset:8320
    ds_read_b64_tr_b16 v[134:135], v115 offset:8832
    ds_read_b64_tr_b16 v[136:137], v115 offset:32
    ds_read_b64_tr_b16 v[138:139], v115 offset:544
    ds_read_b64_tr_b16 v[140:141], v115 offset:8352
    ds_read_b64_tr_b16 v[142:143], v115 offset:8864
    s_waitcnt vmcnt(20)
    s_waitcnt lgkmcnt(0)
    s_barrier
    s_mul_i32 s19, s13, 4160
    s_add_u32 m0, s19, 80640
    s_add_u32 s16, s49, 24576
    buffer_load_dwordx4 v112, s[8:11], s16 offen lds
    s_add_u32 m0, s19, 81680
    s_add_u32 s16, s49, 25600
    buffer_load_dwordx4 v112, s[8:11], s16 offen lds
    s_add_u32 m0, s19, 82720
    s_add_u32 s16, s49, 26624
    buffer_load_dwordx4 v112, s[8:11], s16 offen lds
    s_add_u32 m0, s19, 83760
    s_add_u32 s16, s49, 27648
    buffer_load_dwordx4 v112, s[8:11], s16 offen lds
    v_add_u32 v115, 97408, v113
    ds_read_b64_tr_b16 v[144:145], v115 offset:0
    ds_read_b64_tr_b16 v[146:147], v115 offset:512
    ds_read_b64_tr_b16 v[148:149], v115 offset:8320
    ds_read_b64_tr_b16 v[150:151], v115 offset:8832
    ds_read_b64_tr_b16 v[152:153], v115 offset:32
    ds_read_b64_tr_b16 v[154:155], v115 offset:544
    ds_read_b64_tr_b16 v[156:157], v115 offset:8352
    ds_read_b64_tr_b16 v[158:159], v115 offset:8864
    s_waitcnt vmcnt(20)
    s_waitcnt lgkmcnt(0)
    s_barrier
    s_mul_i32 s19, s13, 4160
    s_add_u32 m0, s19, 97280
    s_add_u32 s16, s49, 49152
    buffer_load_dwordx4 v112, s[8:11], s16 offen lds
    s_add_u32 m0, s19, 98320
    s_add_u32 s16, s49, 50176
    buffer_load_dwordx4 v112, s[8:11], s16 offen lds
    s_add_u32 m0, s19, 99360
    s_add_u32 s16, s49, 51200
    buffer_load_dwordx4 v112, s[8:11], s16 offen lds
    s_add_u32 m0, s19, 100400
    s_add_u32 s16, s49, 52224
    buffer_load_dwordx4 v112, s[8:11], s16 offen lds
    v_add_u32 v115, 114048, v113
    ds_read_b64_tr_b16 v[64:65], v115 offset:0
    ds_read_b64_tr_b16 v[66:67], v115 offset:512
    ds_read_b64_tr_b16 v[68:69], v115 offset:8320
    ds_read_b64_tr_b16 v[70:71], v115 offset:8832
    ds_read_b64_tr_b16 a[168:169], v115 offset:32
    ds_read_b64_tr_b16 a[170:171], v115 offset:544
    ds_read_b64_tr_b16 a[172:173], v115 offset:8352
    ds_read_b64_tr_b16 a[174:175], v115 offset:8864
    s_waitcnt vmcnt(20)
    s_waitcnt lgkmcnt(0)
    s_barrier
    s_mul_i32 s19, s13, 4160
    s_add_u32 m0, s19, 113920
    s_add_u32 s16, s49, 57344
    buffer_load_dwordx4 v112, s[8:11], s16 offen lds
    s_add_u32 m0, s19, 114960
    s_add_u32 s16, s49, 58368
    buffer_load_dwordx4 v112, s[8:11], s16 offen lds
    s_add_u32 m0, s19, 116000
    s_add_u32 s16, s49, 59392
    buffer_load_dwordx4 v112, s[8:11], s16 offen lds
    s_add_u32 m0, s19, 117040
    s_add_u32 s16, s49, 60416
    buffer_load_dwordx4 v112, s[8:11], s16 offen lds
    v_add_u32 v115, 130688, v113
    ds_read_b64_tr_b16 a[176:177], v115 offset:0
    ds_read_b64_tr_b16 a[178:179], v115 offset:512
    ds_read_b64_tr_b16 a[180:181], v115 offset:8320
    ds_read_b64_tr_b16 a[182:183], v115 offset:8832
    ds_read_b64_tr_b16 a[184:185], v115 offset:32
    ds_read_b64_tr_b16 a[186:187], v115 offset:544
    ds_read_b64_tr_b16 a[188:189], v115 offset:8352
    ds_read_b64_tr_b16 a[190:191], v115 offset:8864
    v_and_b32 v118, 0xf0, v0
    global_load_dwordx2 v[116:117], v118, s[56:57] sc1
    s_waitcnt vmcnt(21)
    s_waitcnt lgkmcnt(0)
    s_barrier
    s_mul_i32 s19, s13, 4160
    s_add_u32 m0, s19, 130560
    s_add_u32 s16, s49, 81920
    buffer_load_dwordx4 v112, s[8:11], s16 offen lds
    s_add_u32 m0, s19, 131600
    s_add_u32 s16, s49, 82944
    buffer_load_dwordx4 v112, s[8:11], s16 offen lds
    s_add_u32 m0, s19, 132640
    s_add_u32 s16, s49, 83968
    buffer_load_dwordx4 v112, s[8:11], s16 offen lds
    s_add_u32 m0, s19, 133680
    s_add_u32 s16, s49, 84992
    buffer_load_dwordx4 v112, s[8:11], s16 offen lds
    v_add_u32 v115, 147328, v113
    ds_read_b64_tr_b16 a[192:193], v115 offset:0
    ds_read_b64_tr_b16 a[194:195], v115 offset:512
    ds_read_b64_tr_b16 a[196:197], v115 offset:8320
    ds_read_b64_tr_b16 a[198:199], v115 offset:8832
    ds_read_b64_tr_b16 a[200:201], v115 offset:32
    ds_read_b64_tr_b16 a[202:203], v115 offset:544
    ds_read_b64_tr_b16 a[204:205], v115 offset:8352
    ds_read_b64_tr_b16 a[206:207], v115 offset:8864
    s_waitcnt vmcnt(21)
    s_waitcnt lgkmcnt(0)
    s_barrier
    s_mul_i32 s19, s13, 4160
    s_add_u32 m0, s19, 147200
    s_add_u32 s16, s49, 90112
    buffer_load_dwordx4 v112, s[8:11], s16 offen lds
    s_add_u32 m0, s19, 148240
    s_add_u32 s16, s49, 91136
    buffer_load_dwordx4 v112, s[8:11], s16 offen lds
    s_add_u32 m0, s19, 149280
    s_add_u32 s16, s49, 92160
    buffer_load_dwordx4 v112, s[8:11], s16 offen lds
    s_add_u32 m0, s19, 150320
    s_add_u32 s16, s49, 93184
    buffer_load_dwordx4 v112, s[8:11], s16 offen lds
    v_add_u32 v115, 47488, v113
    ds_read_b64_tr_b16 a[208:209], v115 offset:0
    ds_read_b64_tr_b16 a[210:211], v115 offset:512
    ds_read_b64_tr_b16 a[212:213], v115 offset:8320
    ds_read_b64_tr_b16 a[214:215], v115 offset:8832
    ds_read_b64_tr_b16 a[216:217], v115 offset:32
    ds_read_b64_tr_b16 a[218:219], v115 offset:544
    ds_read_b64_tr_b16 a[220:221], v115 offset:8352
    ds_read_b64_tr_b16 a[222:223], v115 offset:8864
    s_waitcnt vmcnt(21)
    s_waitcnt lgkmcnt(0)
    s_barrier
    s_mul_i32 s19, s13, 4160
    s_add_u32 m0, s19, 47360
    s_add_u32 s16, s49, 114688
    buffer_load_dwordx4 v112, s[8:11], s16 offen lds
    s_add_u32 m0, s19, 48400
    s_add_u32 s16, s49, 115712
    buffer_load_dwordx4 v112, s[8:11], s16 offen lds
    s_add_u32 m0, s19, 49440
    s_add_u32 s16, s49, 116736
    buffer_load_dwordx4 v112, s[8:11], s16 offen lds
    s_add_u32 m0, s19, 50480
    s_add_u32 s16, s49, 117760
    buffer_load_dwordx4 v112, s[8:11], s16 offen lds
    v_add_u32 v115, 64128, v114
    ds_read_b64_tr_b16 v[160:161], v115 offset:0
    ds_read_b64_tr_b16 v[162:163], v115 offset:2080
    ds_read_b64_tr_b16 v[192:193], v115 offset:256
    ds_read_b64_tr_b16 v[194:195], v115 offset:2336
    ds_read_b64_tr_b16 v[224:225], v115 offset:512
    ds_read_b64_tr_b16 v[226:227], v115 offset:2592
    ds_read_b64_tr_b16 v[16:17], v115 offset:768
    ds_read_b64_tr_b16 v[18:19], v115 offset:2848
    s_waitcnt vmcnt(21)
    s_waitcnt lgkmcnt(0)
    s_barrier
    s_mul_i32 s19, s13, 4160
    s_add_u32 m0, s19, 64000
    s_add_u32 s16, s49, 122880
    buffer_load_dwordx4 v112, s[8:11], s16 offen lds
    s_add_u32 m0, s19, 65040
    s_add_u32 s16, s49, 123904
    buffer_load_dwordx4 v112, s[8:11], s16 offen lds
    s_add_u32 m0, s19, 66080
    s_add_u32 s16, s49, 124928
    buffer_load_dwordx4 v112, s[8:11], s16 offen lds
    s_add_u32 m0, s19, 67120
    s_add_u32 s16, s49, 125952
    buffer_load_dwordx4 v112, s[8:11], s16 offen lds
    v_add_u32 v115, 80768, v114
    ds_read_b64_tr_b16 v[164:165], v115 offset:0
    ds_read_b64_tr_b16 v[166:167], v115 offset:2080
    ds_read_b64_tr_b16 v[196:197], v115 offset:256
    ds_read_b64_tr_b16 v[198:199], v115 offset:2336
    ds_read_b64_tr_b16 v[228:229], v115 offset:512
    ds_read_b64_tr_b16 v[230:231], v115 offset:2592
    ds_read_b64_tr_b16 v[20:21], v115 offset:768
    ds_read_b64_tr_b16 v[22:23], v115 offset:2848
    s_waitcnt vmcnt(21)
    s_waitcnt lgkmcnt(0)
    s_barrier
    s_load_dwordx2 s[8:9], s[0:1], 16
    s_mov_b32 s10, 4194304
    s_mov_b32 s11, 0x20000
    s_waitcnt lgkmcnt(0)
    v_lshrrev_b32 v123, 8, v0
    v_lshl_add_u32 v123, s13, 4, v123
    v_mul_u32_u24 v123, 8192, v123
    v_and_b32 v112, 0xf0, v0
    v_add_u32 v112, v123, v112
    s_mul_i32 s19, s13, 4160
    s_add_u32 m0, s19, 80640
    s_add_u32 s16, s48, 0
    buffer_load_dwordx4 v112, s[8:11], s16 offen lds
    s_add_u32 m0, s19, 81680
    s_add_u32 s16, s48, 32768
    buffer_load_dwordx4 v112, s[8:11], s16 offen lds
    s_add_u32 m0, s19, 82720
    s_add_u32 s16, s48, 65536
    buffer_load_dwordx4 v112, s[8:11], s16 offen lds
    s_add_u32 m0, s19, 83760
    s_add_u32 s16, s48, 98304
    buffer_load_dwordx4 v112, s[8:11], s16 offen lds
    v_add_u32 v115, 97408, v114
    ds_read_b64_tr_b16 v[168:169], v115 offset:0
    ds_read_b64_tr_b16 v[170:171], v115 offset:2080
    ds_read_b64_tr_b16 v[200:201], v115 offset:256
    ds_read_b64_tr_b16 v[202:203], v115 offset:2336
    ds_read_b64_tr_b16 v[232:233], v115 offset:512
    ds_read_b64_tr_b16 v[234:235], v115 offset:2592
    ds_read_b64_tr_b16 v[24:25], v115 offset:768
    ds_read_b64_tr_b16 v[26:27], v115 offset:2848
    s_waitcnt vmcnt(21)
    s_waitcnt lgkmcnt(0)
    s_barrier
    s_mul_i32 s19, s13, 4160
    s_add_u32 m0, s19, 97280
    s_add_u32 s16, s48, 524288
    buffer_load_dwordx4 v112, s[8:11], s16 offen lds
    s_add_u32 m0, s19, 98320
    s_add_u32 s16, s48, 557056
    buffer_load_dwordx4 v112, s[8:11], s16 offen lds
    s_add_u32 m0, s19, 99360
    s_add_u32 s16, s48, 589824
    buffer_load_dwordx4 v112, s[8:11], s16 offen lds
    s_add_u32 m0, s19, 100400
    s_add_u32 s16, s48, 622592
    buffer_load_dwordx4 v112, s[8:11], s16 offen lds
    v_add_u32 v115, 114048, v114
    ds_read_b64_tr_b16 v[172:173], v115 offset:0
    ds_read_b64_tr_b16 v[174:175], v115 offset:2080
    ds_read_b64_tr_b16 v[204:205], v115 offset:256
    ds_read_b64_tr_b16 v[206:207], v115 offset:2336
    ds_read_b64_tr_b16 v[236:237], v115 offset:512
    ds_read_b64_tr_b16 v[238:239], v115 offset:2592
    ds_read_b64_tr_b16 v[28:29], v115 offset:768
    ds_read_b64_tr_b16 v[30:31], v115 offset:2848
    s_waitcnt vmcnt(20)
    s_waitcnt lgkmcnt(0)
    s_barrier
    s_mul_i32 s19, s13, 4160
    s_add_u32 m0, s19, 113920
    s_add_u32 s16, s48, 1048576
    buffer_load_dwordx4 v112, s[8:11], s16 offen lds
    s_add_u32 m0, s19, 114960
    s_add_u32 s16, s48, 1081344
    buffer_load_dwordx4 v112, s[8:11], s16 offen lds
    s_add_u32 m0, s19, 116000
    s_add_u32 s16, s48, 1114112
    buffer_load_dwordx4 v112, s[8:11], s16 offen lds
    s_add_u32 m0, s19, 117040
    s_add_u32 s16, s48, 1146880
    buffer_load_dwordx4 v112, s[8:11], s16 offen lds
    v_add_u32 v115, 130688, v114
    ds_read_b64_tr_b16 v[176:177], v115 offset:0
    ds_read_b64_tr_b16 v[178:179], v115 offset:2080
    ds_read_b64_tr_b16 v[208:209], v115 offset:256
    ds_read_b64_tr_b16 v[210:211], v115 offset:2336
    ds_read_b64_tr_b16 v[240:241], v115 offset:512
    ds_read_b64_tr_b16 v[242:243], v115 offset:2592
    ds_read_b64_tr_b16 v[32:33], v115 offset:768
    ds_read_b64_tr_b16 v[34:35], v115 offset:2848
    s_cmp_lg_u32 s59, 0
    s_cbranch_scc1 L_vok_266
    s_branch L_vc_268
L_vp_265:
    v_and_b32 v118, 0xf0, v0
    global_load_dwordx2 v[116:117], v118, s[56:57] sc1
    s_waitcnt vmcnt(0)
L_vc_268:
    v_lshrrev_b32 v119, 8, v117
    s_nop 1
    v_add_u32_dpp v119, v119, v119 quad_perm:[1,0,3,2] row_mask:0xf bank_mask:0xf
    s_nop 1
    v_add_u32_dpp v119, v119, v119 quad_perm:[2,3,0,1] row_mask:0xf bank_mask:0xf
    s_nop 1
    v_add_u32_dpp v119, v119, v119 row_half_mirror row_mask:0xf bank_mask:0xf
    s_nop 1
    v_add_u32_dpp v119, v119, v119 row_mirror row_mask:0xf bank_mask:0xf
    v_cmp_ne_u32 vcc, 0x100, v119
    s_cbranch_vccz L_vgo_267
    s_add_u32 s40, s40, 1
    s_cmp_gt_u32 s40, 262144
    s_cbranch_scc1 L_abort
    s_sleep 2
    s_branch L_vp_265
L_vgo_267:
    s_mov_b32 s59, 1
    v_cmp_ne_u32 vcc, -1, v116
    s_and_b32 s16, vcc_lo, 0x5555
    v_cmp_ne_u32 vcc, 0x2000, v117
    s_and_b32 s17, vcc_lo, 0x5555
    s_or_b32 s16, s16, s17
    s_cbranch_scc0 L_vok_266
    v_lshrrev_b32 v119, 8, v117
    v_cmp_ne_u32 vcc, 32, v119
    s_and_b32 s60, vcc_lo, 0x5555
    s_branch L_redo
L_vok_266:
    v_mov_b32 v116, 0
    v_mov_b32 v117, 0
    v_mov_b32 v118, 0
    v_mov_b32 v119, 0
    v_mov_b32 v120, -1
    buffer_store_dwordx2 v[116:117], v9, s[4:7], s20 offen sc1
    buffer_store_dwordx2 v[116:117], v9, s[4:7], s21 offen sc1
    buffer_store_dwordx2 v[116:117], v9, s[4:7], s25 offen sc1
    buffer_store_dwordx2 v[116:117], v9, s[4:7], s37 offen sc1
    s_add_u32 s16, s26, s30
    buffer_store_dword v120, v11, s[4:7], s16 offen sc1
    s_add_u32 s16, s27, s30
    buffer_store_dword v120, v11, s[4:7], s16 offen sc1
    s_add_u32 s16, s28, s30
    buffer_store_dword v120, v11, s[4:7], s16 offen sc1
    s_waitcnt vmcnt(27)
    s_waitcnt lgkmcnt(0)
    s_barrier
    s_mul_i32 s19, s13, 4160
    s_add_u32 m0, s19, 130560
    s_add_u32 s16, s48, 1572864
    buffer_load_dwordx4 v112, s[8:11], s16 offen lds
    s_add_u32 m0, s19, 131600
    s_add_u32 s16, s48, 1605632
    buffer_load_dwordx4 v112, s[8:11], s16 offen lds
    s_add_u32 m0, s19, 132640
    s_add_u32 s16, s48, 1638400
    buffer_load_dwordx4 v112, s[8:11], s16 offen lds
    s_add_u32 m0, s19, 133680
    s_add_u32 s16, s48, 1671168
    buffer_load_dwordx4 v112, s[8:11], s16 offen lds
    v_add_u32 v115, 147328, v114
    ds_read_b64_tr_b16 v[180:181], v115 offset:0
    ds_read_b64_tr_b16 v[182:183], v115 offset:2080
    ds_read_b64_tr_b16 v[212:213], v115 offset:256
    ds_read_b64_tr_b16 v[214:215], v115 offset:2336
    ds_read_b64_tr_b16 v[244:245], v115 offset:512
    ds_read_b64_tr_b16 v[246:247], v115 offset:2592
    ds_read_b64_tr_b16 v[36:37], v115 offset:768
    ds_read_b64_tr_b16 v[38:39], v115 offset:2848
    s_waitcnt vmcnt(27)
    s_waitcnt lgkmcnt(0)
    s_barrier
    s_mul_i32 s19, s13, 4160
    s_add_u32 m0, s19, 147200
    s_add_u32 s16, s48, 2097152
    buffer_load_dwordx4 v112, s[8:11], s16 offen lds
    s_add_u32 m0, s19, 148240
    s_add_u32 s16, s48, 2129920
    buffer_load_dwordx4 v112, s[8:11], s16 offen lds
    s_add_u32 m0, s19, 149280
    s_add_u32 s16, s48, 2162688
    buffer_load_dwordx4 v112, s[8:11], s16 offen lds
    s_add_u32 m0, s19, 150320
    s_add_u32 s16, s48, 2195456
    buffer_load_dwordx4 v112, s[8:11], s16 offen lds
    v_add_u32 v115, 47488, v114
    ds_read_b64_tr_b16 v[184:185], v115 offset:0
    ds_read_b64_tr_b16 v[186:187], v115 offset:2080
    ds_read_b64_tr_b16 v[216:217], v115 offset:256
    ds_read_b64_tr_b16 v[218:219], v115 offset:2336
    ds_read_b64_tr_b16 v[248:249], v115 offset:512
    ds_read_b64_tr_b16 v[250:251], v115 offset:2592
    ds_read_b64_tr_b16 v[40:41], v115 offset:768
    ds_read_b64_tr_b16 v[42:43], v115 offset:2848
    s_waitcnt vmcnt(27)
    s_waitcnt lgkmcnt(0)
    s_barrier
    s_mul_i32 s19, s13, 4160
    s_add_u32 m0, s19, 47360
    s_add_u32 s16, s48, 2621440
    buffer_load_dwordx4 v112, s[8:11], s16 offen lds
    s_add_u32 m0, s19, 48400
    s_add_u32 s16, s48, 2654208
    buffer_load_dwordx4 v112, s[8:11], s16 offen lds
    s_add_u32 m0, s19, 49440
    s_add_u32 s16, s48, 2686976
    buffer_load_dwordx4 v112, s[8:11], s16 offen lds
    s_add_u32 m0, s19, 50480
    s_add_u32 s16, s48, 2719744
    buffer_load_dwordx4 v112, s[8:11], s16 offen lds
    v_add_u32 v115, 64128, v114
    ds_read_b64_tr_b16 v[188:189], v115 offset:0
    ds_read_b64_tr_b16 v[190:191], v115 offset:2080
    ds_read_b64_tr_b16 v[220:221], v115 offset:256
    ds_read_b64_tr_b16 v[222:223], v115 offset:2336
    ds_read_b64_tr_b16 v[252:253], v115 offset:512
    ds_read_b64_tr_b16 v[254:255], v115 offset:2592
    ds_read_b64_tr_b16 v[44:45], v115 offset:768
    ds_read_b64_tr_b16 v[46:47], v115 offset:2848
    s_waitcnt lgkmcnt(0)
    ds_write_b128 v0, v[16:19] offset:4096
    ds_write_b128 v0, v[20:23] offset:5120
    ds_write_b128 v0, v[24:27] offset:12288
    ds_write_b128 v0, v[28:31] offset:13312
    ds_write_b128 v0, v[32:35] offset:20480
    ds_write_b128 v0, v[36:39] offset:21504
    ds_write_b128 v0, v[40:43] offset:28672
    ds_write_b128 v0, v[44:47] offset:29696
    s_waitcnt vmcnt(27)
    s_waitcnt lgkmcnt(0)
    s_barrier
    s_mul_i32 s19, s13, 4160
    s_add_u32 m0, s19, 64000
    s_add_u32 s16, s48, 3145728
    buffer_load_dwordx4 v112, s[8:11], s16 offen lds
    s_add_u32 m0, s19, 65040
    s_add_u32 s16, s48, 3178496
    buffer_load_dwordx4 v112, s[8:11], s16 offen lds
    s_add_u32 m0, s19, 66080
    s_add_u32 s16, s48, 3211264
    buffer_load_dwordx4 v112, s[8:11], s16 offen lds
    s_add_u32 m0, s19, 67120
    s_add_u32 s16, s48, 3244032
    buffer_load_dwordx4 v112, s[8:11], s16 offen lds
    v_add_u32 v115, 80768, v113
    ds_read_b64_tr_b16 a[32:33], v115 offset:0
    ds_read_b64_tr_b16 a[34:35], v115 offset:512
    ds_read_b64_tr_b16 a[36:37], v115 offset:8320
    ds_read_b64_tr_b16 a[38:39], v115 offset:8832
    ds_read_b64_tr_b16 a[40:41], v115 offset:32
    ds_read_b64_tr_b16 a[42:43], v115 offset:544
    ds_read_b64_tr_b16 a[44:45], v115 offset:8352
    ds_read_b64_tr_b16 a[46:47], v115 offset:8864
    v_lshlrev_b32 v124, 16, v0
    s_lshl_b32 s16, s13, 26
    s_add_u32 s16, s16, 1048448
    buffer_load_dword v124, v124, s[4:7], s16 offen sc1
    s_waitcnt vmcnt(28)
    s_waitcnt lgkmcnt(0)
    s_barrier
    s_mul_i32 s19, s13, 4160
    s_add_u32 m0, s19, 80640
    s_add_u32 s16, s48, 3670016
    buffer_load_dwordx4 v112, s[8:11], s16 offen lds
    s_add_u32 m0, s19, 81680
    s_add_u32 s16, s48, 3702784
    buffer_load_dwordx4 v112, s[8:11], s16 offen lds
    s_add_u32 m0, s19, 82720
    s_add_u32 s16, s48, 3735552
    buffer_load_dwordx4 v112, s[8:11], s16 offen lds
    s_add_u32 m0, s19, 83760
    s_add_u32 s16, s48, 3768320
    buffer_load_dwordx4 v112, s[8:11], s16 offen lds
    v_add_u32 v115, 97408, v113
    ds_read_b64_tr_b16 a[48:49], v115 offset:0
    ds_read_b64_tr_b16 a[50:51], v115 offset:512
    ds_read_b64_tr_b16 a[52:53], v115 offset:8320
    ds_read_b64_tr_b16 a[54:55], v115 offset:8832
    ds_read_b64_tr_b16 a[56:57], v115 offset:32
    ds_read_b64_tr_b16 a[58:59], v115 offset:544
    ds_read_b64_tr_b16 a[60:61], v115 offset:8352
    ds_read_b64_tr_b16 a[62:63], v115 offset:8864
    s_waitcnt vmcnt(28)
    s_waitcnt lgkmcnt(0)
    s_barrier
    s_load_dwordx2 s[8:9], s[0:1], 24
    s_mov_b32 s10, 4194304
    s_mov_b32 s11, 0x20000
    s_waitcnt lgkmcnt(0)
    v_lshrrev_b32 v123, 8, v0
    v_lshl_add_u32 v123, s13, 4, v123
    v_mul_u32_u24 v123, 8192, v123
    v_and_b32 v112, 0xf0, v0
    v_add_u32 v112, v123, v112
    s_mul_i32 s19, s13, 4160
    s_add_u32 m0, s19, 97280
    s_add_u32 s16, s48, 0
    buffer_load_dwordx4 v112, s[8:11], s16 offen lds
    s_add_u32 m0, s19, 98320
    s_add_u32 s16, s48, 32768
    buffer_load_dwordx4 v112, s[8:11], s16 offen lds
    s_add_u32 m0, s19, 99360
    s_add_u32 s16, s48, 65536
    buffer_load_dwordx4 v112, s[8:11], s16 offen lds
    s_add_u32 m0, s19, 100400
    s_add_u32 s16, s48, 98304
    buffer_load_dwordx4 v112, s[8:11], s16 offen lds
    v_add_u32 v115, 114048, v113
    ds_read_b64_tr_b16 a[64:65], v115 offset:0
    ds_read_b64_tr_b16 a[66:67], v115 offset:512
    ds_read_b64_tr_b16 a[68:69], v115 offset:8320
    ds_read_b64_tr_b16 a[70:71], v115 offset:8832
    ds_read_b64_tr_b16 a[72:73], v115 offset:32
    ds_read_b64_tr_b16 a[74:75], v115 offset:544
    ds_read_b64_tr_b16 a[76:77], v115 offset:8352
    ds_read_b64_tr_b16 a[78:79], v115 offset:8864
    s_waitcnt vmcnt(21)
    s_waitcnt lgkmcnt(0)
    s_barrier
    s_mul_i32 s19, s13, 4160
    s_add_u32 m0, s19, 113920
    s_add_u32 s16, s48, 524288
    buffer_load_dwordx4 v112, s[8:11], s16 offen lds
    s_add_u32 m0, s19, 114960
    s_add_u32 s16, s48, 557056
    buffer_load_dwordx4 v112, s[8:11], s16 offen lds
    s_add_u32 m0, s19, 116000
    s_add_u32 s16, s48, 589824
    buffer_load_dwordx4 v112, s[8:11], s16 offen lds
    s_add_u32 m0, s19, 117040
    s_add_u32 s16, s48, 622592
    buffer_load_dwordx4 v112, s[8:11], s16 offen lds
    v_add_u32 v115, 130688, v113
    ds_read_b64_tr_b16 a[80:81], v115 offset:0
    ds_read_b64_tr_b16 a[82:83], v115 offset:512
    ds_read_b64_tr_b16 a[84:85], v115 offset:8320
    ds_read_b64_tr_b16 a[86:87], v115 offset:8832
    ds_read_b64_tr_b16 a[88:89], v115 offset:32
    ds_read_b64_tr_b16 a[90:91], v115 offset:544
    ds_read_b64_tr_b16 a[92:93], v115 offset:8352
    ds_read_b64_tr_b16 a[94:95], v115 offset:8864
    s_lshl_b32 s16, s12, 2
    s_add_u32 s16, s16, s13
    s_lshl_b32 s16, s16, 2
    s_add_u32 s16, s16, 24576
    v_mov_b32 v121, 1
    s_mov_b64 exec, 1
    buffer_store_dword v121, off, s[4:7], s16 sc1
    s_mov_b64 exec, -1
    s_waitcnt vmcnt(22)
    s_waitcnt lgkmcnt(0)
    s_barrier
    s_mul_i32 s19, s13, 4160
    s_add_u32 m0, s19, 130560
    s_add_u32 s16, s48, 1048576
    buffer_load_dwordx4 v112, s[8:11], s16 offen lds
    s_add_u32 m0, s19, 131600
    s_add_u32 s16, s48, 1081344
    buffer_load_dwordx4 v112, s[8:11], s16 offen lds
    s_add_u32 m0, s19, 132640
    s_add_u32 s16, s48, 1114112
    buffer_load_dwordx4 v112, s[8:11], s16 offen lds
    s_add_u32 m0, s19, 133680
    s_add_u32 s16, s48, 1146880
    buffer_load_dwordx4 v112, s[8:11], s16 offen lds
    v_add_u32 v115, 147328, v113
    ds_read_b64_tr_b16 v[16:17], v115 offset:0
    ds_read_b64_tr_b16 v[18:19], v115 offset:512
    ds_read_b64_tr_b16 v[20:21], v115 offset:8320
    ds_read_b64_tr_b16 v[22:23], v115 offset:8832
    ds_read_b64_tr_b16 v[24:25], v115 offset:32
    ds_read_b64_tr_b16 v[26:27], v115 offset:544
    ds_read_b64_tr_b16 v[28:29], v115 offset:8352
    ds_read_b64_tr_b16 v[30:31], v115 offset:8864
    s_waitcnt vmcnt(22)
    s_waitcnt lgkmcnt(0)
    s_barrier
    s_mul_i32 s19, s13, 4160
    s_add_u32 m0, s19, 147200
    s_add_u32 s16, s48, 1572864
    buffer_load_dwordx4 v112, s[8:11], s16 offen lds
    s_add_u32 m0, s19, 148240
    s_add_u32 s16, s48, 1605632
    buffer_load_dwordx4 v112, s[8:11], s16 offen lds
    s_add_u32 m0, s19, 149280
    s_add_u32 s16, s48, 1638400
    buffer_load_dwordx4 v112, s[8:11], s16 offen lds
    s_add_u32 m0, s19, 150320
    s_add_u32 s16, s48, 1671168
    buffer_load_dwordx4 v112, s[8:11], s16 offen lds
    v_add_u32 v115, 47488, v113
    ds_read_b64_tr_b16 v[32:33], v115 offset:0
    ds_read_b64_tr_b16 v[34:35], v115 offset:512
    ds_read_b64_tr_b16 v[36:37], v115 offset:8320
    ds_read_b64_tr_b16 v[38:39], v115 offset:8832
    ds_read_b64_tr_b16 v[40:41], v115 offset:32
    ds_read_b64_tr_b16 v[42:43], v115 offset:544
    ds_read_b64_tr_b16 v[44:45], v115 offset:8352
    ds_read_b64_tr_b16 v[46:47], v115 offset:8864
    s_waitcnt vmcnt(22)
    s_waitcnt lgkmcnt(0)
    s_barrier
    s_mul_i32 s19, s13, 4160
    s_add_u32 m0, s19, 47360
    s_add_u32 s16, s48, 2097152
    buffer_load_dwordx4 v112, s[8:11], s16 offen lds
    s_add_u32 m0, s19, 48400
    s_add_u32 s16, s48, 2129920
    buffer_load_dwordx4 v112, s[8:11], s16 offen lds
    s_add_u32 m0, s19, 49440
    s_add_u32 s16, s48, 2162688
    buffer_load_dwordx4 v112, s[8:11], s16 offen lds
    s_add_u32 m0, s19, 50480
    s_add_u32 s16, s48, 2195456
    buffer_load_dwordx4 v112, s[8:11], s16 offen lds
    v_add_u32 v115, 64128, v113
    ds_read_b64_tr_b16 a[0:1], v115 offset:0
    ds_read_b64_tr_b16 a[2:3], v115 offset:512
    ds_read_b64_tr_b16 a[4:5], v115 offset:8320
    ds_read_b64_tr_b16 a[6:7], v115 offset:8832
    ds_read_b64_tr_b16 a[8:9], v115 offset:32
    ds_read_b64_tr_b16 a[10:11], v115 offset:544
    ds_read_b64_tr_b16 a[12:13], v115 offset:8352
    ds_read_b64_tr_b16 a[14:15], v115 offset:8864
    s_waitcnt vmcnt(21)
    s_waitcnt lgkmcnt(0)
    s_barrier
    s_mul_i32 s19, s13, 4160
    s_add_u32 m0, s19, 64000
    s_add_u32 s16, s48, 2621440
    buffer_load_dwordx4 v112, s[8:11], s16 offen lds
    s_add_u32 m0, s19, 65040
    s_add_u32 s16, s48, 2654208
    buffer_load_dwordx4 v112, s[8:11], s16 offen lds
    s_add_u32 m0, s19, 66080
    s_add_u32 s16, s48, 2686976
    buffer_load_dwordx4 v112, s[8:11], s16 offen lds
    s_add_u32 m0, s19, 67120
    s_add_u32 s16, s48, 2719744
    buffer_load_dwordx4 v112, s[8:11], s16 offen lds
    v_add_u32 v115, 80768, v113
    ds_read_b64_tr_b16 a[16:17], v115 offset:0
    ds_read_b64_tr_b16 a[18:19], v115 offset:512
    ds_read_b64_tr_b16 a[20:21], v115 offset:8320
    ds_read_b64_tr_b16 a[22:23], v115 offset:8832
    ds_read_b64_tr_b16 a[24:25], v115 offset:32
    ds_read_b64_tr_b16 a[26:27], v115 offset:544
    ds_read_b64_tr_b16 a[28:29], v115 offset:8352
    ds_read_b64_tr_b16 a[30:31], v115 offset:8864
    s_waitcnt vmcnt(21)
    s_waitcnt lgkmcnt(0)
    s_barrier
    s_mul_i32 s19, s13, 4160
    s_add_u32 m0, s19, 80640
    s_add_u32 s16, s48, 3145728
    buffer_load_dwordx4 v112, s[8:11], s16 offen lds
    s_add_u32 m0, s19, 81680
    s_add_u32 s16, s48, 3178496
    buffer_load_dwordx4 v112, s[8:11], s16 offen lds
    s_add_u32 m0, s19, 82720
    s_add_u32 s16, s48, 3211264
    buffer_load_dwordx4 v112, s[8:11], s16 offen lds
    s_add_u32 m0, s19, 83760
    s_add_u32 s16, s48, 3244032
    buffer_load_dwordx4 v112, s[8:11], s16 offen lds
    v_add_u32 v115, 97408, v113
    ds_read_b64_tr_b16 v[96:97], v115 offset:0
    ds_read_b64_tr_b16 v[98:99], v115 offset:512
    ds_read_b64_tr_b16 v[100:101], v115 offset:8320
    ds_read_b64_tr_b16 v[102:103], v115 offset:8832
    ds_read_b64_tr_b16 a[120:121], v115 offset:32
    ds_read_b64_tr_b16 a[122:123], v115 offset:544
    ds_read_b64_tr_b16 a[124:125], v115 offset:8352
    ds_read_b64_tr_b16 a[126:127], v115 offset:8864
    s_waitcnt vmcnt(21)
    s_waitcnt lgkmcnt(0)
    s_barrier
    s_mul_i32 s19, s13, 4160
    s_add_u32 m0, s19, 97280
    s_add_u32 s16, s48, 3670016
    buffer_load_dwordx4 v112, s[8:11], s16 offen lds
    s_add_u32 m0, s19, 98320
    s_add_u32 s16, s48, 3702784
    buffer_load_dwordx4 v112, s[8:11], s16 offen lds
    s_add_u32 m0, s19, 99360
    s_add_u32 s16, s48, 3735552
    buffer_load_dwordx4 v112, s[8:11], s16 offen lds
    s_add_u32 m0, s19, 100400
    s_add_u32 s16, s48, 3768320
    buffer_load_dwordx4 v112, s[8:11], s16 offen lds
    v_add_u32 v115, 114048, v113
    ds_read_b64_tr_b16 a[128:129], v115 offset:0
    ds_read_b64_tr_b16 a[130:131], v115 offset:512
    ds_read_b64_tr_b16 a[132:133], v115 offset:8320
    ds_read_b64_tr_b16 a[134:135], v115 offset:8832
    ds_read_b64_tr_b16 a[136:137], v115 offset:32
    ds_read_b64_tr_b16 a[138:139], v115 offset:544
    ds_read_b64_tr_b16 a[140:141], v115 offset:8352
    ds_read_b64_tr_b16 a[142:143], v115 offset:8864
    s_waitcnt vmcnt(20)
    s_waitcnt lgkmcnt(0)
    s_barrier
    v_add_u32 v115, 130688, v113
    ds_read_b64_tr_b16 a[144:145], v115 offset:0
    ds_read_b64_tr_b16 a[146:147], v115 offset:512
    ds_read_b64_tr_b16 a[148:149], v115 offset:8320
    ds_read_b64_tr_b16 a[150:151], v115 offset:8832
    ds_read_b64_tr_b16 a[152:153], v115 offset:32
    ds_read_b64_tr_b16 a[154:155], v115 offset:544
    ds_read_b64_tr_b16 a[156:157], v115 offset:8352
    ds_read_b64_tr_b16 a[158:159], v115 offset:8864
    s_waitcnt vmcnt(16)
    s_waitcnt lgkmcnt(0)
    s_barrier
    v_add_u32 v115, 147328, v113
    ds_read_b64_tr_b16 a[160:161], v115 offset:0
    ds_read_b64_tr_b16 a[162:163], v115 offset:512
    ds_read_b64_tr_b16 a[164:165], v115 offset:8320
    ds_read_b64_tr_b16 a[166:167], v115 offset:8832
    ds_read_b64_tr_b16 v[104:105], v115 offset:32
    ds_read_b64_tr_b16 v[106:107], v115 offset:544
    ds_read_b64_tr_b16 v[108:109], v115 offset:8352
    ds_read_b64_tr_b16 v[110:111], v115 offset:8864
    s_waitcnt vmcnt(12)
    s_waitcnt lgkmcnt(0)
    s_barrier
    v_add_u32 v115, 47488, v113
    ds_read_b64_tr_b16 v[48:49], v115 offset:0
    ds_read_b64_tr_b16 v[50:51], v115 offset:512
    ds_read_b64_tr_b16 v[52:53], v115 offset:8320
    ds_read_b64_tr_b16 v[54:55], v115 offset:8832
    ds_read_b64_tr_b16 v[56:57], v115 offset:32
    ds_read_b64_tr_b16 v[58:59], v115 offset:544
    ds_read_b64_tr_b16 v[60:61], v115 offset:8352
    ds_read_b64_tr_b16 v[62:63], v115 offset:8864
    s_waitcnt vmcnt(8)
    s_waitcnt lgkmcnt(0)
    s_barrier
    v_add_u32 v115, 64128, v113
    ds_read_b64_tr_b16 v[72:73], v115 offset:0
    ds_read_b64_tr_b16 v[74:75], v115 offset:512
    ds_read_b64_tr_b16 v[76:77], v115 offset:8320
    ds_read_b64_tr_b16 v[78:79], v115 offset:8832
    ds_read_b64_tr_b16 a[96:97], v115 offset:32
    ds_read_b64_tr_b16 a[98:99], v115 offset:544
    ds_read_b64_tr_b16 a[100:101], v115 offset:8352
    ds_read_b64_tr_b16 a[102:103], v115 offset:8864
    v_lshrrev_b32 v118, 1, v0
    s_mov_b32 s16, 24576
    buffer_load_dwordx2 v[116:117], v118, s[4:7], s16 offen sc1
    s_load_dwordx2 s[8:9], s[0:1], 8
    s_mov_b32 s10, 8192
    s_mov_b32 s11, 0x20000
    s_waitcnt lgkmcnt(0)
    v_lshlrev_b32 v119, 3, v0
    buffer_load_dword v119, v119, s[8:11], 0 offen
    s_waitcnt vmcnt(6)
    s_waitcnt lgkmcnt(0)
    s_barrier
    v_add_u32 v115, 80768, v113
    ds_read_b64_tr_b16 v[80:81], v115 offset:0
    ds_read_b64_tr_b16 v[82:83], v115 offset:512
    ds_read_b64_tr_b16 v[84:85], v115 offset:8320
    ds_read_b64_tr_b16 v[86:87], v115 offset:8832
    ds_read_b64_tr_b16 a[104:105], v115 offset:32
    ds_read_b64_tr_b16 a[106:107], v115 offset:544
    ds_read_b64_tr_b16 a[108:109], v115 offset:8352
    ds_read_b64_tr_b16 a[110:111], v115 offset:8864
    s_waitcnt vmcnt(2)
    s_waitcnt lgkmcnt(0)
    s_barrier
    v_add_u32 v115, 97408, v113
    ds_read_b64_tr_b16 v[88:89], v115 offset:0
    ds_read_b64_tr_b16 v[90:91], v115 offset:512
    ds_read_b64_tr_b16 v[92:93], v115 offset:8320
    ds_read_b64_tr_b16 v[94:95], v115 offset:8832
    ds_read_b64_tr_b16 a[112:113], v115 offset:32
    ds_read_b64_tr_b16 a[114:115], v115 offset:544
    ds_read_b64_tr_b16 a[116:117], v115 offset:8352
    ds_read_b64_tr_b16 a[118:119], v115 offset:8864
    s_waitcnt lgkmcnt(0)
    s_barrier
    s_waitcnt lgkmcnt(0)
    ds_write_b128 v0, v[16:19] offset:36864
    ds_write_b128 v0, v[20:23] offset:37888
    ds_write_b128 v0, v[24:27] offset:45056
    ds_write_b128 v0, v[28:31] offset:46080
    ds_write_b128 v0, v[32:35] offset:53248
    ds_write_b128 v0, v[36:39] offset:54272
    ds_write_b128 v0, v[40:43] offset:61440
    ds_write_b128 v0, v[44:47] offset:62464
    ds_write_b128 v1, v[48:51] offset:4096
    ds_write_b128 v1, v[52:55] offset:5120
    ds_write_b128 v1, v[56:59] offset:12288
    ds_write_b128 v1, v[60:63] offset:13312
    ds_write_b128 v1, v[64:67] offset:20480
    ds_write_b128 v1, v[68:71] offset:21504
    ds_write_b128 v1, v[72:75] offset:28672
    ds_write_b128 v1, v[76:79] offset:29696
    ds_write_b128 v1, v[80:83] offset:36864
    ds_write_b128 v1, v[84:87] offset:37888
    ds_write_b128 v1, v[88:91] offset:45056
    ds_write_b128 v1, v[92:95] offset:46080
    ds_write_b128 v1, v[96:99] offset:53248
    ds_write_b128 v1, v[100:103] offset:54272
    ds_write_b128 v1, v[104:107] offset:61440
    ds_write_b128 v1, v[108:111] offset:62464
    s_branch L_lwe_256
L_lw3_255:
    s_load_dwordx2 s[8:9], s[0:1], 32
    s_mov_b32 s10, 4194304
    s_mov_b32 s11, 0x20000
    s_waitcnt lgkmcnt(0)
    v_lshrrev_b32 v123, 8, v0
    v_lshl_add_u32 v123, s13, 4, v123
    v_mul_u32_u24 v123, 8192, v123
    v_and_b32 v112, 0xf0, v0
    v_add_u32 v112, v123, v112
    s_mul_i32 s19, s13, 4160
    s_add_u32 m0, s19, 47360
    s_add_u32 s16, s48, 0
    buffer_load_dwordx4 v112, s[8:11], s16 offen lds
    s_add_u32 m0, s19, 48400
    s_add_u32 s16, s48, 32768
    buffer_load_dwordx4 v112, s[8:11], s16 offen lds
    s_add_u32 m0, s19, 49440
    s_add_u32 s16, s48, 65536
    buffer_load_dwordx4 v112, s[8:11], s16 offen lds
    s_add_u32 m0, s19, 50480
    s_add_u32 s16, s48, 98304
    buffer_load_dwordx4 v112, s[8:11], s16 offen lds
    s_mul_i32 s19, s13, 4160
    s_add_u32 m0, s19, 64000
    s_add_u32 s16, s48, 524288
    buffer_load_dwordx4 v112, s[8:11], s16 offen lds
    s_add_u32 m0, s19, 65040
    s_add_u32 s16, s48, 557056
    buffer_load_dwordx4 v112, s[8:11], s16 offen lds
    s_add_u32 m0, s19, 66080
    s_add_u32 s16, s48, 589824
    buffer_load_dwordx4 v112, s[8:11], s16 offen lds
    s_add_u32 m0, s19, 67120
    s_add_u32 s16, s48, 622592
    buffer_load_dwordx4 v112, s[8:11], s16 offen lds
    s_mul_i32 s19, s13, 4160
    s_add_u32 m0, s19, 80640
    s_add_u32 s16, s48, 1048576
    buffer_load_dwordx4 v112, s[8:11], s16 offen lds
    s_add_u32 m0, s19, 81680
    s_add_u32 s16, s48, 1081344
    buffer_load_dwordx4 v112, s[8:11], s16 offen lds
    s_add_u32 m0, s19, 82720
    s_add_u32 s16, s48, 1114112
    buffer_load_dwordx4 v112, s[8:11], s16 offen lds
    s_add_u32 m0, s19, 83760
    s_add_u32 s16, s48, 1146880
    buffer_load_dwordx4 v112, s[8:11], s16 offen lds
    s_mul_i32 s19, s13, 4160
    s_add_u32 m0, s19, 97280
    s_add_u32 s16, s48, 1572864
    buffer_load_dwordx4 v112, s[8:11], s16 offen lds
    s_add_u32 m0, s19, 98320
    s_add_u32 s16, s48, 1605632
    buffer_load_dwordx4 v112, s[8:11], s16 offen lds
    s_add_u32 m0, s19, 99360
    s_add_u32 s16, s48, 1638400
    buffer_load_dwordx4 v112, s[8:11], s16 offen lds
    s_add_u32 m0, s19, 100400
    s_add_u32 s16, s48, 1671168
    buffer_load_dwordx4 v112, s[8:11], s16 offen lds
    s_mul_i32 s19, s13, 4160
    s_add_u32 m0, s19, 113920
    s_add_u32 s16, s48, 2097152
    buffer_load_dwordx4 v112, s[8:11], s16 offen lds
    s_add_u32 m0, s19, 114960
    s_add_u32 s16, s48, 2129920
    buffer_load_dwordx4 v112, s[8:11], s16 offen lds
    s_add_u32 m0, s19, 116000
    s_add_u32 s16, s48, 2162688
    buffer_load_dwordx4 v112, s[8:11], s16 offen lds
    s_add_u32 m0, s19, 117040
    s_add_u32 s16, s48, 2195456
    buffer_load_dwordx4 v112, s[8:11], s16 offen lds
    s_mul_i32 s19, s13, 4160
    s_add_u32 m0, s19, 130560
    s_add_u32 s16, s48, 2621440
    buffer_load_dwordx4 v112, s[8:11], s16 offen lds
    s_add_u32 m0, s19, 131600
    s_add_u32 s16, s48, 2654208
    buffer_load_dwordx4 v112, s[8:11], s16 offen lds
    s_add_u32 m0, s19, 132640
    s_add_u32 s16, s48, 2686976
    buffer_load_dwordx4 v112, s[8:11], s16 offen lds
    s_add_u32 m0, s19, 133680
    s_add_u32 s16, s48, 2719744
    buffer_load_dwordx4 v112, s[8:11], s16 offen lds
    s_waitcnt vmcnt(20)
    s_waitcnt lgkmcnt(0)
    s_barrier
    s_mul_i32 s19, s13, 4160
    s_add_u32 m0, s19, 147200
    s_add_u32 s16, s48, 3145728
    buffer_load_dwordx4 v112, s[8:11], s16 offen lds
    s_add_u32 m0, s19, 148240
    s_add_u32 s16, s48, 3178496
    buffer_load_dwordx4 v112, s[8:11], s16 offen lds
    s_add_u32 m0, s19, 149280
    s_add_u32 s16, s48, 3211264
    buffer_load_dwordx4 v112, s[8:11], s16 offen lds
    s_add_u32 m0, s19, 150320
    s_add_u32 s16, s48, 3244032
    buffer_load_dwordx4 v112, s[8:11], s16 offen lds
    v_add_u32 v115, 47552, v113
    ds_read_b64_tr_b16 a[192:193], v115 offset:0
    ds_read_b64_tr_b16 a[194:195], v115 offset:512
    ds_read_b64_tr_b16 a[196:197], v115 offset:8320
    ds_read_b64_tr_b16 a[198:199], v115 offset:8832
    ds_read_b64_tr_b16 a[200:201], v115 offset:32
    ds_read_b64_tr_b16 a[202:203], v115 offset:544
    ds_read_b64_tr_b16 a[204:205], v115 offset:8352
    ds_read_b64_tr_b16 a[206:207], v115 offset:8864
    s_waitcnt vmcnt(20)
    s_waitcnt lgkmcnt(0)
    s_barrier
    s_mul_i32 s19, s13, 4160
    s_add_u32 m0, s19, 47360
    s_add_u32 s16, s48, 3670016
    buffer_load_dwordx4 v112, s[8:11], s16 offen lds
    s_add_u32 m0, s19, 48400
    s_add_u32 s16, s48, 3702784
    buffer_load_dwordx4 v112, s[8:11], s16 offen lds
    s_add_u32 m0, s19, 49440
    s_add_u32 s16, s48, 3735552
    buffer_load_dwordx4 v112, s[8:11], s16 offen lds
    s_add_u32 m0, s19, 50480
    s_add_u32 s16, s48, 3768320
    buffer_load_dwordx4 v112, s[8:11], s16 offen lds
    v_add_u32 v115, 64192, v113
    ds_read_b64_tr_b16 a[208:209], v115 offset:0
    ds_read_b64_tr_b16 a[210:211], v115 offset:512
    ds_read_b64_tr_b16 a[212:213], v115 offset:8320
    ds_read_b64_tr_b16 a[214:215], v115 offset:8832
    ds_read_b64_tr_b16 a[216:217], v115 offset:32
    ds_read_b64_tr_b16 a[218:219], v115 offset:544
    ds_read_b64_tr_b16 a[220:221], v115 offset:8352
    ds_read_b64_tr_b16 a[222:223], v115 offset:8864
    s_waitcnt vmcnt(20)
    s_waitcnt lgkmcnt(0)
    s_barrier
    s_load_dwordx2 s[8:9], s[0:1], 40
    s_mov_b32 s10, 4194304
    s_mov_b32 s11, 0x20000
    s_waitcnt lgkmcnt(0)
    v_mov_b32 v112, v0
    s_mul_i32 s19, s13, 4160
    s_add_u32 m0, s19, 64000
    s_add_u32 s16, s49, 20480
    buffer_load_dwordx4 v112, s[8:11], s16 offen lds
    s_add_u32 m0, s19, 65040
    s_add_u32 s16, s49, 21504
    buffer_load_dwordx4 v112, s[8:11], s16 offen lds
    s_add_u32 m0, s19, 66080
    s_add_u32 s16, s49, 22528
    buffer_load_dwordx4 v112, s[8:11], s16 offen lds
    s_add_u32 m0, s19, 67120
    s_add_u32 s16, s49, 23552
    buffer_load_dwordx4 v112, s[8:11], s16 offen lds
    v_add_u32 v115, 80832, v113
    ds_read_b64_tr_b16 a[224:225], v115 offset:0
    ds_read_b64_tr_b16 a[226:227], v115 offset:512
    ds_read_b64_tr_b16 a[228:229], v115 offset:8320
    ds_read_b64_tr_b16 a[230:231], v115 offset:8832
    ds_read_b64_tr_b16 a[232:233], v115 offset:32
    ds_read_b64_tr_b16 a[234:235], v115 offset:544
    ds_read_b64_tr_b16 a[236:237], v115 offset:8352
    ds_read_b64_tr_b16 a[238:239], v115 offset:8864
    s_waitcnt vmcnt(20)
    s_waitcnt lgkmcnt(0)
    s_barrier
    s_mul_i32 s19, s13, 4160
    s_add_u32 m0, s19, 80640
    s_add_u32 s16, s49, 28672
    buffer_load_dwordx4 v112, s[8:11], s16 offen lds
    s_add_u32 m0, s19, 81680
    s_add_u32 s16, s49, 29696
    buffer_load_dwordx4 v112, s[8:11], s16 offen lds
    s_add_u32 m0, s19, 82720
    s_add_u32 s16, s49, 30720
    buffer_load_dwordx4 v112, s[8:11], s16 offen lds
    s_add_u32 m0, s19, 83760
    s_add_u32 s16, s49, 31744
    buffer_load_dwordx4 v112, s[8:11], s16 offen lds
    v_add_u32 v115, 97472, v113
    ds_read_b64_tr_b16 a[240:241], v115 offset:0
    ds_read_b64_tr_b16 a[242:243], v115 offset:512
    ds_read_b64_tr_b16 a[244:245], v115 offset:8320
    ds_read_b64_tr_b16 a[246:247], v115 offset:8832
    ds_read_b64_tr_b16 a[248:249], v115 offset:32
    ds_read_b64_tr_b16 a[250:251], v115 offset:544
    ds_read_b64_tr_b16 a[252:253], v115 offset:8352
    ds_read_b64_tr_b16 a[254:255], v115 offset:8864
    s_waitcnt vmcnt(20)
    s_waitcnt lgkmcnt(0)
    s_barrier
    s_mul_i32 s19, s13, 4160
    s_add_u32 m0, s19, 97280
    s_add_u32 s16, s49, 53248
    buffer_load_dwordx4 v112, s[8:11], s16 offen lds
    s_add_u32 m0, s19, 98320
    s_add_u32 s16, s49, 54272
    buffer_load_dwordx4 v112, s[8:11], s16 offen lds
    s_add_u32 m0, s19, 99360
    s_add_u32 s16, s49, 55296
    buffer_load_dwordx4 v112, s[8:11], s16 offen lds
    s_add_u32 m0, s19, 100400
    s_add_u32 s16, s49, 56320
    buffer_load_dwordx4 v112, s[8:11], s16 offen lds
    v_add_u32 v115, 114112, v113
    ds_read_b64_tr_b16 v[128:129], v115 offset:0
    ds_read_b64_tr_b16 v[130:131], v115 offset:512
    ds_read_b64_tr_b16 v[132:133], v115 offset:8320
    ds_read_b64_tr_b16 v[134:135], v115 offset:8832
    ds_read_b64_tr_b16 v[136:137], v115 offset:32
    ds_read_b64_tr_b16 v[138:139], v115 offset:544
    ds_read_b64_tr_b16 v[140:141], v115 offset:8352
    ds_read_b64_tr_b16 v[142:143], v115 offset:8864
    s_waitcnt vmcnt(20)
    s_waitcnt lgkmcnt(0)
    s_barrier
    s_mul_i32 s19, s13, 4160
    s_add_u32 m0, s19, 113920
    s_add_u32 s16, s49, 61440
    buffer_load_dwordx4 v112, s[8:11], s16 offen lds
    s_add_u32 m0, s19, 114960
    s_add_u32 s16, s49, 62464
    buffer_load_dwordx4 v112, s[8:11], s16 offen lds
    s_add_u32 m0, s19, 116000
    s_add_u32 s16, s49, 63488
    buffer_load_dwordx4 v112, s[8:11], s16 offen lds
    s_add_u32 m0, s19, 117040
    s_add_u32 s16, s49, 64512
    buffer_load_dwordx4 v112, s[8:11], s16 offen lds
    v_add_u32 v115, 130752, v113
    ds_read_b64_tr_b16 v[144:145], v115 offset:0
    ds_read_b64_tr_b16 v[146:147], v115 offset:512
    ds_read_b64_tr_b16 v[148:149], v115 offset:8320
    ds_read_b64_tr_b16 v[150:151], v115 offset:8832
    ds_read_b64_tr_b16 v[152:153], v115 offset:32
    ds_read_b64_tr_b16 v[154:155], v115 offset:544
    ds_read_b64_tr_b16 v[156:157], v115 offset:8352
    ds_read_b64_tr_b16 v[158:159], v115 offset:8864
    v_and_b32 v118, 0xf0, v0
    global_load_dwordx2 v[116:117], v118, s[56:57] sc1
    s_waitcnt vmcnt(21)
    s_waitcnt lgkmcnt(0)
    s_barrier
    s_mul_i32 s19, s13, 4160
    s_add_u32 m0, s19, 130560
    s_add_u32 s16, s49, 86016
    buffer_load_dwordx4 v112, s[8:11], s16 offen lds
    s_add_u32 m0, s19, 131600
    s_add_u32 s16, s49, 87040
    buffer_load_dwordx4 v112, s[8:11], s16 offen lds
    s_add_u32 m0, s19, 132640
    s_add_u32 s16, s49, 88064
    buffer_load_dwordx4 v112, s[8:11], s16 offen lds
    s_add_u32 m0, s19, 133680
    s_add_u32 s16, s49, 89088
    buffer_load_dwordx4 v112, s[8:11], s16 offen lds
    v_add_u32 v115, 147392, v113
    ds_read_b64_tr_b16 v[64:65], v115 offset:0
    ds_read_b64_tr_b16 v[66:67], v115 offset:512
    ds_read_b64_tr_b16 v[68:69], v115 offset:8320
    ds_read_b64_tr_b16 v[70:71], v115 offset:8832
    ds_read_b64_tr_b16 a[168:169], v115 offset:32
    ds_read_b64_tr_b16 a[170:171], v115 offset:544
    ds_read_b64_tr_b16 a[172:173], v115 offset:8352
    ds_read_b64_tr_b16 a[174:175], v115 offset:8864
    s_waitcnt vmcnt(21)
    s_waitcnt lgkmcnt(0)
    s_barrier
    s_mul_i32 s19, s13, 4160
    s_add_u32 m0, s19, 147200
    s_add_u32 s16, s49, 94208
    buffer_load_dwordx4 v112, s[8:11], s16 offen lds
    s_add_u32 m0, s19, 148240
    s_add_u32 s16, s49, 95232
    buffer_load_dwordx4 v112, s[8:11], s16 offen lds
    s_add_u32 m0, s19, 149280
    s_add_u32 s16, s49, 96256
    buffer_load_dwordx4 v112, s[8:11], s16 offen lds
    s_add_u32 m0, s19, 150320
    s_add_u32 s16, s49, 97280
    buffer_load_dwordx4 v112, s[8:11], s16 offen lds
    v_add_u32 v115, 47552, v113
    ds_read_b64_tr_b16 a[176:177], v115 offset:0
    ds_read_b64_tr_b16 a[178:179], v115 offset:512
    ds_read_b64_tr_b16 a[180:181], v115 offset:8320
    ds_read_b64_tr_b16 a[182:183], v115 offset:8832
    ds_read_b64_tr_b16 a[184:185], v115 offset:32
    ds_read_b64_tr_b16 a[186:187], v115 offset:544
    ds_read_b64_tr_b16 a[188:189], v115 offset:8352
    ds_read_b64_tr_b16 a[190:191], v115 offset:8864
    s_waitcnt vmcnt(21)
    s_waitcnt lgkmcnt(0)
    s_barrier
    s_mul_i32 s19, s13, 4160
    s_add_u32 m0, s19, 47360
    s_add_u32 s16, s49, 118784
    buffer_load_dwordx4 v112, s[8:11], s16 offen lds
    s_add_u32 m0, s19, 48400
    s_add_u32 s16, s49, 119808
    buffer_load_dwordx4 v112, s[8:11], s16 offen lds
    s_add_u32 m0, s19, 49440
    s_add_u32 s16, s49, 120832
    buffer_load_dwordx4 v112, s[8:11], s16 offen lds
    s_add_u32 m0, s19, 50480
    s_add_u32 s16, s49, 121856
    buffer_load_dwordx4 v112, s[8:11], s16 offen lds
    v_add_u32 v115, 64192, v114
    ds_read_b64_tr_b16 v[160:161], v115 offset:0
    ds_read_b64_tr_b16 v[162:163], v115 offset:2080
    ds_read_b64_tr_b16 v[192:193], v115 offset:256
    ds_read_b64_tr_b16 v[194:195], v115 offset:2336
    ds_read_b64_tr_b16 v[224:225], v115 offset:512
    ds_read_b64_tr_b16 v[226:227], v115 offset:2592
    ds_read_b64_tr_b16 v[16:17], v115 offset:768
    ds_read_b64_tr_b16 v[18:19], v115 offset:2848
    s_waitcnt vmcnt(21)
    s_waitcnt lgkmcnt(0)
    s_barrier
    s_mul_i32 s19, s13, 4160
    s_add_u32 m0, s19, 64000
    s_add_u32 s16, s49, 126976
    buffer_load_dwordx4 v112, s[8:11], s16 offen lds
    s_add_u32 m0, s19, 65040
    s_add_u32 s16, s49, 128000
    buffer_load_dwordx4 v112, s[8:11], s16 offen lds
    s_add_u32 m0, s19, 66080
    s_add_u32 s16, s49, 129024
    buffer_load_dwordx4 v112, s[8:11], s16 offen lds
    s_add_u32 m0, s19, 67120
    s_add_u32 s16, s49, 130048
    buffer_load_dwordx4 v112, s[8:11], s16 offen lds
    v_add_u32 v115, 80832, v114
    ds_read_b64_tr_b16 v[164:165], v115 offset:0
    ds_read_b64_tr_b16 v[166:167], v115 offset:2080
    ds_read_b64_tr_b16 v[196:197], v115 offset:256
    ds_read_b64_tr_b16 v[198:199], v115 offset:2336
    ds_read_b64_tr_b16 v[228:229], v115 offset:512
    ds_read_b64_tr_b16 v[230:231], v115 offset:2592
    ds_read_b64_tr_b16 v[20:21], v115 offset:768
    ds_read_b64_tr_b16 v[22:23], v115 offset:2848
    s_waitcnt vmcnt(21)
    s_waitcnt lgkmcnt(0)
    s_barrier
    s_load_dwordx2 s[8:9], s[0:1], 16
    s_mov_b32 s10, 4194304
    s_mov_b32 s11, 0x20000
    s_waitcnt lgkmcnt(0)
    v_lshrrev_b32 v123, 8, v0
    v_lshl_add_u32 v123, s13, 4, v123
    v_mul_u32_u24 v123, 8192, v123
    v_and_b32 v112, 0xf0, v0
    v_add_u32 v112, v123, v112
    s_mul_i32 s19, s13, 4160
    s_add_u32 m0, s19, 80640
    s_add_u32 s16, s48, 0
    buffer_load_dwordx4 v112, s[8:11], s16 offen lds
    s_add_u32 m0, s19, 81680
    s_add_u32 s16, s48, 32768
    buffer_load_dwordx4 v112, s[8:11], s16 offen lds
    s_add_u32 m0, s19, 82720
    s_add_u32 s16, s48, 65536
    buffer_load_dwordx4 v112, s[8:11], s16 offen lds
    s_add_u32 m0, s19, 83760
    s_add_u32 s16, s48, 98304
    buffer_load_dwordx4 v112, s[8:11], s16 offen lds
    v_add_u32 v115, 97472, v114
    ds_read_b64_tr_b16 v[168:169], v115 offset:0
    ds_read_b64_tr_b16 v[170:171], v115 offset:2080
    ds_read_b64_tr_b16 v[200:201], v115 offset:256
    ds_read_b64_tr_b16 v[202:203], v115 offset:2336
    ds_read_b64_tr_b16 v[232:233], v115 offset:512
    ds_read_b64_tr_b16 v[234:235], v115 offset:2592
    ds_read_b64_tr_b16 v[24:25], v115 offset:768
    ds_read_b64_tr_b16 v[26:27], v115 offset:2848
    s_waitcnt vmcnt(21)
    s_waitcnt lgkmcnt(0)
    s_barrier
    s_mul_i32 s19, s13, 4160
    s_add_u32 m0, s19, 97280
    s_add_u32 s16, s48, 524288
    buffer_load_dwordx4 v112, s[8:11], s16 offen lds
    s_add_u32 m0, s19, 98320
    s_add_u32 s16, s48, 557056
    buffer_load_dwordx4 v112, s[8:11], s16 offen lds
    s_add_u32 m0, s19, 99360
    s_add_u32 s16, s48, 589824
    buffer_load_dwordx4 v112, s[8:11], s16 offen lds
    s_add_u32 m0, s19, 100400
    s_add_u32 s16, s48, 622592
    buffer_load_dwordx4 v112, s[8:11], s16 offen lds
    v_add_u32 v115, 114112, v114
    ds_read_b64_tr_b16 v[172:173], v115 offset:0
    ds_read_b64_tr_b16 v[174:175], v115 offset:2080
    ds_read_b64_tr_b16 v[204:205], v115 offset:256
    ds_read_b64_tr_b16 v[206:207], v115 offset:2336
    ds_read_b64_tr_b16 v[236:237], v115 offset:512
    ds_read_b64_tr_b16 v[238:239], v115 offset:2592
    ds_read_b64_tr_b16 v[28:29], v115 offset:768
    ds_read_b64_tr_b16 v[30:31], v115 offset:2848
    s_waitcnt vmcnt(20)
    s_waitcnt lgkmcnt(0)
    s_barrier
    s_mul_i32 s19, s13, 4160
    s_add_u32 m0, s19, 113920
    s_add_u32 s16, s48, 1048576
    buffer_load_dwordx4 v112, s[8:11], s16 offen lds
    s_add_u32 m0, s19, 114960
    s_add_u32 s16, s48, 1081344
    buffer_load_dwordx4 v112, s[8:11], s16 offen lds
    s_add_u32 m0, s19, 116000
    s_add_u32 s16, s48, 1114112
    buffer_load_dwordx4 v112, s[8:11], s16 offen lds
    s_add_u32 m0, s19, 117040
    s_add_u32 s16, s48, 1146880
    buffer_load_dwordx4 v112, s[8:11], s16 offen lds
    v_add_u32 v115, 130752, v114
    ds_read_b64_tr_b16 v[176:177], v115 offset:0
    ds_read_b64_tr_b16 v[178:179], v115 offset:2080
    ds_read_b64_tr_b16 v[208:209], v115 offset:256
    ds_read_b64_tr_b16 v[210:211], v115 offset:2336
    ds_read_b64_tr_b16 v[240:241], v115 offset:512
    ds_read_b64_tr_b16 v[242:243], v115 offset:2592
    ds_read_b64_tr_b16 v[32:33], v115 offset:768
    ds_read_b64_tr_b16 v[34:35], v115 offset:2848
    s_cmp_lg_u32 s59, 0
    s_cbranch_scc1 L_vok_270
    s_branch L_vc_272
L_vp_269:
    v_and_b32 v118, 0xf0, v0
    global_load_dwordx2 v[116:117], v118, s[56:57] sc1
    s_waitcnt vmcnt(0)
L_vc_272:
    v_lshrrev_b32 v119, 8, v117
    s_nop 1
    v_add_u32_dpp v119, v119, v119 quad_perm:[1,0,3,2] row_mask:0xf bank_mask:0xf
    s_nop 1
    v_add_u32_dpp v119, v119, v119 quad_perm:[2,3,0,1] row_mask:0xf bank_mask:0xf
    s_nop 1
    v_add_u32_dpp v119, v119, v119 row_half_mirror row_mask:0xf bank_mask:0xf
    s_nop 1
    v_add_u32_dpp v119, v119, v119 row_mirror row_mask:0xf bank_mask:0xf
    v_cmp_ne_u32 vcc, 0x100, v119
    s_cbranch_vccz L_vgo_271
    s_add_u32 s40, s40, 1
    s_cmp_gt_u32 s40, 262144
    s_cbranch_scc1 L_abort
    s_sleep 2
    s_branch L_vp_269
L_vgo_271:
    s_mov_b32 s59, 1
    v_cmp_ne_u32 vcc, -1, v116
    s_and_b32 s16, vcc_lo, 0x5555
    v_cmp_ne_u32 vcc, 0x2000, v117
    s_and_b32 s17, vcc_lo, 0x5555
    s_or_b32 s16, s16, s17
    s_cbranch_scc0 L_vok_270
    v_lshrrev_b32 v119, 8, v117
    v_cmp_ne_u32 vcc, 32, v119
    s_and_b32 s60, vcc_lo, 0x5555
    s_branch L_redo
L_vok_270:
    v_mov_b32 v116, 0
    v_mov_b32 v117, 0
    v_mov_b32 v118, 0
    v_mov_b32 v119, 0
    v_mov_b32 v120, -1
    buffer_store_dwordx2 v[116:117], v9, s[4:7], s20 offen sc1
    buffer_store_dwordx2 v[116:117], v9, s[4:7], s21 offen sc1
    buffer_store_dwordx2 v[116:117], v9, s[4:7], s25 offen sc1
    buffer_store_dwordx2 v[116:117], v9, s[4:7], s37 offen sc1
    s_add_u32 s16, s26, s30
    buffer_store_dword v120, v11, s[4:7], s16 offen sc1
    s_add_u32 s16, s27, s30
    buffer_store_dword v120, v11, s[4:7], s16 offen sc1
    s_add_u32 s16, s28, s30
    buffer_store_dword v120, v11, s[4:7], s16 offen sc1
    s_waitcnt vmcnt(27)
    s_waitcnt lgkmcnt(0)
    s_barrier
    s_mul_i32 s19, s13, 4160
    s_add_u32 m0, s19, 130560
    s_add_u32 s16, s48, 1572864
    buffer_load_dwordx4 v112, s[8:11], s16 offen lds
    s_add_u32 m0, s19, 131600
    s_add_u32 s16, s48, 1605632
    buffer_load_dwordx4 v112, s[8:11], s16 offen lds
    s_add_u32 m0, s19, 132640
    s_add_u32 s16, s48, 1638400
    buffer_load_dwordx4 v112, s[8:11], s16 offen lds
    s_add_u32 m0, s19, 133680
    s_add_u32 s16, s48, 1671168
    buffer_load_dwordx4 v112, s[8:11], s16 offen lds
    v_add_u32 v115, 147392, v114
    ds_read_b64_tr_b16 v[180:181], v115 offset:0
    ds_read_b64_tr_b16 v[182:183], v115 offset:2080
    ds_read_b64_tr_b16 v[212:213], v115 offset:256
    ds_read_b64_tr_b16 v[214:215], v115 offset:2336
    ds_read_b64_tr_b16 v[244:245], v115 offset:512
    ds_read_b64_tr_b16 v[246:247], v115 offset:2592
    ds_read_b64_tr_b16 v[36:37], v115 offset:768
    ds_read_b64_tr_b16 v[38:39], v115 offset:2848
    s_waitcnt vmcnt(27)
    s_waitcnt lgkmcnt(0)
    s_barrier
    s_mul_i32 s19, s13, 4160
    s_add_u32 m0, s19, 147200
    s_add_u32 s16, s48, 2097152
    buffer_load_dwordx4 v112, s[8:11], s16 offen lds
    s_add_u32 m0, s19, 148240
    s_add_u32 s16, s48, 2129920
    buffer_load_dwordx4 v112, s[8:11], s16 offen lds
    s_add_u32 m0, s19, 149280
    s_add_u32 s16, s48, 2162688
    buffer_load_dwordx4 v112, s[8:11], s16 offen lds
    s_add_u32 m0, s19, 150320
    s_add_u32 s16, s48, 2195456
    buffer_load_dwordx4 v112, s[8:11], s16 offen lds
    v_add_u32 v115, 47552, v114
    ds_read_b64_tr_b16 v[184:185], v115 offset:0
    ds_read_b64_tr_b16 v[186:187], v115 offset:2080
    ds_read_b64_tr_b16 v[216:217], v115 offset:256
    ds_read_b64_tr_b16 v[218:219], v115 offset:2336
    ds_read_b64_tr_b16 v[248:249], v115 offset:512
    ds_read_b64_tr_b16 v[250:251], v115 offset:2592
    ds_read_b64_tr_b16 v[40:41], v115 offset:768
    ds_read_b64_tr_b16 v[42:43], v115 offset:2848
    s_waitcnt vmcnt(27)
    s_waitcnt lgkmcnt(0)
    s_barrier
    s_mul_i32 s19, s13, 4160
    s_add_u32 m0, s19, 47360
    s_add_u32 s16, s48, 2621440
    buffer_load_dwordx4 v112, s[8:11], s16 offen lds
    s_add_u32 m0, s19, 48400
    s_add_u32 s16, s48, 2654208
    buffer_load_dwordx4 v112, s[8:11], s16 offen lds
    s_add_u32 m0, s19, 49440
    s_add_u32 s16, s48, 2686976
    buffer_load_dwordx4 v112, s[8:11], s16 offen lds
    s_add_u32 m0, s19, 50480
    s_add_u32 s16, s48, 2719744
    buffer_load_dwordx4 v112, s[8:11], s16 offen lds
    v_add_u32 v115, 64192, v114
    ds_read_b64_tr_b16 v[188:189], v115 offset:0
    ds_read_b64_tr_b16 v[190:191], v115 offset:2080
    ds_read_b64_tr_b16 v[220:221], v115 offset:256
    ds_read_b64_tr_b16 v[222:223], v115 offset:2336
    ds_read_b64_tr_b16 v[252:253], v115 offset:512
    ds_read_b64_tr_b16 v[254:255], v115 offset:2592
    ds_read_b64_tr_b16 v[44:45], v115 offset:768
    ds_read_b64_tr_b16 v[46:47], v115 offset:2848
    s_waitcnt lgkmcnt(0)
    ds_write_b128 v0, v[16:19] offset:6144
    ds_write_b128 v0, v[20:23] offset:7168
    ds_write_b128 v0, v[24:27] offset:14336
    ds_write_b128 v0, v[28:31] offset:15360
    ds_write_b128 v0, v[32:35] offset:22528
    ds_write_b128 v0, v[36:39] offset:23552
    ds_write_b128 v0, v[40:43] offset:30720
    ds_write_b128 v0, v[44:47] offset:31744
    s_waitcnt vmcnt(27)
    s_waitcnt lgkmcnt(0)
    s_barrier
    s_mul_i32 s19, s13, 4160
    s_add_u32 m0, s19, 64000
    s_add_u32 s16, s48, 3145728
    buffer_load_dwordx4 v112, s[8:11], s16 offen lds
    s_add_u32 m0, s19, 65040
    s_add_u32 s16, s48, 3178496
    buffer_load_dwordx4 v112, s[8:11], s16 offen lds
    s_add_u32 m0, s19, 66080
    s_add_u32 s16, s48, 3211264
    buffer_load_dwordx4 v112, s[8:11], s16 offen lds
    s_add_u32 m0, s19, 67120
    s_add_u32 s16, s48, 3244032
    buffer_load_dwordx4 v112, s[8:11], s16 offen lds
    v_add_u32 v115, 80832, v113
    ds_read_b64_tr_b16 a[0:1], v115 offset:0
    ds_read_b64_tr_b16 a[2:3], v115 offset:512
    ds_read_b64_tr_b16 a[4:5], v115 offset:8320
    ds_read_b64_tr_b16 a[6:7], v115 offset:8832
    ds_read_b64_tr_b16 a[8:9], v115 offset:32
    ds_read_b64_tr_b16 a[10:11], v115 offset:544
    ds_read_b64_tr_b16 a[12:13], v115 offset:8352
    ds_read_b64_tr_b16 a[14:15], v115 offset:8864
    v_lshlrev_b32 v124, 16, v0
    s_lshl_b32 s16, s13, 26
    s_add_u32 s16, s16, 1048448
    buffer_load_dword v124, v124, s[4:7], s16 offen sc1
    s_waitcnt vmcnt(28)
    s_waitcnt lgkmcnt(0)
    s_barrier
    s_mul_i32 s19, s13, 4160
    s_add_u32 m0, s19, 80640
    s_add_u32 s16, s48, 3670016
    buffer_load_dwordx4 v112, s[8:11], s16 offen lds
    s_add_u32 m0, s19, 81680
    s_add_u32 s16, s48, 3702784
    buffer_load_dwordx4 v112, s[8:11], s16 offen lds
    s_add_u32 m0, s19, 82720
    s_add_u32 s16, s48, 3735552
    buffer_load_dwordx4 v112, s[8:11], s16 offen lds
    s_add_u32 m0, s19, 83760
    s_add_u32 s16, s48, 3768320
    buffer_load_dwordx4 v112, s[8:11], s16 offen lds
    v_add_u32 v115, 97472, v113
    ds_read_b64_tr_b16 a[16:17], v115 offset:0
    ds_read_b64_tr_b16 a[18:19], v115 offset:512
    ds_read_b64_tr_b16 a[20:21], v115 offset:8320
    ds_read_b64_tr_b16 a[22:23], v115 offset:8832
    ds_read_b64_tr_b16 a[24:25], v115 offset:32
    ds_read_b64_tr_b16 a[26:27], v115 offset:544
    ds_read_b64_tr_b16 a[28:29], v115 offset:8352
    ds_read_b64_tr_b16 a[30:31], v115 offset:8864
    s_waitcnt vmcnt(28)
    s_waitcnt lgkmcnt(0)
    s_barrier
    s_load_dwordx2 s[8:9], s[0:1], 24
    s_mov_b32 s10, 4194304
    s_mov_b32 s11, 0x20000
    s_waitcnt lgkmcnt(0)
    v_lshrrev_b32 v123, 8, v0
    v_lshl_add_u32 v123, s13, 4, v123
    v_mul_u32_u24 v123, 8192, v123
    v_and_b32 v112, 0xf0, v0
    v_add_u32 v112, v123, v112
    s_mul_i32 s19, s13, 4160
    s_add_u32 m0, s19, 97280
    s_add_u32 s16, s48, 0
    buffer_load_dwordx4 v112, s[8:11], s16 offen lds
    s_add_u32 m0, s19, 98320
    s_add_u32 s16, s48, 32768
    buffer_load_dwordx4 v112, s[8:11], s16 offen lds
    s_add_u32 m0, s19, 99360
    s_add_u32 s16, s48, 65536
    buffer_load_dwordx4 v112, s[8:11], s16 offen lds
    s_add_u32 m0, s19, 100400
    s_add_u32 s16, s48, 98304
    buffer_load_dwordx4 v112, s[8:11], s16 offen lds
    v_add_u32 v115, 114112, v113
    ds_read_b64_tr_b16 a[32:33], v115 offset:0
    ds_read_b64_tr_b16 a[34:35], v115 offset:512
    ds_read_b64_tr_b16 a[36:37], v115 offset:8320
    ds_read_b64_tr_b16 a[38:39], v115 offset:8832
    ds_read_b64_tr_b16 a[40:41], v115 offset:32
    ds_read_b64_tr_b16 a[42:43], v115 offset:544
    ds_read_b64_tr_b16 a[44:45], v115 offset:8352
    ds_read_b64_tr_b16 a[46:47], v115 offset:8864
    s_waitcnt vmcnt(21)
    s_waitcnt lgkmcnt(0)
    s_barrier
    s_mul_i32 s19, s13, 4160
    s_add_u32 m0, s19, 113920
    s_add_u32 s16, s48, 524288
    buffer_load_dwordx4 v112, s[8:11], s16 offen lds
    s_add_u32 m0, s19, 114960
    s_add_u32 s16, s48, 557056
    buffer_load_dwordx4 v112, s[8:11], s16 offen lds
    s_add_u32 m0, s19, 116000
    s_add_u32 s16, s48, 589824
    buffer_load_dwordx4 v112, s[8:11], s16 offen lds
    s_add_u32 m0, s19, 117040
    s_add_u32 s16, s48, 622592
    buffer_load_dwordx4 v112, s[8:11], s16 offen lds
    v_add_u32 v115, 130752, v113
    ds_read_b64_tr_b16 a[48:49], v115 offset:0
    ds_read_b64_tr_b16 a[50:51], v115 offset:512
    ds_read_b64_tr_b16 a[52:53], v115 offset:8320
    ds_read_b64_tr_b16 a[54:55], v115 offset:8832
    ds_read_b64_tr_b16 a[56:57], v115 offset:32
    ds_read_b64_tr_b16 a[58:59], v115 offset:544
    ds_read_b64_tr_b16 a[60:61], v115 offset:8352
    ds_read_b64_tr_b16 a[62:63], v115 offset:8864
    s_lshl_b32 s16, s12, 2
    s_add_u32 s16, s16, s13
    s_lshl_b32 s16, s16, 2
    s_add_u32 s16, s16, 24576
    v_mov_b32 v121, 1
    s_mov_b64 exec, 1
    buffer_store_dword v121, off, s[4:7], s16 sc1
    s_mov_b64 exec, -1
    s_waitcnt vmcnt(22)
    s_waitcnt lgkmcnt(0)
    s_barrier
    s_mul_i32 s19, s13, 4160
    s_add_u32 m0, s19, 130560
    s_add_u32 s16, s48, 1048576
    buffer_load_dwordx4 v112, s[8:11], s16 offen lds
    s_add_u32 m0, s19, 131600
    s_add_u32 s16, s48, 1081344
    buffer_load_dwordx4 v112, s[8:11], s16 offen lds
    s_add_u32 m0, s19, 132640
    s_add_u32 s16, s48, 1114112
    buffer_load_dwordx4 v112, s[8:11], s16 offen lds
    s_add_u32 m0, s19, 133680
    s_add_u32 s16, s48, 1146880
    buffer_load_dwordx4 v112, s[8:11], s16 offen lds
    v_add_u32 v115, 147392, v113
    ds_read_b64_tr_b16 a[64:65], v115 offset:0
    ds_read_b64_tr_b16 a[66:67], v115 offset:512
    ds_read_b64_tr_b16 a[68:69], v115 offset:8320
    ds_read_b64_tr_b16 a[70:71], v115 offset:8832
    ds_read_b64_tr_b16 a[72:73], v115 offset:32
    ds_read_b64_tr_b16 a[74:75], v115 offset:544
    ds_read_b64_tr_b16 a[76:77], v115 offset:8352
    ds_read_b64_tr_b16 a[78:79], v115 offset:8864
    s_waitcnt vmcnt(22)
    s_waitcnt lgkmcnt(0)
    s_barrier
    s_mul_i32 s19, s13, 4160
    s_add_u32 m0, s19, 147200
    s_add_u32 s16, s48, 1572864
    buffer_load_dwordx4 v112, s[8:11], s16 offen lds
    s_add_u32 m0, s19, 148240
    s_add_u32 s16, s48, 1605632
    buffer_load_dwordx4 v112, s[8:11], s16 offen lds
    s_add_u32 m0, s19, 149280
    s_add_u32 s16, s48, 1638400
    buffer_load_dwordx4 v112, s[8:11], s16 offen lds
    s_add_u32 m0, s19, 150320
    s_add_u32 s16, s48, 1671168
    buffer_load_dwordx4 v112, s[8:11], s16 offen lds
    v_add_u32 v115, 47552, v113
    ds_read_b64_tr_b16 a[80:81], v115 offset:0
    ds_read_b64_tr_b16 a[82:83], v115 offset:512
    ds_read_b64_tr_b16 a[84:85], v115 offset:8320
    ds_read_b64_tr_b16 a[86:87], v115 offset:8832
    ds_read_b64_tr_b16 a[88:89], v115 offset:32
    ds_read_b64_tr_b16 a[90:91], v115 offset:544
    ds_read_b64_tr_b16 a[92:93], v115 offset:8352
    ds_read_b64_tr_b16 a[94:95], v115 offset:8864
    s_waitcnt vmcnt(22)
    s_waitcnt lgkmcnt(0)
    s_barrier
    s_mul_i32 s19, s13, 4160
    s_add_u32 m0, s19, 47360
    s_add_u32 s16, s48, 2097152
    buffer_load_dwordx4 v112, s[8:11], s16 offen lds
    s_add_u32 m0, s19, 48400
    s_add_u32 s16, s48, 2129920
    buffer_load_dwordx4 v112, s[8:11], s16 offen lds
    s_add_u32 m0, s19, 49440
    s_add_u32 s16, s48, 2162688
    buffer_load_dwordx4 v112, s[8:11], s16 offen lds
    s_add_u32 m0, s19, 50480
    s_add_u32 s16, s48, 2195456
    buffer_load_dwordx4 v112, s[8:11], s16 offen lds
    v_add_u32 v115, 64192, v113
    ds_read_b64_tr_b16 v[16:17], v115 offset:0
    ds_read_b64_tr_b16 v[18:19], v115 offset:512
    ds_read_b64_tr_b16 v[20:21], v115 offset:8320
    ds_read_b64_tr_b16 v[22:23], v115 offset:8832
    ds_read_b64_tr_b16 v[24:25], v115 offset:32
    ds_read_b64_tr_b16 v[26:27], v115 offset:544
    ds_read_b64_tr_b16 v[28:29], v115 offset:8352
    ds_read_b64_tr_b16 v[30:31], v115 offset:8864
    s_waitcnt vmcnt(21)
    s_waitcnt lgkmcnt(0)
    s_barrier
    s_mul_i32 s19, s13, 4160
    s_add_u32 m0, s19, 64000
    s_add_u32 s16, s48, 2621440
    buffer_load_dwordx4 v112, s[8:11], s16 offen lds
    s_add_u32 m0, s19, 65040
    s_add_u32 s16, s48, 2654208
    buffer_load_dwordx4 v112, s[8:11], s16 offen lds
    s_add_u32 m0, s19, 66080
    s_add_u32 s16, s48, 2686976
    buffer_load_dwordx4 v112, s[8:11], s16 offen lds
    s_add_u32 m0, s19, 67120
    s_add_u32 s16, s48, 2719744
    buffer_load_dwordx4 v112, s[8:11], s16 offen lds
    v_add_u32 v115, 80832, v113
    ds_read_b64_tr_b16 v[32:33], v115 offset:0
    ds_read_b64_tr_b16 v[34:35], v115 offset:512
    ds_read_b64_tr_b16 v[36:37], v115 offset:8320
    ds_read_b64_tr_b16 v[38:39], v115 offset:8832
    ds_read_b64_tr_b16 v[40:41], v115 offset:32
    ds_read_b64_tr_b16 v[42:43], v115 offset:544
    ds_read_b64_tr_b16 v[44:45], v115 offset:8352
    ds_read_b64_tr_b16 v[46:47], v115 offset:8864
    s_waitcnt vmcnt(21)
    s_waitcnt lgkmcnt(0)
    s_barrier
    s_mul_i32 s19, s13, 4160
    s_add_u32 m0, s19, 80640
    s_add_u32 s16, s48, 3145728
    buffer_load_dwordx4 v112, s[8:11], s16 offen lds
    s_add_u32 m0, s19, 81680
    s_add_u32 s16, s48, 3178496
    buffer_load_dwordx4 v112, s[8:11], s16 offen lds
    s_add_u32 m0, s19, 82720
    s_add_u32 s16, s48, 3211264
    buffer_load_dwordx4 v112, s[8:11], s16 offen lds
    s_add_u32 m0, s19, 83760
    s_add_u32 s16, s48, 3244032
    buffer_load_dwordx4 v112, s[8:11], s16 offen lds
    v_add_u32 v115, 97472, v113
    ds_read_b64_tr_b16 v[80:81], v115 offset:0
    ds_read_b64_tr_b16 v[82:83], v115 offset:512
    ds_read_b64_tr_b16 v[84:85], v115 offset:8320
    ds_read_b64_tr_b16 v[86:87], v115 offset:8832
    ds_read_b64_tr_b16 a[104:105], v115 offset:32
    ds_read_b64_tr_b16 a[106:107], v115 offset:544
    ds_read_b64_tr_b16 a[108:109], v115 offset:8352
    ds_read_b64_tr_b16 a[110:111], v115 offset:8864
    s_waitcnt vmcnt(21)
    s_waitcnt lgkmcnt(0)
    s_barrier
    s_mul_i32 s19, s13, 4160
    s_add_u32 m0, s19, 97280
    s_add_u32 s16, s48, 3670016
    buffer_load_dwordx4 v112, s[8:11], s16 offen lds
    s_add_u32 m0, s19, 98320
    s_add_u32 s16, s48, 3702784
    buffer_load_dwordx4 v112, s[8:11], s16 offen lds
    s_add_u32 m0, s19, 99360
    s_add_u32 s16, s48, 3735552
    buffer_load_dwordx4 v112, s[8:11], s16 offen lds
    s_add_u32 m0, s19, 100400
    s_add_u32 s16, s48, 3768320
    buffer_load_dwordx4 v112, s[8:11], s16 offen lds
    v_add_u32 v115, 114112, v113
    ds_read_b64_tr_b16 v[88:89], v115 offset:0
    ds_read_b64_tr_b16 v[90:91], v115 offset:512
    ds_read_b64_tr_b16 v[92:93], v115 offset:8320
    ds_read_b64_tr_b16 v[94:95], v115 offset:8832
    ds_read_b64_tr_b16 a[112:113], v115 offset:32
    ds_read_b64_tr_b16 a[114:115], v115 offset:544
    ds_read_b64_tr_b16 a[116:117], v115 offset:8352
    ds_read_b64_tr_b16 a[118:119], v115 offset:8864
    s_waitcnt vmcnt(20)
    s_waitcnt lgkmcnt(0)
    s_barrier
    v_add_u32 v115, 130752, v113
    ds_read_b64_tr_b16 v[96:97], v115 offset:0
    ds_read_b64_tr_b16 v[98:99], v115 offset:512
    ds_read_b64_tr_b16 v[100:101], v115 offset:8320
    ds_read_b64_tr_b16 v[102:103], v115 offset:8832
    ds_read_b64_tr_b16 a[120:121], v115 offset:32
    ds_read_b64_tr_b16 a[122:123], v115 offset:544
    ds_read_b64_tr_b16 a[124:125], v115 offset:8352
    ds_read_b64_tr_b16 a[126:127], v115 offset:8864
    s_waitcnt vmcnt(16)
    s_waitcnt lgkmcnt(0)
    s_barrier
    v_add_u32 v115, 147392, v113
    ds_read_b64_tr_b16 a[128:129], v115 offset:0
    ds_read_b64_tr_b16 a[130:131], v115 offset:512
    ds_read_b64_tr_b16 a[132:133], v115 offset:8320
    ds_read_b64_tr_b16 a[134:135], v115 offset:8832
    ds_read_b64_tr_b16 a[136:137], v115 offset:32
    ds_read_b64_tr_b16 a[138:139], v115 offset:544
    ds_read_b64_tr_b16 a[140:141], v115 offset:8352
    ds_read_b64_tr_b16 a[142:143], v115 offset:8864
    s_waitcnt vmcnt(12)
    s_waitcnt lgkmcnt(0)
    s_barrier
    v_add_u32 v115, 47552, v113
    ds_read_b64_tr_b16 a[144:145], v115 offset:0
    ds_read_b64_tr_b16 a[146:147], v115 offset:512
    ds_read_b64_tr_b16 a[148:149], v115 offset:8320
    ds_read_b64_tr_b16 a[150:151], v115 offset:8832
    ds_read_b64_tr_b16 a[152:153], v115 offset:32
    ds_read_b64_tr_b16 a[154:155], v115 offset:544
    ds_read_b64_tr_b16 a[156:157], v115 offset:8352
    ds_read_b64_tr_b16 a[158:159], v115 offset:8864
    s_waitcnt vmcnt(8)
    s_waitcnt lgkmcnt(0)
    s_barrier
    v_add_u32 v115, 64192, v113
    ds_read_b64_tr_b16 a[160:161], v115 offset:0
    ds_read_b64_tr_b16 a[162:163], v115 offset:512
    ds_read_b64_tr_b16 a[164:165], v115 offset:8320
    ds_read_b64_tr_b16 a[166:167], v115 offset:8832
    ds_read_b64_tr_b16 v[104:105], v115 offset:32
    ds_read_b64_tr_b16 v[106:107], v115 offset:544
    ds_read_b64_tr_b16 v[108:109], v115 offset:8352
    ds_read_b64_tr_b16 v[110:111], v115 offset:8864
    v_lshrrev_b32 v118, 1, v0
    s_mov_b32 s16, 24576
    buffer_load_dwordx2 v[116:117], v118, s[4:7], s16 offen sc1
    s_load_dwordx2 s[8:9], s[0:1], 8
    s_mov_b32 s10, 8192
    s_mov_b32 s11, 0x20000
    s_waitcnt lgkmcnt(0)
    v_lshlrev_b32 v119, 3, v0
    buffer_load_dword v119, v119, s[8:11], 0 offen
    s_waitcnt vmcnt(6)
    s_waitcnt lgkmcnt(0)
    s_barrier
    v_add_u32 v115, 80832, v113
    ds_read_b64_tr_b16 v[48:49], v115 offset:0
    ds_read_b64_tr_b16 v[50:51], v115 offset:512
    ds_read_b64_tr_b16 v[52:53], v115 offset:8320
    ds_read_b64_tr_b16 v[54:55], v115 offset:8832
    ds_read_b64_tr_b16 v[56:57], v115 offset:32
    ds_read_b64_tr_b16 v[58:59], v115 offset:544
    ds_read_b64_tr_b16 v[60:61], v115 offset:8352
    ds_read_b64_tr_b16 v[62:63], v115 offset:8864
    s_waitcnt vmcnt(2)
    s_waitcnt lgkmcnt(0)
    s_barrier
    v_add_u32 v115, 97472, v113
    ds_read_b64_tr_b16 v[72:73], v115 offset:0
    ds_read_b64_tr_b16 v[74:75], v115 offset:512
    ds_read_b64_tr_b16 v[76:77], v115 offset:8320
    ds_read_b64_tr_b16 v[78:79], v115 offset:8832
    ds_read_b64_tr_b16 a[96:97], v115 offset:32
    ds_read_b64_tr_b16 a[98:99], v115 offset:544
    ds_read_b64_tr_b16 a[100:101], v115 offset:8352
    ds_read_b64_tr_b16 a[102:103], v115 offset:8864
    s_waitcnt lgkmcnt(0)
    s_barrier
    s_waitcnt lgkmcnt(0)
    ds_write_b128 v0, v[16:19] offset:38912
    ds_write_b128 v0, v[20:23] offset:39936
    ds_write_b128 v0, v[24:27] offset:47104
    ds_write_b128 v0, v[28:31] offset:48128
    ds_write_b128 v0, v[32:35] offset:55296
    ds_write_b128 v0, v[36:39] offset:56320
    ds_write_b128 v0, v[40:43] offset:63488
    ds_write_b128 v0, v[44:47] offset:64512
    ds_write_b128 v1, v[48:51] offset:6144
    ds_write_b128 v1, v[52:55] offset:7168
    ds_write_b128 v1, v[56:59] offset:14336
    ds_write_b128 v1, v[60:63] offset:15360
    ds_write_b128 v1, v[64:67] offset:22528
    ds_write_b128 v1, v[68:71] offset:23552
    ds_write_b128 v1, v[72:75] offset:30720
    ds_write_b128 v1, v[76:79] offset:31744
    ds_write_b128 v1, v[80:83] offset:38912
    ds_write_b128 v1, v[84:87] offset:39936
    ds_write_b128 v1, v[88:91] offset:47104
    ds_write_b128 v1, v[92:95] offset:48128
    ds_write_b128 v1, v[96:99] offset:55296
    ds_write_b128 v1, v[100:103] offset:56320
    ds_write_b128 v1, v[104:107] offset:63488
    ds_write_b128 v1, v[108:111] offset:64512
L_lwe_256:
    v_mov_b32 v80, 0
    v_mov_b32 v81, 0
    v_mov_b32 v82, 0
    v_mov_b32 v83, 0
    s_mul_i32 s16, s13, 2688
    v_add_u32 v121, s16, v5
    ds_write_b128 v121, v[80:83] offset:19456
    ds_write_b128 v121, v[80:83] offset:20480
    ds_write_b128 v121, v[80:83] offset:21120
    v_bfe_u32 v88, v0, 7, 1
    v_bfe_u32 v89, v0, 4, 1
    v_lshl_add_u32 v88, v89, 1, v88
    v_bfe_u32 v89, v0, 5, 1
    v_lshl_add_u32 v88, v89, 3, v88
    v_bfe_u32 v89, v0, 6, 1
    v_lshlrev_b32 v89, 4, v89
    v_mov_b32 v90, 0x3f80
    v_lshlrev_b32 v89, v89, v90
    v_cmp_eq_u32 vcc, 0, v88
    s_nop 1
    v_cndmask_b32 v92, 0, v89, vcc
    v_cmp_eq_u32 vcc, 1, v88
    s_nop 1
    v_cndmask_b32 v93, 0, v89, vcc
    v_cmp_eq_u32 vcc, 2, v88
    s_nop 1
    v_cndmask_b32 v94, 0, v89, vcc
    v_cmp_eq_u32 vcc, 3, v88
    s_nop 1
    v_cndmask_b32 v95, 0, v89, vcc
    ds_write_b128 v5, v[92:95] offset:17408
    ds_write_b128 v5, v[80:83] offset:18432
    s_waitcnt lgkmcnt(0)
    s_waitcnt vmcnt(0)
    v_min_u32 v116, v116, v117
    v_cmp_eq_u32 vcc, 0, v116
    s_cbranch_vccz L_tbok
    v_lshrrev_b32 v101, 2, v0
    s_mov_b32 s16, 24576
    s_branch L_wg_275
L_wf_273:
    s_sleep 1
L_wg_275:
    buffer_load_dword v100, v101, s[4:7], s16 offen offset:0 sc1
    s_add_u32 s40, s40, 1
    s_cmp_gt_u32 s40, 262144
    s_cbranch_scc1 L_abort
    s_waitcnt vmcnt(0)
    v_cmp_eq_u32 vcc, 0, v100
    s_cbranch_vccnz L_wf_273
L_wfo_274:
    s_branch L_wg_278
L_wf_276:
    s_sleep 1
L_wg_278:
    buffer_load_dword v100, v101, s[4:7], s16 offen offset:256 sc1
    s_add_u32 s40, s40, 1
    s_cmp_gt_u32 s40, 262144
    s_cbranch_scc1 L_abort
    s_waitcnt vmcnt(0)
    v_cmp_eq_u32 vcc, 0, v100
    s_cbranch_vccnz L_wf_276
L_wfo_277:
L_tbok:
    s_barrier
    s_mov_b32 s15, 0
    s_cmp_lg_u32 s60, 0
    s_cbranch_scc1 L_tslow
L_tfast:
    s_mov_b32 s14, 0
    s_mul_i32 s16, s15, 33554432
    s_lshl_b32 s17, s12, 14
    s_add_u32 s16, s16, s17
    s_lshl_b32 s17, s13, 12
    s_add_u32 s16, s16, s17
    s_add_u32 s32, s16, 16777216
    s_add_u32 s31, s32, 524288
    s_add_u32 s44, s32, 33030144
    s_lshl_b32 s33, s15, 19
    s_lshl_b32 s17, s13, 11
    s_add_u32 s33, s33, s17
    s_lshr_b32 s17, s12, 2
    s_lshl_b32 s17, s17, 8
    s_add_u32 s33, s33, s17
    s_and_b32 s17, s12, 2
    s_lshl_b32 s17, s17, 5
    s_add_u32 s33, s33, s17
    s_and_b32 s17, s12, 1
    s_lshl_b32 s17, s17, 3
    s_add_u32 s33, s33, s17
    s_add_u32 s33, s33, 174063616
    s_lshl_b32 s16, s15, 5
    s_add_u32 s16, s16, s12
    s_lshl_b32 s35, s16, 8
    s_add_u32 s35, s35, 0
    s_lshl_b32 s36, s15, 6
    s_add_u32 s36, s36, 1
    s_load_dwordx2 s[8:9], s[0:1], 8
    s_mov_b32 s10, 8192
    s_mov_b32 s11, 0x20000
    v_bfe_u32 v80, v0, 4, 1
    v_bfe_u32 v81, v0, 6, 2
    v_lshl_add_u32 v80, v81, 1, v80
    v_lshlrev_b32 v80, 10, v80
    v_bfe_u32 v81, v0, 5, 1
    v_lshl_add_u32 v80, v81, 4, v80
    v_bfe_u32 v81, v0, 8, 2
    v_lshl_add_u32 v80, v81, 5, v80
    s_lshl_b32 s16, s13, 8
    s_and_b32 s17, s12, 2
    s_lshl_b32 s17, s17, 11
    s_add_u32 s17, s17, s16
    s_lshr_b32 s18, s12, 2
    s_lshl_b32 s18, s18, 5
    s_add_u32 s17, s17, s18
    s_and_b32 s18, s12, 1
    s_lshl_b32 s18, s18, 4
    s_add_u32 s17, s17, s18
    v_lshrrev_b32 v82, 8, v0
    v_lshlrev_b32 v82, 10, v82
    v_bfe_u32 v81, v0, 4, 2
    v_lshl_add_u32 v82, v81, 2, v82
    s_waitcnt lgkmcnt(0)
    buffer_load_dwordx4 v[16:19], v80, s[8:11], s16 offen offset:0
    buffer_load_dwordx4 v[20:23], v80, s[8:11], s16 offen offset:128
    buffer_load_dword v120, v82, s[8:11], s17 offen
    s_cmp_eq_u32 s13, 1
    s_cbranch_scc1 L_wv1_280
    s_cmp_eq_u32 s13, 2
    s_cbranch_scc1 L_wv2_281
    s_cmp_eq_u32 s13, 3
    s_cbranch_scc1 L_wv3_282
L_wv0_279:
    ds_read_b128 v[48:51], v0 offset:57344
    ds_read_b128 v[52:55], v0 offset:58368
    ds_read_b128 v[56:59], v1 offset:0
    ds_read_b128 v[60:63], v1 offset:1024
    ds_read_b128 v[64:67], v1 offset:8192
    ds_read_b128 v[68:71], v1 offset:9216
    ds_read_b128 v[72:75], v1 offset:16384
    ds_read_b128 v[76:79], v1 offset:17408
    ds_read_b128 v[24:27], v0 offset:32768
    ds_read_b128 v[28:31], v0 offset:33792
    ds_read_b128 v[32:35], v0 offset:40960
    ds_read_b128 v[36:39], v0 offset:41984
    ds_read_b128 v[40:43], v0 offset:49152
    ds_read_b128 v[44:47], v0 offset:50176
    v_mov_b64 v[80:81], 0
    v_mov_b64 v[82:83], 0
    v_mov_b64 v[84:85], 0
    v_mov_b64 v[86:87], 0
    v_mov_b64 v[88:89], 0
    v_mov_b64 v[90:91], 0
    v_mov_b64 v[92:93], 0
    v_mov_b64 v[94:95], 0
    v_mov_b64 v[96:97], 0
    v_mov_b64 v[98:99], 0
    v_mov_b64 v[100:101], 0
    v_mov_b64 v[102:103], 0
    v_and_b32 v121, 16, v0
    v_lshrrev_b32 v122, 8, v0
    v_lshl_add_u32 v121, v122, 1, v121
    v_bfe_u32 v122, v0, 5, 1
    v_lshl_add_u32 v121, v121, 1, v122
    v_lshlrev_b32 v121, 2, v121
    v_lshlrev_b32 v126, 3, v0
    s_mov_b32 m0, s43
    s_waitcnt vmcnt(0)
    v_min_u32 v120, -2, v120
    s_cmp_lg_u32 s15, 0
    s_cbranch_scc1 L_w2_292
L_w1_291:
    buffer_load_dword v123, off, s[4:7], s35 sc1
    s_add_u32 s40, s40, 1
    s_cmp_gt_u32 s40, 262144
    s_cbranch_scc1 L_abort
    s_waitcnt vmcnt(0)
    v_cmp_eq_u32 vcc, 0, v123
    s_cbranch_vccnz L_w1_291
    s_branch L_w3_293
L_w2_292:
    buffer_load_dword v123, off, s[4:7], s35 sc1
    buffer_load_dwordx4 v[104:107], v0, s[4:7], s32 offen offset:0 sc1
    buffer_load_dwordx4 v[108:111], v0, s[4:7], s32 offen offset:1024 sc1
    buffer_load_dwordx4 v[112:115], v0, s[4:7], s32 offen offset:2048 sc1
    buffer_load_dwordx4 v[116:119], v0, s[4:7], s32 offen offset:3072 sc1
    s_add_u32 s40, s40, 1
    s_cmp_gt_u32 s40, 262144
    s_cbranch_scc1 L_abort
    s_waitcnt vmcnt(0)
    v_cmp_ne_u32 vcc, 0, v123
    s_cbranch_vccnz L_w3_293
    v_max_u32 v127, v104, v105
    v_max3_u32 v127, v127, v106, v107
    v_max3_u32 v127, v127, v108, v109
    v_max3_u32 v127, v127, v110, v111
    v_max3_u32 v127, v127, v112, v113
    v_max3_u32 v127, v127, v114, v115
    v_max3_u32 v127, v127, v116, v117
    v_max3_u32 v127, v127, v118, v119
    v_cmp_eq_u32 vcc, -1, v127
    s_cbranch_vccnz L_w2_292
L_w3_293:
    s_waitcnt vmcnt(0) lgkmcnt(0)
    s_branch L_st_294
L_kvw_286:
    buffer_load_dword v123, off, s[4:7], s35 sc1
    s_add_u32 s40, s40, 1
    s_cmp_gt_u32 s40, 262144
    s_cbranch_scc1 L_abort
    s_waitcnt vmcnt(0)
    v_cmp_eq_u32 vcc, 0, v123
    s_cbranch_vccnz L_kvw_286
    s_branch L_kvok_287
L_st_294:
    s_branch L_arr_284
L_poll2_285:
    buffer_load_dwordx4 v[16:19], v0, s[4:7], s19 offen sc1
    buffer_load_dwordx4 v[20:23], v0, s[4:7], s19 offen offset:1024 sc1
    s_waitcnt vmcnt(2)
    v_max3_u32 v127, v16, v17, v18
    v_max3_u32 v127, v127, v19, v20
    v_max3_u32 v127, v127, v21, v22
    v_max_u32 v127, v127, v23
    v_cmp_eq_u32 vcc, -1, v127
    s_cbranch_vccz L_arr_284
L_poll3_296:
    s_add_u32 s40, s40, 1
    s_cmp_gt_u32 s40, 262144
    s_cbranch_scc1 L_abort
    v_max3_u32 v127, v16, v17, v18
    v_max3_u32 v127, v127, v19, v20
    v_max3_u32 v127, v127, v21, v22
    v_max_u32 v127, v127, v23
    v_cmp_eq_u32 vcc, -1, v127
    s_cbranch_vccz L_arr_284
    v_max3_u32 v127, v16, v17, v18
    v_max3_u32 v127, v127, v19, v20
    v_max3_u32 v127, v127, v21, v22
    v_max_u32 v127, v127, v23
    v_cmp_eq_u32 vcc, -1, v127
    s_cbranch_vccz L_arr_284
    v_max3_u32 v127, v16, v17, v18
    v_max3_u32 v127, v127, v19, v20
    v_max3_u32 v127, v127, v21, v22
    v_max_u32 v127, v127, v23
    v_cmp_eq_u32 vcc, -1, v127
    s_cbranch_vccz L_arr_284
    v_max3_u32 v127, v16, v17, v18
    v_max3_u32 v127, v127, v19, v20
    v_max3_u32 v127, v127, v21, v22
    v_max_u32 v127, v127, v23
    v_cmp_eq_u32 vcc, -1, v127
    s_cbranch_vccz L_arr_284
    buffer_load_dwordx4 v[16:19], v0, s[4:7], s19 offen sc1
    buffer_load_dwordx4 v[20:23], v0, s[4:7], s19 offen offset:1024 sc1
    s_branch L_poll3_296
L_poll2c_295:
    v_mov_b32 v12, v12
    s_waitcnt vmcnt(3) lgkmcnt(0)
    v_max3_u32 v127, v16, v17, v18
    v_max_u32 v127, v127, v19
    s_waitcnt vmcnt(2)
    v_max3_u32 v127, v127, v20, v21
    v_max3_u32 v127, v127, v22, v23
    v_cmp_eq_u32 vcc, -1, v127
    s_cbranch_vccnz L_poll2_285
L_arr_284:
    ds_write_b128 v5, v[16:19] offset:0
    v_smfmac_f32_16x16x64_bf16 v[80:83], v[16:19], v[24:31], v10
    s_nop 0
    ds_write_b128 v5, v[20:23] offset:1024
    v_smfmac_f32_16x16x64_bf16 v[84:87], v[16:19], v[32:39], v10
    v_smfmac_f32_16x16x64_bf16 v[80:83], v[20:23], v[40:47], v10
    s_nop 0
    buffer_load_dwordx4 v[112:115], v0, s[4:7], s32 offen offset:2048 sc1
    buffer_load_dwordx4 v[116:119], v0, s[4:7], s32 offen offset:3072 sc1
    v_smfmac_f32_16x16x64_bf16 v[84:87], v[20:23], v[48:55], v10
    s_nop 0
    buffer_load_dwordx4 v[104:107], v0, s[4:7], s32 offen offset:0 sc1
    buffer_load_dwordx4 v[108:111], v0, s[4:7], s32 offen offset:1024 sc1
    v_smfmac_f32_16x16x64_bf16 v[88:91], v[16:19], v[56:63], v10
    s_add_u32 s35, s35, 4
    s_add_u32 s36, s36, 1
    s_waitcnt lgkmcnt(0)
    s_barrier
    ds_read_b128 v[24:27], v5 offset:2048
    v_smfmac_f32_16x16x64_bf16 v[92:95], v[16:19], v[64:71], v10
    s_nop 0
    ds_read_b128 v[28:31], v5 offset:3072
    buffer_load_dword off, s[4:7], s35 sc1 lds
    v_smfmac_f32_16x16x64_bf16 v[96:99], v[16:19], v[72:79], v10
    s_nop 0
    ds_read_b128 v[32:35], v5 offset:4096
    v_smfmac_f32_16x16x64_bf16 v[96:99], v[20:23], a[176:183], v10
    s_nop 0
    ds_read_b128 v[36:39], v5 offset:5120
    s_waitcnt lgkmcnt(3)
    v_smfmac_f32_16x16x64_bf16 v[80:83], v[24:27], a[0:7], v10
    s_nop 0
    ds_read_b128 v[40:43], v5 offset:6144
    v_smfmac_f32_16x16x64_bf16 v[84:87], v[24:27], a[8:15], v10
    s_waitcnt lgkmcnt(3)
    ds_read_b128 v[44:47], v5 offset:7168
    v_smfmac_f32_16x16x64_bf16 v[80:83], v[28:31], a[16:23], v10
    s_mov_b64 exec, s[46:47]
    buffer_store_dword v120, v121, s[4:7], s33 offen sc1
    s_mov_b64 exec, -1
    v_smfmac_f32_16x16x64_bf16 v[84:87], v[28:31], a[24:31], v10
    s_waitcnt lgkmcnt(2)
    ds_read_b128 v[48:51], v1 offset:24576
    v_smfmac_f32_16x16x64_bf16 v[80:83], v[32:35], a[32:39], v10
    s_nop 0
    ds_read_b128 v[52:55], v1 offset:25600
    v_smfmac_f32_16x16x64_bf16 v[84:87], v[32:35], a[40:47], v10
    s_nop 0
    ds_read_b128 v[56:59], v1 offset:32768
    v_smfmac_f32_16x16x64_bf16 v[80:83], v[36:39], a[48:55], v10
    s_waitcnt lgkmcnt(3)
    ds_read_b128 v[60:63], v1 offset:33792
    v_smfmac_f32_16x16x64_bf16 v[80:83], v[40:43], a[64:71], v10
    s_nop 0
    ds_read_b128 v[64:67], v1 offset:40960
    v_smfmac_f32_16x16x64_bf16 v[80:83], v[44:47], a[80:87], v10
    s_nop 0
    ds_read_b128 v[68:71], v1 offset:41984
    s_nop 0
    v_smfmac_f32_16x16x64_bf16 v[84:87], v[36:39], a[56:63], v10
    s_nop 0
    ds_read_b128 v[72:75], v1 offset:49152
    s_nop 0
    v_smfmac_f32_16x16x64_bf16 v[84:87], v[40:43], a[72:79], v10
    s_nop 0
    ds_read_b128 v[76:79], v1 offset:50176
    v_add_f32 v80, v80, v82
    v_smfmac_f32_16x16x64_bf16 v[84:87], v[44:47], a[88:95], v10
    s_waitcnt lgkmcnt(4)
    s_nop 0
    v_add_f32 v81, v81, v83
    v_smfmac_f32_16x16x64_bf16 v[88:91], v[20:23], v[48:55], v10
    s_nop 1
    v_cvt_pk_bf16_f32 v80, v80, v81
    v_smfmac_f32_16x16x64_bf16 v[92:95], v[20:23], a[96:103], v10
    s_waitcnt lgkmcnt(0)
    ds_write_b32 v2, v80 offset:24
    v_add_f32 v84, v84, v86
    v_add_f32 v85, v85, v87
    v_cvt_pk_bf16_f32 v84, v84, v85
    v_smfmac_f32_16x16x64_bf16 v[88:91], v[24:27], v[56:63], v10
    s_nop 0
    ds_write_b32 v2, v84 offset:664
    v_smfmac_f32_16x16x64_bf16 v[92:95], v[24:27], a[104:111], v10
    s_nop 0
    ds_read_b64_tr_b16 v[120:121], v4 offset:24
    ds_read_b64_tr_b16 v[122:123], v4 offset:344
    v_smfmac_f32_16x16x64_bf16 v[88:91], v[28:31], v[64:71], v10
    s_nop 0
    ds_read_b64_tr_b16 v[124:125], v4 offset:8
    ds_read_b64_tr_b16 v[126:127], v4 offset:328
    v_smfmac_f32_16x16x64_bf16 v[92:95], v[28:31], a[112:119], v10
    s_nop 0
    ds_read_b128 v[48:51], v1 offset:57344
    v_smfmac_f32_16x16x64_bf16 v[88:91], v[32:35], v[72:79], v10
    s_nop 0
    ds_read_b128 v[52:55], v1 offset:58368
    v_smfmac_f32_16x16x64_bf16 v[92:95], v[32:35], a[120:127], v10
    s_waitcnt vmcnt(2)
    v_smfmac_f32_16x16x64_bf16 v[88:91], v[36:39], a[128:135], v10
    s_waitcnt lgkmcnt(2)
    v_mfma_f32_16x16x32_bf16 v[80:83], v[104:107], v[120:123], 0
    v_mfma_f32_16x16x32_bf16 v[80:83], v[108:111], v[124:127], v[80:83]
    s_nop 2
    v_smfmac_f32_16x16x64_bf16 v[88:91], v[40:43], a[144:151], v10
    s_nop 2
    v_smfmac_f32_16x16x64_bf16 v[88:91], v[44:47], a[160:167], v10
    s_nop 0
    ds_write2st64_b32 v6, v80, v81 offset0:0 offset1:1
    v_smfmac_f32_16x16x64_bf16 v[92:95], v[36:39], a[136:143], v10
    s_waitcnt lgkmcnt(1)
    ds_write2st64_b32 v6, v82, v83 offset0:2 offset1:3
    v_smfmac_f32_16x16x64_bf16 v[92:95], v[40:43], a[152:159], v10
    s_nop 1
    v_add_f32 v88, v88, v90
    v_add_f32 v89, v89, v91
    v_cvt_pk_bf16_f32 v88, v88, v89
    v_smfmac_f32_16x16x64_bf16 v[92:95], v[44:47], v[48:55], v10
    s_nop 0
    ds_write_b32 v3, v88 offset:1408
    v_smfmac_f32_16x16x64_bf16 v[96:99], v[24:27], a[192:199], v10
    s_nop 0
    ds_read_b128 v[48:51], v0 offset:0
    s_nop 0
    v_smfmac_f32_16x16x64_bf16 v[96:99], v[28:31], a[208:215], v10
    s_nop 1
    v_add_f32 v92, v92, v94
    v_add_f32 v93, v93, v95
    v_cvt_pk_bf16_f32 v92, v92, v93
    v_smfmac_f32_16x16x64_bf16 v[96:99], v[32:35], a[224:231], v10
    s_nop 0
    ds_write_b32 v3, v92 offset:2048
    ds_read_b64_tr_b16 v[88:89], v4 offset:1408
    ds_read_b64_tr_b16 v[90:91], v4 offset:1728
    v_smfmac_f32_16x16x64_bf16 v[96:99], v[36:39], a[240:247], v10
    s_waitcnt lgkmcnt(5)
    s_barrier
    ds_read2st64_b32 v[104:105], v6 offset0:0 offset1:4
    v_smfmac_f32_16x16x64_bf16 v[96:99], v[40:43], v[128:135], v10
    s_nop 0
    ds_read2st64_b32 v[106:107], v6 offset0:8 offset1:12
    v_smfmac_f32_16x16x64_bf16 v[96:99], v[44:47], v[144:151], v10
    s_add_u32 s16, s28, s30
    ds_read_b128 v[52:55], v0 offset:1024
    s_waitcnt lgkmcnt(3)
    v_mfma_f32_16x16x32_bf16 v[84:87], v[88:91], v[120:123], 0
    s_nop 0
    v_mov_b32 v89, 0
    s_nop 0
    v_smfmac_f32_16x16x64_bf16 v[100:103], v[16:19], a[168:175], v10
    s_waitcnt lgkmcnt(1)
    v_add_f32 v104, v104, v105
    v_add_f32 v106, v106, v107
    v_smfmac_f32_16x16x64_bf16 v[100:103], v[20:23], a[184:191], v10
    s_nop 0
    ds_write_b64 v7, v[84:85] offset:12288
    v_add_f32 v104, v104, v106
    v_mul_f32 v104, s41, v104
    v_smfmac_f32_16x16x64_bf16 v[100:103], v[24:27], a[200:207], v10
    v_exp_f32 v104, v104
    v_add_f32 v96, v96, v98
    v_cvt_pk_bf16_f32 v107, v104, v104
    v_smfmac_f32_16x16x64_bf16 v[100:103], v[28:31], a[216:223], v10
    s_nop 0
    ds_write_b16 v7, v107 offset:14336
    v_smfmac_f32_16x16x64_bf16 v[100:103], v[32:35], a[232:239], v10
    v_add_f32 v97, v97, v99
    v_smfmac_f32_16x16x64_bf16 v[100:103], v[36:39], a[248:255], v10
    s_waitcnt lgkmcnt(1)
    s_barrier
    ds_read_b64 v[80:81], v8 offset:12288
    v_smfmac_f32_16x16x64_bf16 v[100:103], v[40:43], v[136:143], v10
    s_nop 0
    ds_read_b64 v[82:83], v8 offset:12800
    ds_read_b64 v[84:85], v8 offset:13312
    ds_read_b64 v[86:87], v8 offset:13824
    v_smfmac_f32_16x16x64_bf16 v[100:103], v[44:47], v[152:159], v10
    s_waitcnt lgkmcnt(4)
    s_barrier
    ds_read_b128 v[92:95], v8 offset:14336
    v_cvt_pk_bf16_f32 v104, v96, v97
    v_cvt_pk_bf16_f32 v105, v96, v97
    v_mov_b64 v[16:17], 0
    v_mov_b64 v[18:19], 0
    s_waitcnt vmcnt(4)
    v_mov_b64 v[20:21], 0
    v_mov_b64 v[22:23], 0
    s_waitcnt lgkmcnt(1)
    v_pk_add_f32 v[80:81], v[80:81], v[82:83]
    v_pk_add_f32 v[84:85], v[84:85], v[86:87]
    v_pk_add_f32 v[80:81], v[80:81], v[84:85]
    v_mul_f32 v80, s41, v80
    v_mul_f32 v81, s41, v81
    s_waitcnt lgkmcnt(0)
    v_mfma_f32_16x16x32_bf16 v[108:111], v[12:15], v[92:95], 0
    v_exp_f32 v90, v80
    v_mfma_f32_16x16x32_bf16 v[120:123], v[112:115], v[92:95], 0
    v_exp_f32 v91, v81
    v_mfma_f32_16x16x32_bf16 v[124:127], v[116:119], v[92:95], 0
    v_cvt_pk_bf16_f32 v88, v90, v91
    v_add_f32 v100, v100, v102
    v_add_f32 v101, v101, v103
    v_mfma_f32_16x16x16_bf16 v[108:111], v[12:13], v[88:89], v[108:111]
    s_nop 0
    v_cvt_pk_bf16_f32 v106, v100, v101
    v_cvt_pk_bf16_f32 v107, v100, v101
    v_mfma_f32_16x16x16_bf16 v[120:123], v[104:105], v[88:89], v[120:123]
    s_nop 0
    v_mov_b64 v[24:25], 0
    v_mov_b64 v[26:27], 0
    v_mfma_f32_16x16x16_bf16 v[124:127], v[106:107], v[88:89], v[124:127]
    v_rcp_f32 v110, v108
    v_mov_b64 v[28:29], 0
    v_max_f32 v109, v108, v110
    v_cmp_ngt_f32 vcc, s42, v109
    v_pk_mul_f32 v[120:121], v[120:121], v[110:111] op_sel_hi:[1,0]
    v_pk_mul_f32 v[122:123], v[122:123], v[110:111] op_sel_hi:[1,0]
    v_cvt_pk_bf16_f32 v120, v120, v121
    v_cvt_pk_bf16_f32 v121, v122, v123
    v_pk_mul_f32 v[124:125], v[124:125], v[110:111] op_sel_hi:[1,0]
    v_pk_mul_f32 v[126:127], v[126:127], v[110:111] op_sel_hi:[1,0]
    v_cvt_pk_bf16_f32 v122, v124, v125
    v_cvt_pk_bf16_f32 v123, v126, v127
    v_cndmask_b32 v82, v120, v122, s[38:39]
    v_cndmask_b32 v83, v121, v123, s[38:39]
    v_smfmac_f32_16x16x64_bf16 v[16:19], v[120:123], v[160:167], v10 abid:1
    s_nop 0
    ds_write_b64 v7, v[82:83] offset:14848
    v_smfmac_f32_16x16x64_bf16 v[20:23], v[120:123], v[192:199], v10 abid:1
    s_cbranch_vccnz L_slow_288
L_back_289:
    v_mov_b64 v[30:31], 0
    v_mov_b32 v46, -1
    s_mov_b64 exec, s[46:47]
    buffer_store_dword v46, v11, s[4:7], s16 offen
    s_mov_b64 exec, -1
    v_smfmac_f32_16x16x64_bf16 v[24:27], v[120:123], v[224:231], v10 abid:1
    s_waitcnt lgkmcnt(0)
    s_barrier
    ds_read_b128 v[112:115], v8 offset:15360
    v_smfmac_f32_16x16x64_bf16 v[28:31], v[120:123], v[48:55], v10 abid:1
    s_nop 0
    ds_read_b128 v[116:119], v8 offset:15872
    ds_read_b128 v[124:127], v8 offset:16384
    v_mov_b32 v12, v12
    s_add_u32 s33, s33, 8192
    s_mov_b32 s32, s31
    s_add_u32 s31, s31, 524288
    v_mov_b32 v12, v12
    s_waitcnt lgkmcnt(2)
    v_smfmac_f32_16x16x64_bf16 v[16:19], v[112:115], v[168:175], v10 abid:1
    s_min_u32 s31, s31, s44
    ds_read_b128 v[56:59], v0 offset:8192
    s_add_u32 s14, s14, 1
    v_smfmac_f32_16x16x64_bf16 v[20:23], v[112:115], v[200:207], v10 abid:1
    s_waitcnt lgkmcnt(2)
    ds_read_b128 v[60:63], v0 offset:9216
    s_add_u32 s18, s27, s30
    v_smfmac_f32_16x16x64_bf16 v[16:19], v[116:119], v[176:183], v10 abid:1
    s_waitcnt lgkmcnt(2)
    ds_read_b128 v[64:67], v0 offset:16384
    s_mov_b32 s16, s26
    v_smfmac_f32_16x16x64_bf16 v[16:19], v[124:127], v[184:191], v10 abid:1
    s_mov_b32 s26, s27
    ds_read_b128 v[68:71], v0 offset:17408
    s_mov_b32 s27, s28
    v_smfmac_f32_16x16x64_bf16 v[20:23], v[116:119], v[208:215], v10 abid:1
    s_mov_b32 s28, s16
    ds_read_b128 v[72:75], v0 offset:24576
    s_add_u32 s19, s26, s29
    v_smfmac_f32_16x16x64_bf16 v[20:23], v[124:127], v[216:223], v10 abid:1
    s_nop 0
    ds_read_b128 v[76:79], v0 offset:25600
    v_mul_f32 v16, s23, v16
    v_cvt_pk_bf16_f32 v32, v16, v17
    v_cvt_pk_bf16_f32 v33, v18, v19
    v_and_or_b32 v32, v32, -2, s22
    v_smfmac_f32_16x16x64_bf16 v[24:27], v[112:115], v[232:239], v10 abid:1
    s_nop 0
    buffer_store_dwordx2 v[32:33], v9, s[4:7], s20 offen
    v_smfmac_f32_16x16x64_bf16 v[24:27], v[116:119], v[240:247], v10 abid:1
    s_nop 0
    ds_read_b128 v[40:43], v5 offset:17408
    v_mul_f32 v20, s23, v20
    v_cvt_pk_bf16_f32 v34, v20, v21
    v_cvt_pk_bf16_f32 v35, v22, v23
    v_and_or_b32 v34, v34, -2, s22
    v_smfmac_f32_16x16x64_bf16 v[24:27], v[124:127], v[248:255], v10 abid:1
    s_waitcnt lgkmcnt(1)
    buffer_store_dwordx2 v[34:35], v9, s[4:7], s21 offen
    v_smfmac_f32_16x16x64_bf16 v[28:31], v[112:115], v[56:63], v10 abid:1
    s_nop 0
    s_nop 0
    s_nop 0
    v_smfmac_f32_16x16x64_bf16 v[28:31], v[116:119], v[64:71], v10 abid:1
    s_nop 0
    s_nop 0
    v_mul_f32 v24, s23, v24
    v_cvt_pk_bf16_f32 v36, v24, v25
    v_smfmac_f32_16x16x64_bf16 v[28:31], v[124:127], v[72:79], v10 abid:1
    s_waitcnt lgkmcnt(0)
    s_nop 0
    v_cvt_pk_bf16_f32 v37, v26, v27
    v_and_or_b32 v36, v36, -2, s22
    buffer_store_dwordx2 v[36:37], v9, s[4:7], s25 offen
    v_mov_b64 v[80:81], 0
    v_mov_b64 v[82:83], 0
    v_mov_b64 v[84:85], 0
    v_mul_f32 v28, s23, v28
    v_cvt_pk_bf16_f32 v38, v28, v29
    v_cvt_pk_bf16_f32 v39, v30, v31
    v_and_or_b32 v38, v38, -2, s22
    buffer_store_dwordx2 v[38:39], v9, s[4:7], s37 offen
    v_mov_b64 v[86:87], 0
    s_nop 0
    ds_read_b128 v[48:51], v0 offset:57344
    v_mov_b64 v[88:89], 0
    v_mov_b64 v[90:91], 0
    s_nop 0
    ds_read_b128 v[52:55], v0 offset:58368
    v_mov_b64 v[92:93], 0
    v_mov_b64 v[94:95], 0
    s_nop 0
    ds_read_b128 v[56:59], v1 offset:0
    v_mov_b64 v[96:97], 0
    v_mov_b64 v[98:99], 0
    s_nop 0
    ds_read_b128 v[60:63], v1 offset:1024
    v_mov_b64 v[100:101], 0
    v_mov_b64 v[102:103], 0
    s_nop 0
    ds_read_b128 v[64:67], v1 offset:8192
    v_and_b32 v121, 16, v0
    v_lshrrev_b32 v122, 8, v0
    s_nop 0
    ds_read_b128 v[68:71], v1 offset:9216
    v_lshl_add_u32 v121, v122, 1, v121
    v_bfe_u32 v122, v0, 5, 1
    s_nop 0
    ds_read_b128 v[72:75], v1 offset:16384
    v_lshl_add_u32 v121, v121, 1, v122
    buffer_load_dwordx4 v[16:19], v0, s[4:7], s24 offen offset:0 sc1
    buffer_load_dwordx4 v[20:23], v0, s[4:7], s24 offen offset:1024 sc1
    s_nop 0
    ds_read_b128 v[76:79], v1 offset:17408
    v_lshlrev_b32 v121, 2, v121
    v_lshlrev_b32 v126, 3, v0
    s_mov_b32 m0, s43
    s_nop 15
    s_nop 13
    buffer_load_dwordx4 v[112:115], v0, s[4:7], s24 offen offset:0 sc1
    buffer_load_dwordx4 v[116:119], v0, s[4:7], s24 offen offset:1024 sc1
    s_waitcnt vmcnt(3)
    v_mfma_f32_16x16x32_bf16 v[108:111], v[40:43], v[16:19], 0
    v_xor_b32 v44, s22, v16
    v_bitop3_b32 v44, v44, v18, s22 bitop3:0xf6
    s_waitcnt vmcnt(2)
    v_mfma_f32_16x16x32_bf16 v[108:111], v[40:43], v[20:23], v[108:111]
    v_bitop3_b32 v44, v44, v20, s22 bitop3:0xf6
    v_bitop3_b32 v44, v44, v22, s22 bitop3:0xf6
    v_and_b32 v44, 1, v44
    v_cmp_ne_u32 vcc, 0, v44
    s_cbranch_vccnz L_gt1_299
    ds_read_b32 v123, v6 offset:10240
    s_nop 1
L_gok_298:
    v_add_f32_dpp v108, v108, v108 row_ror:8 row_mask:0xf bank_mask:0xf
    v_add_f32_dpp v109, v109, v109 row_ror:8 row_mask:0xf bank_mask:0xf
    s_xor_b32 s22, s22, 1
    v_add_f32_dpp v108, v108, v108 row_ror:4 row_mask:0xf bank_mask:0xf
    v_add_f32_dpp v109, v109, v109 row_ror:4 row_mask:0xf bank_mask:0xf
    v_cvt_pk_bf16_f32 v44, v108, v109
    v_min_u32 v120, -2, v44
    s_mov_b64 exec, s[46:47]
    buffer_store_dword v120, v11, s[4:7], s18 offen
    s_mov_b64 exec, -1
    s_xor_b32 s23, s23, 0xff1340
    s_waitcnt lgkmcnt(0)
    v_cmp_ne_u32 vcc, s36, v123
    s_cmp_eq_u32 s14, 63
    s_cbranch_scc1 L_exit_290
    s_cbranch_vccnz L_kvw_286
L_kvok_287:
    ds_read_b128 v[24:27], v0 offset:32768
    s_nop 0
    ds_read_b128 v[28:31], v0 offset:33792
    s_nop 0
    ds_read_b128 v[32:35], v0 offset:40960
    s_nop 0
    ds_read_b128 v[36:39], v0 offset:41984
    s_nop 0
    ds_read_b128 v[40:43], v0 offset:49152
    s_nop 0
    ds_read_b128 v[44:47], v0 offset:50176
    s_nop 0
    s_nop 13
    buffer_load_dwordx4 v[16:19], v0, s[4:7], s19 offen sc1
    buffer_load_dwordx4 v[20:23], v0, s[4:7], s19 offen offset:1024 sc1
    s_nop 15
    s_nop 15
    buffer_load_dwordx4 v[16:19], v0, s[4:7], s19 offen sc1
    buffer_load_dwordx4 v[20:23], v0, s[4:7], s19 offen offset:1024 sc1
    v_mov_b32 v12, v12
    s_branch L_poll2c_295
L_gt1_299:
    s_nop 0
    s_waitcnt vmcnt(1)
    v_mfma_f32_16x16x32_bf16 v[108:111], v[40:43], v[112:115], 0
    v_xor_b32 v44, s22, v112
    v_bitop3_b32 v44, v44, v114, s22 bitop3:0xf6
    s_waitcnt vmcnt(0)
    v_mfma_f32_16x16x32_bf16 v[108:111], v[40:43], v[116:119], v[108:111]
    v_bitop3_b32 v44, v44, v116, s22 bitop3:0xf6
    v_bitop3_b32 v44, v44, v118, s22 bitop3:0xf6
    v_and_b32 v44, 1, v44
    v_cmp_ne_u32 vcc, 0, v44
    s_cbranch_vccnz L_gt2_300
    ds_read_b32 v123, v6 offset:10240
    s_nop 0
    s_branch L_gok_298
L_gt2_300:
    buffer_load_dwordx4 v[16:19], v0, s[4:7], s24 offen offset:0 sc1
    buffer_load_dwordx4 v[20:23], v0, s[4:7], s24 offen offset:1024 sc1
    s_add_u32 s40, s40, 1
    s_cmp_gt_u32 s40, 262144
    s_cbranch_scc1 L_abort
    s_waitcnt vmcnt(1)
    v_mfma_f32_16x16x32_bf16 v[108:111], v[40:43], v[16:19], 0
    v_xor_b32 v44, s22, v16
    v_bitop3_b32 v44, v44, v18, s22 bitop3:0xf6
    s_waitcnt vmcnt(0)
    v_mfma_f32_16x16x32_bf16 v[108:111], v[40:43], v[20:23], v[108:111]
    v_bitop3_b32 v44, v44, v20, s22 bitop3:0xf6
    v_bitop3_b32 v44, v44, v22, s22 bitop3:0xf6
    v_and_b32 v44, 1, v44
    v_cmp_ne_u32 vcc, 0, v44
    s_cbranch_vccnz L_gt2_300
    ds_read_b32 v123, v6 offset:10240
    s_nop 0
    s_branch L_gok_298
L_slow_288:
    ds_read2st64_b32 v[32:33], v6 offset0:0 offset1:1
    ds_read2st64_b32 v[34:35], v6 offset0:2 offset1:3
    ds_read2st64_b32 v[36:37], v6 offset0:4 offset1:5
    ds_read2st64_b32 v[38:39], v6 offset0:6 offset1:7
    ds_read2st64_b32 v[40:41], v6 offset0:8 offset1:9
    ds_read2st64_b32 v[42:43], v6 offset0:10 offset1:11
    ds_read2st64_b32 v[44:45], v6 offset0:12 offset1:13
    ds_read2st64_b32 v[46:47], v6 offset0:14 offset1:15
    s_waitcnt lgkmcnt(0)
    v_add_f32 v32, v32, v36
    v_add_f32 v40, v40, v44
    v_add_f32 v32, v32, v40
    v_mul_f32 v32, s41, v32
    v_add_f32 v33, v33, v37
    v_add_f32 v41, v41, v45
    v_add_f32 v33, v33, v41
    v_mul_f32 v33, s41, v33
    v_add_f32 v34, v34, v38
    v_add_f32 v42, v42, v46
    v_add_f32 v34, v34, v42
    v_mul_f32 v34, s41, v34
    v_add_f32 v35, v35, v39
    v_add_f32 v43, v43, v47
    v_add_f32 v35, v35, v43
    v_mul_f32 v35, s41, v35
    v_max3_f32 v84, v32, v33, v34
    v_max3_f32 v84, v84, v35, v80
    v_max_f32 v84, v84, v81
    s_nop 1
    v_max_f32_dpp v84, v84, v84 row_ror:8 row_mask:0xf bank_mask:0xf
    v_mov_b32 v85, v84
    s_nop 1
    v_permlane16_swap_b32 v84, v85
    v_max_f32 v84, v84, v85
    v_mov_b32 v85, v84
    s_nop 1
    v_permlane32_swap_b32 v84, v85
    v_max_f32 v84, v84, v85
    v_sub_f32 v32, v32, v84
    v_sub_f32 v33, v33, v84
    v_sub_f32 v34, v34, v84
    v_sub_f32 v35, v35, v84
    v_sub_f32 v90, v80, v84
    v_sub_f32 v91, v81, v84
    v_exp_f32 v32, v32
    v_exp_f32 v33, v33
    v_exp_f32 v34, v34
    v_exp_f32 v35, v35
    v_exp_f32 v90, v90
    v_exp_f32 v91, v91
    v_cvt_pk_bf16_f32 v36, v32, v33
    v_cvt_pk_bf16_f32 v37, v34, v35
    v_cvt_pk_bf16_f32 v88, v90, v91
    v_mov_b64 v[92:93], v[36:37]
    v_mov_b64 v[94:95], v[36:37]
    s_nop 1
    v_mov_b32_dpp v92, v36 row_ror:8 row_mask:0xf bank_mask:0xc
    v_mov_b32_dpp v93, v37 row_ror:8 row_mask:0xf bank_mask:0xc
    v_mov_b32_dpp v94, v36 row_ror:8 row_mask:0xf bank_mask:0x3
    v_mov_b32_dpp v95, v37 row_ror:8 row_mask:0xf bank_mask:0x3
    s_nop 1
    v_mfma_f32_16x16x32_bf16 v[108:111], v[12:15], v[92:95], 0
    v_mfma_f32_16x16x32_bf16 v[120:123], v[112:115], v[92:95], 0
    v_mfma_f32_16x16x32_bf16 v[124:127], v[116:119], v[92:95], 0
    s_nop 5
    v_mfma_f32_16x16x16_bf16 v[108:111], v[12:13], v[88:89], v[108:111]
    s_nop 0
    s_nop 1
    v_mfma_f32_16x16x16_bf16 v[120:123], v[104:105], v[88:89], v[120:123]
    s_nop 0
    v_mov_b64 v[24:25], 0
    v_mov_b64 v[26:27], 0
    v_mfma_f32_16x16x16_bf16 v[124:127], v[106:107], v[88:89], v[124:127]
    v_rcp_f32 v110, v108
    v_mov_b64 v[28:29], 0
    v_max_f32 v109, v108, v110
    v_cmp_ngt_f32 vcc, s42, v109
    v_pk_mul_f32 v[120:121], v[120:121], v[110:111] op_sel_hi:[1,0]
    v_pk_mul_f32 v[122:123], v[122:123], v[110:111] op_sel_hi:[1,0]
    v_cvt_pk_bf16_f32 v120, v120, v121
    v_cvt_pk_bf16_f32 v121, v122, v123
    v_pk_mul_f32 v[124:125], v[124:125], v[110:111] op_sel_hi:[1,0]
    v_pk_mul_f32 v[126:127], v[126:127], v[110:111] op_sel_hi:[1,0]
    v_cvt_pk_bf16_f32 v122, v124, v125
    v_cvt_pk_bf16_f32 v123, v126, v127
    v_cndmask_b32 v82, v120, v122, s[38:39]
    v_cndmask_b32 v83, v121, v123, s[38:39]
    v_mov_b64 v[16:17], 0
    v_mov_b64 v[18:19], 0
    v_mov_b64 v[20:21], 0
    v_mov_b64 v[22:23], 0
    ds_write_b64 v7, v[82:83] offset:14848
    v_smfmac_f32_16x16x64_bf16 v[16:19], v[120:123], v[160:167], v10 abid:1
    v_smfmac_f32_16x16x64_bf16 v[20:23], v[120:123], v[192:199], v10 abid:1
    s_branch L_back_289
L_exit_290:
    s_mov_b64 exec, s[46:47]
    buffer_store_dword v120, v121, s[4:7], s33 offen sc1
    s_mov_b64 exec, -1
    s_waitcnt vmcnt(1)
    s_barrier
    s_branch L_ldone_283
L_wv1_280:
    ds_read_b128 v[48:51], v0 offset:59392
    ds_read_b128 v[52:55], v0 offset:60416
    ds_read_b128 v[56:59], v1 offset:2048
    ds_read_b128 v[60:63], v1 offset:3072
    ds_read_b128 v[64:67], v1 offset:10240
    ds_read_b128 v[68:71], v1 offset:11264
    ds_read_b128 v[72:75], v1 offset:18432
    ds_read_b128 v[76:79], v1 offset:19456
    ds_read_b128 v[24:27], v0 offset:34816
    ds_read_b128 v[28:31], v0 offset:35840
    ds_read_b128 v[32:35], v0 offset:43008
    ds_read_b128 v[36:39], v0 offset:44032
    ds_read_b128 v[40:43], v0 offset:51200
    ds_read_b128 v[44:47], v0 offset:52224
    v_mov_b64 v[80:81], 0
    v_mov_b64 v[82:83], 0
    v_mov_b64 v[84:85], 0
    v_mov_b64 v[86:87], 0
    v_mov_b64 v[88:89], 0
    v_mov_b64 v[90:91], 0
    v_mov_b64 v[92:93], 0
    v_mov_b64 v[94:95], 0
    v_mov_b64 v[96:97], 0
    v_mov_b64 v[98:99], 0
    v_mov_b64 v[100:101], 0
    v_mov_b64 v[102:103], 0
    v_and_b32 v121, 16, v0
    v_lshrrev_b32 v122, 8, v0
    v_lshl_add_u32 v121, v122, 1, v121
    v_bfe_u32 v122, v0, 5, 1
    v_lshl_add_u32 v121, v121, 1, v122
    v_lshlrev_b32 v121, 2, v121
    v_lshlrev_b32 v126, 3, v0
    s_mov_b32 m0, s43
    s_waitcnt vmcnt(0)
    v_min_u32 v120, -2, v120
    s_cmp_lg_u32 s15, 0
    s_cbranch_scc1 L_w2_309
L_w1_308:
    buffer_load_dword v123, off, s[4:7], s35 sc1
    s_add_u32 s40, s40, 1
    s_cmp_gt_u32 s40, 262144
    s_cbranch_scc1 L_abort
    s_waitcnt vmcnt(0)
    v_cmp_eq_u32 vcc, 0, v123
    s_cbranch_vccnz L_w1_308
    s_branch L_w3_310
L_w2_309:
    buffer_load_dword v123, off, s[4:7], s35 sc1
    buffer_load_dwordx4 v[104:107], v0, s[4:7], s32 offen offset:0 sc1
    buffer_load_dwordx4 v[108:111], v0, s[4:7], s32 offen offset:1024 sc1
    buffer_load_dwordx4 v[112:115], v0, s[4:7], s32 offen offset:2048 sc1
    buffer_load_dwordx4 v[116:119], v0, s[4:7], s32 offen offset:3072 sc1
    s_add_u32 s40, s40, 1
    s_cmp_gt_u32 s40, 262144
    s_cbranch_scc1 L_abort
    s_waitcnt vmcnt(0)
    v_cmp_ne_u32 vcc, 0, v123
    s_cbranch_vccnz L_w3_310
    v_max_u32 v127, v104, v105
    v_max3_u32 v127, v127, v106, v107
    v_max3_u32 v127, v127, v108, v109
    v_max3_u32 v127, v127, v110, v111
    v_max3_u32 v127, v127, v112, v113
    v_max3_u32 v127, v127, v114, v115
    v_max3_u32 v127, v127, v116, v117
    v_max3_u32 v127, v127, v118, v119
    v_cmp_eq_u32 vcc, -1, v127
    s_cbranch_vccnz L_w2_309
L_w3_310:
    s_waitcnt vmcnt(0) lgkmcnt(0)
    s_branch L_st_311
L_kvw_303:
    buffer_load_dword v123, off, s[4:7], s35 sc1
    s_add_u32 s40, s40, 1
    s_cmp_gt_u32 s40, 262144
    s_cbranch_scc1 L_abort
    s_waitcnt vmcnt(0)
    v_cmp_eq_u32 vcc, 0, v123
    s_cbranch_vccnz L_kvw_303
    s_branch L_kvok_304
L_st_311:
    s_branch L_arr_301
L_poll2_302:
    buffer_load_dwordx4 v[16:19], v0, s[4:7], s19 offen sc1
    buffer_load_dwordx4 v[20:23], v0, s[4:7], s19 offen offset:1024 sc1
    s_waitcnt vmcnt(2)
    v_max3_u32 v127, v16, v17, v18
    v_max3_u32 v127, v127, v19, v20
    v_max3_u32 v127, v127, v21, v22
    v_max_u32 v127, v127, v23
    v_cmp_eq_u32 vcc, -1, v127
    s_cbranch_vccz L_arr_301
L_poll3_313:
    s_add_u32 s40, s40, 1
    s_cmp_gt_u32 s40, 262144
    s_cbranch_scc1 L_abort
    v_max3_u32 v127, v16, v17, v18
    v_max3_u32 v127, v127, v19, v20
    v_max3_u32 v127, v127, v21, v22
    v_max_u32 v127, v127, v23
    v_cmp_eq_u32 vcc, -1, v127
    s_cbranch_vccz L_arr_301
    v_max3_u32 v127, v16, v17, v18
    v_max3_u32 v127, v127, v19, v20
    v_max3_u32 v127, v127, v21, v22
    v_max_u32 v127, v127, v23
    v_cmp_eq_u32 vcc, -1, v127
    s_cbranch_vccz L_arr_301
    v_max3_u32 v127, v16, v17, v18
    v_max3_u32 v127, v127, v19, v20
    v_max3_u32 v127, v127, v21, v22
    v_max_u32 v127, v127, v23
    v_cmp_eq_u32 vcc, -1, v127
    s_cbranch_vccz L_arr_301
    v_max3_u32 v127, v16, v17, v18
    v_max3_u32 v127, v127, v19, v20
    v_max3_u32 v127, v127, v21, v22
    v_max_u32 v127, v127, v23
    v_cmp_eq_u32 vcc, -1, v127
    s_cbranch_vccz L_arr_301
    buffer_load_dwordx4 v[16:19], v0, s[4:7], s19 offen sc1
    buffer_load_dwordx4 v[20:23], v0, s[4:7], s19 offen offset:1024 sc1
    s_branch L_poll3_313
L_poll2c_312:
    v_mov_b32 v12, v12
    s_waitcnt vmcnt(3) lgkmcnt(0)
    v_max3_u32 v127, v16, v17, v18
    v_max_u32 v127, v127, v19
    s_waitcnt vmcnt(2)
    v_max3_u32 v127, v127, v20, v21
    v_max3_u32 v127, v127, v22, v23
    v_cmp_eq_u32 vcc, -1, v127
    s_cbranch_vccnz L_poll2_302
L_arr_301:
    ds_write_b128 v5, v[16:19] offset:2048
    v_smfmac_f32_16x16x64_bf16 v[80:83], v[16:19], v[24:31], v10
    s_nop 0
    ds_write_b128 v5, v[20:23] offset:3072
    v_smfmac_f32_16x16x64_bf16 v[84:87], v[16:19], v[32:39], v10
    v_smfmac_f32_16x16x64_bf16 v[80:83], v[20:23], v[40:47], v10
    s_nop 0
    buffer_load_dwordx4 v[112:115], v0, s[4:7], s32 offen offset:2048 sc1
    buffer_load_dwordx4 v[116:119], v0, s[4:7], s32 offen offset:3072 sc1
    v_smfmac_f32_16x16x64_bf16 v[84:87], v[20:23], v[48:55], v10
    s_nop 0
    buffer_load_dwordx4 v[104:107], v0, s[4:7], s32 offen offset:0 sc1
    buffer_load_dwordx4 v[108:111], v0, s[4:7], s32 offen offset:1024 sc1
    v_smfmac_f32_16x16x64_bf16 v[88:91], v[16:19], v[56:63], v10
    s_add_u32 s35, s35, 4
    s_add_u32 s36, s36, 1
    s_sub_u32 s17, s31, 4096
    s_waitcnt lgkmcnt(0)
    s_barrier
    ds_read_b128 v[24:27], v5 offset:4096
    v_smfmac_f32_16x16x64_bf16 v[92:95], v[16:19], v[64:71], v10
    s_nop 0
    ds_read_b128 v[28:31], v5 offset:5120
    v_smfmac_f32_16x16x64_bf16 v[96:99], v[16:19], v[72:79], v10
    s_nop 0
    ds_read_b128 v[32:35], v5 offset:6144
    v_smfmac_f32_16x16x64_bf16 v[96:99], v[20:23], a[176:183], v10
    s_nop 0
    ds_read_b128 v[36:39], v5 offset:7168
    s_waitcnt lgkmcnt(3)
    v_smfmac_f32_16x16x64_bf16 v[80:83], v[24:27], a[0:7], v10
    s_nop 0
    ds_read_b128 v[40:43], v5 offset:0
    v_smfmac_f32_16x16x64_bf16 v[84:87], v[24:27], a[8:15], v10
    s_waitcnt lgkmcnt(3)
    ds_read_b128 v[44:47], v5 offset:1024
    v_smfmac_f32_16x16x64_bf16 v[80:83], v[28:31], a[16:23], v10
    s_nop 0
    ds_read_b128 v[48:51], v1 offset:26624
    v_smfmac_f32_16x16x64_bf16 v[84:87], v[28:31], a[24:31], v10
    s_waitcnt lgkmcnt(3)
    ds_read_b128 v[52:55], v1 offset:27648
    v_smfmac_f32_16x16x64_bf16 v[80:83], v[32:35], a[32:39], v10
    s_nop 0
    ds_read_b128 v[56:59], v1 offset:34816
    buffer_load_dword v126, s[4:7], s17 offen sc1 lds
    v_smfmac_f32_16x16x64_bf16 v[84:87], v[32:35], a[40:47], v10
    s_nop 0
    ds_read_b128 v[60:63], v1 offset:35840
    v_smfmac_f32_16x16x64_bf16 v[80:83], v[36:39], a[48:55], v10
    s_waitcnt lgkmcnt(4)
    ds_read_b128 v[64:67], v1 offset:43008
    v_smfmac_f32_16x16x64_bf16 v[80:83], v[40:43], a[64:71], v10
    s_mov_b64 exec, s[46:47]
    buffer_store_dword v120, v121, s[4:7], s33 offen sc1
    s_mov_b64 exec, -1
    v_smfmac_f32_16x16x64_bf16 v[80:83], v[44:47], a[80:87], v10
    s_nop 0
    ds_read_b128 v[68:71], v1 offset:44032
    s_nop 0
    v_smfmac_f32_16x16x64_bf16 v[84:87], v[36:39], a[56:63], v10
    s_nop 0
    ds_read_b128 v[72:75], v1 offset:51200
    s_nop 0
    v_smfmac_f32_16x16x64_bf16 v[84:87], v[40:43], a[72:79], v10
    s_nop 0
    ds_read_b128 v[76:79], v1 offset:52224
    v_add_f32 v80, v80, v82
    v_smfmac_f32_16x16x64_bf16 v[84:87], v[44:47], a[88:95], v10
    s_waitcnt lgkmcnt(4)
    s_nop 0
    v_add_f32 v81, v81, v83
    v_smfmac_f32_16x16x64_bf16 v[88:91], v[20:23], v[48:55], v10
    s_nop 1
    v_cvt_pk_bf16_f32 v80, v80, v81
    v_smfmac_f32_16x16x64_bf16 v[92:95], v[20:23], a[96:103], v10
    s_waitcnt lgkmcnt(0)
    ds_write_b32 v2, v80 offset:24
    v_add_f32 v84, v84, v86
    v_add_f32 v85, v85, v87
    v_cvt_pk_bf16_f32 v84, v84, v85
    v_smfmac_f32_16x16x64_bf16 v[88:91], v[24:27], v[56:63], v10
    s_nop 0
    ds_write_b32 v2, v84 offset:664
    v_smfmac_f32_16x16x64_bf16 v[92:95], v[24:27], a[104:111], v10
    s_nop 0
    ds_read_b64_tr_b16 v[120:121], v4 offset:24
    ds_read_b64_tr_b16 v[122:123], v4 offset:344
    v_smfmac_f32_16x16x64_bf16 v[88:91], v[28:31], v[64:71], v10
    s_nop 0
    ds_read_b64_tr_b16 v[124:125], v4 offset:8
    ds_read_b64_tr_b16 v[126:127], v4 offset:328
    v_smfmac_f32_16x16x64_bf16 v[92:95], v[28:31], a[112:119], v10
    s_nop 0
    ds_read_b128 v[48:51], v1 offset:59392
    v_smfmac_f32_16x16x64_bf16 v[88:91], v[32:35], v[72:79], v10
    s_nop 0
    ds_read_b128 v[52:55], v1 offset:60416
    v_smfmac_f32_16x16x64_bf16 v[92:95], v[32:35], a[120:127], v10
    s_waitcnt vmcnt(2)
    v_smfmac_f32_16x16x64_bf16 v[88:91], v[36:39], a[128:135], v10
    s_waitcnt lgkmcnt(2)
    v_mfma_f32_16x16x32_bf16 v[80:83], v[104:107], v[120:123], 0
    v_mfma_f32_16x16x32_bf16 v[80:83], v[108:111], v[124:127], v[80:83]
    s_nop 2
    v_smfmac_f32_16x16x64_bf16 v[88:91], v[40:43], a[144:151], v10
    s_nop 2
    v_smfmac_f32_16x16x64_bf16 v[88:91], v[44:47], a[160:167], v10
    s_nop 0
    ds_write2st64_b32 v6, v80, v81 offset0:4 offset1:5
    v_smfmac_f32_16x16x64_bf16 v[92:95], v[36:39], a[136:143], v10
    s_waitcnt lgkmcnt(1)
    ds_write2st64_b32 v6, v82, v83 offset0:6 offset1:7
    v_smfmac_f32_16x16x64_bf16 v[92:95], v[40:43], a[152:159], v10
    s_nop 1
    v_add_f32 v88, v88, v90
    v_add_f32 v89, v89, v91
    v_cvt_pk_bf16_f32 v88, v88, v89
    v_smfmac_f32_16x16x64_bf16 v[92:95], v[44:47], v[48:55], v10
    s_nop 0
    ds_write_b32 v3, v88 offset:1408
    v_smfmac_f32_16x16x64_bf16 v[96:99], v[24:27], a[192:199], v10
    s_nop 0
    ds_read_b128 v[56:59], v0 offset:10240
    s_nop 0
    v_smfmac_f32_16x16x64_bf16 v[96:99], v[28:31], a[208:215], v10
    s_nop 1
    v_add_f32 v92, v92, v94
    v_add_f32 v93, v93, v95
    v_cvt_pk_bf16_f32 v92, v92, v93
    v_smfmac_f32_16x16x64_bf16 v[96:99], v[32:35], a[224:231], v10
    s_nop 0
    ds_write_b32 v3, v92 offset:2048
    ds_read_b64_tr_b16 v[88:89], v4 offset:1408
    ds_read_b64_tr_b16 v[90:91], v4 offset:1728
    v_smfmac_f32_16x16x64_bf16 v[96:99], v[36:39], a[240:247], v10
    s_waitcnt lgkmcnt(5)
    s_barrier
    ds_read2st64_b32 v[104:105], v6 offset0:1 offset1:5
    v_smfmac_f32_16x16x64_bf16 v[96:99], v[40:43], v[128:135], v10
    s_nop 0
    ds_read2st64_b32 v[106:107], v6 offset0:9 offset1:13
    v_smfmac_f32_16x16x64_bf16 v[96:99], v[44:47], v[144:151], v10
    s_add_u32 s16, s28, s30
    ds_read_b128 v[60:63], v0 offset:11264
    s_waitcnt lgkmcnt(3)
    v_mfma_f32_16x16x32_bf16 v[84:87], v[88:91], v[120:123], 0
    s_nop 0
    v_mov_b32 v89, 0
    s_nop 0
    v_smfmac_f32_16x16x64_bf16 v[100:103], v[16:19], a[168:175], v10
    s_waitcnt lgkmcnt(1)
    v_add_f32 v104, v104, v105
    v_add_f32 v106, v106, v107
    v_smfmac_f32_16x16x64_bf16 v[100:103], v[20:23], a[184:191], v10
    s_nop 0
    ds_write_b64 v7, v[84:85] offset:12800
    v_add_f32 v104, v104, v106
    v_mul_f32 v104, s41, v104
    v_smfmac_f32_16x16x64_bf16 v[100:103], v[24:27], a[200:207], v10
    v_exp_f32 v104, v104
    v_add_f32 v96, v96, v98
    v_cvt_pk_bf16_f32 v107, v104, v104
    v_smfmac_f32_16x16x64_bf16 v[100:103], v[28:31], a[216:223], v10
    s_nop 0
    ds_write_b16 v7, v107 offset:14338
    v_smfmac_f32_16x16x64_bf16 v[100:103], v[32:35], a[232:239], v10
    v_add_f32 v97, v97, v99
    v_smfmac_f32_16x16x64_bf16 v[100:103], v[36:39], a[248:255], v10
    s_waitcnt lgkmcnt(1)
    s_barrier
    ds_read_b64 v[80:81], v8 offset:12288
    v_smfmac_f32_16x16x64_bf16 v[100:103], v[40:43], v[136:143], v10
    s_nop 0
    ds_read_b64 v[82:83], v8 offset:12800
    ds_read_b64 v[84:85], v8 offset:13312
    ds_read_b64 v[86:87], v8 offset:13824
    v_smfmac_f32_16x16x64_bf16 v[100:103], v[44:47], v[152:159], v10
    s_waitcnt lgkmcnt(4)
    s_barrier
    ds_read_b128 v[92:95], v8 offset:14336
    v_cvt_pk_bf16_f32 v104, v96, v97
    v_cvt_pk_bf16_f32 v105, v96, v97
    v_mov_b64 v[16:17], 0
    v_mov_b64 v[18:19], 0
    s_waitcnt vmcnt(4)
    v_mov_b64 v[20:21], 0
    v_mov_b64 v[22:23], 0
    s_waitcnt lgkmcnt(1)
    v_pk_add_f32 v[80:81], v[80:81], v[82:83]
    v_pk_add_f32 v[84:85], v[84:85], v[86:87]
    v_pk_add_f32 v[80:81], v[80:81], v[84:85]
    v_mul_f32 v80, s41, v80
    v_mul_f32 v81, s41, v81
    s_waitcnt lgkmcnt(0)
    v_mfma_f32_16x16x32_bf16 v[108:111], v[12:15], v[92:95], 0
    v_exp_f32 v90, v80
    v_mfma_f32_16x16x32_bf16 v[120:123], v[112:115], v[92:95], 0
    v_exp_f32 v91, v81
    v_mfma_f32_16x16x32_bf16 v[124:127], v[116:119], v[92:95], 0
    v_cvt_pk_bf16_f32 v88, v90, v91
    v_add_f32 v100, v100, v102
    v_add_f32 v101, v101, v103
    v_mfma_f32_16x16x16_bf16 v[108:111], v[12:13], v[88:89], v[108:111]
    s_nop 0
    v_cvt_pk_bf16_f32 v106, v100, v101
    v_cvt_pk_bf16_f32 v107, v100, v101
    v_mfma_f32_16x16x16_bf16 v[120:123], v[104:105], v[88:89], v[120:123]
    s_nop 0
    v_mov_b64 v[24:25], 0
    v_mov_b64 v[26:27], 0
    v_mfma_f32_16x16x16_bf16 v[124:127], v[106:107], v[88:89], v[124:127]
    v_rcp_f32 v110, v108
    v_mov_b64 v[28:29], 0
    v_max_f32 v109, v108, v110
    v_cmp_ngt_f32 vcc, s42, v109
    v_pk_mul_f32 v[120:121], v[120:121], v[110:111] op_sel_hi:[1,0]
    v_pk_mul_f32 v[122:123], v[122:123], v[110:111] op_sel_hi:[1,0]
    v_cvt_pk_bf16_f32 v120, v120, v121
    v_cvt_pk_bf16_f32 v121, v122, v123
    v_pk_mul_f32 v[124:125], v[124:125], v[110:111] op_sel_hi:[1,0]
    v_pk_mul_f32 v[126:127], v[126:127], v[110:111] op_sel_hi:[1,0]
    v_cvt_pk_bf16_f32 v122, v124, v125
    v_cvt_pk_bf16_f32 v123, v126, v127
    v_cndmask_b32 v82, v120, v122, s[38:39]
    v_cndmask_b32 v83, v121, v123, s[38:39]
    v_smfmac_f32_16x16x64_bf16 v[16:19], v[120:123], v[168:175], v10 abid:1
    s_nop 0
    ds_write_b64 v7, v[82:83] offset:15360
    v_smfmac_f32_16x16x64_bf16 v[20:23], v[120:123], v[200:207], v10 abid:1
    s_cbranch_vccnz L_slow_305
L_back_306:
    v_mov_b64 v[30:31], 0
    v_mov_b32 v46, -1
    s_mov_b64 exec, s[46:47]
    buffer_store_dword v46, v11, s[4:7], s16 offen
    s_mov_b64 exec, -1
    v_smfmac_f32_16x16x64_bf16 v[24:27], v[120:123], v[232:239], v10 abid:1
    s_waitcnt lgkmcnt(0)
    s_barrier
    ds_read_b128 v[112:115], v8 offset:15872
    v_smfmac_f32_16x16x64_bf16 v[28:31], v[120:123], v[56:63], v10 abid:1
    s_nop 0
    ds_read_b128 v[116:119], v8 offset:16384
    ds_read_b128 v[124:127], v8 offset:14848
    v_mov_b32 v12, v12
    s_add_u32 s33, s33, 8192
    s_mov_b32 s32, s31
    s_add_u32 s31, s31, 524288
    v_mov_b32 v12, v12
    s_waitcnt lgkmcnt(2)
    v_smfmac_f32_16x16x64_bf16 v[16:19], v[112:115], v[176:183], v10 abid:1
    s_min_u32 s31, s31, s44
    ds_read_b128 v[64:67], v0 offset:18432
    s_add_u32 s14, s14, 1
    v_smfmac_f32_16x16x64_bf16 v[20:23], v[112:115], v[208:215], v10 abid:1
    s_waitcnt lgkmcnt(2)
    ds_read_b128 v[68:71], v0 offset:19456
    s_add_u32 s18, s27, s30
    v_smfmac_f32_16x16x64_bf16 v[16:19], v[116:119], v[184:191], v10 abid:1
    s_waitcnt lgkmcnt(2)
    ds_read_b128 v[72:75], v0 offset:26624
    s_mov_b32 s16, s26
    v_smfmac_f32_16x16x64_bf16 v[16:19], v[124:127], v[160:167], v10 abid:1
    s_mov_b32 s26, s27
    ds_read_b128 v[76:79], v0 offset:27648
    s_mov_b32 s27, s28
    v_smfmac_f32_16x16x64_bf16 v[20:23], v[116:119], v[216:223], v10 abid:1
    s_mov_b32 s28, s16
    ds_read_b128 v[48:51], v0 offset:2048
    s_add_u32 s19, s26, s29
    v_smfmac_f32_16x16x64_bf16 v[20:23], v[124:127], v[192:199], v10 abid:1
    s_nop 0
    ds_read_b128 v[52:55], v0 offset:3072
    v_mul_f32 v16, s23, v16
    v_cvt_pk_bf16_f32 v32, v16, v17
    v_cvt_pk_bf16_f32 v33, v18, v19
    v_and_or_b32 v32, v32, -2, s22
    v_smfmac_f32_16x16x64_bf16 v[24:27], v[112:115], v[240:247], v10 abid:1
    s_nop 0
    buffer_store_dwordx2 v[32:33], v9, s[4:7], s20 offen
    v_smfmac_f32_16x16x64_bf16 v[24:27], v[116:119], v[248:255], v10 abid:1
    s_nop 0
    ds_read_b128 v[40:43], v5 offset:17408
    v_mul_f32 v20, s23, v20
    v_cvt_pk_bf16_f32 v34, v20, v21
    v_cvt_pk_bf16_f32 v35, v22, v23
    v_and_or_b32 v34, v34, -2, s22
    v_smfmac_f32_16x16x64_bf16 v[24:27], v[124:127], v[224:231], v10 abid:1
    s_waitcnt lgkmcnt(1)
    buffer_store_dwordx2 v[34:35], v9, s[4:7], s21 offen
    v_smfmac_f32_16x16x64_bf16 v[28:31], v[112:115], v[64:71], v10 abid:1
    s_nop 0
    s_nop 0
    s_nop 0
    v_smfmac_f32_16x16x64_bf16 v[28:31], v[116:119], v[72:79], v10 abid:1
    s_nop 0
    s_nop 0
    v_mul_f32 v24, s23, v24
    v_cvt_pk_bf16_f32 v36, v24, v25
    v_smfmac_f32_16x16x64_bf16 v[28:31], v[124:127], v[48:55], v10 abid:1
    s_waitcnt lgkmcnt(0)
    s_nop 0
    v_cvt_pk_bf16_f32 v37, v26, v27
    v_and_or_b32 v36, v36, -2, s22
    buffer_store_dwordx2 v[36:37], v9, s[4:7], s25 offen
    v_mov_b64 v[80:81], 0
    v_mov_b64 v[82:83], 0
    v_mov_b64 v[84:85], 0
    v_mul_f32 v28, s23, v28
    v_cvt_pk_bf16_f32 v38, v28, v29
    v_cvt_pk_bf16_f32 v39, v30, v31
    v_and_or_b32 v38, v38, -2, s22
    buffer_store_dwordx2 v[38:39], v9, s[4:7], s37 offen
    v_mov_b64 v[86:87], 0
    s_nop 0
    ds_read_b128 v[48:51], v0 offset:59392
    v_mov_b64 v[88:89], 0
    v_mov_b64 v[90:91], 0
    s_nop 0
    ds_read_b128 v[52:55], v0 offset:60416
    v_mov_b64 v[92:93], 0
    v_mov_b64 v[94:95], 0
    s_nop 0
    ds_read_b128 v[56:59], v1 offset:2048
    v_mov_b64 v[96:97], 0
    v_mov_b64 v[98:99], 0
    s_nop 0
    ds_read_b128 v[60:63], v1 offset:3072
    v_mov_b64 v[100:101], 0
    v_mov_b64 v[102:103], 0
    s_nop 0
    ds_read_b128 v[64:67], v1 offset:10240
    v_and_b32 v121, 16, v0
    v_lshrrev_b32 v122, 8, v0
    s_nop 0
    ds_read_b128 v[68:71], v1 offset:11264
    v_lshl_add_u32 v121, v122, 1, v121
    v_bfe_u32 v122, v0, 5, 1
    s_nop 0
    ds_read_b128 v[72:75], v1 offset:18432
    v_lshl_add_u32 v121, v121, 1, v122
    v_lshlrev_b32 v121, 2, v121
    s_nop 0
    ds_read_b128 v[76:79], v1 offset:19456
    v_lshlrev_b32 v126, 3, v0
    s_mov_b32 m0, s43
    s_nop 2
    buffer_load_dwordx4 v[16:19], v0, s[4:7], s24 offen offset:0 sc1
    buffer_load_dwordx4 v[20:23], v0, s[4:7], s24 offen offset:1024 sc1
    s_nop 15
    s_nop 15
    s_nop 2
    buffer_load_dwordx4 v[112:115], v0, s[4:7], s24 offen offset:0 sc1
    buffer_load_dwordx4 v[116:119], v0, s[4:7], s24 offen offset:1024 sc1
    s_waitcnt vmcnt(3)
    v_mfma_f32_16x16x32_bf16 v[108:111], v[40:43], v[16:19], 0
    v_xor_b32 v44, s22, v16
    v_bitop3_b32 v44, v44, v18, s22 bitop3:0xf6
    s_waitcnt vmcnt(2)
    v_mfma_f32_16x16x32_bf16 v[108:111], v[40:43], v[20:23], v[108:111]
    v_bitop3_b32 v44, v44, v20, s22 bitop3:0xf6
    v_bitop3_b32 v44, v44, v22, s22 bitop3:0xf6
    v_and_b32 v44, 1, v44
    v_cmp_ne_u32 vcc, 0, v44
    s_cbranch_vccnz L_gt1_316
    ds_read_b32 v123, v6 offset:10240
    s_nop 1
L_gok_315:
    v_add_f32_dpp v108, v108, v108 row_ror:8 row_mask:0xf bank_mask:0xf
    v_add_f32_dpp v109, v109, v109 row_ror:8 row_mask:0xf bank_mask:0xf
    s_xor_b32 s22, s22, 1
    v_add_f32_dpp v108, v108, v108 row_ror:4 row_mask:0xf bank_mask:0xf
    v_add_f32_dpp v109, v109, v109 row_ror:4 row_mask:0xf bank_mask:0xf
    v_cvt_pk_bf16_f32 v44, v108, v109
    v_min_u32 v120, -2, v44
    s_mov_b64 exec, s[46:47]
    buffer_store_dword v120, v11, s[4:7], s18 offen
    s_mov_b64 exec, -1
    s_xor_b32 s23, s23, 0xff1340
    s_waitcnt lgkmcnt(0)
    v_cmp_ne_u32 vcc, s36, v123
    s_cmp_eq_u32 s14, 63
    s_cbranch_scc1 L_exit_307
    s_cbranch_vccnz L_kvw_303
L_kvok_304:
    ds_read_b128 v[24:27], v0 offset:34816
    s_nop 0
    ds_read_b128 v[28:31], v0 offset:35840
    s_nop 0
    ds_read_b128 v[32:35], v0 offset:43008
    s_nop 0
    ds_read_b128 v[36:39], v0 offset:44032
    s_nop 0
    ds_read_b128 v[40:43], v0 offset:51200
    s_nop 0
    ds_read_b128 v[44:47], v0 offset:52224
    s_nop 0
    s_nop 10
    buffer_load_dwordx4 v[16:19], v0, s[4:7], s19 offen sc1
    buffer_load_dwordx4 v[20:23], v0, s[4:7], s19 offen offset:1024 sc1
    s_nop 15
    s_nop 15
    buffer_load_dwordx4 v[16:19], v0, s[4:7], s19 offen sc1
    buffer_load_dwordx4 v[20:23], v0, s[4:7], s19 offen offset:1024 sc1
    v_mov_b32 v12, v12
    s_branch L_poll2c_312
L_gt1_316:
    s_nop 0
    s_waitcnt vmcnt(1)
    v_mfma_f32_16x16x32_bf16 v[108:111], v[40:43], v[112:115], 0
    v_xor_b32 v44, s22, v112
    v_bitop3_b32 v44, v44, v114, s22 bitop3:0xf6
    s_waitcnt vmcnt(0)
    v_mfma_f32_16x16x32_bf16 v[108:111], v[40:43], v[116:119], v[108:111]
    v_bitop3_b32 v44, v44, v116, s22 bitop3:0xf6
    v_bitop3_b32 v44, v44, v118, s22 bitop3:0xf6
    v_and_b32 v44, 1, v44
    v_cmp_ne_u32 vcc, 0, v44
    s_cbranch_vccnz L_gt2_317
    ds_read_b32 v123, v6 offset:10240
    s_nop 0
    s_branch L_gok_315
L_gt2_317:
    buffer_load_dwordx4 v[16:19], v0, s[4:7], s24 offen offset:0 sc1
    buffer_load_dwordx4 v[20:23], v0, s[4:7], s24 offen offset:1024 sc1
    s_add_u32 s40, s40, 1
    s_cmp_gt_u32 s40, 262144
    s_cbranch_scc1 L_abort
    s_waitcnt vmcnt(1)
    v_mfma_f32_16x16x32_bf16 v[108:111], v[40:43], v[16:19], 0
    v_xor_b32 v44, s22, v16
    v_bitop3_b32 v44, v44, v18, s22 bitop3:0xf6
    s_waitcnt vmcnt(0)
    v_mfma_f32_16x16x32_bf16 v[108:111], v[40:43], v[20:23], v[108:111]
    v_bitop3_b32 v44, v44, v20, s22 bitop3:0xf6
    v_bitop3_b32 v44, v44, v22, s22 bitop3:0xf6
    v_and_b32 v44, 1, v44
    v_cmp_ne_u32 vcc, 0, v44
    s_cbranch_vccnz L_gt2_317
    ds_read_b32 v123, v6 offset:10240
    s_nop 0
    s_branch L_gok_315
L_slow_305:
    ds_read2st64_b32 v[32:33], v6 offset0:0 offset1:1
    ds_read2st64_b32 v[34:35], v6 offset0:2 offset1:3
    ds_read2st64_b32 v[36:37], v6 offset0:4 offset1:5
    ds_read2st64_b32 v[38:39], v6 offset0:6 offset1:7
    ds_read2st64_b32 v[40:41], v6 offset0:8 offset1:9
    ds_read2st64_b32 v[42:43], v6 offset0:10 offset1:11
    ds_read2st64_b32 v[44:45], v6 offset0:12 offset1:13
    ds_read2st64_b32 v[46:47], v6 offset0:14 offset1:15
    s_waitcnt lgkmcnt(0)
    v_add_f32 v32, v32, v36
    v_add_f32 v40, v40, v44
    v_add_f32 v32, v32, v40
    v_mul_f32 v32, s41, v32
    v_add_f32 v33, v33, v37
    v_add_f32 v41, v41, v45
    v_add_f32 v33, v33, v41
    v_mul_f32 v33, s41, v33
    v_add_f32 v34, v34, v38
    v_add_f32 v42, v42, v46
    v_add_f32 v34, v34, v42
    v_mul_f32 v34, s41, v34
    v_add_f32 v35, v35, v39
    v_add_f32 v43, v43, v47
    v_add_f32 v35, v35, v43
    v_mul_f32 v35, s41, v35
    v_max3_f32 v84, v32, v33, v34
    v_max3_f32 v84, v84, v35, v80
    v_max_f32 v84, v84, v81
    s_nop 1
    v_max_f32_dpp v84, v84, v84 row_ror:8 row_mask:0xf bank_mask:0xf
    v_mov_b32 v85, v84
    s_nop 1
    v_permlane16_swap_b32 v84, v85
    v_max_f32 v84, v84, v85
    v_mov_b32 v85, v84
    s_nop 1
    v_permlane32_swap_b32 v84, v85
    v_max_f32 v84, v84, v85
    v_sub_f32 v32, v32, v84
    v_sub_f32 v33, v33, v84
    v_sub_f32 v34, v34, v84
    v_sub_f32 v35, v35, v84
    v_sub_f32 v90, v80, v84
    v_sub_f32 v91, v81, v84
    v_exp_f32 v32, v32
    v_exp_f32 v33, v33
    v_exp_f32 v34, v34
    v_exp_f32 v35, v35
    v_exp_f32 v90, v90
    v_exp_f32 v91, v91
    v_cvt_pk_bf16_f32 v36, v32, v33
    v_cvt_pk_bf16_f32 v37, v34, v35
    v_cvt_pk_bf16_f32 v88, v90, v91
    v_mov_b64 v[92:93], v[36:37]
    v_mov_b64 v[94:95], v[36:37]
    s_nop 1
    v_mov_b32_dpp v92, v36 row_ror:8 row_mask:0xf bank_mask:0xc
    v_mov_b32_dpp v93, v37 row_ror:8 row_mask:0xf bank_mask:0xc
    v_mov_b32_dpp v94, v36 row_ror:8 row_mask:0xf bank_mask:0x3
    v_mov_b32_dpp v95, v37 row_ror:8 row_mask:0xf bank_mask:0x3
    s_nop 1
    v_mfma_f32_16x16x32_bf16 v[108:111], v[12:15], v[92:95], 0
    v_mfma_f32_16x16x32_bf16 v[120:123], v[112:115], v[92:95], 0
    v_mfma_f32_16x16x32_bf16 v[124:127], v[116:119], v[92:95], 0
    s_nop 5
    v_mfma_f32_16x16x16_bf16 v[108:111], v[12:13], v[88:89], v[108:111]
    s_nop 0
    s_nop 1
    v_mfma_f32_16x16x16_bf16 v[120:123], v[104:105], v[88:89], v[120:123]
    s_nop 0
    v_mov_b64 v[24:25], 0
    v_mov_b64 v[26:27], 0
    v_mfma_f32_16x16x16_bf16 v[124:127], v[106:107], v[88:89], v[124:127]
    v_rcp_f32 v110, v108
    v_mov_b64 v[28:29], 0
    v_max_f32 v109, v108, v110
    v_cmp_ngt_f32 vcc, s42, v109
    v_pk_mul_f32 v[120:121], v[120:121], v[110:111] op_sel_hi:[1,0]
    v_pk_mul_f32 v[122:123], v[122:123], v[110:111] op_sel_hi:[1,0]
    v_cvt_pk_bf16_f32 v120, v120, v121
    v_cvt_pk_bf16_f32 v121, v122, v123
    v_pk_mul_f32 v[124:125], v[124:125], v[110:111] op_sel_hi:[1,0]
    v_pk_mul_f32 v[126:127], v[126:127], v[110:111] op_sel_hi:[1,0]
    v_cvt_pk_bf16_f32 v122, v124, v125
    v_cvt_pk_bf16_f32 v123, v126, v127
    v_cndmask_b32 v82, v120, v122, s[38:39]
    v_cndmask_b32 v83, v121, v123, s[38:39]
    v_mov_b64 v[16:17], 0
    v_mov_b64 v[18:19], 0
    v_mov_b64 v[20:21], 0
    v_mov_b64 v[22:23], 0
    ds_write_b64 v7, v[82:83] offset:15360
    v_smfmac_f32_16x16x64_bf16 v[16:19], v[120:123], v[168:175], v10 abid:1
    v_smfmac_f32_16x16x64_bf16 v[20:23], v[120:123], v[200:207], v10 abid:1
    s_branch L_back_306
L_exit_307:
    s_mov_b64 exec, s[46:47]
    buffer_store_dword v120, v121, s[4:7], s33 offen sc1
    s_mov_b64 exec, -1
    s_waitcnt vmcnt(1)
    s_barrier
    s_branch L_ldone_283
L_wv2_281:
    ds_read_b128 v[48:51], v0 offset:61440
    ds_read_b128 v[52:55], v0 offset:62464
    ds_read_b128 v[56:59], v1 offset:4096
    ds_read_b128 v[60:63], v1 offset:5120
    ds_read_b128 v[64:67], v1 offset:12288
    ds_read_b128 v[68:71], v1 offset:13312
    ds_read_b128 v[72:75], v1 offset:20480
    ds_read_b128 v[76:79], v1 offset:21504
    ds_read_b128 v[24:27], v0 offset:36864
    ds_read_b128 v[28:31], v0 offset:37888
    ds_read_b128 v[32:35], v0 offset:45056
    ds_read_b128 v[36:39], v0 offset:46080
    ds_read_b128 v[40:43], v0 offset:53248
    ds_read_b128 v[44:47], v0 offset:54272
    v_mov_b64 v[80:81], 0
    v_mov_b64 v[82:83], 0
    v_mov_b64 v[84:85], 0
    v_mov_b64 v[86:87], 0
    v_mov_b64 v[88:89], 0
    v_mov_b64 v[90:91], 0
    v_mov_b64 v[92:93], 0
    v_mov_b64 v[94:95], 0
    v_mov_b64 v[96:97], 0
    v_mov_b64 v[98:99], 0
    v_mov_b64 v[100:101], 0
    v_mov_b64 v[102:103], 0
    v_and_b32 v121, 16, v0
    v_lshrrev_b32 v122, 8, v0
    v_lshl_add_u32 v121, v122, 1, v121
    v_bfe_u32 v122, v0, 5, 1
    v_lshl_add_u32 v121, v121, 1, v122
    v_lshlrev_b32 v121, 2, v121
    v_lshlrev_b32 v126, 3, v0
    s_mov_b32 m0, s43
    s_waitcnt vmcnt(0)
    v_min_u32 v120, -2, v120
    s_cmp_lg_u32 s15, 0
    s_cbranch_scc1 L_w2_326
L_w1_325:
    buffer_load_dword v123, off, s[4:7], s35 sc1
    s_add_u32 s40, s40, 1
    s_cmp_gt_u32 s40, 262144
    s_cbranch_scc1 L_abort
    s_waitcnt vmcnt(0)
    v_cmp_eq_u32 vcc, 0, v123
    s_cbranch_vccnz L_w1_325
    s_branch L_w3_327
L_w2_326:
    buffer_load_dword v123, off, s[4:7], s35 sc1
    buffer_load_dwordx4 v[104:107], v0, s[4:7], s32 offen offset:0 sc1
    buffer_load_dwordx4 v[108:111], v0, s[4:7], s32 offen offset:1024 sc1
    buffer_load_dwordx4 v[112:115], v0, s[4:7], s32 offen offset:2048 sc1
    buffer_load_dwordx4 v[116:119], v0, s[4:7], s32 offen offset:3072 sc1
    s_add_u32 s40, s40, 1
    s_cmp_gt_u32 s40, 262144
    s_cbranch_scc1 L_abort
    s_waitcnt vmcnt(0)
    v_cmp_ne_u32 vcc, 0, v123
    s_cbranch_vccnz L_w3_327
    v_max_u32 v127, v104, v105
    v_max3_u32 v127, v127, v106, v107
    v_max3_u32 v127, v127, v108, v109
    v_max3_u32 v127, v127, v110, v111
    v_max3_u32 v127, v127, v112, v113
    v_max3_u32 v127, v127, v114, v115
    v_max3_u32 v127, v127, v116, v117
    v_max3_u32 v127, v127, v118, v119
    v_cmp_eq_u32 vcc, -1, v127
    s_cbranch_vccnz L_w2_326
L_w3_327:
    s_waitcnt vmcnt(0) lgkmcnt(0)
    s_branch L_st_328
L_kvw_320:
    buffer_load_dword v123, off, s[4:7], s35 sc1
    s_add_u32 s40, s40, 1
    s_cmp_gt_u32 s40, 262144
    s_cbranch_scc1 L_abort
    s_waitcnt vmcnt(0)
    v_cmp_eq_u32 vcc, 0, v123
    s_cbranch_vccnz L_kvw_320
    s_branch L_kvok_321
L_st_328:
    s_branch L_arr_318
L_poll2_319:
    buffer_load_dwordx4 v[16:19], v0, s[4:7], s19 offen sc1
    buffer_load_dwordx4 v[20:23], v0, s[4:7], s19 offen offset:1024 sc1
    s_waitcnt vmcnt(2)
    v_max3_u32 v127, v16, v17, v18
    v_max3_u32 v127, v127, v19, v20
    v_max3_u32 v127, v127, v21, v22
    v_max_u32 v127, v127, v23
    v_cmp_eq_u32 vcc, -1, v127
    s_cbranch_vccz L_arr_318
L_poll3_330:
    s_add_u32 s40, s40, 1
    s_cmp_gt_u32 s40, 262144
    s_cbranch_scc1 L_abort
    v_max3_u32 v127, v16, v17, v18
    v_max3_u32 v127, v127, v19, v20
    v_max3_u32 v127, v127, v21, v22
    v_max_u32 v127, v127, v23
    v_cmp_eq_u32 vcc, -1, v127
    s_cbranch_vccz L_arr_318
    v_max3_u32 v127, v16, v17, v18
    v_max3_u32 v127, v127, v19, v20
    v_max3_u32 v127, v127, v21, v22
    v_max_u32 v127, v127, v23
    v_cmp_eq_u32 vcc, -1, v127
    s_cbranch_vccz L_arr_318
    v_max3_u32 v127, v16, v17, v18
    v_max3_u32 v127, v127, v19, v20
    v_max3_u32 v127, v127, v21, v22
    v_max_u32 v127, v127, v23
    v_cmp_eq_u32 vcc, -1, v127
    s_cbranch_vccz L_arr_318
    v_max3_u32 v127, v16, v17, v18
    v_max3_u32 v127, v127, v19, v20
    v_max3_u32 v127, v127, v21, v22
    v_max_u32 v127, v127, v23
    v_cmp_eq_u32 vcc, -1, v127
    s_cbranch_vccz L_arr_318
    buffer_load_dwordx4 v[16:19], v0, s[4:7], s19 offen sc1
    buffer_load_dwordx4 v[20:23], v0, s[4:7], s19 offen offset:1024 sc1
    s_branch L_poll3_330
L_poll2c_329:
    v_mov_b32 v12, v12
    s_waitcnt vmcnt(3) lgkmcnt(0)
    v_max3_u32 v127, v16, v17, v18
    v_max_u32 v127, v127, v19
    s_waitcnt vmcnt(2)
    v_max3_u32 v127, v127, v20, v21
    v_max3_u32 v127, v127, v22, v23
    v_cmp_eq_u32 vcc, -1, v127
    s_cbranch_vccnz L_poll2_319
L_arr_318:
    ds_write_b128 v5, v[16:19] offset:4096
    v_smfmac_f32_16x16x64_bf16 v[80:83], v[16:19], v[24:31], v10
    s_nop 0
    ds_write_b128 v5, v[20:23] offset:5120
    v_smfmac_f32_16x16x64_bf16 v[84:87], v[16:19], v[32:39], v10
    v_smfmac_f32_16x16x64_bf16 v[80:83], v[20:23], v[40:47], v10
    s_nop 0
    buffer_load_dwordx4 v[112:115], v0, s[4:7], s32 offen offset:2048 sc1
    buffer_load_dwordx4 v[116:119], v0, s[4:7], s32 offen offset:3072 sc1
    v_smfmac_f32_16x16x64_bf16 v[84:87], v[20:23], v[48:55], v10
    s_nop 0
    buffer_load_dwordx4 v[104:107], v0, s[4:7], s32 offen offset:0 sc1
    buffer_load_dwordx4 v[108:111], v0, s[4:7], s32 offen offset:1024 sc1
    v_smfmac_f32_16x16x64_bf16 v[88:91], v[16:19], v[56:63], v10
    s_add_u32 s35, s35, 4
    s_add_u32 s36, s36, 1
    s_waitcnt lgkmcnt(0)
    s_barrier
    ds_read_b128 v[24:27], v5 offset:6144
    v_smfmac_f32_16x16x64_bf16 v[92:95], v[16:19], v[64:71], v10
    s_nop 0
    ds_read_b128 v[28:31], v5 offset:7168
    v_smfmac_f32_16x16x64_bf16 v[96:99], v[16:19], v[72:79], v10
    s_nop 0
    ds_read_b128 v[32:35], v5 offset:0
    v_smfmac_f32_16x16x64_bf16 v[96:99], v[20:23], a[176:183], v10
    s_nop 0
    ds_read_b128 v[36:39], v5 offset:1024
    s_waitcnt lgkmcnt(3)
    v_smfmac_f32_16x16x64_bf16 v[80:83], v[24:27], a[0:7], v10
    s_nop 0
    ds_read_b128 v[40:43], v5 offset:2048
    v_smfmac_f32_16x16x64_bf16 v[84:87], v[24:27], a[8:15], v10
    s_waitcnt lgkmcnt(3)
    ds_read_b128 v[44:47], v5 offset:3072
    v_smfmac_f32_16x16x64_bf16 v[80:83], v[28:31], a[16:23], v10
    s_nop 0
    ds_read_b128 v[48:51], v1 offset:28672
    v_smfmac_f32_16x16x64_bf16 v[84:87], v[28:31], a[24:31], v10
    s_waitcnt lgkmcnt(3)
    ds_read_b128 v[52:55], v1 offset:29696
    v_smfmac_f32_16x16x64_bf16 v[80:83], v[32:35], a[32:39], v10
    s_mov_b64 exec, s[46:47]
    buffer_store_dword v120, v121, s[4:7], s33 offen sc1
    s_mov_b64 exec, -1
    v_smfmac_f32_16x16x64_bf16 v[84:87], v[32:35], a[40:47], v10
    s_nop 0
    ds_read_b128 v[56:59], v1 offset:36864
    v_smfmac_f32_16x16x64_bf16 v[80:83], v[36:39], a[48:55], v10
    s_waitcnt lgkmcnt(3)
    ds_read_b128 v[60:63], v1 offset:37888
    v_smfmac_f32_16x16x64_bf16 v[80:83], v[40:43], a[64:71], v10
    s_nop 0
    ds_read_b128 v[64:67], v1 offset:45056
    v_smfmac_f32_16x16x64_bf16 v[80:83], v[44:47], a[80:87], v10
    s_nop 0
    ds_read_b128 v[68:71], v1 offset:46080
    s_nop 0
    v_smfmac_f32_16x16x64_bf16 v[84:87], v[36:39], a[56:63], v10
    s_nop 0
    ds_read_b128 v[72:75], v1 offset:53248
    s_nop 0
    v_smfmac_f32_16x16x64_bf16 v[84:87], v[40:43], a[72:79], v10
    s_nop 0
    ds_read_b128 v[76:79], v1 offset:54272
    v_add_f32 v80, v80, v82
    v_smfmac_f32_16x16x64_bf16 v[84:87], v[44:47], a[88:95], v10
    s_waitcnt lgkmcnt(4)
    s_nop 0
    v_add_f32 v81, v81, v83
    v_smfmac_f32_16x16x64_bf16 v[88:91], v[20:23], v[48:55], v10
    s_nop 1
    v_cvt_pk_bf16_f32 v80, v80, v81
    v_smfmac_f32_16x16x64_bf16 v[92:95], v[20:23], a[96:103], v10
    s_waitcnt lgkmcnt(0)
    ds_write_b32 v2, v80 offset:24
    v_add_f32 v84, v84, v86
    v_add_f32 v85, v85, v87
    v_cvt_pk_bf16_f32 v84, v84, v85
    v_smfmac_f32_16x16x64_bf16 v[88:91], v[24:27], v[56:63], v10
    s_nop 0
    ds_write_b32 v2, v84 offset:664
    v_smfmac_f32_16x16x64_bf16 v[92:95], v[24:27], a[104:111], v10
    s_nop 0
    ds_read_b64_tr_b16 v[120:121], v4 offset:24
    ds_read_b64_tr_b16 v[122:123], v4 offset:344
    v_smfmac_f32_16x16x64_bf16 v[88:91], v[28:31], v[64:71], v10
    s_nop 0
    ds_read_b64_tr_b16 v[124:125], v4 offset:8
    ds_read_b64_tr_b16 v[126:127], v4 offset:328
    v_smfmac_f32_16x16x64_bf16 v[92:95], v[28:31], a[112:119], v10
    s_nop 0
    ds_read_b128 v[48:51], v1 offset:61440
    v_smfmac_f32_16x16x64_bf16 v[88:91], v[32:35], v[72:79], v10
    s_nop 0
    ds_read_b128 v[52:55], v1 offset:62464
    v_smfmac_f32_16x16x64_bf16 v[92:95], v[32:35], a[120:127], v10
    s_waitcnt vmcnt(1)
    v_smfmac_f32_16x16x64_bf16 v[88:91], v[36:39], a[128:135], v10
    s_waitcnt lgkmcnt(2)
    v_mfma_f32_16x16x32_bf16 v[80:83], v[104:107], v[120:123], 0
    v_mfma_f32_16x16x32_bf16 v[80:83], v[108:111], v[124:127], v[80:83]
    s_nop 2
    v_smfmac_f32_16x16x64_bf16 v[88:91], v[40:43], a[144:151], v10
    s_nop 2
    v_smfmac_f32_16x16x64_bf16 v[88:91], v[44:47], a[160:167], v10
    s_nop 0
    ds_write2st64_b32 v6, v80, v81 offset0:8 offset1:9
    v_smfmac_f32_16x16x64_bf16 v[92:95], v[36:39], a[136:143], v10
    s_waitcnt lgkmcnt(1)
    ds_write2st64_b32 v6, v82, v83 offset0:10 offset1:11
    v_smfmac_f32_16x16x64_bf16 v[92:95], v[40:43], a[152:159], v10
    s_nop 1
    v_add_f32 v88, v88, v90
    v_add_f32 v89, v89, v91
    v_cvt_pk_bf16_f32 v88, v88, v89
    v_smfmac_f32_16x16x64_bf16 v[92:95], v[44:47], v[48:55], v10
    s_nop 0
    ds_write_b32 v3, v88 offset:1408
    v_smfmac_f32_16x16x64_bf16 v[96:99], v[24:27], a[192:199], v10
    s_nop 0
    ds_read_b128 v[64:67], v0 offset:20480
    s_nop 0
    v_smfmac_f32_16x16x64_bf16 v[96:99], v[28:31], a[208:215], v10
    s_nop 1
    v_add_f32 v92, v92, v94
    v_add_f32 v93, v93, v95
    v_cvt_pk_bf16_f32 v92, v92, v93
    v_smfmac_f32_16x16x64_bf16 v[96:99], v[32:35], a[224:231], v10
    s_nop 0
    ds_write_b32 v3, v92 offset:2048
    ds_read_b64_tr_b16 v[88:89], v4 offset:1408
    ds_read_b64_tr_b16 v[90:91], v4 offset:1728
    v_smfmac_f32_16x16x64_bf16 v[96:99], v[36:39], a[240:247], v10
    s_waitcnt lgkmcnt(5)
    s_barrier
    ds_read2st64_b32 v[104:105], v6 offset0:2 offset1:6
    v_smfmac_f32_16x16x64_bf16 v[96:99], v[40:43], v[128:135], v10
    s_nop 0
    ds_read2st64_b32 v[106:107], v6 offset0:10 offset1:14
    v_smfmac_f32_16x16x64_bf16 v[96:99], v[44:47], v[144:151], v10
    s_add_u32 s16, s28, s30
    ds_read_b128 v[68:71], v0 offset:21504
    s_waitcnt lgkmcnt(3)
    v_mfma_f32_16x16x32_bf16 v[84:87], v[88:91], v[120:123], 0
    s_nop 0
    v_mov_b32 v89, 0
    s_nop 0
    v_smfmac_f32_16x16x64_bf16 v[100:103], v[16:19], a[168:175], v10
    s_waitcnt lgkmcnt(1)
    v_add_f32 v104, v104, v105
    v_add_f32 v106, v106, v107
    v_smfmac_f32_16x16x64_bf16 v[100:103], v[20:23], a[184:191], v10
    s_nop 0
    ds_write_b64 v7, v[84:85] offset:13312
    v_add_f32 v104, v104, v106
    v_mul_f32 v104, s41, v104
    v_smfmac_f32_16x16x64_bf16 v[100:103], v[24:27], a[200:207], v10
    v_exp_f32 v104, v104
    v_add_f32 v96, v96, v98
    v_cvt_pk_bf16_f32 v107, v104, v104
    v_smfmac_f32_16x16x64_bf16 v[100:103], v[28:31], a[216:223], v10
    s_nop 0
    ds_write_b16 v7, v107 offset:14340
    v_smfmac_f32_16x16x64_bf16 v[100:103], v[32:35], a[232:239], v10
    v_add_f32 v97, v97, v99
    v_smfmac_f32_16x16x64_bf16 v[100:103], v[36:39], a[248:255], v10
    s_waitcnt lgkmcnt(1)
    s_barrier
    ds_read_b64 v[80:81], v8 offset:12288
    v_smfmac_f32_16x16x64_bf16 v[100:103], v[40:43], v[136:143], v10
    s_nop 0
    ds_read_b64 v[82:83], v8 offset:12800
    ds_read_b64 v[84:85], v8 offset:13312
    ds_read_b64 v[86:87], v8 offset:13824
    v_smfmac_f32_16x16x64_bf16 v[100:103], v[44:47], v[152:159], v10
    s_waitcnt lgkmcnt(4)
    s_barrier
    ds_read_b128 v[92:95], v8 offset:14336
    v_cvt_pk_bf16_f32 v104, v96, v97
    v_cvt_pk_bf16_f32 v105, v96, v97
    v_mov_b64 v[16:17], 0
    v_mov_b64 v[18:19], 0
    s_waitcnt vmcnt(3)
    v_mov_b64 v[20:21], 0
    v_mov_b64 v[22:23], 0
    s_waitcnt lgkmcnt(1)
    v_pk_add_f32 v[80:81], v[80:81], v[82:83]
    v_pk_add_f32 v[84:85], v[84:85], v[86:87]
    v_pk_add_f32 v[80:81], v[80:81], v[84:85]
    v_mul_f32 v80, s41, v80
    v_mul_f32 v81, s41, v81
    s_waitcnt lgkmcnt(0)
    v_mfma_f32_16x16x32_bf16 v[108:111], v[12:15], v[92:95], 0
    v_exp_f32 v90, v80
    v_mfma_f32_16x16x32_bf16 v[120:123], v[112:115], v[92:95], 0
    v_exp_f32 v91, v81
    v_mfma_f32_16x16x32_bf16 v[124:127], v[116:119], v[92:95], 0
    v_cvt_pk_bf16_f32 v88, v90, v91
    v_add_f32 v100, v100, v102
    v_add_f32 v101, v101, v103
    v_mfma_f32_16x16x16_bf16 v[108:111], v[12:13], v[88:89], v[108:111]
    s_nop 0
    v_cvt_pk_bf16_f32 v106, v100, v101
    v_cvt_pk_bf16_f32 v107, v100, v101
    v_mfma_f32_16x16x16_bf16 v[120:123], v[104:105], v[88:89], v[120:123]
    s_nop 0
    v_mov_b64 v[24:25], 0
    v_mov_b64 v[26:27], 0
    v_mfma_f32_16x16x16_bf16 v[124:127], v[106:107], v[88:89], v[124:127]
    v_rcp_f32 v110, v108
    v_mov_b64 v[28:29], 0
    v_max_f32 v109, v108, v110
    v_cmp_ngt_f32 vcc, s42, v109
    v_pk_mul_f32 v[120:121], v[120:121], v[110:111] op_sel_hi:[1,0]
    v_pk_mul_f32 v[122:123], v[122:123], v[110:111] op_sel_hi:[1,0]
    v_cvt_pk_bf16_f32 v120, v120, v121
    v_cvt_pk_bf16_f32 v121, v122, v123
    v_pk_mul_f32 v[124:125], v[124:125], v[110:111] op_sel_hi:[1,0]
    v_pk_mul_f32 v[126:127], v[126:127], v[110:111] op_sel_hi:[1,0]
    v_cvt_pk_bf16_f32 v122, v124, v125
    v_cvt_pk_bf16_f32 v123, v126, v127
    v_cndmask_b32 v82, v120, v122, s[38:39]
    v_cndmask_b32 v83, v121, v123, s[38:39]
    v_smfmac_f32_16x16x64_bf16 v[16:19], v[120:123], v[176:183], v10 abid:1
    s_nop 0
    ds_write_b64 v7, v[82:83] offset:15872
    v_smfmac_f32_16x16x64_bf16 v[20:23], v[120:123], v[208:215], v10 abid:1
    s_cbranch_vccnz L_slow_322
L_back_323:
    v_mov_b64 v[30:31], 0
    v_mov_b32 v46, -1
    s_mov_b64 exec, s[46:47]
    buffer_store_dword v46, v11, s[4:7], s16 offen
    s_mov_b64 exec, -1
    v_smfmac_f32_16x16x64_bf16 v[24:27], v[120:123], v[240:247], v10 abid:1
    s_waitcnt lgkmcnt(0)
    s_barrier
    ds_read_b128 v[112:115], v8 offset:16384
    v_smfmac_f32_16x16x64_bf16 v[28:31], v[120:123], v[64:71], v10 abid:1
    s_nop 0
    ds_read_b128 v[116:119], v8 offset:14848
    ds_read_b128 v[124:127], v8 offset:15360
    v_mov_b32 v12, v12
    s_add_u32 s33, s33, 8192
    s_mov_b32 s32, s31
    s_add_u32 s31, s31, 524288
    v_mov_b32 v12, v12
    s_waitcnt lgkmcnt(2)
    v_smfmac_f32_16x16x64_bf16 v[16:19], v[112:115], v[184:191], v10 abid:1
    s_min_u32 s31, s31, s44
    ds_read_b128 v[72:75], v0 offset:28672
    s_add_u32 s14, s14, 1
    v_smfmac_f32_16x16x64_bf16 v[20:23], v[112:115], v[216:223], v10 abid:1
    s_waitcnt lgkmcnt(2)
    ds_read_b128 v[76:79], v0 offset:29696
    s_add_u32 s18, s27, s30
    v_smfmac_f32_16x16x64_bf16 v[16:19], v[116:119], v[160:167], v10 abid:1
    s_waitcnt lgkmcnt(2)
    ds_read_b128 v[48:51], v0 offset:4096
    s_mov_b32 s16, s26
    v_smfmac_f32_16x16x64_bf16 v[16:19], v[124:127], v[168:175], v10 abid:1
    s_mov_b32 s26, s27
    ds_read_b128 v[52:55], v0 offset:5120
    s_mov_b32 s27, s28
    v_smfmac_f32_16x16x64_bf16 v[20:23], v[116:119], v[192:199], v10 abid:1
    s_mov_b32 s28, s16
    ds_read_b128 v[56:59], v0 offset:12288
    s_add_u32 s19, s26, s29
    v_smfmac_f32_16x16x64_bf16 v[20:23], v[124:127], v[200:207], v10 abid:1
    s_nop 0
    ds_read_b128 v[60:63], v0 offset:13312
    v_mul_f32 v16, s23, v16
    v_cvt_pk_bf16_f32 v32, v16, v17
    v_cvt_pk_bf16_f32 v33, v18, v19
    v_and_or_b32 v32, v32, -2, s22
    v_smfmac_f32_16x16x64_bf16 v[24:27], v[112:115], v[248:255], v10 abid:1
    s_nop 0
    buffer_store_dwordx2 v[32:33], v9, s[4:7], s20 offen
    v_smfmac_f32_16x16x64_bf16 v[24:27], v[116:119], v[224:231], v10 abid:1
    s_nop 0
    ds_read_b128 v[40:43], v5 offset:17408
    v_mul_f32 v20, s23, v20
    v_cvt_pk_bf16_f32 v34, v20, v21
    v_cvt_pk_bf16_f32 v35, v22, v23
    v_and_or_b32 v34, v34, -2, s22
    v_smfmac_f32_16x16x64_bf16 v[24:27], v[124:127], v[232:239], v10 abid:1
    s_waitcnt lgkmcnt(1)
    buffer_store_dwordx2 v[34:35], v9, s[4:7], s21 offen
    v_smfmac_f32_16x16x64_bf16 v[28:31], v[112:115], v[72:79], v10 abid:1
    s_nop 0
    s_nop 0
    s_nop 0
    v_smfmac_f32_16x16x64_bf16 v[28:31], v[116:119], v[48:55], v10 abid:1
    s_nop 0
    s_nop 0
    v_mul_f32 v24, s23, v24
    v_cvt_pk_bf16_f32 v36, v24, v25
    v_smfmac_f32_16x16x64_bf16 v[28:31], v[124:127], v[56:63], v10 abid:1
    s_waitcnt lgkmcnt(0)
    s_nop 0
    v_cvt_pk_bf16_f32 v37, v26, v27
    v_and_or_b32 v36, v36, -2, s22
    buffer_store_dwordx2 v[36:37], v9, s[4:7], s25 offen
    v_mov_b64 v[80:81], 0
    v_mov_b64 v[82:83], 0
    v_mov_b64 v[84:85], 0
    v_mul_f32 v28, s23, v28
    v_cvt_pk_bf16_f32 v38, v28, v29
    v_cvt_pk_bf16_f32 v39, v30, v31
    v_and_or_b32 v38, v38, -2, s22
    buffer_store_dwordx2 v[38:39], v9, s[4:7], s37 offen
    v_mov_b64 v[86:87], 0
    s_nop 0
    ds_read_b128 v[48:51], v0 offset:61440
    v_mov_b64 v[88:89], 0
    v_mov_b64 v[90:91], 0
    s_nop 0
    ds_read_b128 v[52:55], v0 offset:62464
    v_mov_b64 v[92:93], 0
    v_mov_b64 v[94:95], 0
    s_nop 0
    ds_read_b128 v[56:59], v1 offset:4096
    v_mov_b64 v[96:97], 0
    v_mov_b64 v[98:99], 0
    s_nop 0
    ds_read_b128 v[60:63], v1 offset:5120
    v_mov_b64 v[100:101], 0
    v_mov_b64 v[102:103], 0
    s_nop 0
    ds_read_b128 v[64:67], v1 offset:12288
    v_and_b32 v121, 16, v0
    v_lshrrev_b32 v122, 8, v0
    s_nop 0
    ds_read_b128 v[68:71], v1 offset:13312
    v_lshl_add_u32 v121, v122, 1, v121
    v_bfe_u32 v122, v0, 5, 1
    s_nop 0
    ds_read_b128 v[72:75], v1 offset:20480
    v_lshl_add_u32 v121, v121, 1, v122
    v_lshlrev_b32 v121, 2, v121
    s_nop 0
    ds_read_b128 v[76:79], v1 offset:21504
    v_lshlrev_b32 v126, 3, v0
    s_mov_b32 m0, s43
    s_nop 11
    buffer_load_dwordx4 v[16:19], v0, s[4:7], s24 offen offset:0 sc1
    buffer_load_dwordx4 v[20:23], v0, s[4:7], s24 offen offset:1024 sc1
    s_nop 15
    s_nop 15
    s_nop 3
    buffer_load_dwordx4 v[112:115], v0, s[4:7], s24 offen offset:0 sc1
    buffer_load_dwordx4 v[116:119], v0, s[4:7], s24 offen offset:1024 sc1
    s_waitcnt vmcnt(3)
    v_mfma_f32_16x16x32_bf16 v[108:111], v[40:43], v[16:19], 0
    v_xor_b32 v44, s22, v16
    v_bitop3_b32 v44, v44, v18, s22 bitop3:0xf6
    s_waitcnt vmcnt(2)
    v_mfma_f32_16x16x32_bf16 v[108:111], v[40:43], v[20:23], v[108:111]
    v_bitop3_b32 v44, v44, v20, s22 bitop3:0xf6
    v_bitop3_b32 v44, v44, v22, s22 bitop3:0xf6
    v_and_b32 v44, 1, v44
    v_cmp_ne_u32 vcc, 0, v44
    s_cbranch_vccnz L_gt1_333
    ds_read_b32 v123, v6 offset:10240
    s_nop 1
L_gok_332:
    v_add_f32_dpp v108, v108, v108 row_ror:8 row_mask:0xf bank_mask:0xf
    v_add_f32_dpp v109, v109, v109 row_ror:8 row_mask:0xf bank_mask:0xf
    s_xor_b32 s22, s22, 1
    v_add_f32_dpp v108, v108, v108 row_ror:4 row_mask:0xf bank_mask:0xf
    v_add_f32_dpp v109, v109, v109 row_ror:4 row_mask:0xf bank_mask:0xf
    v_cvt_pk_bf16_f32 v44, v108, v109
    v_min_u32 v120, -2, v44
    s_mov_b64 exec, s[46:47]
    buffer_store_dword v120, v11, s[4:7], s18 offen
    s_mov_b64 exec, -1
    s_xor_b32 s23, s23, 0xff1340
    s_waitcnt lgkmcnt(0)
    v_cmp_ne_u32 vcc, s36, v123
    s_cmp_eq_u32 s14, 63
    s_cbranch_scc1 L_exit_324
    s_cbranch_vccnz L_kvw_320
L_kvok_321:
    ds_read_b128 v[24:27], v0 offset:36864
    s_nop 0
    ds_read_b128 v[28:31], v0 offset:37888
    s_nop 0
    ds_read_b128 v[32:35], v0 offset:45056
    s_nop 0
    ds_read_b128 v[36:39], v0 offset:46080
    s_nop 0
    ds_read_b128 v[40:43], v0 offset:53248
    s_nop 0
    ds_read_b128 v[44:47], v0 offset:54272
    s_nop 0
    s_nop 13
    buffer_load_dwordx4 v[16:19], v0, s[4:7], s19 offen sc1
    buffer_load_dwordx4 v[20:23], v0, s[4:7], s19 offen offset:1024 sc1
    s_nop 15
    s_nop 15
    buffer_load_dwordx4 v[16:19], v0, s[4:7], s19 offen sc1
    buffer_load_dwordx4 v[20:23], v0, s[4:7], s19 offen offset:1024 sc1
    v_mov_b32 v12, v12
    s_branch L_poll2c_329
L_gt1_333:
    s_nop 0
    s_waitcnt vmcnt(1)
    v_mfma_f32_16x16x32_bf16 v[108:111], v[40:43], v[112:115], 0
    v_xor_b32 v44, s22, v112
    v_bitop3_b32 v44, v44, v114, s22 bitop3:0xf6
    s_waitcnt vmcnt(0)
    v_mfma_f32_16x16x32_bf16 v[108:111], v[40:43], v[116:119], v[108:111]
    v_bitop3_b32 v44, v44, v116, s22 bitop3:0xf6
    v_bitop3_b32 v44, v44, v118, s22 bitop3:0xf6
    v_and_b32 v44, 1, v44
    v_cmp_ne_u32 vcc, 0, v44
    s_cbranch_vccnz L_gt2_334
    ds_read_b32 v123, v6 offset:10240
    s_nop 0
    s_branch L_gok_332
L_gt2_334:
    buffer_load_dwordx4 v[16:19], v0, s[4:7], s24 offen offset:0 sc1
    buffer_load_dwordx4 v[20:23], v0, s[4:7], s24 offen offset:1024 sc1
    s_add_u32 s40, s40, 1
    s_cmp_gt_u32 s40, 262144
    s_cbranch_scc1 L_abort
    s_waitcnt vmcnt(1)
    v_mfma_f32_16x16x32_bf16 v[108:111], v[40:43], v[16:19], 0
    v_xor_b32 v44, s22, v16
    v_bitop3_b32 v44, v44, v18, s22 bitop3:0xf6
    s_waitcnt vmcnt(0)
    v_mfma_f32_16x16x32_bf16 v[108:111], v[40:43], v[20:23], v[108:111]
    v_bitop3_b32 v44, v44, v20, s22 bitop3:0xf6
    v_bitop3_b32 v44, v44, v22, s22 bitop3:0xf6
    v_and_b32 v44, 1, v44
    v_cmp_ne_u32 vcc, 0, v44
    s_cbranch_vccnz L_gt2_334
    ds_read_b32 v123, v6 offset:10240
    s_nop 0
    s_branch L_gok_332
L_slow_322:
    ds_read2st64_b32 v[32:33], v6 offset0:0 offset1:1
    ds_read2st64_b32 v[34:35], v6 offset0:2 offset1:3
    ds_read2st64_b32 v[36:37], v6 offset0:4 offset1:5
    ds_read2st64_b32 v[38:39], v6 offset0:6 offset1:7
    ds_read2st64_b32 v[40:41], v6 offset0:8 offset1:9
    ds_read2st64_b32 v[42:43], v6 offset0:10 offset1:11
    ds_read2st64_b32 v[44:45], v6 offset0:12 offset1:13
    ds_read2st64_b32 v[46:47], v6 offset0:14 offset1:15
    s_waitcnt lgkmcnt(0)
    v_add_f32 v32, v32, v36
    v_add_f32 v40, v40, v44
    v_add_f32 v32, v32, v40
    v_mul_f32 v32, s41, v32
    v_add_f32 v33, v33, v37
    v_add_f32 v41, v41, v45
    v_add_f32 v33, v33, v41
    v_mul_f32 v33, s41, v33
    v_add_f32 v34, v34, v38
    v_add_f32 v42, v42, v46
    v_add_f32 v34, v34, v42
    v_mul_f32 v34, s41, v34
    v_add_f32 v35, v35, v39
    v_add_f32 v43, v43, v47
    v_add_f32 v35, v35, v43
    v_mul_f32 v35, s41, v35
    v_max3_f32 v84, v32, v33, v34
    v_max3_f32 v84, v84, v35, v80
    v_max_f32 v84, v84, v81
    s_nop 1
    v_max_f32_dpp v84, v84, v84 row_ror:8 row_mask:0xf bank_mask:0xf
    v_mov_b32 v85, v84
    s_nop 1
    v_permlane16_swap_b32 v84, v85
    v_max_f32 v84, v84, v85
    v_mov_b32 v85, v84
    s_nop 1
    v_permlane32_swap_b32 v84, v85
    v_max_f32 v84, v84, v85
    v_sub_f32 v32, v32, v84
    v_sub_f32 v33, v33, v84
    v_sub_f32 v34, v34, v84
    v_sub_f32 v35, v35, v84
    v_sub_f32 v90, v80, v84
    v_sub_f32 v91, v81, v84
    v_exp_f32 v32, v32
    v_exp_f32 v33, v33
    v_exp_f32 v34, v34
    v_exp_f32 v35, v35
    v_exp_f32 v90, v90
    v_exp_f32 v91, v91
    v_cvt_pk_bf16_f32 v36, v32, v33
    v_cvt_pk_bf16_f32 v37, v34, v35
    v_cvt_pk_bf16_f32 v88, v90, v91
    v_mov_b64 v[92:93], v[36:37]
    v_mov_b64 v[94:95], v[36:37]
    s_nop 1
    v_mov_b32_dpp v92, v36 row_ror:8 row_mask:0xf bank_mask:0xc
    v_mov_b32_dpp v93, v37 row_ror:8 row_mask:0xf bank_mask:0xc
    v_mov_b32_dpp v94, v36 row_ror:8 row_mask:0xf bank_mask:0x3
    v_mov_b32_dpp v95, v37 row_ror:8 row_mask:0xf bank_mask:0x3
    s_nop 1
    v_mfma_f32_16x16x32_bf16 v[108:111], v[12:15], v[92:95], 0
    v_mfma_f32_16x16x32_bf16 v[120:123], v[112:115], v[92:95], 0
    v_mfma_f32_16x16x32_bf16 v[124:127], v[116:119], v[92:95], 0
    s_nop 5
    v_mfma_f32_16x16x16_bf16 v[108:111], v[12:13], v[88:89], v[108:111]
    s_nop 0
    s_nop 1
    v_mfma_f32_16x16x16_bf16 v[120:123], v[104:105], v[88:89], v[120:123]
    s_nop 0
    v_mov_b64 v[24:25], 0
    v_mov_b64 v[26:27], 0
    v_mfma_f32_16x16x16_bf16 v[124:127], v[106:107], v[88:89], v[124:127]
    v_rcp_f32 v110, v108
    v_mov_b64 v[28:29], 0
    v_max_f32 v109, v108, v110
    v_cmp_ngt_f32 vcc, s42, v109
    v_pk_mul_f32 v[120:121], v[120:121], v[110:111] op_sel_hi:[1,0]
    v_pk_mul_f32 v[122:123], v[122:123], v[110:111] op_sel_hi:[1,0]
    v_cvt_pk_bf16_f32 v120, v120, v121
    v_cvt_pk_bf16_f32 v121, v122, v123
    v_pk_mul_f32 v[124:125], v[124:125], v[110:111] op_sel_hi:[1,0]
    v_pk_mul_f32 v[126:127], v[126:127], v[110:111] op_sel_hi:[1,0]
    v_cvt_pk_bf16_f32 v122, v124, v125
    v_cvt_pk_bf16_f32 v123, v126, v127
    v_cndmask_b32 v82, v120, v122, s[38:39]
    v_cndmask_b32 v83, v121, v123, s[38:39]
    v_mov_b64 v[16:17], 0
    v_mov_b64 v[18:19], 0
    v_mov_b64 v[20:21], 0
    v_mov_b64 v[22:23], 0
    ds_write_b64 v7, v[82:83] offset:15872
    v_smfmac_f32_16x16x64_bf16 v[16:19], v[120:123], v[176:183], v10 abid:1
    v_smfmac_f32_16x16x64_bf16 v[20:23], v[120:123], v[208:215], v10 abid:1
    s_branch L_back_323
L_exit_324:
    s_mov_b64 exec, s[46:47]
    buffer_store_dword v120, v121, s[4:7], s33 offen sc1
    s_mov_b64 exec, -1
    s_waitcnt vmcnt(1)
    s_barrier
    s_branch L_ldone_283
L_wv3_282:
    ds_read_b128 v[48:51], v0 offset:63488
    ds_read_b128 v[52:55], v0 offset:64512
    ds_read_b128 v[56:59], v1 offset:6144
    ds_read_b128 v[60:63], v1 offset:7168
    ds_read_b128 v[64:67], v1 offset:14336
    ds_read_b128 v[68:71], v1 offset:15360
    ds_read_b128 v[72:75], v1 offset:22528
    ds_read_b128 v[76:79], v1 offset:23552
    ds_read_b128 v[24:27], v0 offset:38912
    ds_read_b128 v[28:31], v0 offset:39936
    ds_read_b128 v[32:35], v0 offset:47104
    ds_read_b128 v[36:39], v0 offset:48128
    ds_read_b128 v[40:43], v0 offset:55296
    ds_read_b128 v[44:47], v0 offset:56320
    v_mov_b64 v[80:81], 0
    v_mov_b64 v[82:83], 0
    v_mov_b64 v[84:85], 0
    v_mov_b64 v[86:87], 0
    v_mov_b64 v[88:89], 0
    v_mov_b64 v[90:91], 0
    v_mov_b64 v[92:93], 0
    v_mov_b64 v[94:95], 0
    v_mov_b64 v[96:97], 0
    v_mov_b64 v[98:99], 0
    v_mov_b64 v[100:101], 0
    v_mov_b64 v[102:103], 0
    v_and_b32 v121, 16, v0
    v_lshrrev_b32 v122, 8, v0
    v_lshl_add_u32 v121, v122, 1, v121
    v_bfe_u32 v122, v0, 5, 1
    v_lshl_add_u32 v121, v121, 1, v122
    v_lshlrev_b32 v121, 2, v121
    v_lshlrev_b32 v126, 3, v0
    s_mov_b32 m0, s43
    s_waitcnt vmcnt(0)
    v_min_u32 v120, -2, v120
    s_cmp_lg_u32 s15, 0
    s_cbranch_scc1 L_w2_343
L_w1_342:
    buffer_load_dword v123, off, s[4:7], s35 sc1
    s_add_u32 s40, s40, 1
    s_cmp_gt_u32 s40, 262144
    s_cbranch_scc1 L_abort
    s_waitcnt vmcnt(0)
    v_cmp_eq_u32 vcc, 0, v123
    s_cbranch_vccnz L_w1_342
    s_branch L_w3_344
L_w2_343:
    buffer_load_dword v123, off, s[4:7], s35 sc1
    buffer_load_dwordx4 v[104:107], v0, s[4:7], s32 offen offset:0 sc1
    buffer_load_dwordx4 v[108:111], v0, s[4:7], s32 offen offset:1024 sc1
    buffer_load_dwordx4 v[112:115], v0, s[4:7], s32 offen offset:2048 sc1
    buffer_load_dwordx4 v[116:119], v0, s[4:7], s32 offen offset:3072 sc1
    s_add_u32 s40, s40, 1
    s_cmp_gt_u32 s40, 262144
    s_cbranch_scc1 L_abort
    s_waitcnt vmcnt(0)
    v_cmp_ne_u32 vcc, 0, v123
    s_cbranch_vccnz L_w3_344
    v_max_u32 v127, v104, v105
    v_max3_u32 v127, v127, v106, v107
    v_max3_u32 v127, v127, v108, v109
    v_max3_u32 v127, v127, v110, v111
    v_max3_u32 v127, v127, v112, v113
    v_max3_u32 v127, v127, v114, v115
    v_max3_u32 v127, v127, v116, v117
    v_max3_u32 v127, v127, v118, v119
    v_cmp_eq_u32 vcc, -1, v127
    s_cbranch_vccnz L_w2_343
L_w3_344:
    s_waitcnt vmcnt(0) lgkmcnt(0)
    s_branch L_st_345
L_kvw_337:
    buffer_load_dword v123, off, s[4:7], s35 sc1
    s_add_u32 s40, s40, 1
    s_cmp_gt_u32 s40, 262144
    s_cbranch_scc1 L_abort
    s_waitcnt vmcnt(0)
    v_cmp_eq_u32 vcc, 0, v123
    s_cbranch_vccnz L_kvw_337
    s_branch L_kvok_338
L_st_345:
    s_branch L_arr_335
L_poll2_336:
    buffer_load_dwordx4 v[16:19], v0, s[4:7], s19 offen sc1
    buffer_load_dwordx4 v[20:23], v0, s[4:7], s19 offen offset:1024 sc1
    s_waitcnt vmcnt(2)
    v_max3_u32 v127, v16, v17, v18
    v_max3_u32 v127, v127, v19, v20
    v_max3_u32 v127, v127, v21, v22
    v_max_u32 v127, v127, v23
    v_cmp_eq_u32 vcc, -1, v127
    s_cbranch_vccz L_arr_335
L_poll3_347:
    s_add_u32 s40, s40, 1
    s_cmp_gt_u32 s40, 262144
    s_cbranch_scc1 L_abort
    v_max3_u32 v127, v16, v17, v18
    v_max3_u32 v127, v127, v19, v20
    v_max3_u32 v127, v127, v21, v22
    v_max_u32 v127, v127, v23
    v_cmp_eq_u32 vcc, -1, v127
    s_cbranch_vccz L_arr_335
    v_max3_u32 v127, v16, v17, v18
    v_max3_u32 v127, v127, v19, v20
    v_max3_u32 v127, v127, v21, v22
    v_max_u32 v127, v127, v23
    v_cmp_eq_u32 vcc, -1, v127
    s_cbranch_vccz L_arr_335
    v_max3_u32 v127, v16, v17, v18
    v_max3_u32 v127, v127, v19, v20
    v_max3_u32 v127, v127, v21, v22
    v_max_u32 v127, v127, v23
    v_cmp_eq_u32 vcc, -1, v127
    s_cbranch_vccz L_arr_335
    v_max3_u32 v127, v16, v17, v18
    v_max3_u32 v127, v127, v19, v20
    v_max3_u32 v127, v127, v21, v22
    v_max_u32 v127, v127, v23
    v_cmp_eq_u32 vcc, -1, v127
    s_cbranch_vccz L_arr_335
    buffer_load_dwordx4 v[16:19], v0, s[4:7], s19 offen sc1
    buffer_load_dwordx4 v[20:23], v0, s[4:7], s19 offen offset:1024 sc1
    s_branch L_poll3_347
L_poll2c_346:
    v_mov_b32 v12, v12
    s_waitcnt vmcnt(3) lgkmcnt(0)
    v_max3_u32 v127, v16, v17, v18
    v_max_u32 v127, v127, v19
    s_waitcnt vmcnt(2)
    v_max3_u32 v127, v127, v20, v21
    v_max3_u32 v127, v127, v22, v23
    v_cmp_eq_u32 vcc, -1, v127
    s_cbranch_vccnz L_poll2_336
L_arr_335:
    ds_write_b128 v5, v[16:19] offset:6144
    v_smfmac_f32_16x16x64_bf16 v[80:83], v[16:19], v[24:31], v10
    s_nop 0
    ds_write_b128 v5, v[20:23] offset:7168
    v_smfmac_f32_16x16x64_bf16 v[84:87], v[16:19], v[32:39], v10
    v_smfmac_f32_16x16x64_bf16 v[80:83], v[20:23], v[40:47], v10
    s_nop 0
    buffer_load_dwordx4 v[112:115], v0, s[4:7], s32 offen offset:2048 sc1
    buffer_load_dwordx4 v[116:119], v0, s[4:7], s32 offen offset:3072 sc1
    v_smfmac_f32_16x16x64_bf16 v[84:87], v[20:23], v[48:55], v10
    s_nop 0
    buffer_load_dwordx4 v[104:107], v0, s[4:7], s32 offen offset:0 sc1
    buffer_load_dwordx4 v[108:111], v0, s[4:7], s32 offen offset:1024 sc1
    v_smfmac_f32_16x16x64_bf16 v[88:91], v[16:19], v[56:63], v10
    s_add_u32 s35, s35, 4
    s_add_u32 s36, s36, 1
    s_sub_u32 s17, s31, 4096
    s_waitcnt lgkmcnt(0)
    s_barrier
    ds_read_b128 v[24:27], v5 offset:0
    v_smfmac_f32_16x16x64_bf16 v[92:95], v[16:19], v[64:71], v10
    s_nop 0
    ds_read_b128 v[28:31], v5 offset:1024
    v_smfmac_f32_16x16x64_bf16 v[96:99], v[16:19], v[72:79], v10
    s_nop 0
    ds_read_b128 v[32:35], v5 offset:2048
    v_smfmac_f32_16x16x64_bf16 v[96:99], v[20:23], a[176:183], v10
    s_nop 0
    ds_read_b128 v[36:39], v5 offset:3072
    s_waitcnt lgkmcnt(3)
    v_smfmac_f32_16x16x64_bf16 v[80:83], v[24:27], a[0:7], v10
    s_nop 0
    ds_read_b128 v[40:43], v5 offset:4096
    v_smfmac_f32_16x16x64_bf16 v[84:87], v[24:27], a[8:15], v10
    s_waitcnt lgkmcnt(3)
    ds_read_b128 v[44:47], v5 offset:5120
    v_smfmac_f32_16x16x64_bf16 v[80:83], v[28:31], a[16:23], v10
    s_nop 0
    ds_read_b128 v[48:51], v1 offset:30720
    v_smfmac_f32_16x16x64_bf16 v[84:87], v[28:31], a[24:31], v10
    s_waitcnt lgkmcnt(3)
    ds_read_b128 v[52:55], v1 offset:31744
    v_smfmac_f32_16x16x64_bf16 v[80:83], v[32:35], a[32:39], v10
    s_nop 0
    ds_read_b128 v[56:59], v1 offset:38912
    buffer_load_dword v126, s[4:7], s17 offen sc1 lds
    v_smfmac_f32_16x16x64_bf16 v[84:87], v[32:35], a[40:47], v10
    s_nop 0
    ds_read_b128 v[60:63], v1 offset:39936
    v_smfmac_f32_16x16x64_bf16 v[80:83], v[36:39], a[48:55], v10
    s_waitcnt lgkmcnt(4)
    ds_read_b128 v[64:67], v1 offset:47104
    v_smfmac_f32_16x16x64_bf16 v[80:83], v[40:43], a[64:71], v10
    s_nop 0
    ds_read_b128 v[68:71], v1 offset:48128
    v_smfmac_f32_16x16x64_bf16 v[80:83], v[44:47], a[80:87], v10
    s_mov_b64 exec, s[46:47]
    buffer_store_dword v120, v121, s[4:7], s33 offen sc1
    s_mov_b64 exec, -1
    v_smfmac_f32_16x16x64_bf16 v[84:87], v[36:39], a[56:63], v10
    s_nop 0
    ds_read_b128 v[72:75], v1 offset:55296
    s_nop 0
    v_smfmac_f32_16x16x64_bf16 v[84:87], v[40:43], a[72:79], v10
    s_nop 0
    ds_read_b128 v[76:79], v1 offset:56320
    v_add_f32 v80, v80, v82
    v_smfmac_f32_16x16x64_bf16 v[84:87], v[44:47], a[88:95], v10
    s_waitcnt lgkmcnt(4)
    s_nop 0
    v_add_f32 v81, v81, v83
    v_smfmac_f32_16x16x64_bf16 v[88:91], v[20:23], v[48:55], v10
    s_nop 1
    v_cvt_pk_bf16_f32 v80, v80, v81
    v_smfmac_f32_16x16x64_bf16 v[92:95], v[20:23], a[96:103], v10
    s_waitcnt lgkmcnt(0)
    ds_write_b32 v2, v80 offset:24
    v_add_f32 v84, v84, v86
    v_add_f32 v85, v85, v87
    v_cvt_pk_bf16_f32 v84, v84, v85
    v_smfmac_f32_16x16x64_bf16 v[88:91], v[24:27], v[56:63], v10
    s_nop 0
    ds_write_b32 v2, v84 offset:664
    v_smfmac_f32_16x16x64_bf16 v[92:95], v[24:27], a[104:111], v10
    s_nop 0
    ds_read_b64_tr_b16 v[120:121], v4 offset:24
    ds_read_b64_tr_b16 v[122:123], v4 offset:344
    v_smfmac_f32_16x16x64_bf16 v[88:91], v[28:31], v[64:71], v10
    s_nop 0
    ds_read_b64_tr_b16 v[124:125], v4 offset:8
    ds_read_b64_tr_b16 v[126:127], v4 offset:328
    v_smfmac_f32_16x16x64_bf16 v[92:95], v[28:31], a[112:119], v10
    s_nop 0
    ds_read_b128 v[48:51], v1 offset:63488
    v_smfmac_f32_16x16x64_bf16 v[88:91], v[32:35], v[72:79], v10
    s_nop 0
    ds_read_b128 v[52:55], v1 offset:64512
    v_smfmac_f32_16x16x64_bf16 v[92:95], v[32:35], a[120:127], v10
    s_waitcnt vmcnt(2)
    v_smfmac_f32_16x16x64_bf16 v[88:91], v[36:39], a[128:135], v10
    s_waitcnt lgkmcnt(2)
    v_mfma_f32_16x16x32_bf16 v[80:83], v[104:107], v[120:123], 0
    v_mfma_f32_16x16x32_bf16 v[80:83], v[108:111], v[124:127], v[80:83]
    s_nop 2
    v_smfmac_f32_16x16x64_bf16 v[88:91], v[40:43], a[144:151], v10
    s_nop 2
    v_smfmac_f32_16x16x64_bf16 v[88:91], v[44:47], a[160:167], v10
    s_nop 0
    ds_write2st64_b32 v6, v80, v81 offset0:12 offset1:13
    v_smfmac_f32_16x16x64_bf16 v[92:95], v[36:39], a[136:143], v10
    s_waitcnt lgkmcnt(1)
    ds_write2st64_b32 v6, v82, v83 offset0:14 offset1:15
    v_smfmac_f32_16x16x64_bf16 v[92:95], v[40:43], a[152:159], v10
    s_nop 1
    v_add_f32 v88, v88, v90
    v_add_f32 v89, v89, v91
    v_cvt_pk_bf16_f32 v88, v88, v89
    v_smfmac_f32_16x16x64_bf16 v[92:95], v[44:47], v[48:55], v10
    s_nop 0
    ds_write_b32 v3, v88 offset:1408
    v_smfmac_f32_16x16x64_bf16 v[96:99], v[24:27], a[192:199], v10
    s_nop 0
    ds_read_b128 v[72:75], v0 offset:30720
    s_nop 0
    v_smfmac_f32_16x16x64_bf16 v[96:99], v[28:31], a[208:215], v10
    s_nop 1
    v_add_f32 v92, v92, v94
    v_add_f32 v93, v93, v95
    v_cvt_pk_bf16_f32 v92, v92, v93
    v_smfmac_f32_16x16x64_bf16 v[96:99], v[32:35], a[224:231], v10
    s_nop 0
    ds_write_b32 v3, v92 offset:2048
    ds_read_b64_tr_b16 v[88:89], v4 offset:1408
    ds_read_b64_tr_b16 v[90:91], v4 offset:1728
    v_smfmac_f32_16x16x64_bf16 v[96:99], v[36:39], a[240:247], v10
    s_waitcnt lgkmcnt(5)
    s_barrier
    ds_read2st64_b32 v[104:105], v6 offset0:3 offset1:7
    v_smfmac_f32_16x16x64_bf16 v[96:99], v[40:43], v[128:135], v10
    s_nop 0
    ds_read2st64_b32 v[106:107], v6 offset0:11 offset1:15
    v_smfmac_f32_16x16x64_bf16 v[96:99], v[44:47], v[144:151], v10
    s_add_u32 s16, s28, s30
    ds_read_b128 v[76:79], v0 offset:31744
    s_waitcnt lgkmcnt(3)
    v_mfma_f32_16x16x32_bf16 v[84:87], v[88:91], v[120:123], 0
    s_nop 0
    v_mov_b32 v89, 0
    s_nop 0
    v_smfmac_f32_16x16x64_bf16 v[100:103], v[16:19], a[168:175], v10
    s_waitcnt lgkmcnt(1)
    v_add_f32 v104, v104, v105
    v_add_f32 v106, v106, v107
    v_smfmac_f32_16x16x64_bf16 v[100:103], v[20:23], a[184:191], v10
    s_nop 0
    ds_write_b64 v7, v[84:85] offset:13824
    v_add_f32 v104, v104, v106
    v_mul_f32 v104, s41, v104
    v_smfmac_f32_16x16x64_bf16 v[100:103], v[24:27], a[200:207], v10
    v_exp_f32 v104, v104
    v_add_f32 v96, v96, v98
    v_cvt_pk_bf16_f32 v107, v104, v104
    v_smfmac_f32_16x16x64_bf16 v[100:103], v[28:31], a[216:223], v10
    s_nop 0
    ds_write_b16 v7, v107 offset:14342
    v_smfmac_f32_16x16x64_bf16 v[100:103], v[32:35], a[232:239], v10
    v_add_f32 v97, v97, v99
    v_smfmac_f32_16x16x64_bf16 v[100:103], v[36:39], a[248:255], v10
    s_waitcnt lgkmcnt(1)
    s_barrier
    ds_read_b64 v[80:81], v8 offset:12288
    v_smfmac_f32_16x16x64_bf16 v[100:103], v[40:43], v[136:143], v10
    s_nop 0
    ds_read_b64 v[82:83], v8 offset:12800
    ds_read_b64 v[84:85], v8 offset:13312
    ds_read_b64 v[86:87], v8 offset:13824
    v_smfmac_f32_16x16x64_bf16 v[100:103], v[44:47], v[152:159], v10
    s_waitcnt lgkmcnt(4)
    s_barrier
    ds_read_b128 v[92:95], v8 offset:14336
    v_cvt_pk_bf16_f32 v104, v96, v97
    v_cvt_pk_bf16_f32 v105, v96, v97
    v_mov_b64 v[16:17], 0
    v_mov_b64 v[18:19], 0
    s_waitcnt vmcnt(4)
    v_mov_b64 v[20:21], 0
    v_mov_b64 v[22:23], 0
    s_waitcnt lgkmcnt(1)
    v_pk_add_f32 v[80:81], v[80:81], v[82:83]
    v_pk_add_f32 v[84:85], v[84:85], v[86:87]
    v_pk_add_f32 v[80:81], v[80:81], v[84:85]
    v_mul_f32 v80, s41, v80
    v_mul_f32 v81, s41, v81
    s_waitcnt lgkmcnt(0)
    v_mfma_f32_16x16x32_bf16 v[108:111], v[12:15], v[92:95], 0
    v_exp_f32 v90, v80
    v_mfma_f32_16x16x32_bf16 v[120:123], v[112:115], v[92:95], 0
    v_exp_f32 v91, v81
    v_mfma_f32_16x16x32_bf16 v[124:127], v[116:119], v[92:95], 0
    v_cvt_pk_bf16_f32 v88, v90, v91
    v_add_f32 v100, v100, v102
    v_add_f32 v101, v101, v103
    v_mfma_f32_16x16x16_bf16 v[108:111], v[12:13], v[88:89], v[108:111]
    s_nop 0
    v_cvt_pk_bf16_f32 v106, v100, v101
    v_cvt_pk_bf16_f32 v107, v100, v101
    v_mfma_f32_16x16x16_bf16 v[120:123], v[104:105], v[88:89], v[120:123]
    s_nop 0
    v_mov_b64 v[24:25], 0
    v_mov_b64 v[26:27], 0
    v_mfma_f32_16x16x16_bf16 v[124:127], v[106:107], v[88:89], v[124:127]
    v_rcp_f32 v110, v108
    v_mov_b64 v[28:29], 0
    v_max_f32 v109, v108, v110
    v_cmp_ngt_f32 vcc, s42, v109
    v_pk_mul_f32 v[120:121], v[120:121], v[110:111] op_sel_hi:[1,0]
    v_pk_mul_f32 v[122:123], v[122:123], v[110:111] op_sel_hi:[1,0]
    v_cvt_pk_bf16_f32 v120, v120, v121
    v_cvt_pk_bf16_f32 v121, v122, v123
    v_pk_mul_f32 v[124:125], v[124:125], v[110:111] op_sel_hi:[1,0]
    v_pk_mul_f32 v[126:127], v[126:127], v[110:111] op_sel_hi:[1,0]
    v_cvt_pk_bf16_f32 v122, v124, v125
    v_cvt_pk_bf16_f32 v123, v126, v127
    v_cndmask_b32 v82, v120, v122, s[38:39]
    v_cndmask_b32 v83, v121, v123, s[38:39]
    v_smfmac_f32_16x16x64_bf16 v[16:19], v[120:123], v[184:191], v10 abid:1
    s_nop 0
    ds_write_b64 v7, v[82:83] offset:16384
    v_smfmac_f32_16x16x64_bf16 v[20:23], v[120:123], v[216:223], v10 abid:1
    s_cbranch_vccnz L_slow_339
L_back_340:
    v_mov_b64 v[30:31], 0
    v_mov_b32 v46, -1
    s_mov_b64 exec, s[46:47]
    buffer_store_dword v46, v11, s[4:7], s16 offen
    s_mov_b64 exec, -1
    v_smfmac_f32_16x16x64_bf16 v[24:27], v[120:123], v[248:255], v10 abid:1
    s_waitcnt lgkmcnt(0)
    s_barrier
    ds_read_b128 v[112:115], v8 offset:14848
    v_smfmac_f32_16x16x64_bf16 v[28:31], v[120:123], v[72:79], v10 abid:1
    s_nop 0
    ds_read_b128 v[116:119], v8 offset:15360
    ds_read_b128 v[124:127], v8 offset:15872
    v_mov_b32 v12, v12
    s_add_u32 s33, s33, 8192
    s_mov_b32 s32, s31
    s_add_u32 s31, s31, 524288
    v_mov_b32 v12, v12
    s_waitcnt lgkmcnt(2)
    v_smfmac_f32_16x16x64_bf16 v[16:19], v[112:115], v[160:167], v10 abid:1
    s_min_u32 s31, s31, s44
    ds_read_b128 v[48:51], v0 offset:6144
    s_add_u32 s14, s14, 1
    v_smfmac_f32_16x16x64_bf16 v[20:23], v[112:115], v[192:199], v10 abid:1
    s_waitcnt lgkmcnt(2)
    ds_read_b128 v[52:55], v0 offset:7168
    s_add_u32 s18, s27, s30
    v_smfmac_f32_16x16x64_bf16 v[16:19], v[116:119], v[168:175], v10 abid:1
    s_waitcnt lgkmcnt(2)
    ds_read_b128 v[56:59], v0 offset:14336
    s_mov_b32 s16, s26
    v_smfmac_f32_16x16x64_bf16 v[16:19], v[124:127], v[176:183], v10 abid:1
    s_mov_b32 s26, s27
    ds_read_b128 v[60:63], v0 offset:15360
    s_mov_b32 s27, s28
    v_smfmac_f32_16x16x64_bf16 v[20:23], v[116:119], v[200:207], v10 abid:1
    s_mov_b32 s28, s16
    ds_read_b128 v[64:67], v0 offset:22528
    s_add_u32 s19, s26, s29
    v_smfmac_f32_16x16x64_bf16 v[20:23], v[124:127], v[208:215], v10 abid:1
    s_nop 0
    ds_read_b128 v[68:71], v0 offset:23552
    v_mul_f32 v16, s23, v16
    v_cvt_pk_bf16_f32 v32, v16, v17
    v_cvt_pk_bf16_f32 v33, v18, v19
    v_and_or_b32 v32, v32, -2, s22
    v_smfmac_f32_16x16x64_bf16 v[24:27], v[112:115], v[224:231], v10 abid:1
    s_nop 0
    buffer_store_dwordx2 v[32:33], v9, s[4:7], s20 offen
    v_smfmac_f32_16x16x64_bf16 v[24:27], v[116:119], v[232:239], v10 abid:1
    s_nop 0
    ds_read_b128 v[40:43], v5 offset:17408
    v_mul_f32 v20, s23, v20
    v_cvt_pk_bf16_f32 v34, v20, v21
    v_cvt_pk_bf16_f32 v35, v22, v23
    v_and_or_b32 v34, v34, -2, s22
    v_smfmac_f32_16x16x64_bf16 v[24:27], v[124:127], v[240:247], v10 abid:1
    s_waitcnt lgkmcnt(1)
    buffer_store_dwordx2 v[34:35], v9, s[4:7], s21 offen
    v_smfmac_f32_16x16x64_bf16 v[28:31], v[112:115], v[48:55], v10 abid:1
    s_nop 0
    s_nop 0
    s_nop 0
    v_smfmac_f32_16x16x64_bf16 v[28:31], v[116:119], v[56:63], v10 abid:1
    s_nop 0
    s_nop 0
    v_mul_f32 v24, s23, v24
    v_cvt_pk_bf16_f32 v36, v24, v25
    v_smfmac_f32_16x16x64_bf16 v[28:31], v[124:127], v[64:71], v10 abid:1
    s_waitcnt lgkmcnt(0)
    s_nop 0
    v_cvt_pk_bf16_f32 v37, v26, v27
    v_and_or_b32 v36, v36, -2, s22
    buffer_store_dwordx2 v[36:37], v9, s[4:7], s25 offen
    v_mov_b64 v[80:81], 0
    v_mov_b64 v[82:83], 0
    v_mov_b64 v[84:85], 0
    v_mul_f32 v28, s23, v28
    v_cvt_pk_bf16_f32 v38, v28, v29
    v_cvt_pk_bf16_f32 v39, v30, v31
    v_and_or_b32 v38, v38, -2, s22
    buffer_store_dwordx2 v[38:39], v9, s[4:7], s37 offen
    v_mov_b64 v[86:87], 0
    s_nop 0
    ds_read_b128 v[48:51], v0 offset:63488
    v_mov_b64 v[88:89], 0
    v_mov_b64 v[90:91], 0
    s_nop 0
    ds_read_b128 v[52:55], v0 offset:64512
    v_mov_b64 v[92:93], 0
    v_mov_b64 v[94:95], 0
    s_nop 0
    ds_read_b128 v[56:59], v1 offset:6144
    v_mov_b64 v[96:97], 0
    v_mov_b64 v[98:99], 0
    s_nop 0
    ds_read_b128 v[60:63], v1 offset:7168
    v_mov_b64 v[100:101], 0
    v_mov_b64 v[102:103], 0
    s_nop 0
    ds_read_b128 v[64:67], v1 offset:14336
    v_and_b32 v121, 16, v0
    v_lshrrev_b32 v122, 8, v0
    s_nop 0
    ds_read_b128 v[68:71], v1 offset:15360
    v_lshl_add_u32 v121, v122, 1, v121
    v_bfe_u32 v122, v0, 5, 1
    s_nop 0
    ds_read_b128 v[72:75], v1 offset:22528
    v_lshl_add_u32 v121, v121, 1, v122
    v_lshlrev_b32 v121, 2, v121
    s_nop 0
    ds_read_b128 v[76:79], v1 offset:23552
    v_lshlrev_b32 v126, 3, v0
    s_mov_b32 m0, s43
    s_nop 15
    s_nop 6
    buffer_load_dwordx4 v[16:19], v0, s[4:7], s24 offen offset:0 sc1
    buffer_load_dwordx4 v[20:23], v0, s[4:7], s24 offen offset:1024 sc1
    s_nop 15
    s_nop 15
    s_nop 6
    buffer_load_dwordx4 v[112:115], v0, s[4:7], s24 offen offset:0 sc1
    buffer_load_dwordx4 v[116:119], v0, s[4:7], s24 offen offset:1024 sc1
    s_waitcnt vmcnt(3)
    v_mfma_f32_16x16x32_bf16 v[108:111], v[40:43], v[16:19], 0
    v_xor_b32 v44, s22, v16
    v_bitop3_b32 v44, v44, v18, s22 bitop3:0xf6
    s_waitcnt vmcnt(2)
    v_mfma_f32_16x16x32_bf16 v[108:111], v[40:43], v[20:23], v[108:111]
    v_bitop3_b32 v44, v44, v20, s22 bitop3:0xf6
    v_bitop3_b32 v44, v44, v22, s22 bitop3:0xf6
    v_and_b32 v44, 1, v44
    v_cmp_ne_u32 vcc, 0, v44
    s_cbranch_vccnz L_gt1_350
    ds_read_b32 v123, v6 offset:10240
    s_nop 1
L_gok_349:
    v_add_f32_dpp v108, v108, v108 row_ror:8 row_mask:0xf bank_mask:0xf
    v_add_f32_dpp v109, v109, v109 row_ror:8 row_mask:0xf bank_mask:0xf
    s_xor_b32 s22, s22, 1
    v_add_f32_dpp v108, v108, v108 row_ror:4 row_mask:0xf bank_mask:0xf
    v_add_f32_dpp v109, v109, v109 row_ror:4 row_mask:0xf bank_mask:0xf
    v_cvt_pk_bf16_f32 v44, v108, v109
    v_min_u32 v120, -2, v44
    s_mov_b64 exec, s[46:47]
    buffer_store_dword v120, v11, s[4:7], s18 offen
    s_mov_b64 exec, -1
    s_xor_b32 s23, s23, 0xff1340
    s_waitcnt lgkmcnt(0)
    v_cmp_ne_u32 vcc, s36, v123
    s_cmp_eq_u32 s14, 63
    s_cbranch_scc1 L_exit_341
    s_cbranch_vccnz L_kvw_337
L_kvok_338:
    ds_read_b128 v[24:27], v0 offset:38912
    s_nop 0
    ds_read_b128 v[28:31], v0 offset:39936
    s_nop 0
    ds_read_b128 v[32:35], v0 offset:47104
    s_nop 0
    ds_read_b128 v[36:39], v0 offset:48128
    s_nop 0
    ds_read_b128 v[40:43], v0 offset:55296
    s_nop 0
    ds_read_b128 v[44:47], v0 offset:56320
    s_nop 0
    s_nop 13
    buffer_load_dwordx4 v[16:19], v0, s[4:7], s19 offen sc1
    buffer_load_dwordx4 v[20:23], v0, s[4:7], s19 offen offset:1024 sc1
    s_nop 15
    s_nop 15
    buffer_load_dwordx4 v[16:19], v0, s[4:7], s19 offen sc1
    buffer_load_dwordx4 v[20:23], v0, s[4:7], s19 offen offset:1024 sc1
    v_mov_b32 v12, v12
    s_branch L_poll2c_346
L_gt1_350:
    s_nop 0
    s_waitcnt vmcnt(1)
    v_mfma_f32_16x16x32_bf16 v[108:111], v[40:43], v[112:115], 0
    v_xor_b32 v44, s22, v112
    v_bitop3_b32 v44, v44, v114, s22 bitop3:0xf6
    s_waitcnt vmcnt(0)
    v_mfma_f32_16x16x32_bf16 v[108:111], v[40:43], v[116:119], v[108:111]
    v_bitop3_b32 v44, v44, v116, s22 bitop3:0xf6
    v_bitop3_b32 v44, v44, v118, s22 bitop3:0xf6
    v_and_b32 v44, 1, v44
    v_cmp_ne_u32 vcc, 0, v44
    s_cbranch_vccnz L_gt2_351
    ds_read_b32 v123, v6 offset:10240
    s_nop 0
    s_branch L_gok_349
L_gt2_351:
    buffer_load_dwordx4 v[16:19], v0, s[4:7], s24 offen offset:0 sc1
    buffer_load_dwordx4 v[20:23], v0, s[4:7], s24 offen offset:1024 sc1
    s_add_u32 s40, s40, 1
    s_cmp_gt_u32 s40, 262144
    s_cbranch_scc1 L_abort
    s_waitcnt vmcnt(1)
    v_mfma_f32_16x16x32_bf16 v[108:111], v[40:43], v[16:19], 0
    v_xor_b32 v44, s22, v16
    v_bitop3_b32 v44, v44, v18, s22 bitop3:0xf6
    s_waitcnt vmcnt(0)
    v_mfma_f32_16x16x32_bf16 v[108:111], v[40:43], v[20:23], v[108:111]
    v_bitop3_b32 v44, v44, v20, s22 bitop3:0xf6
    v_bitop3_b32 v44, v44, v22, s22 bitop3:0xf6
    v_and_b32 v44, 1, v44
    v_cmp_ne_u32 vcc, 0, v44
    s_cbranch_vccnz L_gt2_351
    ds_read_b32 v123, v6 offset:10240
    s_nop 0
    s_branch L_gok_349
L_slow_339:
    ds_read2st64_b32 v[32:33], v6 offset0:0 offset1:1
    ds_read2st64_b32 v[34:35], v6 offset0:2 offset1:3
    ds_read2st64_b32 v[36:37], v6 offset0:4 offset1:5
    ds_read2st64_b32 v[38:39], v6 offset0:6 offset1:7
    ds_read2st64_b32 v[40:41], v6 offset0:8 offset1:9
    ds_read2st64_b32 v[42:43], v6 offset0:10 offset1:11
    ds_read2st64_b32 v[44:45], v6 offset0:12 offset1:13
    ds_read2st64_b32 v[46:47], v6 offset0:14 offset1:15
    s_waitcnt lgkmcnt(0)
    v_add_f32 v32, v32, v36
    v_add_f32 v40, v40, v44
    v_add_f32 v32, v32, v40
    v_mul_f32 v32, s41, v32
    v_add_f32 v33, v33, v37
    v_add_f32 v41, v41, v45
    v_add_f32 v33, v33, v41
    v_mul_f32 v33, s41, v33
    v_add_f32 v34, v34, v38
    v_add_f32 v42, v42, v46
    v_add_f32 v34, v34, v42
    v_mul_f32 v34, s41, v34
    v_add_f32 v35, v35, v39
    v_add_f32 v43, v43, v47
    v_add_f32 v35, v35, v43
    v_mul_f32 v35, s41, v35
    v_max3_f32 v84, v32, v33, v34
    v_max3_f32 v84, v84, v35, v80
    v_max_f32 v84, v84, v81
    s_nop 1
    v_max_f32_dpp v84, v84, v84 row_ror:8 row_mask:0xf bank_mask:0xf
    v_mov_b32 v85, v84
    s_nop 1
    v_permlane16_swap_b32 v84, v85
    v_max_f32 v84, v84, v85
    v_mov_b32 v85, v84
    s_nop 1
    v_permlane32_swap_b32 v84, v85
    v_max_f32 v84, v84, v85
    v_sub_f32 v32, v32, v84
    v_sub_f32 v33, v33, v84
    v_sub_f32 v34, v34, v84
    v_sub_f32 v35, v35, v84
    v_sub_f32 v90, v80, v84
    v_sub_f32 v91, v81, v84
    v_exp_f32 v32, v32
    v_exp_f32 v33, v33
    v_exp_f32 v34, v34
    v_exp_f32 v35, v35
    v_exp_f32 v90, v90
    v_exp_f32 v91, v91
    v_cvt_pk_bf16_f32 v36, v32, v33
    v_cvt_pk_bf16_f32 v37, v34, v35
    v_cvt_pk_bf16_f32 v88, v90, v91
    v_mov_b64 v[92:93], v[36:37]
    v_mov_b64 v[94:95], v[36:37]
    s_nop 1
    v_mov_b32_dpp v92, v36 row_ror:8 row_mask:0xf bank_mask:0xc
    v_mov_b32_dpp v93, v37 row_ror:8 row_mask:0xf bank_mask:0xc
    v_mov_b32_dpp v94, v36 row_ror:8 row_mask:0xf bank_mask:0x3
    v_mov_b32_dpp v95, v37 row_ror:8 row_mask:0xf bank_mask:0x3
    s_nop 1
    v_mfma_f32_16x16x32_bf16 v[108:111], v[12:15], v[92:95], 0
    v_mfma_f32_16x16x32_bf16 v[120:123], v[112:115], v[92:95], 0
    v_mfma_f32_16x16x32_bf16 v[124:127], v[116:119], v[92:95], 0
    s_nop 5
    v_mfma_f32_16x16x16_bf16 v[108:111], v[12:13], v[88:89], v[108:111]
    s_nop 0
    s_nop 1
    v_mfma_f32_16x16x16_bf16 v[120:123], v[104:105], v[88:89], v[120:123]
    s_nop 0
    v_mov_b64 v[24:25], 0
    v_mov_b64 v[26:27], 0
    v_mfma_f32_16x16x16_bf16 v[124:127], v[106:107], v[88:89], v[124:127]
    v_rcp_f32 v110, v108
    v_mov_b64 v[28:29], 0
    v_max_f32 v109, v108, v110
    v_cmp_ngt_f32 vcc, s42, v109
    v_pk_mul_f32 v[120:121], v[120:121], v[110:111] op_sel_hi:[1,0]
    v_pk_mul_f32 v[122:123], v[122:123], v[110:111] op_sel_hi:[1,0]
    v_cvt_pk_bf16_f32 v120, v120, v121
    v_cvt_pk_bf16_f32 v121, v122, v123
    v_pk_mul_f32 v[124:125], v[124:125], v[110:111] op_sel_hi:[1,0]
    v_pk_mul_f32 v[126:127], v[126:127], v[110:111] op_sel_hi:[1,0]
    v_cvt_pk_bf16_f32 v122, v124, v125
    v_cvt_pk_bf16_f32 v123, v126, v127
    v_cndmask_b32 v82, v120, v122, s[38:39]
    v_cndmask_b32 v83, v121, v123, s[38:39]
    v_mov_b64 v[16:17], 0
    v_mov_b64 v[18:19], 0
    v_mov_b64 v[20:21], 0
    v_mov_b64 v[22:23], 0
    ds_write_b64 v7, v[82:83] offset:16384
    v_smfmac_f32_16x16x64_bf16 v[16:19], v[120:123], v[184:191], v10 abid:1
    v_smfmac_f32_16x16x64_bf16 v[20:23], v[120:123], v[216:223], v10 abid:1
    s_branch L_back_340
L_exit_341:
    s_mov_b64 exec, s[46:47]
    buffer_store_dword v120, v121, s[4:7], s33 offen sc1
    s_mov_b64 exec, -1
    s_waitcnt vmcnt(1)
    s_barrier
    s_branch L_ldone_283
L_ldone_283:
    s_add_u32 s15, s15, 1
    s_cmp_lt_u32 s15, 2
    s_cbranch_scc1 L_tfast
    s_branch L_help
L_tslow:
    s_mov_b32 s14, 0
    s_mul_i32 s16, s15, 33554432
    s_lshl_b32 s17, s12, 14
    s_add_u32 s16, s16, s17
    s_lshl_b32 s17, s13, 12
    s_add_u32 s16, s16, s17
    s_add_u32 s32, s16, 16777216
    s_add_u32 s31, s32, 524288
    s_add_u32 s44, s32, 33030144
    s_lshl_b32 s33, s15, 19
    s_lshl_b32 s17, s13, 11
    s_add_u32 s33, s33, s17
    s_lshr_b32 s17, s12, 2
    s_lshl_b32 s17, s17, 8
    s_add_u32 s33, s33, s17
    s_and_b32 s17, s12, 2
    s_lshl_b32 s17, s17, 5
    s_add_u32 s33, s33, s17
    s_and_b32 s17, s12, 1
    s_lshl_b32 s17, s17, 3
    s_add_u32 s33, s33, s17
    s_add_u32 s33, s33, 174063616
    s_lshl_b32 s16, s15, 5
    s_add_u32 s16, s16, s12
    s_lshl_b32 s35, s16, 8
    s_add_u32 s35, s35, 0
    s_lshl_b32 s36, s15, 6
    s_add_u32 s36, s36, 1
    s_load_dwordx2 s[8:9], s[0:1], 8
    s_mov_b32 s10, 8192
    s_mov_b32 s11, 0x20000
    v_bfe_u32 v80, v0, 4, 1
    v_bfe_u32 v81, v0, 6, 2
    v_lshl_add_u32 v80, v81, 1, v80
    v_lshlrev_b32 v80, 10, v80
    v_bfe_u32 v81, v0, 5, 1
    v_lshl_add_u32 v80, v81, 4, v80
    v_bfe_u32 v81, v0, 8, 2
    v_lshl_add_u32 v80, v81, 5, v80
    s_lshl_b32 s16, s13, 8
    s_and_b32 s17, s12, 2
    s_lshl_b32 s17, s17, 11
    s_add_u32 s17, s17, s16
    s_lshr_b32 s18, s12, 2
    s_lshl_b32 s18, s18, 5
    s_add_u32 s17, s17, s18
    s_and_b32 s18, s12, 1
    s_lshl_b32 s18, s18, 4
    s_add_u32 s17, s17, s18
    v_lshrrev_b32 v82, 8, v0
    v_lshlrev_b32 v82, 10, v82
    v_bfe_u32 v81, v0, 4, 2
    v_lshl_add_u32 v82, v81, 2, v82
    s_waitcnt lgkmcnt(0)
    buffer_load_dwordx4 v[16:19], v80, s[8:11], s16 offen offset:0
    buffer_load_dwordx4 v[20:23], v80, s[8:11], s16 offen offset:128
    buffer_load_dword v120, v82, s[8:11], s17 offen
    s_cmp_eq_u32 s13, 1
    s_cbranch_scc1 L_wv1_353
    s_cmp_eq_u32 s13, 2
    s_cbranch_scc1 L_wv2_354
    s_cmp_eq_u32 s13, 3
    s_cbranch_scc1 L_wv3_355
L_wv0_352:
    ds_read_b128 v[48:51], v0 offset:57344
    ds_read_b128 v[52:55], v0 offset:58368
    ds_read_b128 v[56:59], v1 offset:0
    ds_read_b128 v[60:63], v1 offset:1024
    ds_read_b128 v[64:67], v1 offset:8192
    ds_read_b128 v[68:71], v1 offset:9216
    ds_read_b128 v[72:75], v1 offset:16384
    ds_read_b128 v[76:79], v1 offset:17408
    ds_read_b128 v[24:27], v0 offset:32768
    ds_read_b128 v[28:31], v0 offset:33792
    ds_read_b128 v[32:35], v0 offset:40960
    ds_read_b128 v[36:39], v0 offset:41984
    ds_read_b128 v[40:43], v0 offset:49152
    ds_read_b128 v[44:47], v0 offset:50176
    v_mov_b64 v[80:81], 0
    v_mov_b64 v[82:83], 0
    v_mov_b64 v[84:85], 0
    v_mov_b64 v[86:87], 0
    v_mov_b64 v[88:89], 0
    v_mov_b64 v[90:91], 0
    v_mov_b64 v[92:93], 0
    v_mov_b64 v[94:95], 0
    v_mov_b64 v[96:97], 0
    v_mov_b64 v[98:99], 0
    v_mov_b64 v[100:101], 0
    v_mov_b64 v[102:103], 0
    v_and_b32 v121, 16, v0
    v_lshrrev_b32 v122, 8, v0
    v_lshl_add_u32 v121, v122, 1, v121
    v_bfe_u32 v122, v0, 5, 1
    v_lshl_add_u32 v121, v121, 1, v122
    v_lshlrev_b32 v121, 2, v121
    v_lshlrev_b32 v126, 3, v0
    s_mov_b32 m0, s43
    s_waitcnt vmcnt(0)
    v_min_u32 v120, -2, v120
    s_cmp_lg_u32 s15, 0
    s_cbranch_scc1 L_w2_365
L_w1_364:
    buffer_load_dword v123, off, s[4:7], s35 sc1
    s_add_u32 s40, s40, 1
    s_cmp_gt_u32 s40, 262144
    s_cbranch_scc1 L_abort
    s_waitcnt vmcnt(0)
    v_cmp_eq_u32 vcc, 0, v123
    s_cbranch_vccnz L_w1_364
    s_branch L_w3_366
L_w2_365:
    buffer_load_dword v123, off, s[4:7], s35 sc1
    buffer_load_dwordx4 v[104:107], v0, s[4:7], s32 offen offset:0 sc1
    buffer_load_dwordx4 v[108:111], v0, s[4:7], s32 offen offset:1024 sc1
    buffer_load_dwordx4 v[112:115], v0, s[4:7], s32 offen offset:2048 sc1
    buffer_load_dwordx4 v[116:119], v0, s[4:7], s32 offen offset:3072 sc1
    s_add_u32 s40, s40, 1
    s_cmp_gt_u32 s40, 262144
    s_cbranch_scc1 L_abort
    s_waitcnt vmcnt(0)
    v_cmp_ne_u32 vcc, 0, v123
    s_cbranch_vccnz L_w3_366
    v_max_u32 v127, v104, v105
    v_max3_u32 v127, v127, v106, v107
    v_max3_u32 v127, v127, v108, v109
    v_max3_u32 v127, v127, v110, v111
    v_max3_u32 v127, v127, v112, v113
    v_max3_u32 v127, v127, v114, v115
    v_max3_u32 v127, v127, v116, v117
    v_max3_u32 v127, v127, v118, v119
    v_cmp_eq_u32 vcc, -1, v127
    s_cbranch_vccnz L_w2_365
L_w3_366:
    s_waitcnt vmcnt(0) lgkmcnt(0)
    s_branch L_st_367
L_kvw_359:
    buffer_load_dword v123, off, s[4:7], s35 sc1
    s_add_u32 s40, s40, 1
    s_cmp_gt_u32 s40, 262144
    s_cbranch_scc1 L_abort
    s_waitcnt vmcnt(0)
    v_cmp_eq_u32 vcc, 0, v123
    s_cbranch_vccnz L_kvw_359
    s_branch L_kvok_360
L_st_367:
    s_branch L_arr_357
L_poll2_358:
    buffer_load_dwordx4 v[16:19], v0, s[4:7], s19 offen sc1
    buffer_load_dwordx4 v[20:23], v0, s[4:7], s19 offen offset:1024 sc1
    s_waitcnt vmcnt(2)
    v_max3_u32 v127, v16, v17, v18
    v_max3_u32 v127, v127, v19, v20
    v_max3_u32 v127, v127, v21, v22
    v_max_u32 v127, v127, v23
    v_cmp_eq_u32 vcc, -1, v127
    s_cbranch_vccz L_arr_357
L_poll3_369:
    s_add_u32 s40, s40, 1
    s_cmp_gt_u32 s40, 262144
    s_cbranch_scc1 L_abort
    v_max3_u32 v127, v16, v17, v18
    v_max3_u32 v127, v127, v19, v20
    v_max3_u32 v127, v127, v21, v22
    v_max_u32 v127, v127, v23
    v_cmp_eq_u32 vcc, -1, v127
    s_cbranch_vccz L_arr_357
    v_max3_u32 v127, v16, v17, v18
    v_max3_u32 v127, v127, v19, v20
    v_max3_u32 v127, v127, v21, v22
    v_max_u32 v127, v127, v23
    v_cmp_eq_u32 vcc, -1, v127
    s_cbranch_vccz L_arr_357
    v_max3_u32 v127, v16, v17, v18
    v_max3_u32 v127, v127, v19, v20
    v_max3_u32 v127, v127, v21, v22
    v_max_u32 v127, v127, v23
    v_cmp_eq_u32 vcc, -1, v127
    s_cbranch_vccz L_arr_357
    v_max3_u32 v127, v16, v17, v18
    v_max3_u32 v127, v127, v19, v20
    v_max3_u32 v127, v127, v21, v22
    v_max_u32 v127, v127, v23
    v_cmp_eq_u32 vcc, -1, v127
    s_cbranch_vccz L_arr_357
    buffer_load_dwordx4 v[16:19], v0, s[4:7], s19 offen sc1
    buffer_load_dwordx4 v[20:23], v0, s[4:7], s19 offen offset:1024 sc1
    s_branch L_poll3_369
L_poll2c_368:
    v_mov_b32 v12, v12
    s_waitcnt vmcnt(3) lgkmcnt(0)
    v_max3_u32 v127, v16, v17, v18
    v_max_u32 v127, v127, v19
    s_waitcnt vmcnt(2)
    v_max3_u32 v127, v127, v20, v21
    v_max3_u32 v127, v127, v22, v23
    v_cmp_eq_u32 vcc, -1, v127
    s_cbranch_vccnz L_poll2_358
L_arr_357:
    ds_write_b128 v5, v[16:19] offset:0
    v_smfmac_f32_16x16x64_bf16 v[80:83], v[16:19], v[24:31], v10
    s_nop 0
    ds_write_b128 v5, v[20:23] offset:1024
    v_smfmac_f32_16x16x64_bf16 v[84:87], v[16:19], v[32:39], v10
    v_smfmac_f32_16x16x64_bf16 v[80:83], v[20:23], v[40:47], v10
    s_nop 0
    buffer_load_dwordx4 v[112:115], v0, s[4:7], s32 offen offset:2048 sc1
    buffer_load_dwordx4 v[116:119], v0, s[4:7], s32 offen offset:3072 sc1
    v_smfmac_f32_16x16x64_bf16 v[84:87], v[20:23], v[48:55], v10
    s_nop 0
    buffer_load_dwordx4 v[104:107], v0, s[4:7], s32 offen offset:0 sc1
    buffer_load_dwordx4 v[108:111], v0, s[4:7], s32 offen offset:1024 sc1
    v_smfmac_f32_16x16x64_bf16 v[88:91], v[16:19], v[56:63], v10
    s_add_u32 s35, s35, 4
    s_add_u32 s36, s36, 1
    s_waitcnt lgkmcnt(0)
    s_barrier
    ds_read_b128 v[24:27], v5 offset:2048
    v_smfmac_f32_16x16x64_bf16 v[92:95], v[16:19], v[64:71], v10
    s_nop 0
    ds_read_b128 v[28:31], v5 offset:3072
    buffer_load_dword off, s[4:7], s35 sc1 lds
    v_smfmac_f32_16x16x64_bf16 v[96:99], v[16:19], v[72:79], v10
    s_nop 0
    ds_read_b128 v[32:35], v5 offset:4096
    v_smfmac_f32_16x16x64_bf16 v[96:99], v[20:23], a[176:183], v10
    s_nop 0
    ds_read_b128 v[36:39], v5 offset:5120
    s_waitcnt lgkmcnt(3)
    v_smfmac_f32_16x16x64_bf16 v[80:83], v[24:27], a[0:7], v10
    s_nop 0
    ds_read_b128 v[40:43], v5 offset:6144
    v_smfmac_f32_16x16x64_bf16 v[84:87], v[24:27], a[8:15], v10
    s_waitcnt lgkmcnt(3)
    ds_read_b128 v[44:47], v5 offset:7168
    v_smfmac_f32_16x16x64_bf16 v[80:83], v[28:31], a[16:23], v10
    s_mov_b64 exec, s[46:47]
    buffer_store_dword v120, v121, s[4:7], s33 offen sc1
    s_mov_b64 exec, -1
    v_smfmac_f32_16x16x64_bf16 v[84:87], v[28:31], a[24:31], v10
    s_waitcnt lgkmcnt(2)
    ds_read_b128 v[48:51], v1 offset:24576
    v_smfmac_f32_16x16x64_bf16 v[80:83], v[32:35], a[32:39], v10
    s_nop 0
    ds_read_b128 v[52:55], v1 offset:25600
    v_smfmac_f32_16x16x64_bf16 v[84:87], v[32:35], a[40:47], v10
    s_nop 0
    ds_read_b128 v[56:59], v1 offset:32768
    v_smfmac_f32_16x16x64_bf16 v[80:83], v[36:39], a[48:55], v10
    s_waitcnt lgkmcnt(3)
    ds_read_b128 v[60:63], v1 offset:33792
    v_smfmac_f32_16x16x64_bf16 v[80:83], v[40:43], a[64:71], v10
    s_nop 0
    ds_read_b128 v[64:67], v1 offset:40960
    v_smfmac_f32_16x16x64_bf16 v[80:83], v[44:47], a[80:87], v10
    s_nop 0
    ds_read_b128 v[68:71], v1 offset:41984
    s_nop 0
    v_smfmac_f32_16x16x64_bf16 v[84:87], v[36:39], a[56:63], v10
    s_nop 0
    ds_read_b128 v[72:75], v1 offset:49152
    s_nop 0
    v_smfmac_f32_16x16x64_bf16 v[84:87], v[40:43], a[72:79], v10
    s_nop 0
    ds_read_b128 v[76:79], v1 offset:50176
    v_add_f32 v80, v80, v82
    v_smfmac_f32_16x16x64_bf16 v[84:87], v[44:47], a[88:95], v10
    s_waitcnt lgkmcnt(4)
    s_nop 0
    v_add_f32 v81, v81, v83
    v_smfmac_f32_16x16x64_bf16 v[88:91], v[20:23], v[48:55], v10
    s_nop 1
    v_cvt_pk_bf16_f32 v80, v80, v81
    v_smfmac_f32_16x16x64_bf16 v[92:95], v[20:23], a[96:103], v10
    s_waitcnt lgkmcnt(0)
    ds_write_b32 v2, v80 offset:24
    v_add_f32 v84, v84, v86
    v_add_f32 v85, v85, v87
    v_cvt_pk_bf16_f32 v84, v84, v85
    v_smfmac_f32_16x16x64_bf16 v[88:91], v[24:27], v[56:63], v10
    s_nop 0
    ds_write_b32 v2, v84 offset:664
    v_smfmac_f32_16x16x64_bf16 v[92:95], v[24:27], a[104:111], v10
    s_nop 0
    ds_read_b64_tr_b16 v[120:121], v4 offset:24
    ds_read_b64_tr_b16 v[122:123], v4 offset:344
    v_smfmac_f32_16x16x64_bf16 v[88:91], v[28:31], v[64:71], v10
    s_nop 0
    ds_read_b64_tr_b16 v[124:125], v4 offset:8
    ds_read_b64_tr_b16 v[126:127], v4 offset:328
    v_smfmac_f32_16x16x64_bf16 v[92:95], v[28:31], a[112:119], v10
    s_nop 0
    ds_read_b128 v[48:51], v1 offset:57344
    v_smfmac_f32_16x16x64_bf16 v[88:91], v[32:35], v[72:79], v10
    s_nop 0
    ds_read_b128 v[52:55], v1 offset:58368
    v_smfmac_f32_16x16x64_bf16 v[92:95], v[32:35], a[120:127], v10
    s_waitcnt vmcnt(2)
    v_smfmac_f32_16x16x64_bf16 v[88:91], v[36:39], a[128:135], v10
    s_waitcnt lgkmcnt(2)
    v_mfma_f32_16x16x32_bf16 v[80:83], v[104:107], v[120:123], 0
    v_mfma_f32_16x16x32_bf16 v[80:83], v[108:111], v[124:127], v[80:83]
    s_nop 2
    v_smfmac_f32_16x16x64_bf16 v[88:91], v[40:43], a[144:151], v10
    s_nop 2
    v_smfmac_f32_16x16x64_bf16 v[88:91], v[44:47], a[160:167], v10
    s_nop 0
    ds_write2st64_b32 v6, v80, v81 offset0:0 offset1:1
    v_smfmac_f32_16x16x64_bf16 v[92:95], v[36:39], a[136:143], v10
    s_waitcnt lgkmcnt(1)
    ds_write2st64_b32 v6, v82, v83 offset0:2 offset1:3
    v_smfmac_f32_16x16x64_bf16 v[92:95], v[40:43], a[152:159], v10
    s_nop 1
    v_add_f32 v88, v88, v90
    v_add_f32 v89, v89, v91
    v_cvt_pk_bf16_f32 v88, v88, v89
    v_smfmac_f32_16x16x64_bf16 v[92:95], v[44:47], v[48:55], v10
    s_nop 0
    ds_write_b32 v3, v88 offset:1408
    v_smfmac_f32_16x16x64_bf16 v[96:99], v[24:27], a[192:199], v10
    s_nop 0
    ds_read_b128 v[48:51], v0 offset:0
    s_nop 0
    v_smfmac_f32_16x16x64_bf16 v[96:99], v[28:31], a[208:215], v10
    s_nop 1
    v_add_f32 v92, v92, v94
    v_add_f32 v93, v93, v95
    v_cvt_pk_bf16_f32 v92, v92, v93
    v_smfmac_f32_16x16x64_bf16 v[96:99], v[32:35], a[224:231], v10
    s_nop 0
    ds_write_b32 v3, v92 offset:2048
    ds_read_b64_tr_b16 v[88:89], v4 offset:1408
    ds_read_b64_tr_b16 v[90:91], v4 offset:1728
    v_smfmac_f32_16x16x64_bf16 v[96:99], v[36:39], a[240:247], v10
    s_waitcnt lgkmcnt(5)
    s_barrier
    ds_read2st64_b32 v[104:105], v6 offset0:0 offset1:4
    v_smfmac_f32_16x16x64_bf16 v[96:99], v[40:43], v[128:135], v10
    s_nop 0
    ds_read2st64_b32 v[106:107], v6 offset0:8 offset1:12
    v_smfmac_f32_16x16x64_bf16 v[96:99], v[44:47], v[144:151], v10
    s_add_u32 s16, s28, s30
    ds_read_b128 v[52:55], v0 offset:1024
    s_waitcnt lgkmcnt(3)
    v_mfma_f32_16x16x32_bf16 v[84:87], v[88:91], v[120:123], 0
    s_nop 0
    v_mov_b32 v89, 0
    s_nop 0
    v_smfmac_f32_16x16x64_bf16 v[100:103], v[16:19], a[168:175], v10
    s_waitcnt lgkmcnt(1)
    v_add_f32 v104, v104, v105
    v_add_f32 v106, v106, v107
    v_smfmac_f32_16x16x64_bf16 v[100:103], v[20:23], a[184:191], v10
    s_nop 0
    ds_write_b64 v7, v[84:85] offset:12288
    v_add_f32 v104, v104, v106
    v_mul_f32 v104, s41, v104
    v_smfmac_f32_16x16x64_bf16 v[100:103], v[24:27], a[200:207], v10
    v_exp_f32 v104, v104
    v_add_f32 v96, v96, v98
    v_cvt_pk_bf16_f32 v107, v104, v104
    v_smfmac_f32_16x16x64_bf16 v[100:103], v[28:31], a[216:223], v10
    s_nop 0
    ds_write_b16 v7, v107 offset:14336
    v_smfmac_f32_16x16x64_bf16 v[100:103], v[32:35], a[232:239], v10
    v_add_f32 v97, v97, v99
    v_smfmac_f32_16x16x64_bf16 v[100:103], v[36:39], a[248:255], v10
    s_waitcnt lgkmcnt(1)
    s_barrier
    ds_read_b64 v[80:81], v8 offset:12288
    v_smfmac_f32_16x16x64_bf16 v[100:103], v[40:43], v[136:143], v10
    s_nop 0
    ds_read_b64 v[82:83], v8 offset:12800
    ds_read_b64 v[84:85], v8 offset:13312
    ds_read_b64 v[86:87], v8 offset:13824
    v_smfmac_f32_16x16x64_bf16 v[100:103], v[44:47], v[152:159], v10
    s_waitcnt lgkmcnt(4)
    s_barrier
    ds_read_b128 v[92:95], v8 offset:14336
    v_cvt_pk_bf16_f32 v104, v96, v97
    v_cvt_pk_bf16_f32 v105, v96, v97
    v_mov_b64 v[16:17], 0
    v_mov_b64 v[18:19], 0
    s_waitcnt vmcnt(4)
    v_mov_b64 v[20:21], 0
    v_mov_b64 v[22:23], 0
    s_waitcnt lgkmcnt(1)
    v_pk_add_f32 v[80:81], v[80:81], v[82:83]
    v_pk_add_f32 v[84:85], v[84:85], v[86:87]
    v_pk_add_f32 v[80:81], v[80:81], v[84:85]
    v_mul_f32 v80, s41, v80
    v_mul_f32 v81, s41, v81
    s_waitcnt lgkmcnt(0)
    v_mfma_f32_16x16x32_bf16 v[108:111], v[12:15], v[92:95], 0
    v_exp_f32 v90, v80
    v_mfma_f32_16x16x32_bf16 v[120:123], v[112:115], v[92:95], 0
    v_exp_f32 v91, v81
    v_mfma_f32_16x16x32_bf16 v[124:127], v[116:119], v[92:95], 0
    v_cvt_pk_bf16_f32 v88, v90, v91
    v_add_f32 v100, v100, v102
    v_add_f32 v101, v101, v103
    v_mfma_f32_16x16x16_bf16 v[108:111], v[12:13], v[88:89], v[108:111]
    s_nop 0
    v_cvt_pk_bf16_f32 v106, v100, v101
    v_cvt_pk_bf16_f32 v107, v100, v101
    v_mfma_f32_16x16x16_bf16 v[120:123], v[104:105], v[88:89], v[120:123]
    s_nop 0
    v_mov_b64 v[24:25], 0
    v_mov_b64 v[26:27], 0
    v_mfma_f32_16x16x16_bf16 v[124:127], v[106:107], v[88:89], v[124:127]
    v_rcp_f32 v110, v108
    v_mov_b64 v[28:29], 0
    v_max_f32 v109, v108, v110
    v_cmp_ngt_f32 vcc, s42, v109
    v_pk_mul_f32 v[120:121], v[120:121], v[110:111] op_sel_hi:[1,0]
    v_pk_mul_f32 v[122:123], v[122:123], v[110:111] op_sel_hi:[1,0]
    v_cvt_pk_bf16_f32 v120, v120, v121
    v_cvt_pk_bf16_f32 v121, v122, v123
    v_pk_mul_f32 v[124:125], v[124:125], v[110:111] op_sel_hi:[1,0]
    v_pk_mul_f32 v[126:127], v[126:127], v[110:111] op_sel_hi:[1,0]
    v_cvt_pk_bf16_f32 v122, v124, v125
    v_cvt_pk_bf16_f32 v123, v126, v127
    v_cndmask_b32 v82, v120, v122, s[38:39]
    v_cndmask_b32 v83, v121, v123, s[38:39]
    v_smfmac_f32_16x16x64_bf16 v[16:19], v[120:123], v[160:167], v10 abid:1
    s_nop 0
    ds_write_b64 v7, v[82:83] offset:14848
    v_smfmac_f32_16x16x64_bf16 v[20:23], v[120:123], v[192:199], v10 abid:1
    s_cbranch_vccnz L_slow_361
L_back_362:
    v_mov_b64 v[30:31], 0
    v_mov_b32 v46, -1
    s_mov_b64 exec, s[46:47]
    buffer_store_dword v46, v11, s[4:7], s16 offen sc1
    s_mov_b64 exec, -1
    v_smfmac_f32_16x16x64_bf16 v[24:27], v[120:123], v[224:231], v10 abid:1
    s_waitcnt lgkmcnt(0)
    s_barrier
    ds_read_b128 v[112:115], v8 offset:15360
    v_smfmac_f32_16x16x64_bf16 v[28:31], v[120:123], v[48:55], v10 abid:1
    s_nop 0
    ds_read_b128 v[116:119], v8 offset:15872
    ds_read_b128 v[124:127], v8 offset:16384
    v_mov_b32 v12, v12
    s_add_u32 s33, s33, 8192
    s_mov_b32 s32, s31
    s_add_u32 s31, s31, 524288
    v_mov_b32 v12, v12
    s_waitcnt lgkmcnt(2)
    v_smfmac_f32_16x16x64_bf16 v[16:19], v[112:115], v[168:175], v10 abid:1
    s_min_u32 s31, s31, s44
    ds_read_b128 v[56:59], v0 offset:8192
    s_add_u32 s14, s14, 1
    v_smfmac_f32_16x16x64_bf16 v[20:23], v[112:115], v[200:207], v10 abid:1
    s_waitcnt lgkmcnt(2)
    ds_read_b128 v[60:63], v0 offset:9216
    s_add_u32 s18, s27, s30
    v_smfmac_f32_16x16x64_bf16 v[16:19], v[116:119], v[176:183], v10 abid:1
    s_waitcnt lgkmcnt(2)
    ds_read_b128 v[64:67], v0 offset:16384
    s_mov_b32 s16, s26
    v_smfmac_f32_16x16x64_bf16 v[16:19], v[124:127], v[184:191], v10 abid:1
    s_mov_b32 s26, s27
    ds_read_b128 v[68:71], v0 offset:17408
    s_mov_b32 s27, s28
    v_smfmac_f32_16x16x64_bf16 v[20:23], v[116:119], v[208:215], v10 abid:1
    s_mov_b32 s28, s16
    ds_read_b128 v[72:75], v0 offset:24576
    s_add_u32 s19, s26, s29
    v_smfmac_f32_16x16x64_bf16 v[20:23], v[124:127], v[216:223], v10 abid:1
    s_nop 0
    ds_read_b128 v[76:79], v0 offset:25600
    v_mul_f32 v16, s23, v16
    v_cvt_pk_bf16_f32 v32, v16, v17
    v_cvt_pk_bf16_f32 v33, v18, v19
    v_and_or_b32 v32, v32, -2, s22
    v_smfmac_f32_16x16x64_bf16 v[24:27], v[112:115], v[232:239], v10 abid:1
    s_nop 0
    buffer_store_dwordx2 v[32:33], v9, s[4:7], s20 offen sc1
    v_smfmac_f32_16x16x64_bf16 v[24:27], v[116:119], v[240:247], v10 abid:1
    s_nop 0
    ds_read_b128 v[40:43], v5 offset:17408
    v_mul_f32 v20, s23, v20
    v_cvt_pk_bf16_f32 v34, v20, v21
    v_cvt_pk_bf16_f32 v35, v22, v23
    v_and_or_b32 v34, v34, -2, s22
    v_smfmac_f32_16x16x64_bf16 v[24:27], v[124:127], v[248:255], v10 abid:1
    s_waitcnt lgkmcnt(1)
    buffer_store_dwordx2 v[34:35], v9, s[4:7], s21 offen sc1
    v_smfmac_f32_16x16x64_bf16 v[28:31], v[112:115], v[56:63], v10 abid:1
    s_nop 0
    s_nop 0
    s_nop 0
    v_smfmac_f32_16x16x64_bf16 v[28:31], v[116:119], v[64:71], v10 abid:1
    s_nop 0
    s_nop 0
    v_mul_f32 v24, s23, v24
    v_cvt_pk_bf16_f32 v36, v24, v25
    v_smfmac_f32_16x16x64_bf16 v[28:31], v[124:127], v[72:79], v10 abid:1
    s_waitcnt lgkmcnt(0)
    s_nop 0
    v_cvt_pk_bf16_f32 v37, v26, v27
    v_and_or_b32 v36, v36, -2, s22
    buffer_store_dwordx2 v[36:37], v9, s[4:7], s25 offen sc1
    v_mov_b64 v[80:81], 0
    v_mov_b64 v[82:83], 0
    v_mov_b64 v[84:85], 0
    v_mul_f32 v28, s23, v28
    v_cvt_pk_bf16_f32 v38, v28, v29
    v_cvt_pk_bf16_f32 v39, v30, v31
    v_and_or_b32 v38, v38, -2, s22
    buffer_store_dwordx2 v[38:39], v9, s[4:7], s37 offen sc1
    v_mov_b64 v[86:87], 0
    s_nop 0
    ds_read_b128 v[48:51], v0 offset:57344
    v_mov_b64 v[88:89], 0
    v_mov_b64 v[90:91], 0
    s_nop 0
    ds_read_b128 v[52:55], v0 offset:58368
    v_mov_b64 v[92:93], 0
    v_mov_b64 v[94:95], 0
    s_nop 0
    ds_read_b128 v[56:59], v1 offset:0
    v_mov_b64 v[96:97], 0
    v_mov_b64 v[98:99], 0
    s_nop 0
    ds_read_b128 v[60:63], v1 offset:1024
    v_mov_b64 v[100:101], 0
    v_mov_b64 v[102:103], 0
    s_nop 0
    ds_read_b128 v[64:67], v1 offset:8192
    v_and_b32 v121, 16, v0
    v_lshrrev_b32 v122, 8, v0
    s_nop 0
    ds_read_b128 v[68:71], v1 offset:9216
    v_lshl_add_u32 v121, v122, 1, v121
    v_bfe_u32 v122, v0, 5, 1
    s_nop 0
    ds_read_b128 v[72:75], v1 offset:16384
    v_lshl_add_u32 v121, v121, 1, v122
    buffer_load_dwordx4 v[16:19], v0, s[4:7], s24 offen offset:0 sc1
    buffer_load_dwordx4 v[20:23], v0, s[4:7], s24 offen offset:1024 sc1
    s_nop 0
    ds_read_b128 v[76:79], v1 offset:17408
    v_lshlrev_b32 v121, 2, v121
    v_lshlrev_b32 v126, 3, v0
    s_mov_b32 m0, s43
    s_nop 15
    s_nop 13
    buffer_load_dwordx4 v[112:115], v0, s[4:7], s24 offen offset:0 sc1
    buffer_load_dwordx4 v[116:119], v0, s[4:7], s24 offen offset:1024 sc1
    s_waitcnt vmcnt(3)
    v_mfma_f32_16x16x32_bf16 v[108:111], v[40:43], v[16:19], 0
    v_xor_b32 v44, s22, v16
    v_bitop3_b32 v44, v44, v18, s22 bitop3:0xf6
    s_waitcnt vmcnt(2)
    v_mfma_f32_16x16x32_bf16 v[108:111], v[40:43], v[20:23], v[108:111]
    v_bitop3_b32 v44, v44, v20, s22 bitop3:0xf6
    v_bitop3_b32 v44, v44, v22, s22 bitop3:0xf6
    v_and_b32 v44, 1, v44
    v_cmp_ne_u32 vcc, 0, v44
    s_cbranch_vccnz L_gt1_372
    ds_read_b32 v123, v6 offset:10240
    s_nop 1
L_gok_371:
    v_add_f32_dpp v108, v108, v108 row_ror:8 row_mask:0xf bank_mask:0xf
    v_add_f32_dpp v109, v109, v109 row_ror:8 row_mask:0xf bank_mask:0xf
    s_xor_b32 s22, s22, 1
    v_add_f32_dpp v108, v108, v108 row_ror:4 row_mask:0xf bank_mask:0xf
    v_add_f32_dpp v109, v109, v109 row_ror:4 row_mask:0xf bank_mask:0xf
    v_cvt_pk_bf16_f32 v44, v108, v109
    v_min_u32 v120, -2, v44
    s_mov_b64 exec, s[46:47]
    buffer_store_dword v120, v11, s[4:7], s18 offen sc1
    s_mov_b64 exec, -1
    s_xor_b32 s23, s23, 0xff1340
    s_waitcnt lgkmcnt(0)
    v_cmp_ne_u32 vcc, s36, v123
    s_cmp_eq_u32 s14, 63
    s_cbranch_scc1 L_exit_363
    s_cbranch_vccnz L_kvw_359
L_kvok_360:
    ds_read_b128 v[24:27], v0 offset:32768
    s_nop 0
    ds_read_b128 v[28:31], v0 offset:33792
    s_nop 0
    ds_read_b128 v[32:35], v0 offset:40960
    s_nop 0
    ds_read_b128 v[36:39], v0 offset:41984
    s_nop 0
    ds_read_b128 v[40:43], v0 offset:49152
    s_nop 0
    ds_read_b128 v[44:47], v0 offset:50176
    s_nop 0
    s_nop 13
    buffer_load_dwordx4 v[16:19], v0, s[4:7], s19 offen sc1
    buffer_load_dwordx4 v[20:23], v0, s[4:7], s19 offen offset:1024 sc1
    s_nop 15
    s_nop 15
    buffer_load_dwordx4 v[16:19], v0, s[4:7], s19 offen sc1
    buffer_load_dwordx4 v[20:23], v0, s[4:7], s19 offen offset:1024 sc1
    v_mov_b32 v12, v12
    s_branch L_poll2c_368
L_gt1_372:
    s_nop 0
    s_waitcnt vmcnt(1)
    v_mfma_f32_16x16x32_bf16 v[108:111], v[40:43], v[112:115], 0
    v_xor_b32 v44, s22, v112
    v_bitop3_b32 v44, v44, v114, s22 bitop3:0xf6
    s_waitcnt vmcnt(0)
    v_mfma_f32_16x16x32_bf16 v[108:111], v[40:43], v[116:119], v[108:111]
    v_bitop3_b32 v44, v44, v116, s22 bitop3:0xf6
    v_bitop3_b32 v44, v44, v118, s22 bitop3:0xf6
    v_and_b32 v44, 1, v44
    v_cmp_ne_u32 vcc, 0, v44
    s_cbranch_vccnz L_gt2_373
    ds_read_b32 v123, v6 offset:10240
    s_nop 0
    s_branch L_gok_371
L_gt2_373:
    buffer_load_dwordx4 v[16:19], v0, s[4:7], s24 offen offset:0 sc1
    buffer_load_dwordx4 v[20:23], v0, s[4:7], s24 offen offset:1024 sc1
    s_add_u32 s40, s40, 1
    s_cmp_gt_u32 s40, 262144
    s_cbranch_scc1 L_abort
    s_waitcnt vmcnt(1)
    v_mfma_f32_16x16x32_bf16 v[108:111], v[40:43], v[16:19], 0
    v_xor_b32 v44, s22, v16
    v_bitop3_b32 v44, v44, v18, s22 bitop3:0xf6
    s_waitcnt vmcnt(0)
    v_mfma_f32_16x16x32_bf16 v[108:111], v[40:43], v[20:23], v[108:111]
    v_bitop3_b32 v44, v44, v20, s22 bitop3:0xf6
    v_bitop3_b32 v44, v44, v22, s22 bitop3:0xf6
    v_and_b32 v44, 1, v44
    v_cmp_ne_u32 vcc, 0, v44
    s_cbranch_vccnz L_gt2_373
    ds_read_b32 v123, v6 offset:10240
    s_nop 0
    s_branch L_gok_371
L_slow_361:
    ds_read2st64_b32 v[32:33], v6 offset0:0 offset1:1
    ds_read2st64_b32 v[34:35], v6 offset0:2 offset1:3
    ds_read2st64_b32 v[36:37], v6 offset0:4 offset1:5
    ds_read2st64_b32 v[38:39], v6 offset0:6 offset1:7
    ds_read2st64_b32 v[40:41], v6 offset0:8 offset1:9
    ds_read2st64_b32 v[42:43], v6 offset0:10 offset1:11
    ds_read2st64_b32 v[44:45], v6 offset0:12 offset1:13
    ds_read2st64_b32 v[46:47], v6 offset0:14 offset1:15
    s_waitcnt lgkmcnt(0)
    v_add_f32 v32, v32, v36
    v_add_f32 v40, v40, v44
    v_add_f32 v32, v32, v40
    v_mul_f32 v32, s41, v32
    v_add_f32 v33, v33, v37
    v_add_f32 v41, v41, v45
    v_add_f32 v33, v33, v41
    v_mul_f32 v33, s41, v33
    v_add_f32 v34, v34, v38
    v_add_f32 v42, v42, v46
    v_add_f32 v34, v34, v42
    v_mul_f32 v34, s41, v34
    v_add_f32 v35, v35, v39
    v_add_f32 v43, v43, v47
    v_add_f32 v35, v35, v43
    v_mul_f32 v35, s41, v35
    v_max3_f32 v84, v32, v33, v34
    v_max3_f32 v84, v84, v35, v80
    v_max_f32 v84, v84, v81
    s_nop 1
    v_max_f32_dpp v84, v84, v84 row_ror:8 row_mask:0xf bank_mask:0xf
    v_mov_b32 v85, v84
    s_nop 1
    v_permlane16_swap_b32 v84, v85
    v_max_f32 v84, v84, v85
    v_mov_b32 v85, v84
    s_nop 1
    v_permlane32_swap_b32 v84, v85
    v_max_f32 v84, v84, v85
    v_sub_f32 v32, v32, v84
    v_sub_f32 v33, v33, v84
    v_sub_f32 v34, v34, v84
    v_sub_f32 v35, v35, v84
    v_sub_f32 v90, v80, v84
    v_sub_f32 v91, v81, v84
    v_exp_f32 v32, v32
    v_exp_f32 v33, v33
    v_exp_f32 v34, v34
    v_exp_f32 v35, v35
    v_exp_f32 v90, v90
    v_exp_f32 v91, v91
    v_cvt_pk_bf16_f32 v36, v32, v33
    v_cvt_pk_bf16_f32 v37, v34, v35
    v_cvt_pk_bf16_f32 v88, v90, v91
    v_mov_b64 v[92:93], v[36:37]
    v_mov_b64 v[94:95], v[36:37]
    s_nop 1
    v_mov_b32_dpp v92, v36 row_ror:8 row_mask:0xf bank_mask:0xc
    v_mov_b32_dpp v93, v37 row_ror:8 row_mask:0xf bank_mask:0xc
    v_mov_b32_dpp v94, v36 row_ror:8 row_mask:0xf bank_mask:0x3
    v_mov_b32_dpp v95, v37 row_ror:8 row_mask:0xf bank_mask:0x3
    s_nop 1
    v_mfma_f32_16x16x32_bf16 v[108:111], v[12:15], v[92:95], 0
    v_mfma_f32_16x16x32_bf16 v[120:123], v[112:115], v[92:95], 0
    v_mfma_f32_16x16x32_bf16 v[124:127], v[116:119], v[92:95], 0
    s_nop 5
    v_mfma_f32_16x16x16_bf16 v[108:111], v[12:13], v[88:89], v[108:111]
    s_nop 0
    s_nop 1
    v_mfma_f32_16x16x16_bf16 v[120:123], v[104:105], v[88:89], v[120:123]
    s_nop 0
    v_mov_b64 v[24:25], 0
    v_mov_b64 v[26:27], 0
    v_mfma_f32_16x16x16_bf16 v[124:127], v[106:107], v[88:89], v[124:127]
    v_rcp_f32 v110, v108
    v_mov_b64 v[28:29], 0
    v_max_f32 v109, v108, v110
    v_cmp_ngt_f32 vcc, s42, v109
    v_pk_mul_f32 v[120:121], v[120:121], v[110:111] op_sel_hi:[1,0]
    v_pk_mul_f32 v[122:123], v[122:123], v[110:111] op_sel_hi:[1,0]
    v_cvt_pk_bf16_f32 v120, v120, v121
    v_cvt_pk_bf16_f32 v121, v122, v123
    v_pk_mul_f32 v[124:125], v[124:125], v[110:111] op_sel_hi:[1,0]
    v_pk_mul_f32 v[126:127], v[126:127], v[110:111] op_sel_hi:[1,0]
    v_cvt_pk_bf16_f32 v122, v124, v125
    v_cvt_pk_bf16_f32 v123, v126, v127
    v_cndmask_b32 v82, v120, v122, s[38:39]
    v_cndmask_b32 v83, v121, v123, s[38:39]
    v_mov_b64 v[16:17], 0
    v_mov_b64 v[18:19], 0
    v_mov_b64 v[20:21], 0
    v_mov_b64 v[22:23], 0
    ds_write_b64 v7, v[82:83] offset:14848
    v_smfmac_f32_16x16x64_bf16 v[16:19], v[120:123], v[160:167], v10 abid:1
    v_smfmac_f32_16x16x64_bf16 v[20:23], v[120:123], v[192:199], v10 abid:1
    s_branch L_back_362
L_exit_363:
    s_mov_b64 exec, s[46:47]
    buffer_store_dword v120, v121, s[4:7], s33 offen sc1
    s_mov_b64 exec, -1
    s_waitcnt vmcnt(1)
    s_barrier
    s_branch L_ldone_356
L_wv1_353:
    ds_read_b128 v[48:51], v0 offset:59392
    ds_read_b128 v[52:55], v0 offset:60416
    ds_read_b128 v[56:59], v1 offset:2048
    ds_read_b128 v[60:63], v1 offset:3072
    ds_read_b128 v[64:67], v1 offset:10240
    ds_read_b128 v[68:71], v1 offset:11264
    ds_read_b128 v[72:75], v1 offset:18432
    ds_read_b128 v[76:79], v1 offset:19456
    ds_read_b128 v[24:27], v0 offset:34816
    ds_read_b128 v[28:31], v0 offset:35840
    ds_read_b128 v[32:35], v0 offset:43008
    ds_read_b128 v[36:39], v0 offset:44032
    ds_read_b128 v[40:43], v0 offset:51200
    ds_read_b128 v[44:47], v0 offset:52224
    v_mov_b64 v[80:81], 0
    v_mov_b64 v[82:83], 0
    v_mov_b64 v[84:85], 0
    v_mov_b64 v[86:87], 0
    v_mov_b64 v[88:89], 0
    v_mov_b64 v[90:91], 0
    v_mov_b64 v[92:93], 0
    v_mov_b64 v[94:95], 0
    v_mov_b64 v[96:97], 0
    v_mov_b64 v[98:99], 0
    v_mov_b64 v[100:101], 0
    v_mov_b64 v[102:103], 0
    v_and_b32 v121, 16, v0
    v_lshrrev_b32 v122, 8, v0
    v_lshl_add_u32 v121, v122, 1, v121
    v_bfe_u32 v122, v0, 5, 1
    v_lshl_add_u32 v121, v121, 1, v122
    v_lshlrev_b32 v121, 2, v121
    v_lshlrev_b32 v126, 3, v0
    s_mov_b32 m0, s43
    s_waitcnt vmcnt(0)
    v_min_u32 v120, -2, v120
    s_cmp_lg_u32 s15, 0
    s_cbranch_scc1 L_w2_382
L_w1_381:
    buffer_load_dword v123, off, s[4:7], s35 sc1
    s_add_u32 s40, s40, 1
    s_cmp_gt_u32 s40, 262144
    s_cbranch_scc1 L_abort
    s_waitcnt vmcnt(0)
    v_cmp_eq_u32 vcc, 0, v123
    s_cbranch_vccnz L_w1_381
    s_branch L_w3_383
L_w2_382:
    buffer_load_dword v123, off, s[4:7], s35 sc1
    buffer_load_dwordx4 v[104:107], v0, s[4:7], s32 offen offset:0 sc1
    buffer_load_dwordx4 v[108:111], v0, s[4:7], s32 offen offset:1024 sc1
    buffer_load_dwordx4 v[112:115], v0, s[4:7], s32 offen offset:2048 sc1
    buffer_load_dwordx4 v[116:119], v0, s[4:7], s32 offen offset:3072 sc1
    s_add_u32 s40, s40, 1
    s_cmp_gt_u32 s40, 262144
    s_cbranch_scc1 L_abort
    s_waitcnt vmcnt(0)
    v_cmp_ne_u32 vcc, 0, v123
    s_cbranch_vccnz L_w3_383
    v_max_u32 v127, v104, v105
    v_max3_u32 v127, v127, v106, v107
    v_max3_u32 v127, v127, v108, v109
    v_max3_u32 v127, v127, v110, v111
    v_max3_u32 v127, v127, v112, v113
    v_max3_u32 v127, v127, v114, v115
    v_max3_u32 v127, v127, v116, v117
    v_max3_u32 v127, v127, v118, v119
    v_cmp_eq_u32 vcc, -1, v127
    s_cbranch_vccnz L_w2_382
L_w3_383:
    s_waitcnt vmcnt(0) lgkmcnt(0)
    s_branch L_st_384
L_kvw_376:
    buffer_load_dword v123, off, s[4:7], s35 sc1
    s_add_u32 s40, s40, 1
    s_cmp_gt_u32 s40, 262144
    s_cbranch_scc1 L_abort
    s_waitcnt vmcnt(0)
    v_cmp_eq_u32 vcc, 0, v123
    s_cbranch_vccnz L_kvw_376
    s_branch L_kvok_377
L_st_384:
    s_branch L_arr_374
L_poll2_375:
    buffer_load_dwordx4 v[16:19], v0, s[4:7], s19 offen sc1
    buffer_load_dwordx4 v[20:23], v0, s[4:7], s19 offen offset:1024 sc1
    s_waitcnt vmcnt(2)
    v_max3_u32 v127, v16, v17, v18
    v_max3_u32 v127, v127, v19, v20
    v_max3_u32 v127, v127, v21, v22
    v_max_u32 v127, v127, v23
    v_cmp_eq_u32 vcc, -1, v127
    s_cbranch_vccz L_arr_374
L_poll3_386:
    s_add_u32 s40, s40, 1
    s_cmp_gt_u32 s40, 262144
    s_cbranch_scc1 L_abort
    v_max3_u32 v127, v16, v17, v18
    v_max3_u32 v127, v127, v19, v20
    v_max3_u32 v127, v127, v21, v22
    v_max_u32 v127, v127, v23
    v_cmp_eq_u32 vcc, -1, v127
    s_cbranch_vccz L_arr_374
    v_max3_u32 v127, v16, v17, v18
    v_max3_u32 v127, v127, v19, v20
    v_max3_u32 v127, v127, v21, v22
    v_max_u32 v127, v127, v23
    v_cmp_eq_u32 vcc, -1, v127
    s_cbranch_vccz L_arr_374
    v_max3_u32 v127, v16, v17, v18
    v_max3_u32 v127, v127, v19, v20
    v_max3_u32 v127, v127, v21, v22
    v_max_u32 v127, v127, v23
    v_cmp_eq_u32 vcc, -1, v127
    s_cbranch_vccz L_arr_374
    v_max3_u32 v127, v16, v17, v18
    v_max3_u32 v127, v127, v19, v20
    v_max3_u32 v127, v127, v21, v22
    v_max_u32 v127, v127, v23
    v_cmp_eq_u32 vcc, -1, v127
    s_cbranch_vccz L_arr_374
    buffer_load_dwordx4 v[16:19], v0, s[4:7], s19 offen sc1
    buffer_load_dwordx4 v[20:23], v0, s[4:7], s19 offen offset:1024 sc1
    s_branch L_poll3_386
L_poll2c_385:
    v_mov_b32 v12, v12
    s_waitcnt vmcnt(3) lgkmcnt(0)
    v_max3_u32 v127, v16, v17, v18
    v_max_u32 v127, v127, v19
    s_waitcnt vmcnt(2)
    v_max3_u32 v127, v127, v20, v21
    v_max3_u32 v127, v127, v22, v23
    v_cmp_eq_u32 vcc, -1, v127
    s_cbranch_vccnz L_poll2_375
L_arr_374:
    ds_write_b128 v5, v[16:19] offset:2048
    v_smfmac_f32_16x16x64_bf16 v[80:83], v[16:19], v[24:31], v10
    s_nop 0
    ds_write_b128 v5, v[20:23] offset:3072
    v_smfmac_f32_16x16x64_bf16 v[84:87], v[16:19], v[32:39], v10
    v_smfmac_f32_16x16x64_bf16 v[80:83], v[20:23], v[40:47], v10
    s_nop 0
    buffer_load_dwordx4 v[112:115], v0, s[4:7], s32 offen offset:2048 sc1
    buffer_load_dwordx4 v[116:119], v0, s[4:7], s32 offen offset:3072 sc1
    v_smfmac_f32_16x16x64_bf16 v[84:87], v[20:23], v[48:55], v10
    s_nop 0
    buffer_load_dwordx4 v[104:107], v0, s[4:7], s32 offen offset:0 sc1
    buffer_load_dwordx4 v[108:111], v0, s[4:7], s32 offen offset:1024 sc1
    v_smfmac_f32_16x16x64_bf16 v[88:91], v[16:19], v[56:63], v10
    s_add_u32 s35, s35, 4
    s_add_u32 s36, s36, 1
    s_sub_u32 s17, s31, 4096
    s_waitcnt lgkmcnt(0)
    s_barrier
    ds_read_b128 v[24:27], v5 offset:4096
    v_smfmac_f32_16x16x64_bf16 v[92:95], v[16:19], v[64:71], v10
    s_nop 0
    ds_read_b128 v[28:31], v5 offset:5120
    v_smfmac_f32_16x16x64_bf16 v[96:99], v[16:19], v[72:79], v10
    s_nop 0
    ds_read_b128 v[32:35], v5 offset:6144
    v_smfmac_f32_16x16x64_bf16 v[96:99], v[20:23], a[176:183], v10
    s_nop 0
    ds_read_b128 v[36:39], v5 offset:7168
    s_waitcnt lgkmcnt(3)
    v_smfmac_f32_16x16x64_bf16 v[80:83], v[24:27], a[0:7], v10
    s_nop 0
    ds_read_b128 v[40:43], v5 offset:0
    v_smfmac_f32_16x16x64_bf16 v[84:87], v[24:27], a[8:15], v10
    s_waitcnt lgkmcnt(3)
    ds_read_b128 v[44:47], v5 offset:1024
    v_smfmac_f32_16x16x64_bf16 v[80:83], v[28:31], a[16:23], v10
    s_nop 0
    ds_read_b128 v[48:51], v1 offset:26624
    v_smfmac_f32_16x16x64_bf16 v[84:87], v[28:31], a[24:31], v10
    s_waitcnt lgkmcnt(3)
    ds_read_b128 v[52:55], v1 offset:27648
    v_smfmac_f32_16x16x64_bf16 v[80:83], v[32:35], a[32:39], v10
    s_nop 0
    ds_read_b128 v[56:59], v1 offset:34816
    buffer_load_dword v126, s[4:7], s17 offen sc1 lds
    v_smfmac_f32_16x16x64_bf16 v[84:87], v[32:35], a[40:47], v10
    s_nop 0
    ds_read_b128 v[60:63], v1 offset:35840
    v_smfmac_f32_16x16x64_bf16 v[80:83], v[36:39], a[48:55], v10
    s_waitcnt lgkmcnt(4)
    ds_read_b128 v[64:67], v1 offset:43008
    v_smfmac_f32_16x16x64_bf16 v[80:83], v[40:43], a[64:71], v10
    s_mov_b64 exec, s[46:47]
    buffer_store_dword v120, v121, s[4:7], s33 offen sc1
    s_mov_b64 exec, -1
    v_smfmac_f32_16x16x64_bf16 v[80:83], v[44:47], a[80:87], v10
    s_nop 0
    ds_read_b128 v[68:71], v1 offset:44032
    s_nop 0
    v_smfmac_f32_16x16x64_bf16 v[84:87], v[36:39], a[56:63], v10
    s_nop 0
    ds_read_b128 v[72:75], v1 offset:51200
    s_nop 0
    v_smfmac_f32_16x16x64_bf16 v[84:87], v[40:43], a[72:79], v10
    s_nop 0
    ds_read_b128 v[76:79], v1 offset:52224
    v_add_f32 v80, v80, v82
    v_smfmac_f32_16x16x64_bf16 v[84:87], v[44:47], a[88:95], v10
    s_waitcnt lgkmcnt(4)
    s_nop 0
    v_add_f32 v81, v81, v83
    v_smfmac_f32_16x16x64_bf16 v[88:91], v[20:23], v[48:55], v10
    s_nop 1
    v_cvt_pk_bf16_f32 v80, v80, v81
    v_smfmac_f32_16x16x64_bf16 v[92:95], v[20:23], a[96:103], v10
    s_waitcnt lgkmcnt(0)
    ds_write_b32 v2, v80 offset:24
    v_add_f32 v84, v84, v86
    v_add_f32 v85, v85, v87
    v_cvt_pk_bf16_f32 v84, v84, v85
    v_smfmac_f32_16x16x64_bf16 v[88:91], v[24:27], v[56:63], v10
    s_nop 0
    ds_write_b32 v2, v84 offset:664
    v_smfmac_f32_16x16x64_bf16 v[92:95], v[24:27], a[104:111], v10
    s_nop 0
    ds_read_b64_tr_b16 v[120:121], v4 offset:24
    ds_read_b64_tr_b16 v[122:123], v4 offset:344
    v_smfmac_f32_16x16x64_bf16 v[88:91], v[28:31], v[64:71], v10
    s_nop 0
    ds_read_b64_tr_b16 v[124:125], v4 offset:8
    ds_read_b64_tr_b16 v[126:127], v4 offset:328
    v_smfmac_f32_16x16x64_bf16 v[92:95], v[28:31], a[112:119], v10
    s_nop 0
    ds_read_b128 v[48:51], v1 offset:59392
    v_smfmac_f32_16x16x64_bf16 v[88:91], v[32:35], v[72:79], v10
    s_nop 0
    ds_read_b128 v[52:55], v1 offset:60416
    v_smfmac_f32_16x16x64_bf16 v[92:95], v[32:35], a[120:127], v10
    s_waitcnt vmcnt(2)
    v_smfmac_f32_16x16x64_bf16 v[88:91], v[36:39], a[128:135], v10
    s_waitcnt lgkmcnt(2)
    v_mfma_f32_16x16x32_bf16 v[80:83], v[104:107], v[120:123], 0
    v_mfma_f32_16x16x32_bf16 v[80:83], v[108:111], v[124:127], v[80:83]
    s_nop 2
    v_smfmac_f32_16x16x64_bf16 v[88:91], v[40:43], a[144:151], v10
    s_nop 2
    v_smfmac_f32_16x16x64_bf16 v[88:91], v[44:47], a[160:167], v10
    s_nop 0
    ds_write2st64_b32 v6, v80, v81 offset0:4 offset1:5
    v_smfmac_f32_16x16x64_bf16 v[92:95], v[36:39], a[136:143], v10
    s_waitcnt lgkmcnt(1)
    ds_write2st64_b32 v6, v82, v83 offset0:6 offset1:7
    v_smfmac_f32_16x16x64_bf16 v[92:95], v[40:43], a[152:159], v10
    s_nop 1
    v_add_f32 v88, v88, v90
    v_add_f32 v89, v89, v91
    v_cvt_pk_bf16_f32 v88, v88, v89
    v_smfmac_f32_16x16x64_bf16 v[92:95], v[44:47], v[48:55], v10
    s_nop 0
    ds_write_b32 v3, v88 offset:1408
    v_smfmac_f32_16x16x64_bf16 v[96:99], v[24:27], a[192:199], v10
    s_nop 0
    ds_read_b128 v[56:59], v0 offset:10240
    s_nop 0
    v_smfmac_f32_16x16x64_bf16 v[96:99], v[28:31], a[208:215], v10
    s_nop 1
    v_add_f32 v92, v92, v94
    v_add_f32 v93, v93, v95
    v_cvt_pk_bf16_f32 v92, v92, v93
    v_smfmac_f32_16x16x64_bf16 v[96:99], v[32:35], a[224:231], v10
    s_nop 0
    ds_write_b32 v3, v92 offset:2048
    ds_read_b64_tr_b16 v[88:89], v4 offset:1408
    ds_read_b64_tr_b16 v[90:91], v4 offset:1728
    v_smfmac_f32_16x16x64_bf16 v[96:99], v[36:39], a[240:247], v10
    s_waitcnt lgkmcnt(5)
    s_barrier
    ds_read2st64_b32 v[104:105], v6 offset0:1 offset1:5
    v_smfmac_f32_16x16x64_bf16 v[96:99], v[40:43], v[128:135], v10
    s_nop 0
    ds_read2st64_b32 v[106:107], v6 offset0:9 offset1:13
    v_smfmac_f32_16x16x64_bf16 v[96:99], v[44:47], v[144:151], v10
    s_add_u32 s16, s28, s30
    ds_read_b128 v[60:63], v0 offset:11264
    s_waitcnt lgkmcnt(3)
    v_mfma_f32_16x16x32_bf16 v[84:87], v[88:91], v[120:123], 0
    s_nop 0
    v_mov_b32 v89, 0
    s_nop 0
    v_smfmac_f32_16x16x64_bf16 v[100:103], v[16:19], a[168:175], v10
    s_waitcnt lgkmcnt(1)
    v_add_f32 v104, v104, v105
    v_add_f32 v106, v106, v107
    v_smfmac_f32_16x16x64_bf16 v[100:103], v[20:23], a[184:191], v10
    s_nop 0
    ds_write_b64 v7, v[84:85] offset:12800
    v_add_f32 v104, v104, v106
    v_mul_f32 v104, s41, v104
    v_smfmac_f32_16x16x64_bf16 v[100:103], v[24:27], a[200:207], v10
    v_exp_f32 v104, v104
    v_add_f32 v96, v96, v98
    v_cvt_pk_bf16_f32 v107, v104, v104
    v_smfmac_f32_16x16x64_bf16 v[100:103], v[28:31], a[216:223], v10
    s_nop 0
    ds_write_b16 v7, v107 offset:14338
    v_smfmac_f32_16x16x64_bf16 v[100:103], v[32:35], a[232:239], v10
    v_add_f32 v97, v97, v99
    v_smfmac_f32_16x16x64_bf16 v[100:103], v[36:39], a[248:255], v10
    s_waitcnt lgkmcnt(1)
    s_barrier
    ds_read_b64 v[80:81], v8 offset:12288
    v_smfmac_f32_16x16x64_bf16 v[100:103], v[40:43], v[136:143], v10
    s_nop 0
    ds_read_b64 v[82:83], v8 offset:12800
    ds_read_b64 v[84:85], v8 offset:13312
    ds_read_b64 v[86:87], v8 offset:13824
    v_smfmac_f32_16x16x64_bf16 v[100:103], v[44:47], v[152:159], v10
    s_waitcnt lgkmcnt(4)
    s_barrier
    ds_read_b128 v[92:95], v8 offset:14336
    v_cvt_pk_bf16_f32 v104, v96, v97
    v_cvt_pk_bf16_f32 v105, v96, v97
    v_mov_b64 v[16:17], 0
    v_mov_b64 v[18:19], 0
    s_waitcnt vmcnt(4)
    v_mov_b64 v[20:21], 0
    v_mov_b64 v[22:23], 0
    s_waitcnt lgkmcnt(1)
    v_pk_add_f32 v[80:81], v[80:81], v[82:83]
    v_pk_add_f32 v[84:85], v[84:85], v[86:87]
    v_pk_add_f32 v[80:81], v[80:81], v[84:85]
    v_mul_f32 v80, s41, v80
    v_mul_f32 v81, s41, v81
    s_waitcnt lgkmcnt(0)
    v_mfma_f32_16x16x32_bf16 v[108:111], v[12:15], v[92:95], 0
    v_exp_f32 v90, v80
    v_mfma_f32_16x16x32_bf16 v[120:123], v[112:115], v[92:95], 0
    v_exp_f32 v91, v81
    v_mfma_f32_16x16x32_bf16 v[124:127], v[116:119], v[92:95], 0
    v_cvt_pk_bf16_f32 v88, v90, v91
    v_add_f32 v100, v100, v102
    v_add_f32 v101, v101, v103
    v_mfma_f32_16x16x16_bf16 v[108:111], v[12:13], v[88:89], v[108:111]
    s_nop 0
    v_cvt_pk_bf16_f32 v106, v100, v101
    v_cvt_pk_bf16_f32 v107, v100, v101
    v_mfma_f32_16x16x16_bf16 v[120:123], v[104:105], v[88:89], v[120:123]
    s_nop 0
    v_mov_b64 v[24:25], 0
    v_mov_b64 v[26:27], 0
    v_mfma_f32_16x16x16_bf16 v[124:127], v[106:107], v[88:89], v[124:127]
    v_rcp_f32 v110, v108
    v_mov_b64 v[28:29], 0
    v_max_f32 v109, v108, v110
    v_cmp_ngt_f32 vcc, s42, v109
    v_pk_mul_f32 v[120:121], v[120:121], v[110:111] op_sel_hi:[1,0]
    v_pk_mul_f32 v[122:123], v[122:123], v[110:111] op_sel_hi:[1,0]
    v_cvt_pk_bf16_f32 v120, v120, v121
    v_cvt_pk_bf16_f32 v121, v122, v123
    v_pk_mul_f32 v[124:125], v[124:125], v[110:111] op_sel_hi:[1,0]
    v_pk_mul_f32 v[126:127], v[126:127], v[110:111] op_sel_hi:[1,0]
    v_cvt_pk_bf16_f32 v122, v124, v125
    v_cvt_pk_bf16_f32 v123, v126, v127
    v_cndmask_b32 v82, v120, v122, s[38:39]
    v_cndmask_b32 v83, v121, v123, s[38:39]
    v_smfmac_f32_16x16x64_bf16 v[16:19], v[120:123], v[168:175], v10 abid:1
    s_nop 0
    ds_write_b64 v7, v[82:83] offset:15360
    v_smfmac_f32_16x16x64_bf16 v[20:23], v[120:123], v[200:207], v10 abid:1
    s_cbranch_vccnz L_slow_378
L_back_379:
    v_mov_b64 v[30:31], 0
    v_mov_b32 v46, -1
    s_mov_b64 exec, s[46:47]
    buffer_store_dword v46, v11, s[4:7], s16 offen sc1
    s_mov_b64 exec, -1
    v_smfmac_f32_16x16x64_bf16 v[24:27], v[120:123], v[232:239], v10 abid:1
    s_waitcnt lgkmcnt(0)
    s_barrier
    ds_read_b128 v[112:115], v8 offset:15872
    v_smfmac_f32_16x16x64_bf16 v[28:31], v[120:123], v[56:63], v10 abid:1
    s_nop 0
    ds_read_b128 v[116:119], v8 offset:16384
    ds_read_b128 v[124:127], v8 offset:14848
    v_mov_b32 v12, v12
    s_add_u32 s33, s33, 8192
    s_mov_b32 s32, s31
    s_add_u32 s31, s31, 524288
    v_mov_b32 v12, v12
    s_waitcnt lgkmcnt(2)
    v_smfmac_f32_16x16x64_bf16 v[16:19], v[112:115], v[176:183], v10 abid:1
    s_min_u32 s31, s31, s44
    ds_read_b128 v[64:67], v0 offset:18432
    s_add_u32 s14, s14, 1
    v_smfmac_f32_16x16x64_bf16 v[20:23], v[112:115], v[208:215], v10 abid:1
    s_waitcnt lgkmcnt(2)
    ds_read_b128 v[68:71], v0 offset:19456
    s_add_u32 s18, s27, s30
    v_smfmac_f32_16x16x64_bf16 v[16:19], v[116:119], v[184:191], v10 abid:1
    s_waitcnt lgkmcnt(2)
    ds_read_b128 v[72:75], v0 offset:26624
    s_mov_b32 s16, s26
    v_smfmac_f32_16x16x64_bf16 v[16:19], v[124:127], v[160:167], v10 abid:1
    s_mov_b32 s26, s27
    ds_read_b128 v[76:79], v0 offset:27648
    s_mov_b32 s27, s28
    v_smfmac_f32_16x16x64_bf16 v[20:23], v[116:119], v[216:223], v10 abid:1
    s_mov_b32 s28, s16
    ds_read_b128 v[48:51], v0 offset:2048
    s_add_u32 s19, s26, s29
    v_smfmac_f32_16x16x64_bf16 v[20:23], v[124:127], v[192:199], v10 abid:1
    s_nop 0
    ds_read_b128 v[52:55], v0 offset:3072
    v_mul_f32 v16, s23, v16
    v_cvt_pk_bf16_f32 v32, v16, v17
    v_cvt_pk_bf16_f32 v33, v18, v19
    v_and_or_b32 v32, v32, -2, s22
    v_smfmac_f32_16x16x64_bf16 v[24:27], v[112:115], v[240:247], v10 abid:1
    s_nop 0
    buffer_store_dwordx2 v[32:33], v9, s[4:7], s20 offen sc1
    v_smfmac_f32_16x16x64_bf16 v[24:27], v[116:119], v[248:255], v10 abid:1
    s_nop 0
    ds_read_b128 v[40:43], v5 offset:17408
    v_mul_f32 v20, s23, v20
    v_cvt_pk_bf16_f32 v34, v20, v21
    v_cvt_pk_bf16_f32 v35, v22, v23
    v_and_or_b32 v34, v34, -2, s22
    v_smfmac_f32_16x16x64_bf16 v[24:27], v[124:127], v[224:231], v10 abid:1
    s_waitcnt lgkmcnt(1)
    buffer_store_dwordx2 v[34:35], v9, s[4:7], s21 offen sc1
    v_smfmac_f32_16x16x64_bf16 v[28:31], v[112:115], v[64:71], v10 abid:1
    s_nop 0
    s_nop 0
    s_nop 0
    v_smfmac_f32_16x16x64_bf16 v[28:31], v[116:119], v[72:79], v10 abid:1
    s_nop 0
    s_nop 0
    v_mul_f32 v24, s23, v24
    v_cvt_pk_bf16_f32 v36, v24, v25
    v_smfmac_f32_16x16x64_bf16 v[28:31], v[124:127], v[48:55], v10 abid:1
    s_waitcnt lgkmcnt(0)
    s_nop 0
    v_cvt_pk_bf16_f32 v37, v26, v27
    v_and_or_b32 v36, v36, -2, s22
    buffer_store_dwordx2 v[36:37], v9, s[4:7], s25 offen sc1
    v_mov_b64 v[80:81], 0
    v_mov_b64 v[82:83], 0
    v_mov_b64 v[84:85], 0
    v_mul_f32 v28, s23, v28
    v_cvt_pk_bf16_f32 v38, v28, v29
    v_cvt_pk_bf16_f32 v39, v30, v31
    v_and_or_b32 v38, v38, -2, s22
    buffer_store_dwordx2 v[38:39], v9, s[4:7], s37 offen sc1
    v_mov_b64 v[86:87], 0
    s_nop 0
    ds_read_b128 v[48:51], v0 offset:59392
    v_mov_b64 v[88:89], 0
    v_mov_b64 v[90:91], 0
    s_nop 0
    ds_read_b128 v[52:55], v0 offset:60416
    v_mov_b64 v[92:93], 0
    v_mov_b64 v[94:95], 0
    s_nop 0
    ds_read_b128 v[56:59], v1 offset:2048
    v_mov_b64 v[96:97], 0
    v_mov_b64 v[98:99], 0
    s_nop 0
    ds_read_b128 v[60:63], v1 offset:3072
    v_mov_b64 v[100:101], 0
    v_mov_b64 v[102:103], 0
    s_nop 0
    ds_read_b128 v[64:67], v1 offset:10240
    v_and_b32 v121, 16, v0
    v_lshrrev_b32 v122, 8, v0
    s_nop 0
    ds_read_b128 v[68:71], v1 offset:11264
    v_lshl_add_u32 v121, v122, 1, v121
    v_bfe_u32 v122, v0, 5, 1
    s_nop 0
    ds_read_b128 v[72:75], v1 offset:18432
    v_lshl_add_u32 v121, v121, 1, v122
    v_lshlrev_b32 v121, 2, v121
    s_nop 0
    ds_read_b128 v[76:79], v1 offset:19456
    v_lshlrev_b32 v126, 3, v0
    s_mov_b32 m0, s43
    s_nop 2
    buffer_load_dwordx4 v[16:19], v0, s[4:7], s24 offen offset:0 sc1
    buffer_load_dwordx4 v[20:23], v0, s[4:7], s24 offen offset:1024 sc1
    s_nop 15
    s_nop 15
    s_nop 2
    buffer_load_dwordx4 v[112:115], v0, s[4:7], s24 offen offset:0 sc1
    buffer_load_dwordx4 v[116:119], v0, s[4:7], s24 offen offset:1024 sc1
    s_waitcnt vmcnt(3)
    v_mfma_f32_16x16x32_bf16 v[108:111], v[40:43], v[16:19], 0
    v_xor_b32 v44, s22, v16
    v_bitop3_b32 v44, v44, v18, s22 bitop3:0xf6
    s_waitcnt vmcnt(2)
    v_mfma_f32_16x16x32_bf16 v[108:111], v[40:43], v[20:23], v[108:111]
    v_bitop3_b32 v44, v44, v20, s22 bitop3:0xf6
    v_bitop3_b32 v44, v44, v22, s22 bitop3:0xf6
    v_and_b32 v44, 1, v44
    v_cmp_ne_u32 vcc, 0, v44
    s_cbranch_vccnz L_gt1_389
    ds_read_b32 v123, v6 offset:10240
    s_nop 1
L_gok_388:
    v_add_f32_dpp v108, v108, v108 row_ror:8 row_mask:0xf bank_mask:0xf
    v_add_f32_dpp v109, v109, v109 row_ror:8 row_mask:0xf bank_mask:0xf
    s_xor_b32 s22, s22, 1
    v_add_f32_dpp v108, v108, v108 row_ror:4 row_mask:0xf bank_mask:0xf
    v_add_f32_dpp v109, v109, v109 row_ror:4 row_mask:0xf bank_mask:0xf
    v_cvt_pk_bf16_f32 v44, v108, v109
    v_min_u32 v120, -2, v44
    s_mov_b64 exec, s[46:47]
    buffer_store_dword v120, v11, s[4:7], s18 offen sc1
    s_mov_b64 exec, -1
    s_xor_b32 s23, s23, 0xff1340
    s_waitcnt lgkmcnt(0)
    v_cmp_ne_u32 vcc, s36, v123
    s_cmp_eq_u32 s14, 63
    s_cbranch_scc1 L_exit_380
    s_cbranch_vccnz L_kvw_376
L_kvok_377:
    ds_read_b128 v[24:27], v0 offset:34816
    s_nop 0
    ds_read_b128 v[28:31], v0 offset:35840
    s_nop 0
    ds_read_b128 v[32:35], v0 offset:43008
    s_nop 0
    ds_read_b128 v[36:39], v0 offset:44032
    s_nop 0
    ds_read_b128 v[40:43], v0 offset:51200
    s_nop 0
    ds_read_b128 v[44:47], v0 offset:52224
    s_nop 0
    s_nop 10
    buffer_load_dwordx4 v[16:19], v0, s[4:7], s19 offen sc1
    buffer_load_dwordx4 v[20:23], v0, s[4:7], s19 offen offset:1024 sc1
    s_nop 15
    s_nop 15
    buffer_load_dwordx4 v[16:19], v0, s[4:7], s19 offen sc1
    buffer_load_dwordx4 v[20:23], v0, s[4:7], s19 offen offset:1024 sc1
    v_mov_b32 v12, v12
    s_branch L_poll2c_385
L_gt1_389:
    s_nop 0
    s_waitcnt vmcnt(1)
    v_mfma_f32_16x16x32_bf16 v[108:111], v[40:43], v[112:115], 0
    v_xor_b32 v44, s22, v112
    v_bitop3_b32 v44, v44, v114, s22 bitop3:0xf6
    s_waitcnt vmcnt(0)
    v_mfma_f32_16x16x32_bf16 v[108:111], v[40:43], v[116:119], v[108:111]
    v_bitop3_b32 v44, v44, v116, s22 bitop3:0xf6
    v_bitop3_b32 v44, v44, v118, s22 bitop3:0xf6
    v_and_b32 v44, 1, v44
    v_cmp_ne_u32 vcc, 0, v44
    s_cbranch_vccnz L_gt2_390
    ds_read_b32 v123, v6 offset:10240
    s_nop 0
    s_branch L_gok_388
L_gt2_390:
    buffer_load_dwordx4 v[16:19], v0, s[4:7], s24 offen offset:0 sc1
    buffer_load_dwordx4 v[20:23], v0, s[4:7], s24 offen offset:1024 sc1
    s_add_u32 s40, s40, 1
    s_cmp_gt_u32 s40, 262144
    s_cbranch_scc1 L_abort
    s_waitcnt vmcnt(1)
    v_mfma_f32_16x16x32_bf16 v[108:111], v[40:43], v[16:19], 0
    v_xor_b32 v44, s22, v16
    v_bitop3_b32 v44, v44, v18, s22 bitop3:0xf6
    s_waitcnt vmcnt(0)
    v_mfma_f32_16x16x32_bf16 v[108:111], v[40:43], v[20:23], v[108:111]
    v_bitop3_b32 v44, v44, v20, s22 bitop3:0xf6
    v_bitop3_b32 v44, v44, v22, s22 bitop3:0xf6
    v_and_b32 v44, 1, v44
    v_cmp_ne_u32 vcc, 0, v44
    s_cbranch_vccnz L_gt2_390
    ds_read_b32 v123, v6 offset:10240
    s_nop 0
    s_branch L_gok_388
L_slow_378:
    ds_read2st64_b32 v[32:33], v6 offset0:0 offset1:1
    ds_read2st64_b32 v[34:35], v6 offset0:2 offset1:3
    ds_read2st64_b32 v[36:37], v6 offset0:4 offset1:5
    ds_read2st64_b32 v[38:39], v6 offset0:6 offset1:7
    ds_read2st64_b32 v[40:41], v6 offset0:8 offset1:9
    ds_read2st64_b32 v[42:43], v6 offset0:10 offset1:11
    ds_read2st64_b32 v[44:45], v6 offset0:12 offset1:13
    ds_read2st64_b32 v[46:47], v6 offset0:14 offset1:15
    s_waitcnt lgkmcnt(0)
    v_add_f32 v32, v32, v36
    v_add_f32 v40, v40, v44
    v_add_f32 v32, v32, v40
    v_mul_f32 v32, s41, v32
    v_add_f32 v33, v33, v37
    v_add_f32 v41, v41, v45
    v_add_f32 v33, v33, v41
    v_mul_f32 v33, s41, v33
    v_add_f32 v34, v34, v38
    v_add_f32 v42, v42, v46
    v_add_f32 v34, v34, v42
    v_mul_f32 v34, s41, v34
    v_add_f32 v35, v35, v39
    v_add_f32 v43, v43, v47
    v_add_f32 v35, v35, v43
    v_mul_f32 v35, s41, v35
    v_max3_f32 v84, v32, v33, v34
    v_max3_f32 v84, v84, v35, v80
    v_max_f32 v84, v84, v81
    s_nop 1
    v_max_f32_dpp v84, v84, v84 row_ror:8 row_mask:0xf bank_mask:0xf
    v_mov_b32 v85, v84
    s_nop 1
    v_permlane16_swap_b32 v84, v85
    v_max_f32 v84, v84, v85
    v_mov_b32 v85, v84
    s_nop 1
    v_permlane32_swap_b32 v84, v85
    v_max_f32 v84, v84, v85
    v_sub_f32 v32, v32, v84
    v_sub_f32 v33, v33, v84
    v_sub_f32 v34, v34, v84
    v_sub_f32 v35, v35, v84
    v_sub_f32 v90, v80, v84
    v_sub_f32 v91, v81, v84
    v_exp_f32 v32, v32
    v_exp_f32 v33, v33
    v_exp_f32 v34, v34
    v_exp_f32 v35, v35
    v_exp_f32 v90, v90
    v_exp_f32 v91, v91
    v_cvt_pk_bf16_f32 v36, v32, v33
    v_cvt_pk_bf16_f32 v37, v34, v35
    v_cvt_pk_bf16_f32 v88, v90, v91
    v_mov_b64 v[92:93], v[36:37]
    v_mov_b64 v[94:95], v[36:37]
    s_nop 1
    v_mov_b32_dpp v92, v36 row_ror:8 row_mask:0xf bank_mask:0xc
    v_mov_b32_dpp v93, v37 row_ror:8 row_mask:0xf bank_mask:0xc
    v_mov_b32_dpp v94, v36 row_ror:8 row_mask:0xf bank_mask:0x3
    v_mov_b32_dpp v95, v37 row_ror:8 row_mask:0xf bank_mask:0x3
    s_nop 1
    v_mfma_f32_16x16x32_bf16 v[108:111], v[12:15], v[92:95], 0
    v_mfma_f32_16x16x32_bf16 v[120:123], v[112:115], v[92:95], 0
    v_mfma_f32_16x16x32_bf16 v[124:127], v[116:119], v[92:95], 0
    s_nop 5
    v_mfma_f32_16x16x16_bf16 v[108:111], v[12:13], v[88:89], v[108:111]
    s_nop 0
    s_nop 1
    v_mfma_f32_16x16x16_bf16 v[120:123], v[104:105], v[88:89], v[120:123]
    s_nop 0
    v_mov_b64 v[24:25], 0
    v_mov_b64 v[26:27], 0
    v_mfma_f32_16x16x16_bf16 v[124:127], v[106:107], v[88:89], v[124:127]
    v_rcp_f32 v110, v108
    v_mov_b64 v[28:29], 0
    v_max_f32 v109, v108, v110
    v_cmp_ngt_f32 vcc, s42, v109
    v_pk_mul_f32 v[120:121], v[120:121], v[110:111] op_sel_hi:[1,0]
    v_pk_mul_f32 v[122:123], v[122:123], v[110:111] op_sel_hi:[1,0]
    v_cvt_pk_bf16_f32 v120, v120, v121
    v_cvt_pk_bf16_f32 v121, v122, v123
    v_pk_mul_f32 v[124:125], v[124:125], v[110:111] op_sel_hi:[1,0]
    v_pk_mul_f32 v[126:127], v[126:127], v[110:111] op_sel_hi:[1,0]
    v_cvt_pk_bf16_f32 v122, v124, v125
    v_cvt_pk_bf16_f32 v123, v126, v127
    v_cndmask_b32 v82, v120, v122, s[38:39]
    v_cndmask_b32 v83, v121, v123, s[38:39]
    v_mov_b64 v[16:17], 0
    v_mov_b64 v[18:19], 0
    v_mov_b64 v[20:21], 0
    v_mov_b64 v[22:23], 0
    ds_write_b64 v7, v[82:83] offset:15360
    v_smfmac_f32_16x16x64_bf16 v[16:19], v[120:123], v[168:175], v10 abid:1
    v_smfmac_f32_16x16x64_bf16 v[20:23], v[120:123], v[200:207], v10 abid:1
    s_branch L_back_379
L_exit_380:
    s_mov_b64 exec, s[46:47]
    buffer_store_dword v120, v121, s[4:7], s33 offen sc1
    s_mov_b64 exec, -1
    s_waitcnt vmcnt(1)
    s_barrier
    s_branch L_ldone_356
L_wv2_354:
    ds_read_b128 v[48:51], v0 offset:61440
    ds_read_b128 v[52:55], v0 offset:62464
    ds_read_b128 v[56:59], v1 offset:4096
    ds_read_b128 v[60:63], v1 offset:5120
    ds_read_b128 v[64:67], v1 offset:12288
    ds_read_b128 v[68:71], v1 offset:13312
    ds_read_b128 v[72:75], v1 offset:20480
    ds_read_b128 v[76:79], v1 offset:21504
    ds_read_b128 v[24:27], v0 offset:36864
    ds_read_b128 v[28:31], v0 offset:37888
    ds_read_b128 v[32:35], v0 offset:45056
    ds_read_b128 v[36:39], v0 offset:46080
    ds_read_b128 v[40:43], v0 offset:53248
    ds_read_b128 v[44:47], v0 offset:54272
    v_mov_b64 v[80:81], 0
    v_mov_b64 v[82:83], 0
    v_mov_b64 v[84:85], 0
    v_mov_b64 v[86:87], 0
    v_mov_b64 v[88:89], 0
    v_mov_b64 v[90:91], 0
    v_mov_b64 v[92:93], 0
    v_mov_b64 v[94:95], 0
    v_mov_b64 v[96:97], 0
    v_mov_b64 v[98:99], 0
    v_mov_b64 v[100:101], 0
    v_mov_b64 v[102:103], 0
    v_and_b32 v121, 16, v0
    v_lshrrev_b32 v122, 8, v0
    v_lshl_add_u32 v121, v122, 1, v121
    v_bfe_u32 v122, v0, 5, 1
    v_lshl_add_u32 v121, v121, 1, v122
    v_lshlrev_b32 v121, 2, v121
    v_lshlrev_b32 v126, 3, v0
    s_mov_b32 m0, s43
    s_waitcnt vmcnt(0)
    v_min_u32 v120, -2, v120
    s_cmp_lg_u32 s15, 0
    s_cbranch_scc1 L_w2_399
L_w1_398:
    buffer_load_dword v123, off, s[4:7], s35 sc1
    s_add_u32 s40, s40, 1
    s_cmp_gt_u32 s40, 262144
    s_cbranch_scc1 L_abort
    s_waitcnt vmcnt(0)
    v_cmp_eq_u32 vcc, 0, v123
    s_cbranch_vccnz L_w1_398
    s_branch L_w3_400
L_w2_399:
    buffer_load_dword v123, off, s[4:7], s35 sc1
    buffer_load_dwordx4 v[104:107], v0, s[4:7], s32 offen offset:0 sc1
    buffer_load_dwordx4 v[108:111], v0, s[4:7], s32 offen offset:1024 sc1
    buffer_load_dwordx4 v[112:115], v0, s[4:7], s32 offen offset:2048 sc1
    buffer_load_dwordx4 v[116:119], v0, s[4:7], s32 offen offset:3072 sc1
    s_add_u32 s40, s40, 1
    s_cmp_gt_u32 s40, 262144
    s_cbranch_scc1 L_abort
    s_waitcnt vmcnt(0)
    v_cmp_ne_u32 vcc, 0, v123
    s_cbranch_vccnz L_w3_400
    v_max_u32 v127, v104, v105
    v_max3_u32 v127, v127, v106, v107
    v_max3_u32 v127, v127, v108, v109
    v_max3_u32 v127, v127, v110, v111
    v_max3_u32 v127, v127, v112, v113
    v_max3_u32 v127, v127, v114, v115
    v_max3_u32 v127, v127, v116, v117
    v_max3_u32 v127, v127, v118, v119
    v_cmp_eq_u32 vcc, -1, v127
    s_cbranch_vccnz L_w2_399
L_w3_400:
    s_waitcnt vmcnt(0) lgkmcnt(0)
    s_branch L_st_401
L_kvw_393:
    buffer_load_dword v123, off, s[4:7], s35 sc1
    s_add_u32 s40, s40, 1
    s_cmp_gt_u32 s40, 262144
    s_cbranch_scc1 L_abort
    s_waitcnt vmcnt(0)
    v_cmp_eq_u32 vcc, 0, v123
    s_cbranch_vccnz L_kvw_393
    s_branch L_kvok_394
L_st_401:
    s_branch L_arr_391
L_poll2_392:
    buffer_load_dwordx4 v[16:19], v0, s[4:7], s19 offen sc1
    buffer_load_dwordx4 v[20:23], v0, s[4:7], s19 offen offset:1024 sc1
    s_waitcnt vmcnt(2)
    v_max3_u32 v127, v16, v17, v18
    v_max3_u32 v127, v127, v19, v20
    v_max3_u32 v127, v127, v21, v22
    v_max_u32 v127, v127, v23
    v_cmp_eq_u32 vcc, -1, v127
    s_cbranch_vccz L_arr_391
L_poll3_403:
    s_add_u32 s40, s40, 1
    s_cmp_gt_u32 s40, 262144
    s_cbranch_scc1 L_abort
    v_max3_u32 v127, v16, v17, v18
    v_max3_u32 v127, v127, v19, v20
    v_max3_u32 v127, v127, v21, v22
    v_max_u32 v127, v127, v23
    v_cmp_eq_u32 vcc, -1, v127
    s_cbranch_vccz L_arr_391
    v_max3_u32 v127, v16, v17, v18
    v_max3_u32 v127, v127, v19, v20
    v_max3_u32 v127, v127, v21, v22
    v_max_u32 v127, v127, v23
    v_cmp_eq_u32 vcc, -1, v127
    s_cbranch_vccz L_arr_391
    v_max3_u32 v127, v16, v17, v18
    v_max3_u32 v127, v127, v19, v20
    v_max3_u32 v127, v127, v21, v22
    v_max_u32 v127, v127, v23
    v_cmp_eq_u32 vcc, -1, v127
    s_cbranch_vccz L_arr_391
    v_max3_u32 v127, v16, v17, v18
    v_max3_u32 v127, v127, v19, v20
    v_max3_u32 v127, v127, v21, v22
    v_max_u32 v127, v127, v23
    v_cmp_eq_u32 vcc, -1, v127
    s_cbranch_vccz L_arr_391
    buffer_load_dwordx4 v[16:19], v0, s[4:7], s19 offen sc1
    buffer_load_dwordx4 v[20:23], v0, s[4:7], s19 offen offset:1024 sc1
    s_branch L_poll3_403
L_poll2c_402:
    v_mov_b32 v12, v12
    s_waitcnt vmcnt(3) lgkmcnt(0)
    v_max3_u32 v127, v16, v17, v18
    v_max_u32 v127, v127, v19
    s_waitcnt vmcnt(2)
    v_max3_u32 v127, v127, v20, v21
    v_max3_u32 v127, v127, v22, v23
    v_cmp_eq_u32 vcc, -1, v127
    s_cbranch_vccnz L_poll2_392
L_arr_391:
    ds_write_b128 v5, v[16:19] offset:4096
    v_smfmac_f32_16x16x64_bf16 v[80:83], v[16:19], v[24:31], v10
    s_nop 0
    ds_write_b128 v5, v[20:23] offset:5120
    v_smfmac_f32_16x16x64_bf16 v[84:87], v[16:19], v[32:39], v10
    v_smfmac_f32_16x16x64_bf16 v[80:83], v[20:23], v[40:47], v10
    s_nop 0
    buffer_load_dwordx4 v[112:115], v0, s[4:7], s32 offen offset:2048 sc1
    buffer_load_dwordx4 v[116:119], v0, s[4:7], s32 offen offset:3072 sc1
    v_smfmac_f32_16x16x64_bf16 v[84:87], v[20:23], v[48:55], v10
    s_nop 0
    buffer_load_dwordx4 v[104:107], v0, s[4:7], s32 offen offset:0 sc1
    buffer_load_dwordx4 v[108:111], v0, s[4:7], s32 offen offset:1024 sc1
    v_smfmac_f32_16x16x64_bf16 v[88:91], v[16:19], v[56:63], v10
    s_add_u32 s35, s35, 4
    s_add_u32 s36, s36, 1
    s_waitcnt lgkmcnt(0)
    s_barrier
    ds_read_b128 v[24:27], v5 offset:6144
    v_smfmac_f32_16x16x64_bf16 v[92:95], v[16:19], v[64:71], v10
    s_nop 0
    ds_read_b128 v[28:31], v5 offset:7168
    v_smfmac_f32_16x16x64_bf16 v[96:99], v[16:19], v[72:79], v10
    s_nop 0
    ds_read_b128 v[32:35], v5 offset:0
    v_smfmac_f32_16x16x64_bf16 v[96:99], v[20:23], a[176:183], v10
    s_nop 0
    ds_read_b128 v[36:39], v5 offset:1024
    s_waitcnt lgkmcnt(3)
    v_smfmac_f32_16x16x64_bf16 v[80:83], v[24:27], a[0:7], v10
    s_nop 0
    ds_read_b128 v[40:43], v5 offset:2048
    v_smfmac_f32_16x16x64_bf16 v[84:87], v[24:27], a[8:15], v10
    s_waitcnt lgkmcnt(3)
    ds_read_b128 v[44:47], v5 offset:3072
    v_smfmac_f32_16x16x64_bf16 v[80:83], v[28:31], a[16:23], v10
    s_nop 0
    ds_read_b128 v[48:51], v1 offset:28672
    v_smfmac_f32_16x16x64_bf16 v[84:87], v[28:31], a[24:31], v10
    s_waitcnt lgkmcnt(3)
    ds_read_b128 v[52:55], v1 offset:29696
    v_smfmac_f32_16x16x64_bf16 v[80:83], v[32:35], a[32:39], v10
    s_mov_b64 exec, s[46:47]
    buffer_store_dword v120, v121, s[4:7], s33 offen sc1
    s_mov_b64 exec, -1
    v_smfmac_f32_16x16x64_bf16 v[84:87], v[32:35], a[40:47], v10
    s_nop 0
    ds_read_b128 v[56:59], v1 offset:36864
    v_smfmac_f32_16x16x64_bf16 v[80:83], v[36:39], a[48:55], v10
    s_waitcnt lgkmcnt(3)
    ds_read_b128 v[60:63], v1 offset:37888
    v_smfmac_f32_16x16x64_bf16 v[80:83], v[40:43], a[64:71], v10
    s_nop 0
    ds_read_b128 v[64:67], v1 offset:45056
    v_smfmac_f32_16x16x64_bf16 v[80:83], v[44:47], a[80:87], v10
    s_nop 0
    ds_read_b128 v[68:71], v1 offset:46080
    s_nop 0
    v_smfmac_f32_16x16x64_bf16 v[84:87], v[36:39], a[56:63], v10
    s_nop 0
    ds_read_b128 v[72:75], v1 offset:53248
    s_nop 0
    v_smfmac_f32_16x16x64_bf16 v[84:87], v[40:43], a[72:79], v10
    s_nop 0
    ds_read_b128 v[76:79], v1 offset:54272
    v_add_f32 v80, v80, v82
    v_smfmac_f32_16x16x64_bf16 v[84:87], v[44:47], a[88:95], v10
    s_waitcnt lgkmcnt(4)
    s_nop 0
    v_add_f32 v81, v81, v83
    v_smfmac_f32_16x16x64_bf16 v[88:91], v[20:23], v[48:55], v10
    s_nop 1
    v_cvt_pk_bf16_f32 v80, v80, v81
    v_smfmac_f32_16x16x64_bf16 v[92:95], v[20:23], a[96:103], v10
    s_waitcnt lgkmcnt(0)
    ds_write_b32 v2, v80 offset:24
    v_add_f32 v84, v84, v86
    v_add_f32 v85, v85, v87
    v_cvt_pk_bf16_f32 v84, v84, v85
    v_smfmac_f32_16x16x64_bf16 v[88:91], v[24:27], v[56:63], v10
    s_nop 0
    ds_write_b32 v2, v84 offset:664
    v_smfmac_f32_16x16x64_bf16 v[92:95], v[24:27], a[104:111], v10
    s_nop 0
    ds_read_b64_tr_b16 v[120:121], v4 offset:24
    ds_read_b64_tr_b16 v[122:123], v4 offset:344
    v_smfmac_f32_16x16x64_bf16 v[88:91], v[28:31], v[64:71], v10
    s_nop 0
    ds_read_b64_tr_b16 v[124:125], v4 offset:8
    ds_read_b64_tr_b16 v[126:127], v4 offset:328
    v_smfmac_f32_16x16x64_bf16 v[92:95], v[28:31], a[112:119], v10
    s_nop 0
    ds_read_b128 v[48:51], v1 offset:61440
    v_smfmac_f32_16x16x64_bf16 v[88:91], v[32:35], v[72:79], v10
    s_nop 0
    ds_read_b128 v[52:55], v1 offset:62464
    v_smfmac_f32_16x16x64_bf16 v[92:95], v[32:35], a[120:127], v10
    s_waitcnt vmcnt(1)
    v_smfmac_f32_16x16x64_bf16 v[88:91], v[36:39], a[128:135], v10
    s_waitcnt lgkmcnt(2)
    v_mfma_f32_16x16x32_bf16 v[80:83], v[104:107], v[120:123], 0
    v_mfma_f32_16x16x32_bf16 v[80:83], v[108:111], v[124:127], v[80:83]
    s_nop 2
    v_smfmac_f32_16x16x64_bf16 v[88:91], v[40:43], a[144:151], v10
    s_nop 2
    v_smfmac_f32_16x16x64_bf16 v[88:91], v[44:47], a[160:167], v10
    s_nop 0
    ds_write2st64_b32 v6, v80, v81 offset0:8 offset1:9
    v_smfmac_f32_16x16x64_bf16 v[92:95], v[36:39], a[136:143], v10
    s_waitcnt lgkmcnt(1)
    ds_write2st64_b32 v6, v82, v83 offset0:10 offset1:11
    v_smfmac_f32_16x16x64_bf16 v[92:95], v[40:43], a[152:159], v10
    s_nop 1
    v_add_f32 v88, v88, v90
    v_add_f32 v89, v89, v91
    v_cvt_pk_bf16_f32 v88, v88, v89
    v_smfmac_f32_16x16x64_bf16 v[92:95], v[44:47], v[48:55], v10
    s_nop 0
    ds_write_b32 v3, v88 offset:1408
    v_smfmac_f32_16x16x64_bf16 v[96:99], v[24:27], a[192:199], v10
    s_nop 0
    ds_read_b128 v[64:67], v0 offset:20480
    s_nop 0
    v_smfmac_f32_16x16x64_bf16 v[96:99], v[28:31], a[208:215], v10
    s_nop 1
    v_add_f32 v92, v92, v94
    v_add_f32 v93, v93, v95
    v_cvt_pk_bf16_f32 v92, v92, v93
    v_smfmac_f32_16x16x64_bf16 v[96:99], v[32:35], a[224:231], v10
    s_nop 0
    ds_write_b32 v3, v92 offset:2048
    ds_read_b64_tr_b16 v[88:89], v4 offset:1408
    ds_read_b64_tr_b16 v[90:91], v4 offset:1728
    v_smfmac_f32_16x16x64_bf16 v[96:99], v[36:39], a[240:247], v10
    s_waitcnt lgkmcnt(5)
    s_barrier
    ds_read2st64_b32 v[104:105], v6 offset0:2 offset1:6
    v_smfmac_f32_16x16x64_bf16 v[96:99], v[40:43], v[128:135], v10
    s_nop 0
    ds_read2st64_b32 v[106:107], v6 offset0:10 offset1:14
    v_smfmac_f32_16x16x64_bf16 v[96:99], v[44:47], v[144:151], v10
    s_add_u32 s16, s28, s30
    ds_read_b128 v[68:71], v0 offset:21504
    s_waitcnt lgkmcnt(3)
    v_mfma_f32_16x16x32_bf16 v[84:87], v[88:91], v[120:123], 0
    s_nop 0
    v_mov_b32 v89, 0
    s_nop 0
    v_smfmac_f32_16x16x64_bf16 v[100:103], v[16:19], a[168:175], v10
    s_waitcnt lgkmcnt(1)
    v_add_f32 v104, v104, v105
    v_add_f32 v106, v106, v107
    v_smfmac_f32_16x16x64_bf16 v[100:103], v[20:23], a[184:191], v10
    s_nop 0
    ds_write_b64 v7, v[84:85] offset:13312
    v_add_f32 v104, v104, v106
    v_mul_f32 v104, s41, v104
    v_smfmac_f32_16x16x64_bf16 v[100:103], v[24:27], a[200:207], v10
    v_exp_f32 v104, v104
    v_add_f32 v96, v96, v98
    v_cvt_pk_bf16_f32 v107, v104, v104
    v_smfmac_f32_16x16x64_bf16 v[100:103], v[28:31], a[216:223], v10
    s_nop 0
    ds_write_b16 v7, v107 offset:14340
    v_smfmac_f32_16x16x64_bf16 v[100:103], v[32:35], a[232:239], v10
    v_add_f32 v97, v97, v99
    v_smfmac_f32_16x16x64_bf16 v[100:103], v[36:39], a[248:255], v10
    s_waitcnt lgkmcnt(1)
    s_barrier
    ds_read_b64 v[80:81], v8 offset:12288
    v_smfmac_f32_16x16x64_bf16 v[100:103], v[40:43], v[136:143], v10
    s_nop 0
    ds_read_b64 v[82:83], v8 offset:12800
    ds_read_b64 v[84:85], v8 offset:13312
    ds_read_b64 v[86:87], v8 offset:13824
    v_smfmac_f32_16x16x64_bf16 v[100:103], v[44:47], v[152:159], v10
    s_waitcnt lgkmcnt(4)
    s_barrier
    ds_read_b128 v[92:95], v8 offset:14336
    v_cvt_pk_bf16_f32 v104, v96, v97
    v_cvt_pk_bf16_f32 v105, v96, v97
    v_mov_b64 v[16:17], 0
    v_mov_b64 v[18:19], 0
    s_waitcnt vmcnt(3)
    v_mov_b64 v[20:21], 0
    v_mov_b64 v[22:23], 0
    s_waitcnt lgkmcnt(1)
    v_pk_add_f32 v[80:81], v[80:81], v[82:83]
    v_pk_add_f32 v[84:85], v[84:85], v[86:87]
    v_pk_add_f32 v[80:81], v[80:81], v[84:85]
    v_mul_f32 v80, s41, v80
    v_mul_f32 v81, s41, v81
    s_waitcnt lgkmcnt(0)
    v_mfma_f32_16x16x32_bf16 v[108:111], v[12:15], v[92:95], 0
    v_exp_f32 v90, v80
    v_mfma_f32_16x16x32_bf16 v[120:123], v[112:115], v[92:95], 0
    v_exp_f32 v91, v81
    v_mfma_f32_16x16x32_bf16 v[124:127], v[116:119], v[92:95], 0
    v_cvt_pk_bf16_f32 v88, v90, v91
    v_add_f32 v100, v100, v102
    v_add_f32 v101, v101, v103
    v_mfma_f32_16x16x16_bf16 v[108:111], v[12:13], v[88:89], v[108:111]
    s_nop 0
    v_cvt_pk_bf16_f32 v106, v100, v101
    v_cvt_pk_bf16_f32 v107, v100, v101
    v_mfma_f32_16x16x16_bf16 v[120:123], v[104:105], v[88:89], v[120:123]
    s_nop 0
    v_mov_b64 v[24:25], 0
    v_mov_b64 v[26:27], 0
    v_mfma_f32_16x16x16_bf16 v[124:127], v[106:107], v[88:89], v[124:127]
    v_rcp_f32 v110, v108
    v_mov_b64 v[28:29], 0
    v_max_f32 v109, v108, v110
    v_cmp_ngt_f32 vcc, s42, v109
    v_pk_mul_f32 v[120:121], v[120:121], v[110:111] op_sel_hi:[1,0]
    v_pk_mul_f32 v[122:123], v[122:123], v[110:111] op_sel_hi:[1,0]
    v_cvt_pk_bf16_f32 v120, v120, v121
    v_cvt_pk_bf16_f32 v121, v122, v123
    v_pk_mul_f32 v[124:125], v[124:125], v[110:111] op_sel_hi:[1,0]
    v_pk_mul_f32 v[126:127], v[126:127], v[110:111] op_sel_hi:[1,0]
    v_cvt_pk_bf16_f32 v122, v124, v125
    v_cvt_pk_bf16_f32 v123, v126, v127
    v_cndmask_b32 v82, v120, v122, s[38:39]
    v_cndmask_b32 v83, v121, v123, s[38:39]
    v_smfmac_f32_16x16x64_bf16 v[16:19], v[120:123], v[176:183], v10 abid:1
    s_nop 0
    ds_write_b64 v7, v[82:83] offset:15872
    v_smfmac_f32_16x16x64_bf16 v[20:23], v[120:123], v[208:215], v10 abid:1
    s_cbranch_vccnz L_slow_395
L_back_396:
    v_mov_b64 v[30:31], 0
    v_mov_b32 v46, -1
    s_mov_b64 exec, s[46:47]
    buffer_store_dword v46, v11, s[4:7], s16 offen sc1
    s_mov_b64 exec, -1
    v_smfmac_f32_16x16x64_bf16 v[24:27], v[120:123], v[240:247], v10 abid:1
    s_waitcnt lgkmcnt(0)
    s_barrier
    ds_read_b128 v[112:115], v8 offset:16384
    v_smfmac_f32_16x16x64_bf16 v[28:31], v[120:123], v[64:71], v10 abid:1
    s_nop 0
    ds_read_b128 v[116:119], v8 offset:14848
    ds_read_b128 v[124:127], v8 offset:15360
    v_mov_b32 v12, v12
    s_add_u32 s33, s33, 8192
    s_mov_b32 s32, s31
    s_add_u32 s31, s31, 524288
    v_mov_b32 v12, v12
    s_waitcnt lgkmcnt(2)
    v_smfmac_f32_16x16x64_bf16 v[16:19], v[112:115], v[184:191], v10 abid:1
    s_min_u32 s31, s31, s44
    ds_read_b128 v[72:75], v0 offset:28672
    s_add_u32 s14, s14, 1
    v_smfmac_f32_16x16x64_bf16 v[20:23], v[112:115], v[216:223], v10 abid:1
    s_waitcnt lgkmcnt(2)
    ds_read_b128 v[76:79], v0 offset:29696
    s_add_u32 s18, s27, s30
    v_smfmac_f32_16x16x64_bf16 v[16:19], v[116:119], v[160:167], v10 abid:1
    s_waitcnt lgkmcnt(2)
    ds_read_b128 v[48:51], v0 offset:4096
    s_mov_b32 s16, s26
    v_smfmac_f32_16x16x64_bf16 v[16:19], v[124:127], v[168:175], v10 abid:1
    s_mov_b32 s26, s27
    ds_read_b128 v[52:55], v0 offset:5120
    s_mov_b32 s27, s28
    v_smfmac_f32_16x16x64_bf16 v[20:23], v[116:119], v[192:199], v10 abid:1
    s_mov_b32 s28, s16
    ds_read_b128 v[56:59], v0 offset:12288
    s_add_u32 s19, s26, s29
    v_smfmac_f32_16x16x64_bf16 v[20:23], v[124:127], v[200:207], v10 abid:1
    s_nop 0
    ds_read_b128 v[60:63], v0 offset:13312
    v_mul_f32 v16, s23, v16
    v_cvt_pk_bf16_f32 v32, v16, v17
    v_cvt_pk_bf16_f32 v33, v18, v19
    v_and_or_b32 v32, v32, -2, s22
    v_smfmac_f32_16x16x64_bf16 v[24:27], v[112:115], v[248:255], v10 abid:1
    s_nop 0
    buffer_store_dwordx2 v[32:33], v9, s[4:7], s20 offen sc1
    v_smfmac_f32_16x16x64_bf16 v[24:27], v[116:119], v[224:231], v10 abid:1
    s_nop 0
    ds_read_b128 v[40:43], v5 offset:17408
    v_mul_f32 v20, s23, v20
    v_cvt_pk_bf16_f32 v34, v20, v21
    v_cvt_pk_bf16_f32 v35, v22, v23
    v_and_or_b32 v34, v34, -2, s22
    v_smfmac_f32_16x16x64_bf16 v[24:27], v[124:127], v[232:239], v10 abid:1
    s_waitcnt lgkmcnt(1)
    buffer_store_dwordx2 v[34:35], v9, s[4:7], s21 offen sc1
    v_smfmac_f32_16x16x64_bf16 v[28:31], v[112:115], v[72:79], v10 abid:1
    s_nop 0
    s_nop 0
    s_nop 0
    v_smfmac_f32_16x16x64_bf16 v[28:31], v[116:119], v[48:55], v10 abid:1
    s_nop 0
    s_nop 0
    v_mul_f32 v24, s23, v24
    v_cvt_pk_bf16_f32 v36, v24, v25
    v_smfmac_f32_16x16x64_bf16 v[28:31], v[124:127], v[56:63], v10 abid:1
    s_waitcnt lgkmcnt(0)
    s_nop 0
    v_cvt_pk_bf16_f32 v37, v26, v27
    v_and_or_b32 v36, v36, -2, s22
    buffer_store_dwordx2 v[36:37], v9, s[4:7], s25 offen sc1
    v_mov_b64 v[80:81], 0
    v_mov_b64 v[82:83], 0
    v_mov_b64 v[84:85], 0
    v_mul_f32 v28, s23, v28
    v_cvt_pk_bf16_f32 v38, v28, v29
    v_cvt_pk_bf16_f32 v39, v30, v31
    v_and_or_b32 v38, v38, -2, s22
    buffer_store_dwordx2 v[38:39], v9, s[4:7], s37 offen sc1
    v_mov_b64 v[86:87], 0
    s_nop 0
    ds_read_b128 v[48:51], v0 offset:61440
    v_mov_b64 v[88:89], 0
    v_mov_b64 v[90:91], 0
    s_nop 0
    ds_read_b128 v[52:55], v0 offset:62464
    v_mov_b64 v[92:93], 0
    v_mov_b64 v[94:95], 0
    s_nop 0
    ds_read_b128 v[56:59], v1 offset:4096
    v_mov_b64 v[96:97], 0
    v_mov_b64 v[98:99], 0
    s_nop 0
    ds_read_b128 v[60:63], v1 offset:5120
    v_mov_b64 v[100:101], 0
    v_mov_b64 v[102:103], 0
    s_nop 0
    ds_read_b128 v[64:67], v1 offset:12288
    v_and_b32 v121, 16, v0
    v_lshrrev_b32 v122, 8, v0
    s_nop 0
    ds_read_b128 v[68:71], v1 offset:13312
    v_lshl_add_u32 v121, v122, 1, v121
    v_bfe_u32 v122, v0, 5, 1
    s_nop 0
    ds_read_b128 v[72:75], v1 offset:20480
    v_lshl_add_u32 v121, v121, 1, v122
    v_lshlrev_b32 v121, 2, v121
    s_nop 0
    ds_read_b128 v[76:79], v1 offset:21504
    v_lshlrev_b32 v126, 3, v0
    s_mov_b32 m0, s43
    s_nop 11
    buffer_load_dwordx4 v[16:19], v0, s[4:7], s24 offen offset:0 sc1
    buffer_load_dwordx4 v[20:23], v0, s[4:7], s24 offen offset:1024 sc1
    s_nop 15
    s_nop 15
    s_nop 3
    buffer_load_dwordx4 v[112:115], v0, s[4:7], s24 offen offset:0 sc1
    buffer_load_dwordx4 v[116:119], v0, s[4:7], s24 offen offset:1024 sc1
    s_waitcnt vmcnt(3)
    v_mfma_f32_16x16x32_bf16 v[108:111], v[40:43], v[16:19], 0
    v_xor_b32 v44, s22, v16
    v_bitop3_b32 v44, v44, v18, s22 bitop3:0xf6
    s_waitcnt vmcnt(2)
    v_mfma_f32_16x16x32_bf16 v[108:111], v[40:43], v[20:23], v[108:111]
    v_bitop3_b32 v44, v44, v20, s22 bitop3:0xf6
    v_bitop3_b32 v44, v44, v22, s22 bitop3:0xf6
    v_and_b32 v44, 1, v44
    v_cmp_ne_u32 vcc, 0, v44
    s_cbranch_vccnz L_gt1_406
    ds_read_b32 v123, v6 offset:10240
    s_nop 1
L_gok_405:
    v_add_f32_dpp v108, v108, v108 row_ror:8 row_mask:0xf bank_mask:0xf
    v_add_f32_dpp v109, v109, v109 row_ror:8 row_mask:0xf bank_mask:0xf
    s_xor_b32 s22, s22, 1
    v_add_f32_dpp v108, v108, v108 row_ror:4 row_mask:0xf bank_mask:0xf
    v_add_f32_dpp v109, v109, v109 row_ror:4 row_mask:0xf bank_mask:0xf
    v_cvt_pk_bf16_f32 v44, v108, v109
    v_min_u32 v120, -2, v44
    s_mov_b64 exec, s[46:47]
    buffer_store_dword v120, v11, s[4:7], s18 offen sc1
    s_mov_b64 exec, -1
    s_xor_b32 s23, s23, 0xff1340
    s_waitcnt lgkmcnt(0)
    v_cmp_ne_u32 vcc, s36, v123
    s_cmp_eq_u32 s14, 63
    s_cbranch_scc1 L_exit_397
    s_cbranch_vccnz L_kvw_393
L_kvok_394:
    ds_read_b128 v[24:27], v0 offset:36864
    s_nop 0
    ds_read_b128 v[28:31], v0 offset:37888
    s_nop 0
    ds_read_b128 v[32:35], v0 offset:45056
    s_nop 0
    ds_read_b128 v[36:39], v0 offset:46080
    s_nop 0
    ds_read_b128 v[40:43], v0 offset:53248
    s_nop 0
    ds_read_b128 v[44:47], v0 offset:54272
    s_nop 0
    s_nop 13
    buffer_load_dwordx4 v[16:19], v0, s[4:7], s19 offen sc1
    buffer_load_dwordx4 v[20:23], v0, s[4:7], s19 offen offset:1024 sc1
    s_nop 15
    s_nop 15
    buffer_load_dwordx4 v[16:19], v0, s[4:7], s19 offen sc1
    buffer_load_dwordx4 v[20:23], v0, s[4:7], s19 offen offset:1024 sc1
    v_mov_b32 v12, v12
    s_branch L_poll2c_402
L_gt1_406:
    s_nop 0
    s_waitcnt vmcnt(1)
    v_mfma_f32_16x16x32_bf16 v[108:111], v[40:43], v[112:115], 0
    v_xor_b32 v44, s22, v112
    v_bitop3_b32 v44, v44, v114, s22 bitop3:0xf6
    s_waitcnt vmcnt(0)
    v_mfma_f32_16x16x32_bf16 v[108:111], v[40:43], v[116:119], v[108:111]
    v_bitop3_b32 v44, v44, v116, s22 bitop3:0xf6
    v_bitop3_b32 v44, v44, v118, s22 bitop3:0xf6
    v_and_b32 v44, 1, v44
    v_cmp_ne_u32 vcc, 0, v44
    s_cbranch_vccnz L_gt2_407
    ds_read_b32 v123, v6 offset:10240
    s_nop 0
    s_branch L_gok_405
L_gt2_407:
    buffer_load_dwordx4 v[16:19], v0, s[4:7], s24 offen offset:0 sc1
    buffer_load_dwordx4 v[20:23], v0, s[4:7], s24 offen offset:1024 sc1
    s_add_u32 s40, s40, 1
    s_cmp_gt_u32 s40, 262144
    s_cbranch_scc1 L_abort
    s_waitcnt vmcnt(1)
    v_mfma_f32_16x16x32_bf16 v[108:111], v[40:43], v[16:19], 0
    v_xor_b32 v44, s22, v16
    v_bitop3_b32 v44, v44, v18, s22 bitop3:0xf6
    s_waitcnt vmcnt(0)
    v_mfma_f32_16x16x32_bf16 v[108:111], v[40:43], v[20:23], v[108:111]
    v_bitop3_b32 v44, v44, v20, s22 bitop3:0xf6
    v_bitop3_b32 v44, v44, v22, s22 bitop3:0xf6
    v_and_b32 v44, 1, v44
    v_cmp_ne_u32 vcc, 0, v44
    s_cbranch_vccnz L_gt2_407
    ds_read_b32 v123, v6 offset:10240
    s_nop 0
    s_branch L_gok_405
L_slow_395:
    ds_read2st64_b32 v[32:33], v6 offset0:0 offset1:1
    ds_read2st64_b32 v[34:35], v6 offset0:2 offset1:3
    ds_read2st64_b32 v[36:37], v6 offset0:4 offset1:5
    ds_read2st64_b32 v[38:39], v6 offset0:6 offset1:7
    ds_read2st64_b32 v[40:41], v6 offset0:8 offset1:9
    ds_read2st64_b32 v[42:43], v6 offset0:10 offset1:11
    ds_read2st64_b32 v[44:45], v6 offset0:12 offset1:13
    ds_read2st64_b32 v[46:47], v6 offset0:14 offset1:15
    s_waitcnt lgkmcnt(0)
    v_add_f32 v32, v32, v36
    v_add_f32 v40, v40, v44
    v_add_f32 v32, v32, v40
    v_mul_f32 v32, s41, v32
    v_add_f32 v33, v33, v37
    v_add_f32 v41, v41, v45
    v_add_f32 v33, v33, v41
    v_mul_f32 v33, s41, v33
    v_add_f32 v34, v34, v38
    v_add_f32 v42, v42, v46
    v_add_f32 v34, v34, v42
    v_mul_f32 v34, s41, v34
    v_add_f32 v35, v35, v39
    v_add_f32 v43, v43, v47
    v_add_f32 v35, v35, v43
    v_mul_f32 v35, s41, v35
    v_max3_f32 v84, v32, v33, v34
    v_max3_f32 v84, v84, v35, v80
    v_max_f32 v84, v84, v81
    s_nop 1
    v_max_f32_dpp v84, v84, v84 row_ror:8 row_mask:0xf bank_mask:0xf
    v_mov_b32 v85, v84
    s_nop 1
    v_permlane16_swap_b32 v84, v85
    v_max_f32 v84, v84, v85
    v_mov_b32 v85, v84
    s_nop 1
    v_permlane32_swap_b32 v84, v85
    v_max_f32 v84, v84, v85
    v_sub_f32 v32, v32, v84
    v_sub_f32 v33, v33, v84
    v_sub_f32 v34, v34, v84
    v_sub_f32 v35, v35, v84
    v_sub_f32 v90, v80, v84
    v_sub_f32 v91, v81, v84
    v_exp_f32 v32, v32
    v_exp_f32 v33, v33
    v_exp_f32 v34, v34
    v_exp_f32 v35, v35
    v_exp_f32 v90, v90
    v_exp_f32 v91, v91
    v_cvt_pk_bf16_f32 v36, v32, v33
    v_cvt_pk_bf16_f32 v37, v34, v35
    v_cvt_pk_bf16_f32 v88, v90, v91
    v_mov_b64 v[92:93], v[36:37]
    v_mov_b64 v[94:95], v[36:37]
    s_nop 1
    v_mov_b32_dpp v92, v36 row_ror:8 row_mask:0xf bank_mask:0xc
    v_mov_b32_dpp v93, v37 row_ror:8 row_mask:0xf bank_mask:0xc
    v_mov_b32_dpp v94, v36 row_ror:8 row_mask:0xf bank_mask:0x3
    v_mov_b32_dpp v95, v37 row_ror:8 row_mask:0xf bank_mask:0x3
    s_nop 1
    v_mfma_f32_16x16x32_bf16 v[108:111], v[12:15], v[92:95], 0
    v_mfma_f32_16x16x32_bf16 v[120:123], v[112:115], v[92:95], 0
    v_mfma_f32_16x16x32_bf16 v[124:127], v[116:119], v[92:95], 0
    s_nop 5
    v_mfma_f32_16x16x16_bf16 v[108:111], v[12:13], v[88:89], v[108:111]
    s_nop 0
    s_nop 1
    v_mfma_f32_16x16x16_bf16 v[120:123], v[104:105], v[88:89], v[120:123]
    s_nop 0
    v_mov_b64 v[24:25], 0
    v_mov_b64 v[26:27], 0
    v_mfma_f32_16x16x16_bf16 v[124:127], v[106:107], v[88:89], v[124:127]
    v_rcp_f32 v110, v108
    v_mov_b64 v[28:29], 0
    v_max_f32 v109, v108, v110
    v_cmp_ngt_f32 vcc, s42, v109
    v_pk_mul_f32 v[120:121], v[120:121], v[110:111] op_sel_hi:[1,0]
    v_pk_mul_f32 v[122:123], v[122:123], v[110:111] op_sel_hi:[1,0]
    v_cvt_pk_bf16_f32 v120, v120, v121
    v_cvt_pk_bf16_f32 v121, v122, v123
    v_pk_mul_f32 v[124:125], v[124:125], v[110:111] op_sel_hi:[1,0]
    v_pk_mul_f32 v[126:127], v[126:127], v[110:111] op_sel_hi:[1,0]
    v_cvt_pk_bf16_f32 v122, v124, v125
    v_cvt_pk_bf16_f32 v123, v126, v127
    v_cndmask_b32 v82, v120, v122, s[38:39]
    v_cndmask_b32 v83, v121, v123, s[38:39]
    v_mov_b64 v[16:17], 0
    v_mov_b64 v[18:19], 0
    v_mov_b64 v[20:21], 0
    v_mov_b64 v[22:23], 0
    ds_write_b64 v7, v[82:83] offset:15872
    v_smfmac_f32_16x16x64_bf16 v[16:19], v[120:123], v[176:183], v10 abid:1
    v_smfmac_f32_16x16x64_bf16 v[20:23], v[120:123], v[208:215], v10 abid:1
    s_branch L_back_396
L_exit_397:
    s_mov_b64 exec, s[46:47]
    buffer_store_dword v120, v121, s[4:7], s33 offen sc1
    s_mov_b64 exec, -1
    s_waitcnt vmcnt(1)
    s_barrier
    s_branch L_ldone_356
L_wv3_355:
    ds_read_b128 v[48:51], v0 offset:63488
    ds_read_b128 v[52:55], v0 offset:64512
    ds_read_b128 v[56:59], v1 offset:6144
    ds_read_b128 v[60:63], v1 offset:7168
    ds_read_b128 v[64:67], v1 offset:14336
    ds_read_b128 v[68:71], v1 offset:15360
    ds_read_b128 v[72:75], v1 offset:22528
    ds_read_b128 v[76:79], v1 offset:23552
    ds_read_b128 v[24:27], v0 offset:38912
    ds_read_b128 v[28:31], v0 offset:39936
    ds_read_b128 v[32:35], v0 offset:47104
    ds_read_b128 v[36:39], v0 offset:48128
    ds_read_b128 v[40:43], v0 offset:55296
    ds_read_b128 v[44:47], v0 offset:56320
    v_mov_b64 v[80:81], 0
    v_mov_b64 v[82:83], 0
    v_mov_b64 v[84:85], 0
    v_mov_b64 v[86:87], 0
    v_mov_b64 v[88:89], 0
    v_mov_b64 v[90:91], 0
    v_mov_b64 v[92:93], 0
    v_mov_b64 v[94:95], 0
    v_mov_b64 v[96:97], 0
    v_mov_b64 v[98:99], 0
    v_mov_b64 v[100:101], 0
    v_mov_b64 v[102:103], 0
    v_and_b32 v121, 16, v0
    v_lshrrev_b32 v122, 8, v0
    v_lshl_add_u32 v121, v122, 1, v121
    v_bfe_u32 v122, v0, 5, 1
    v_lshl_add_u32 v121, v121, 1, v122
    v_lshlrev_b32 v121, 2, v121
    v_lshlrev_b32 v126, 3, v0
    s_mov_b32 m0, s43
    s_waitcnt vmcnt(0)
    v_min_u32 v120, -2, v120
    s_cmp_lg_u32 s15, 0
    s_cbranch_scc1 L_w2_416
L_w1_415:
    buffer_load_dword v123, off, s[4:7], s35 sc1
    s_add_u32 s40, s40, 1
    s_cmp_gt_u32 s40, 262144
    s_cbranch_scc1 L_abort
    s_waitcnt vmcnt(0)
    v_cmp_eq_u32 vcc, 0, v123
    s_cbranch_vccnz L_w1_415
    s_branch L_w3_417
L_w2_416:
    buffer_load_dword v123, off, s[4:7], s35 sc1
    buffer_load_dwordx4 v[104:107], v0, s[4:7], s32 offen offset:0 sc1
    buffer_load_dwordx4 v[108:111], v0, s[4:7], s32 offen offset:1024 sc1
    buffer_load_dwordx4 v[112:115], v0, s[4:7], s32 offen offset:2048 sc1
    buffer_load_dwordx4 v[116:119], v0, s[4:7], s32 offen offset:3072 sc1
    s_add_u32 s40, s40, 1
    s_cmp_gt_u32 s40, 262144
    s_cbranch_scc1 L_abort
    s_waitcnt vmcnt(0)
    v_cmp_ne_u32 vcc, 0, v123
    s_cbranch_vccnz L_w3_417
    v_max_u32 v127, v104, v105
    v_max3_u32 v127, v127, v106, v107
    v_max3_u32 v127, v127, v108, v109
    v_max3_u32 v127, v127, v110, v111
    v_max3_u32 v127, v127, v112, v113
    v_max3_u32 v127, v127, v114, v115
    v_max3_u32 v127, v127, v116, v117
    v_max3_u32 v127, v127, v118, v119
    v_cmp_eq_u32 vcc, -1, v127
    s_cbranch_vccnz L_w2_416
L_w3_417:
    s_waitcnt vmcnt(0) lgkmcnt(0)
    s_branch L_st_418
L_kvw_410:
    buffer_load_dword v123, off, s[4:7], s35 sc1
    s_add_u32 s40, s40, 1
    s_cmp_gt_u32 s40, 262144
    s_cbranch_scc1 L_abort
    s_waitcnt vmcnt(0)
    v_cmp_eq_u32 vcc, 0, v123
    s_cbranch_vccnz L_kvw_410
    s_branch L_kvok_411
L_st_418:
    s_branch L_arr_408
L_poll2_409:
    buffer_load_dwordx4 v[16:19], v0, s[4:7], s19 offen sc1
    buffer_load_dwordx4 v[20:23], v0, s[4:7], s19 offen offset:1024 sc1
    s_waitcnt vmcnt(2)
    v_max3_u32 v127, v16, v17, v18
    v_max3_u32 v127, v127, v19, v20
    v_max3_u32 v127, v127, v21, v22
    v_max_u32 v127, v127, v23
    v_cmp_eq_u32 vcc, -1, v127
    s_cbranch_vccz L_arr_408
L_poll3_420:
    s_add_u32 s40, s40, 1
    s_cmp_gt_u32 s40, 262144
    s_cbranch_scc1 L_abort
    v_max3_u32 v127, v16, v17, v18
    v_max3_u32 v127, v127, v19, v20
    v_max3_u32 v127, v127, v21, v22
    v_max_u32 v127, v127, v23
    v_cmp_eq_u32 vcc, -1, v127
    s_cbranch_vccz L_arr_408
    v_max3_u32 v127, v16, v17, v18
    v_max3_u32 v127, v127, v19, v20
    v_max3_u32 v127, v127, v21, v22
    v_max_u32 v127, v127, v23
    v_cmp_eq_u32 vcc, -1, v127
    s_cbranch_vccz L_arr_408
    v_max3_u32 v127, v16, v17, v18
    v_max3_u32 v127, v127, v19, v20
    v_max3_u32 v127, v127, v21, v22
    v_max_u32 v127, v127, v23
    v_cmp_eq_u32 vcc, -1, v127
    s_cbranch_vccz L_arr_408
    v_max3_u32 v127, v16, v17, v18
    v_max3_u32 v127, v127, v19, v20
    v_max3_u32 v127, v127, v21, v22
    v_max_u32 v127, v127, v23
    v_cmp_eq_u32 vcc, -1, v127
    s_cbranch_vccz L_arr_408
    buffer_load_dwordx4 v[16:19], v0, s[4:7], s19 offen sc1
    buffer_load_dwordx4 v[20:23], v0, s[4:7], s19 offen offset:1024 sc1
    s_branch L_poll3_420
L_poll2c_419:
    v_mov_b32 v12, v12
    s_waitcnt vmcnt(3) lgkmcnt(0)
    v_max3_u32 v127, v16, v17, v18
    v_max_u32 v127, v127, v19
    s_waitcnt vmcnt(2)
    v_max3_u32 v127, v127, v20, v21
    v_max3_u32 v127, v127, v22, v23
    v_cmp_eq_u32 vcc, -1, v127
    s_cbranch_vccnz L_poll2_409
L_arr_408:
    ds_write_b128 v5, v[16:19] offset:6144
    v_smfmac_f32_16x16x64_bf16 v[80:83], v[16:19], v[24:31], v10
    s_nop 0
    ds_write_b128 v5, v[20:23] offset:7168
    v_smfmac_f32_16x16x64_bf16 v[84:87], v[16:19], v[32:39], v10
    v_smfmac_f32_16x16x64_bf16 v[80:83], v[20:23], v[40:47], v10
    s_nop 0
    buffer_load_dwordx4 v[112:115], v0, s[4:7], s32 offen offset:2048 sc1
    buffer_load_dwordx4 v[116:119], v0, s[4:7], s32 offen offset:3072 sc1
    v_smfmac_f32_16x16x64_bf16 v[84:87], v[20:23], v[48:55], v10
    s_nop 0
    buffer_load_dwordx4 v[104:107], v0, s[4:7], s32 offen offset:0 sc1
    buffer_load_dwordx4 v[108:111], v0, s[4:7], s32 offen offset:1024 sc1
    v_smfmac_f32_16x16x64_bf16 v[88:91], v[16:19], v[56:63], v10
    s_add_u32 s35, s35, 4
    s_add_u32 s36, s36, 1
    s_sub_u32 s17, s31, 4096
    s_waitcnt lgkmcnt(0)
    s_barrier
    ds_read_b128 v[24:27], v5 offset:0
    v_smfmac_f32_16x16x64_bf16 v[92:95], v[16:19], v[64:71], v10
    s_nop 0
    ds_read_b128 v[28:31], v5 offset:1024
    v_smfmac_f32_16x16x64_bf16 v[96:99], v[16:19], v[72:79], v10
    s_nop 0
    ds_read_b128 v[32:35], v5 offset:2048
    v_smfmac_f32_16x16x64_bf16 v[96:99], v[20:23], a[176:183], v10
    s_nop 0
    ds_read_b128 v[36:39], v5 offset:3072
    s_waitcnt lgkmcnt(3)
    v_smfmac_f32_16x16x64_bf16 v[80:83], v[24:27], a[0:7], v10
    s_nop 0
    ds_read_b128 v[40:43], v5 offset:4096
    v_smfmac_f32_16x16x64_bf16 v[84:87], v[24:27], a[8:15], v10
    s_waitcnt lgkmcnt(3)
    ds_read_b128 v[44:47], v5 offset:5120
    v_smfmac_f32_16x16x64_bf16 v[80:83], v[28:31], a[16:23], v10
    s_nop 0
    ds_read_b128 v[48:51], v1 offset:30720
    v_smfmac_f32_16x16x64_bf16 v[84:87], v[28:31], a[24:31], v10
    s_waitcnt lgkmcnt(3)
    ds_read_b128 v[52:55], v1 offset:31744
    v_smfmac_f32_16x16x64_bf16 v[80:83], v[32:35], a[32:39], v10
    s_nop 0
    ds_read_b128 v[56:59], v1 offset:38912
    buffer_load_dword v126, s[4:7], s17 offen sc1 lds
    v_smfmac_f32_16x16x64_bf16 v[84:87], v[32:35], a[40:47], v10
    s_nop 0
    ds_read_b128 v[60:63], v1 offset:39936
    v_smfmac_f32_16x16x64_bf16 v[80:83], v[36:39], a[48:55], v10
    s_waitcnt lgkmcnt(4)
    ds_read_b128 v[64:67], v1 offset:47104
    v_smfmac_f32_16x16x64_bf16 v[80:83], v[40:43], a[64:71], v10
    s_nop 0
    ds_read_b128 v[68:71], v1 offset:48128
    v_smfmac_f32_16x16x64_bf16 v[80:83], v[44:47], a[80:87], v10
    s_mov_b64 exec, s[46:47]
    buffer_store_dword v120, v121, s[4:7], s33 offen sc1
    s_mov_b64 exec, -1
    v_smfmac_f32_16x16x64_bf16 v[84:87], v[36:39], a[56:63], v10
    s_nop 0
    ds_read_b128 v[72:75], v1 offset:55296
    s_nop 0
    v_smfmac_f32_16x16x64_bf16 v[84:87], v[40:43], a[72:79], v10
    s_nop 0
    ds_read_b128 v[76:79], v1 offset:56320
    v_add_f32 v80, v80, v82
    v_smfmac_f32_16x16x64_bf16 v[84:87], v[44:47], a[88:95], v10
    s_waitcnt lgkmcnt(4)
    s_nop 0
    v_add_f32 v81, v81, v83
    v_smfmac_f32_16x16x64_bf16 v[88:91], v[20:23], v[48:55], v10
    s_nop 1
    v_cvt_pk_bf16_f32 v80, v80, v81
    v_smfmac_f32_16x16x64_bf16 v[92:95], v[20:23], a[96:103], v10
    s_waitcnt lgkmcnt(0)
    ds_write_b32 v2, v80 offset:24
    v_add_f32 v84, v84, v86
    v_add_f32 v85, v85, v87
    v_cvt_pk_bf16_f32 v84, v84, v85
    v_smfmac_f32_16x16x64_bf16 v[88:91], v[24:27], v[56:63], v10
    s_nop 0
    ds_write_b32 v2, v84 offset:664
    v_smfmac_f32_16x16x64_bf16 v[92:95], v[24:27], a[104:111], v10
    s_nop 0
    ds_read_b64_tr_b16 v[120:121], v4 offset:24
    ds_read_b64_tr_b16 v[122:123], v4 offset:344
    v_smfmac_f32_16x16x64_bf16 v[88:91], v[28:31], v[64:71], v10
    s_nop 0
    ds_read_b64_tr_b16 v[124:125], v4 offset:8
    ds_read_b64_tr_b16 v[126:127], v4 offset:328
    v_smfmac_f32_16x16x64_bf16 v[92:95], v[28:31], a[112:119], v10
    s_nop 0
    ds_read_b128 v[48:51], v1 offset:63488
    v_smfmac_f32_16x16x64_bf16 v[88:91], v[32:35], v[72:79], v10
    s_nop 0
    ds_read_b128 v[52:55], v1 offset:64512
    v_smfmac_f32_16x16x64_bf16 v[92:95], v[32:35], a[120:127], v10
    s_waitcnt vmcnt(2)
    v_smfmac_f32_16x16x64_bf16 v[88:91], v[36:39], a[128:135], v10
    s_waitcnt lgkmcnt(2)
    v_mfma_f32_16x16x32_bf16 v[80:83], v[104:107], v[120:123], 0
    v_mfma_f32_16x16x32_bf16 v[80:83], v[108:111], v[124:127], v[80:83]
    s_nop 2
    v_smfmac_f32_16x16x64_bf16 v[88:91], v[40:43], a[144:151], v10
    s_nop 2
    v_smfmac_f32_16x16x64_bf16 v[88:91], v[44:47], a[160:167], v10
    s_nop 0
    ds_write2st64_b32 v6, v80, v81 offset0:12 offset1:13
    v_smfmac_f32_16x16x64_bf16 v[92:95], v[36:39], a[136:143], v10
    s_waitcnt lgkmcnt(1)
    ds_write2st64_b32 v6, v82, v83 offset0:14 offset1:15
    v_smfmac_f32_16x16x64_bf16 v[92:95], v[40:43], a[152:159], v10
    s_nop 1
    v_add_f32 v88, v88, v90
    v_add_f32 v89, v89, v91
    v_cvt_pk_bf16_f32 v88, v88, v89
    v_smfmac_f32_16x16x64_bf16 v[92:95], v[44:47], v[48:55], v10
    s_nop 0
    ds_write_b32 v3, v88 offset:1408
    v_smfmac_f32_16x16x64_bf16 v[96:99], v[24:27], a[192:199], v10
    s_nop 0
    ds_read_b128 v[72:75], v0 offset:30720
    s_nop 0
    v_smfmac_f32_16x16x64_bf16 v[96:99], v[28:31], a[208:215], v10
    s_nop 1
    v_add_f32 v92, v92, v94
    v_add_f32 v93, v93, v95
    v_cvt_pk_bf16_f32 v92, v92, v93
    v_smfmac_f32_16x16x64_bf16 v[96:99], v[32:35], a[224:231], v10
    s_nop 0
    ds_write_b32 v3, v92 offset:2048
    ds_read_b64_tr_b16 v[88:89], v4 offset:1408
    ds_read_b64_tr_b16 v[90:91], v4 offset:1728
    v_smfmac_f32_16x16x64_bf16 v[96:99], v[36:39], a[240:247], v10
    s_waitcnt lgkmcnt(5)
    s_barrier
    ds_read2st64_b32 v[104:105], v6 offset0:3 offset1:7
    v_smfmac_f32_16x16x64_bf16 v[96:99], v[40:43], v[128:135], v10
    s_nop 0
    ds_read2st64_b32 v[106:107], v6 offset0:11 offset1:15
    v_smfmac_f32_16x16x64_bf16 v[96:99], v[44:47], v[144:151], v10
    s_add_u32 s16, s28, s30
    ds_read_b128 v[76:79], v0 offset:31744
    s_waitcnt lgkmcnt(3)
    v_mfma_f32_16x16x32_bf16 v[84:87], v[88:91], v[120:123], 0
    s_nop 0
    v_mov_b32 v89, 0
    s_nop 0
    v_smfmac_f32_16x16x64_bf16 v[100:103], v[16:19], a[168:175], v10
    s_waitcnt lgkmcnt(1)
    v_add_f32 v104, v104, v105
    v_add_f32 v106, v106, v107
    v_smfmac_f32_16x16x64_bf16 v[100:103], v[20:23], a[184:191], v10
    s_nop 0
    ds_write_b64 v7, v[84:85] offset:13824
    v_add_f32 v104, v104, v106
    v_mul_f32 v104, s41, v104
    v_smfmac_f32_16x16x64_bf16 v[100:103], v[24:27], a[200:207], v10
    v_exp_f32 v104, v104
    v_add_f32 v96, v96, v98
    v_cvt_pk_bf16_f32 v107, v104, v104
    v_smfmac_f32_16x16x64_bf16 v[100:103], v[28:31], a[216:223], v10
    s_nop 0
    ds_write_b16 v7, v107 offset:14342
    v_smfmac_f32_16x16x64_bf16 v[100:103], v[32:35], a[232:239], v10
    v_add_f32 v97, v97, v99
    v_smfmac_f32_16x16x64_bf16 v[100:103], v[36:39], a[248:255], v10
    s_waitcnt lgkmcnt(1)
    s_barrier
    ds_read_b64 v[80:81], v8 offset:12288
    v_smfmac_f32_16x16x64_bf16 v[100:103], v[40:43], v[136:143], v10
    s_nop 0
    ds_read_b64 v[82:83], v8 offset:12800
    ds_read_b64 v[84:85], v8 offset:13312
    ds_read_b64 v[86:87], v8 offset:13824
    v_smfmac_f32_16x16x64_bf16 v[100:103], v[44:47], v[152:159], v10
    s_waitcnt lgkmcnt(4)
    s_barrier
    ds_read_b128 v[92:95], v8 offset:14336
    v_cvt_pk_bf16_f32 v104, v96, v97
    v_cvt_pk_bf16_f32 v105, v96, v97
    v_mov_b64 v[16:17], 0
    v_mov_b64 v[18:19], 0
    s_waitcnt vmcnt(4)
    v_mov_b64 v[20:21], 0
    v_mov_b64 v[22:23], 0
    s_waitcnt lgkmcnt(1)
    v_pk_add_f32 v[80:81], v[80:81], v[82:83]
    v_pk_add_f32 v[84:85], v[84:85], v[86:87]
    v_pk_add_f32 v[80:81], v[80:81], v[84:85]
    v_mul_f32 v80, s41, v80
    v_mul_f32 v81, s41, v81
    s_waitcnt lgkmcnt(0)
    v_mfma_f32_16x16x32_bf16 v[108:111], v[12:15], v[92:95], 0
    v_exp_f32 v90, v80
    v_mfma_f32_16x16x32_bf16 v[120:123], v[112:115], v[92:95], 0
    v_exp_f32 v91, v81
    v_mfma_f32_16x16x32_bf16 v[124:127], v[116:119], v[92:95], 0
    v_cvt_pk_bf16_f32 v88, v90, v91
    v_add_f32 v100, v100, v102
    v_add_f32 v101, v101, v103
    v_mfma_f32_16x16x16_bf16 v[108:111], v[12:13], v[88:89], v[108:111]
    s_nop 0
    v_cvt_pk_bf16_f32 v106, v100, v101
    v_cvt_pk_bf16_f32 v107, v100, v101
    v_mfma_f32_16x16x16_bf16 v[120:123], v[104:105], v[88:89], v[120:123]
    s_nop 0
    v_mov_b64 v[24:25], 0
    v_mov_b64 v[26:27], 0
    v_mfma_f32_16x16x16_bf16 v[124:127], v[106:107], v[88:89], v[124:127]
    v_rcp_f32 v110, v108
    v_mov_b64 v[28:29], 0
    v_max_f32 v109, v108, v110
    v_cmp_ngt_f32 vcc, s42, v109
    v_pk_mul_f32 v[120:121], v[120:121], v[110:111] op_sel_hi:[1,0]
    v_pk_mul_f32 v[122:123], v[122:123], v[110:111] op_sel_hi:[1,0]
    v_cvt_pk_bf16_f32 v120, v120, v121
    v_cvt_pk_bf16_f32 v121, v122, v123
    v_pk_mul_f32 v[124:125], v[124:125], v[110:111] op_sel_hi:[1,0]
    v_pk_mul_f32 v[126:127], v[126:127], v[110:111] op_sel_hi:[1,0]
    v_cvt_pk_bf16_f32 v122, v124, v125
    v_cvt_pk_bf16_f32 v123, v126, v127
    v_cndmask_b32 v82, v120, v122, s[38:39]
    v_cndmask_b32 v83, v121, v123, s[38:39]
    v_smfmac_f32_16x16x64_bf16 v[16:19], v[120:123], v[184:191], v10 abid:1
    s_nop 0
    ds_write_b64 v7, v[82:83] offset:16384
    v_smfmac_f32_16x16x64_bf16 v[20:23], v[120:123], v[216:223], v10 abid:1
    s_cbranch_vccnz L_slow_412
L_back_413:
    v_mov_b64 v[30:31], 0
    v_mov_b32 v46, -1
    s_mov_b64 exec, s[46:47]
    buffer_store_dword v46, v11, s[4:7], s16 offen sc1
    s_mov_b64 exec, -1
    v_smfmac_f32_16x16x64_bf16 v[24:27], v[120:123], v[248:255], v10 abid:1
    s_waitcnt lgkmcnt(0)
    s_barrier
    ds_read_b128 v[112:115], v8 offset:14848
    v_smfmac_f32_16x16x64_bf16 v[28:31], v[120:123], v[72:79], v10 abid:1
    s_nop 0
    ds_read_b128 v[116:119], v8 offset:15360
    ds_read_b128 v[124:127], v8 offset:15872
    v_mov_b32 v12, v12
    s_add_u32 s33, s33, 8192
    s_mov_b32 s32, s31
    s_add_u32 s31, s31, 524288
    v_mov_b32 v12, v12
    s_waitcnt lgkmcnt(2)
    v_smfmac_f32_16x16x64_bf16 v[16:19], v[112:115], v[160:167], v10 abid:1
    s_min_u32 s31, s31, s44
    ds_read_b128 v[48:51], v0 offset:6144
    s_add_u32 s14, s14, 1
    v_smfmac_f32_16x16x64_bf16 v[20:23], v[112:115], v[192:199], v10 abid:1
    s_waitcnt lgkmcnt(2)
    ds_read_b128 v[52:55], v0 offset:7168
    s_add_u32 s18, s27, s30
    v_smfmac_f32_16x16x64_bf16 v[16:19], v[116:119], v[168:175], v10 abid:1
    s_waitcnt lgkmcnt(2)
    ds_read_b128 v[56:59], v0 offset:14336
    s_mov_b32 s16, s26
    v_smfmac_f32_16x16x64_bf16 v[16:19], v[124:127], v[176:183], v10 abid:1
    s_mov_b32 s26, s27
    ds_read_b128 v[60:63], v0 offset:15360
    s_mov_b32 s27, s28
    v_smfmac_f32_16x16x64_bf16 v[20:23], v[116:119], v[200:207], v10 abid:1
    s_mov_b32 s28, s16
    ds_read_b128 v[64:67], v0 offset:22528
    s_add_u32 s19, s26, s29
    v_smfmac_f32_16x16x64_bf16 v[20:23], v[124:127], v[208:215], v10 abid:1
    s_nop 0
    ds_read_b128 v[68:71], v0 offset:23552
    v_mul_f32 v16, s23, v16
    v_cvt_pk_bf16_f32 v32, v16, v17
    v_cvt_pk_bf16_f32 v33, v18, v19
    v_and_or_b32 v32, v32, -2, s22
    v_smfmac_f32_16x16x64_bf16 v[24:27], v[112:115], v[224:231], v10 abid:1
    s_nop 0
    buffer_store_dwordx2 v[32:33], v9, s[4:7], s20 offen sc1
    v_smfmac_f32_16x16x64_bf16 v[24:27], v[116:119], v[232:239], v10 abid:1
    s_nop 0
    ds_read_b128 v[40:43], v5 offset:17408
    v_mul_f32 v20, s23, v20
    v_cvt_pk_bf16_f32 v34, v20, v21
    v_cvt_pk_bf16_f32 v35, v22, v23
    v_and_or_b32 v34, v34, -2, s22
    v_smfmac_f32_16x16x64_bf16 v[24:27], v[124:127], v[240:247], v10 abid:1
    s_waitcnt lgkmcnt(1)
    buffer_store_dwordx2 v[34:35], v9, s[4:7], s21 offen sc1
    v_smfmac_f32_16x16x64_bf16 v[28:31], v[112:115], v[48:55], v10 abid:1
    s_nop 0
    s_nop 0
    s_nop 0
    v_smfmac_f32_16x16x64_bf16 v[28:31], v[116:119], v[56:63], v10 abid:1
    s_nop 0
    s_nop 0
    v_mul_f32 v24, s23, v24
    v_cvt_pk_bf16_f32 v36, v24, v25
    v_smfmac_f32_16x16x64_bf16 v[28:31], v[124:127], v[64:71], v10 abid:1
    s_waitcnt lgkmcnt(0)
    s_nop 0
    v_cvt_pk_bf16_f32 v37, v26, v27
    v_and_or_b32 v36, v36, -2, s22
    buffer_store_dwordx2 v[36:37], v9, s[4:7], s25 offen sc1
    v_mov_b64 v[80:81], 0
    v_mov_b64 v[82:83], 0
    v_mov_b64 v[84:85], 0
    v_mul_f32 v28, s23, v28
    v_cvt_pk_bf16_f32 v38, v28, v29
    v_cvt_pk_bf16_f32 v39, v30, v31
    v_and_or_b32 v38, v38, -2, s22
    buffer_store_dwordx2 v[38:39], v9, s[4:7], s37 offen sc1
    v_mov_b64 v[86:87], 0
    s_nop 0
    ds_read_b128 v[48:51], v0 offset:63488
    v_mov_b64 v[88:89], 0
    v_mov_b64 v[90:91], 0
    s_nop 0
    ds_read_b128 v[52:55], v0 offset:64512
    v_mov_b64 v[92:93], 0
    v_mov_b64 v[94:95], 0
    s_nop 0
    ds_read_b128 v[56:59], v1 offset:6144
    v_mov_b64 v[96:97], 0
    v_mov_b64 v[98:99], 0
    s_nop 0
    ds_read_b128 v[60:63], v1 offset:7168
    v_mov_b64 v[100:101], 0
    v_mov_b64 v[102:103], 0
    s_nop 0
    ds_read_b128 v[64:67], v1 offset:14336
    v_and_b32 v121, 16, v0
    v_lshrrev_b32 v122, 8, v0
    s_nop 0
    ds_read_b128 v[68:71], v1 offset:15360
    v_lshl_add_u32 v121, v122, 1, v121
    v_bfe_u32 v122, v0, 5, 1
    s_nop 0
    ds_read_b128 v[72:75], v1 offset:22528
    v_lshl_add_u32 v121, v121, 1, v122
    v_lshlrev_b32 v121, 2, v121
    s_nop 0
    ds_read_b128 v[76:79], v1 offset:23552
    v_lshlrev_b32 v126, 3, v0
    s_mov_b32 m0, s43
    s_nop 15
    s_nop 6
    buffer_load_dwordx4 v[16:19], v0, s[4:7], s24 offen offset:0 sc1
    buffer_load_dwordx4 v[20:23], v0, s[4:7], s24 offen offset:1024 sc1
    s_nop 15
    s_nop 15
    s_nop 6
    buffer_load_dwordx4 v[112:115], v0, s[4:7], s24 offen offset:0 sc1
    buffer_load_dwordx4 v[116:119], v0, s[4:7], s24 offen offset:1024 sc1
    s_waitcnt vmcnt(3)
    v_mfma_f32_16x16x32_bf16 v[108:111], v[40:43], v[16:19], 0
    v_xor_b32 v44, s22, v16
    v_bitop3_b32 v44, v44, v18, s22 bitop3:0xf6
    s_waitcnt vmcnt(2)
    v_mfma_f32_16x16x32_bf16 v[108:111], v[40:43], v[20:23], v[108:111]
    v_bitop3_b32 v44, v44, v20, s22 bitop3:0xf6
    v_bitop3_b32 v44, v44, v22, s22 bitop3:0xf6
    v_and_b32 v44, 1, v44
    v_cmp_ne_u32 vcc, 0, v44
    s_cbranch_vccnz L_gt1_423
    ds_read_b32 v123, v6 offset:10240
    s_nop 1
L_gok_422:
    v_add_f32_dpp v108, v108, v108 row_ror:8 row_mask:0xf bank_mask:0xf
    v_add_f32_dpp v109, v109, v109 row_ror:8 row_mask:0xf bank_mask:0xf
    s_xor_b32 s22, s22, 1
    v_add_f32_dpp v108, v108, v108 row_ror:4 row_mask:0xf bank_mask:0xf
    v_add_f32_dpp v109, v109, v109 row_ror:4 row_mask:0xf bank_mask:0xf
    v_cvt_pk_bf16_f32 v44, v108, v109
    v_min_u32 v120, -2, v44
    s_mov_b64 exec, s[46:47]
    buffer_store_dword v120, v11, s[4:7], s18 offen sc1
    s_mov_b64 exec, -1
    s_xor_b32 s23, s23, 0xff1340
    s_waitcnt lgkmcnt(0)
    v_cmp_ne_u32 vcc, s36, v123
    s_cmp_eq_u32 s14, 63
    s_cbranch_scc1 L_exit_414
    s_cbranch_vccnz L_kvw_410
L_kvok_411:
    ds_read_b128 v[24:27], v0 offset:38912
    s_nop 0
    ds_read_b128 v[28:31], v0 offset:39936
    s_nop 0
    ds_read_b128 v[32:35], v0 offset:47104
    s_nop 0
    ds_read_b128 v[36:39], v0 offset:48128
    s_nop 0
    ds_read_b128 v[40:43], v0 offset:55296
    s_nop 0
    ds_read_b128 v[44:47], v0 offset:56320
    s_nop 0
    s_nop 13
    buffer_load_dwordx4 v[16:19], v0, s[4:7], s19 offen sc1
    buffer_load_dwordx4 v[20:23], v0, s[4:7], s19 offen offset:1024 sc1
    s_nop 15
    s_nop 15
    buffer_load_dwordx4 v[16:19], v0, s[4:7], s19 offen sc1
    buffer_load_dwordx4 v[20:23], v0, s[4:7], s19 offen offset:1024 sc1
    v_mov_b32 v12, v12
    s_branch L_poll2c_419
L_gt1_423:
    s_nop 0
    s_waitcnt vmcnt(1)
    v_mfma_f32_16x16x32_bf16 v[108:111], v[40:43], v[112:115], 0
    v_xor_b32 v44, s22, v112
    v_bitop3_b32 v44, v44, v114, s22 bitop3:0xf6
    s_waitcnt vmcnt(0)
    v_mfma_f32_16x16x32_bf16 v[108:111], v[40:43], v[116:119], v[108:111]
    v_bitop3_b32 v44, v44, v116, s22 bitop3:0xf6
    v_bitop3_b32 v44, v44, v118, s22 bitop3:0xf6
    v_and_b32 v44, 1, v44
    v_cmp_ne_u32 vcc, 0, v44
    s_cbranch_vccnz L_gt2_424
    ds_read_b32 v123, v6 offset:10240
    s_nop 0
    s_branch L_gok_422
L_gt2_424:
    buffer_load_dwordx4 v[16:19], v0, s[4:7], s24 offen offset:0 sc1
    buffer_load_dwordx4 v[20:23], v0, s[4:7], s24 offen offset:1024 sc1
    s_add_u32 s40, s40, 1
    s_cmp_gt_u32 s40, 262144
    s_cbranch_scc1 L_abort
    s_waitcnt vmcnt(1)
    v_mfma_f32_16x16x32_bf16 v[108:111], v[40:43], v[16:19], 0
    v_xor_b32 v44, s22, v16
    v_bitop3_b32 v44, v44, v18, s22 bitop3:0xf6
    s_waitcnt vmcnt(0)
    v_mfma_f32_16x16x32_bf16 v[108:111], v[40:43], v[20:23], v[108:111]
    v_bitop3_b32 v44, v44, v20, s22 bitop3:0xf6
    v_bitop3_b32 v44, v44, v22, s22 bitop3:0xf6
    v_and_b32 v44, 1, v44
    v_cmp_ne_u32 vcc, 0, v44
    s_cbranch_vccnz L_gt2_424
    ds_read_b32 v123, v6 offset:10240
    s_nop 0
    s_branch L_gok_422
L_slow_412:
    ds_read2st64_b32 v[32:33], v6 offset0:0 offset1:1
    ds_read2st64_b32 v[34:35], v6 offset0:2 offset1:3
    ds_read2st64_b32 v[36:37], v6 offset0:4 offset1:5
    ds_read2st64_b32 v[38:39], v6 offset0:6 offset1:7
    ds_read2st64_b32 v[40:41], v6 offset0:8 offset1:9
    ds_read2st64_b32 v[42:43], v6 offset0:10 offset1:11
    ds_read2st64_b32 v[44:45], v6 offset0:12 offset1:13
    ds_read2st64_b32 v[46:47], v6 offset0:14 offset1:15
    s_waitcnt lgkmcnt(0)
    v_add_f32 v32, v32, v36
    v_add_f32 v40, v40, v44
    v_add_f32 v32, v32, v40
    v_mul_f32 v32, s41, v32
    v_add_f32 v33, v33, v37
    v_add_f32 v41, v41, v45
    v_add_f32 v33, v33, v41
    v_mul_f32 v33, s41, v33
    v_add_f32 v34, v34, v38
    v_add_f32 v42, v42, v46
    v_add_f32 v34, v34, v42
    v_mul_f32 v34, s41, v34
    v_add_f32 v35, v35, v39
    v_add_f32 v43, v43, v47
    v_add_f32 v35, v35, v43
    v_mul_f32 v35, s41, v35
    v_max3_f32 v84, v32, v33, v34
    v_max3_f32 v84, v84, v35, v80
    v_max_f32 v84, v84, v81
    s_nop 1
    v_max_f32_dpp v84, v84, v84 row_ror:8 row_mask:0xf bank_mask:0xf
    v_mov_b32 v85, v84
    s_nop 1
    v_permlane16_swap_b32 v84, v85
    v_max_f32 v84, v84, v85
    v_mov_b32 v85, v84
    s_nop 1
    v_permlane32_swap_b32 v84, v85
    v_max_f32 v84, v84, v85
    v_sub_f32 v32, v32, v84
    v_sub_f32 v33, v33, v84
    v_sub_f32 v34, v34, v84
    v_sub_f32 v35, v35, v84
    v_sub_f32 v90, v80, v84
    v_sub_f32 v91, v81, v84
    v_exp_f32 v32, v32
    v_exp_f32 v33, v33
    v_exp_f32 v34, v34
    v_exp_f32 v35, v35
    v_exp_f32 v90, v90
    v_exp_f32 v91, v91
    v_cvt_pk_bf16_f32 v36, v32, v33
    v_cvt_pk_bf16_f32 v37, v34, v35
    v_cvt_pk_bf16_f32 v88, v90, v91
    v_mov_b64 v[92:93], v[36:37]
    v_mov_b64 v[94:95], v[36:37]
    s_nop 1
    v_mov_b32_dpp v92, v36 row_ror:8 row_mask:0xf bank_mask:0xc
    v_mov_b32_dpp v93, v37 row_ror:8 row_mask:0xf bank_mask:0xc
    v_mov_b32_dpp v94, v36 row_ror:8 row_mask:0xf bank_mask:0x3
    v_mov_b32_dpp v95, v37 row_ror:8 row_mask:0xf bank_mask:0x3
    s_nop 1
    v_mfma_f32_16x16x32_bf16 v[108:111], v[12:15], v[92:95], 0
    v_mfma_f32_16x16x32_bf16 v[120:123], v[112:115], v[92:95], 0
    v_mfma_f32_16x16x32_bf16 v[124:127], v[116:119], v[92:95], 0
    s_nop 5
    v_mfma_f32_16x16x16_bf16 v[108:111], v[12:13], v[88:89], v[108:111]
    s_nop 0
    s_nop 1
    v_mfma_f32_16x16x16_bf16 v[120:123], v[104:105], v[88:89], v[120:123]
    s_nop 0
    v_mov_b64 v[24:25], 0
    v_mov_b64 v[26:27], 0
    v_mfma_f32_16x16x16_bf16 v[124:127], v[106:107], v[88:89], v[124:127]
    v_rcp_f32 v110, v108
    v_mov_b64 v[28:29], 0
    v_max_f32 v109, v108, v110
    v_cmp_ngt_f32 vcc, s42, v109
    v_pk_mul_f32 v[120:121], v[120:121], v[110:111] op_sel_hi:[1,0]
    v_pk_mul_f32 v[122:123], v[122:123], v[110:111] op_sel_hi:[1,0]
    v_cvt_pk_bf16_f32 v120, v120, v121
    v_cvt_pk_bf16_f32 v121, v122, v123
    v_pk_mul_f32 v[124:125], v[124:125], v[110:111] op_sel_hi:[1,0]
    v_pk_mul_f32 v[126:127], v[126:127], v[110:111] op_sel_hi:[1,0]
    v_cvt_pk_bf16_f32 v122, v124, v125
    v_cvt_pk_bf16_f32 v123, v126, v127
    v_cndmask_b32 v82, v120, v122, s[38:39]
    v_cndmask_b32 v83, v121, v123, s[38:39]
    v_mov_b64 v[16:17], 0
    v_mov_b64 v[18:19], 0
    v_mov_b64 v[20:21], 0
    v_mov_b64 v[22:23], 0
    ds_write_b64 v7, v[82:83] offset:16384
    v_smfmac_f32_16x16x64_bf16 v[16:19], v[120:123], v[184:191], v10 abid:1
    v_smfmac_f32_16x16x64_bf16 v[20:23], v[120:123], v[216:223], v10 abid:1
    s_branch L_back_413
L_exit_414:
    s_mov_b64 exec, s[46:47]
    buffer_store_dword v120, v121, s[4:7], s33 offen sc1
    s_mov_b64 exec, -1
    s_waitcnt vmcnt(1)
    s_barrier
    s_branch L_ldone_356
L_ldone_356:
    s_add_u32 s15, s15, 1
    s_cmp_lt_u32 s15, 2
    s_cbranch_scc1 L_tslow
    s_branch L_help
L_last:
    s_endpgm

.section .rodata,"a"
.p2align 6
.amdhsa_kernel interleave_layers__memory_aug_recurrent_mem_tr__softmax_full_mha__prompt_kernel
  .amdhsa_next_free_vgpr 512
  .amdhsa_next_free_sgpr 102
  .amdhsa_accum_offset 256
  .amdhsa_group_segment_fixed_size 0
  .amdhsa_kernarg_size 104
  .amdhsa_user_sgpr_count 2
  .amdhsa_user_sgpr_kernarg_segment_ptr 1
  .amdhsa_system_sgpr_workgroup_id_x 1
.end_amdhsa_kernel
```
